```python
import torch

def _softmax(x, axis=-1):
    return torch.softmax(x, dim=axis)

def _gelu(x):
    return torch.nn.functional.gelu(x, approximate='tanh')

def _silu(x):
    return torch.nn.functional.silu(x)

def _sigmoid(x):
    return torch.sigmoid(x)

def _layernorm(x, axis=-1, eps=1e-05):
    m = x.mean(dim=axis, keepdim=True)
    v = x.var(dim=axis, keepdim=True, unbiased=False)
    return (x - m) / torch.sqrt(v + eps)

def _scatter_add(tgt, idx, src, axis=0):
    return tgt.clone().index_add_(axis, idx, src)

def _segment_sum(src, seg, n):
    out = torch.zeros((n,) + src.shape[1:], dtype=src.dtype)
    return out.index_add_(0, seg, src)

def _pad(x, pw):
    flat = tuple((v for pair in reversed(pw) for v in pair))
    return torch.nn.functional.pad(x, flat)
kernel_name = 'adaLN_cond__mha_block_cached__dense_activation_silu__prompt'

def setup_inputs():

    _w = lambda a: (lambda t: t.to(torch.bfloat16) if t.is_floating_point() else t)(torch.as_tensor(a))

    def _A_setup():
        B, Sq, D = (1, 2048, 640)
        H, Sk, Dh = (32, 2048, 128)
        return {'x': _w((lambda *s: torch.randn(*s, dtype=torch.bfloat16) * 0.1)(B, Sq, D)), 'k_cache': _w((lambda *s: torch.randn(*s, dtype=torch.bfloat16) * 0.8)(B, H, Sk, Dh)), 'v_cache': _w((lambda *s: torch.randn(*s, dtype=torch.bfloat16) * 3.2)(B, H, Sk, Dh)), 'wq': _w((lambda *s: torch.randn(*s, dtype=torch.bfloat16) * 0.8)(D, H * Dh) * D ** (-0.5)), 'wo': _w((lambda *s: torch.randn(*s, dtype=torch.bfloat16) * 3.2)(H * Dh, D) * (H * Dh) ** (-0.5))}
    _A_in = _A_setup()

    def _B_setup():
        B, S, D, F = (1, 2048, 640, 1728)
        return {'x': _w((lambda *s: torch.randn(*s, dtype=torch.bfloat16) * 0.1)(B, S, D)), 'w1': _w((lambda *s: torch.randn(*s, dtype=torch.bfloat16) * 3.2)(D, F) * D ** (-0.5)), 'w2': _w((lambda *s: torch.randn(*s, dtype=torch.bfloat16) * 3.2)(F, D) * F ** (-0.5))}
    _B_in = _B_setup()
    return {'A_x': _A_in['x'], 'A_k_cache': _A_in['k_cache'], 'A_v_cache': _A_in['v_cache'], 'A_wq': _A_in['wq'], 'A_wo': _A_in['wo'], 'B_x': _B_in['x'], 'B_w1': _B_in['w1'], 'B_w2': _B_in['w2'], 'c': _w((lambda *s: torch.randn(*s, dtype=torch.bfloat16) * 0.2)(1, 640) * 8.0), 'w_mod': _w((lambda *s: torch.randn(*s, dtype=torch.bfloat16) * 0.2)(640, 6 * 640) * 640 ** (-0.5) * 8.0)}

def reference(A_x, A_k_cache, A_v_cache, A_wq, A_wo, B_x, B_w1, B_w2, c, w_mod):

    def _A_ref(x, k_cache, v_cache, wq, wo):
        B, Sq, D = x.shape
        H, Dh = (32, 128)
        q = (lambda x, *d: x.permute(*d))((x @ wq).reshape(B, Sq, H, Dh), 0, 2, 1, 3)
        scores = torch.einsum('bhqd,bhkd->bhqk', q, k_cache) * Dh ** (-0.5)
        p = _softmax(scores, axis=-1)
        o = torch.einsum('bhqk,bhkd->bhqd', p, v_cache)
        return (lambda x, *d: x.permute(*d))(o, 0, 2, 1, 3).reshape(B, Sq, H * Dh) @ wo

    def _B_ref(x, w1, w2):
        h = torch.einsum('bsd,df->bsf', x, w1)
        h = _silu(h)
        out = torch.einsum('bsf,fd->bsd', h, w2)
        return out
    x = A_x
    mod = (_silu(c) @ w_mod).reshape(c.shape[0], 6, 1, -1)
    sa, ca, ga, sb, cb, gb = (mod[:, 0].clone(), mod[:, 1].clone(), mod[:, 2].clone(), mod[:, 3].clone(), mod[:, 4].clone(), mod[:, 5].clone())
    h = _layernorm(x, axis=-1) * (1 + ca) + sa
    x = x + ga * _A_ref(h, A_k_cache, A_v_cache, A_wq, A_wo)
    h = _layernorm(x, axis=-1) * (1 + cb) + sb
    x = x + gb * _B_ref(h, B_w1, B_w2)
    return x
```

```asm
; @launch grid=(256,1,1) block=(256,1,1) lds=163840
.amdgcn_target "amdgcn-amd-amdhsa--gfx950"
.text
.globl adaLN_cond__mha_block_cached__dense_activation_silu__prompt_kernel
.p2align 8
.type adaLN_cond__mha_block_cached__dense_activation_silu__prompt_kernel,@function
adaLN_cond__mha_block_cached__dense_activation_silu__prompt_kernel:
    s_cmp_ge_u32 s2, 256
    s_cbranch_scc1 L_done
    s_load_dwordx2 s[4:5], s[0:1], 0
    s_load_dwordx4 s[24:27], s[0:1], 64
    s_load_dwordx2 s[6:7], s[0:1], 88
    s_load_dwordx2 s[90:91], s[0:1], 96
    v_mov_b32 v249, v0
    v_lshrrev_b32 v1, 6, v0
    s_nop 0
    v_readfirstlane_b32 s32, v1
    s_mov_b32 s63, 0
    s_cmp_ge_u32 s2, 248
    s_cbranch_scc1 L_role_init
    s_cmp_ge_u32 s2, 128
    s_cbranch_scc1 L_role_gemv
    v_and_b32 v1, 15, v0
    v_bfe_u32 v2, v0, 4, 2
    v_lshrrev_b32 v3, 6, v0
    s_lshl_b32 s3, s2, 4
    v_add_u32 v4, s3, v1
    s_movk_i32 s3, 1280
    v_mul_lo_u32 v4, v4, s3
    v_mul_u32_u24 v5, 320, v3
    v_lshlrev_b32 v6, 3, v2
    v_add3_u32 v4, v4, v5, v6
    s_waitcnt lgkmcnt(0)
    s_mov_b32 s56, s4
    s_mov_b32 s57, s5
    s_and_b32 s57, s57, 0xffff
    s_mov_b32 s58, 0x280000
    s_mov_b32 s59, 0x20000
    buffer_load_dwordx2 v[20:21], v4, s[56:59], 0 offen offset:0
    buffer_load_dwordx2 v[22:23], v4, s[56:59], 0 offen offset:32
    buffer_load_dwordx2 v[24:25], v4, s[56:59], 0 offen offset:64
    buffer_load_dwordx2 v[26:27], v4, s[56:59], 0 offen offset:96
    buffer_load_dwordx2 v[28:29], v4, s[56:59], 0 offen offset:128
    buffer_load_dwordx2 v[30:31], v4, s[56:59], 0 offen offset:160
    buffer_load_dwordx2 v[32:33], v4, s[56:59], 0 offen offset:192
    buffer_load_dwordx2 v[34:35], v4, s[56:59], 0 offen offset:224
    buffer_load_dwordx2 v[36:37], v4, s[56:59], 0 offen offset:256
    buffer_load_dwordx2 v[38:39], v4, s[56:59], 0 offen offset:288
    s_mov_b32 s48, s6
    s_mov_b32 s49, s7
    s_and_b32 s49, s49, 0xffff
    s_mov_b32 s50, 0x100
    s_mov_b32 s51, 0x20000
    s_add_u32 s92, s90, 0x28000
    s_addc_u32 s93, s91, 0
    s_and_b32 s93, s93, 0xffff
    s_mov_b32 s94, 0x5000
    s_mov_b32 s95, 0x20000
    v_mov_b32 v252, 0
    buffer_load_dword v253, v252, s[48:51], 0 offen sc1
    s_waitcnt vmcnt(1)
    s_add_u32 s56, s90, 0x40000
    s_addc_u32 s57, s91, 0
    s_and_b32 s57, s57, 0xffff
    s_mov_b32 s58, 0x280000
    s_mov_b32 s59, 0x20000
    v_lshlrev_b32 v40, 16, v20
    v_and_b32 v41, 0xffff0000, v20
    v_lshlrev_b32 v42, 16, v21
    v_and_b32 v43, 0xffff0000, v21
    v_lshlrev_b32 v44, 16, v22
    v_and_b32 v45, 0xffff0000, v22
    v_lshlrev_b32 v46, 16, v23
    v_and_b32 v47, 0xffff0000, v23
    v_lshlrev_b32 v48, 16, v24
    v_and_b32 v49, 0xffff0000, v24
    v_lshlrev_b32 v50, 16, v25
    v_and_b32 v51, 0xffff0000, v25
    v_lshlrev_b32 v52, 16, v26
    v_and_b32 v53, 0xffff0000, v26
    v_lshlrev_b32 v54, 16, v27
    v_and_b32 v55, 0xffff0000, v27
    v_lshlrev_b32 v56, 16, v28
    v_and_b32 v57, 0xffff0000, v28
    v_lshlrev_b32 v58, 16, v29
    v_and_b32 v59, 0xffff0000, v29
    v_lshlrev_b32 v60, 16, v30
    v_and_b32 v61, 0xffff0000, v30
    v_lshlrev_b32 v62, 16, v31
    v_and_b32 v63, 0xffff0000, v31
    v_lshlrev_b32 v64, 16, v32
    v_and_b32 v65, 0xffff0000, v32
    v_lshlrev_b32 v66, 16, v33
    v_and_b32 v67, 0xffff0000, v33
    v_lshlrev_b32 v68, 16, v34
    v_and_b32 v69, 0xffff0000, v34
    v_lshlrev_b32 v70, 16, v35
    v_and_b32 v71, 0xffff0000, v35
    v_lshlrev_b32 v72, 16, v36
    v_and_b32 v73, 0xffff0000, v36
    v_lshlrev_b32 v74, 16, v37
    v_and_b32 v75, 0xffff0000, v37
    v_lshlrev_b32 v76, 16, v38
    v_and_b32 v77, 0xffff0000, v38
    v_lshlrev_b32 v78, 16, v39
    v_and_b32 v79, 0xffff0000, v39
    v_lshlrev_b32 v7, 6, v3
    v_lshl_add_u32 v7, v1, 2, v7
    v_add_u32 v7, 137216, v7
    v_lshlrev_b32 v8, 2, v1
    v_add_u32 v8, 137216, v8
    v_add_f32 v10, v40, v41
    v_add_f32 v9, v42, v43
    v_add_f32 v10, v10, v44
    v_add_f32 v9, v9, v45
    v_add_f32 v10, v10, v46
    v_add_f32 v9, v9, v47
    v_add_f32 v10, v10, v48
    v_add_f32 v9, v9, v49
    v_add_f32 v10, v10, v50
    v_add_f32 v9, v9, v51
    v_add_f32 v10, v10, v52
    v_add_f32 v9, v9, v53
    v_add_f32 v10, v10, v54
    v_add_f32 v9, v9, v55
    v_add_f32 v10, v10, v56
    v_add_f32 v9, v9, v57
    v_add_f32 v10, v10, v58
    v_add_f32 v9, v9, v59
    v_add_f32 v10, v10, v60
    v_add_f32 v9, v9, v61
    v_add_f32 v10, v10, v62
    v_add_f32 v9, v9, v63
    v_add_f32 v10, v10, v64
    v_add_f32 v9, v9, v65
    v_add_f32 v10, v10, v66
    v_add_f32 v9, v9, v67
    v_add_f32 v10, v10, v68
    v_add_f32 v9, v9, v69
    v_add_f32 v10, v10, v70
    v_add_f32 v9, v9, v71
    v_add_f32 v10, v10, v72
    v_add_f32 v9, v9, v73
    v_add_f32 v10, v10, v74
    v_add_f32 v9, v9, v75
    v_add_f32 v10, v10, v76
    v_add_f32 v9, v9, v77
    v_add_f32 v10, v10, v78
    v_add_f32 v9, v9, v79
    v_add_f32 v10, v10, v9
    v_mov_b32 v11, v10
    s_nop 1
    v_permlane16_swap_b32 v11, v10
    v_add_f32 v10, v10, v11
    v_mov_b32 v11, v10
    s_nop 1
    v_permlane32_swap_b32 v11, v10
    v_add_f32 v10, v10, v11
    ds_write_b32 v7, v10 offset:0
    s_waitcnt lgkmcnt(0)
    s_barrier
    ds_read_b32 v12, v8 offset:0
    ds_read_b32 v13, v8 offset:64
    ds_read_b32 v14, v8 offset:128
    ds_read_b32 v15, v8 offset:192
    s_waitcnt lgkmcnt(2)
    v_add_f32 v12, v12, v13
    s_waitcnt lgkmcnt(0)
    v_add_f32 v14, v14, v15
    v_add_f32 v10, v12, v14
    v_mul_f32 v10, 0x3acccccd, v10
    v_sub_f32 v40, v40, v10
    v_sub_f32 v41, v41, v10
    v_sub_f32 v42, v42, v10
    v_sub_f32 v43, v43, v10
    v_sub_f32 v44, v44, v10
    v_sub_f32 v45, v45, v10
    v_sub_f32 v46, v46, v10
    v_sub_f32 v47, v47, v10
    v_sub_f32 v48, v48, v10
    v_sub_f32 v49, v49, v10
    v_sub_f32 v50, v50, v10
    v_sub_f32 v51, v51, v10
    v_sub_f32 v52, v52, v10
    v_sub_f32 v53, v53, v10
    v_sub_f32 v54, v54, v10
    v_sub_f32 v55, v55, v10
    v_sub_f32 v56, v56, v10
    v_sub_f32 v57, v57, v10
    v_sub_f32 v58, v58, v10
    v_sub_f32 v59, v59, v10
    v_sub_f32 v60, v60, v10
    v_sub_f32 v61, v61, v10
    v_sub_f32 v62, v62, v10
    v_sub_f32 v63, v63, v10
    v_sub_f32 v64, v64, v10
    v_sub_f32 v65, v65, v10
    v_sub_f32 v66, v66, v10
    v_sub_f32 v67, v67, v10
    v_sub_f32 v68, v68, v10
    v_sub_f32 v69, v69, v10
    v_sub_f32 v70, v70, v10
    v_sub_f32 v71, v71, v10
    v_sub_f32 v72, v72, v10
    v_sub_f32 v73, v73, v10
    v_sub_f32 v74, v74, v10
    v_sub_f32 v75, v75, v10
    v_sub_f32 v76, v76, v10
    v_sub_f32 v77, v77, v10
    v_sub_f32 v78, v78, v10
    v_sub_f32 v79, v79, v10
    v_mul_f32 v10, v40, v40
    v_mul_f32 v9, v41, v41
    v_fmac_f32 v10, v42, v42
    v_fmac_f32 v9, v43, v43
    v_fmac_f32 v10, v44, v44
    v_fmac_f32 v9, v45, v45
    v_fmac_f32 v10, v46, v46
    v_fmac_f32 v9, v47, v47
    v_fmac_f32 v10, v48, v48
    v_fmac_f32 v9, v49, v49
    v_fmac_f32 v10, v50, v50
    v_fmac_f32 v9, v51, v51
    v_fmac_f32 v10, v52, v52
    v_fmac_f32 v9, v53, v53
    v_fmac_f32 v10, v54, v54
    v_fmac_f32 v9, v55, v55
    v_fmac_f32 v10, v56, v56
    v_fmac_f32 v9, v57, v57
    v_fmac_f32 v10, v58, v58
    v_fmac_f32 v9, v59, v59
    v_fmac_f32 v10, v60, v60
    v_fmac_f32 v9, v61, v61
    v_fmac_f32 v10, v62, v62
    v_fmac_f32 v9, v63, v63
    v_fmac_f32 v10, v64, v64
    v_fmac_f32 v9, v65, v65
    v_fmac_f32 v10, v66, v66
    v_fmac_f32 v9, v67, v67
    v_fmac_f32 v10, v68, v68
    v_fmac_f32 v9, v69, v69
    v_fmac_f32 v10, v70, v70
    v_fmac_f32 v9, v71, v71
    v_fmac_f32 v10, v72, v72
    v_fmac_f32 v9, v73, v73
    v_fmac_f32 v10, v74, v74
    v_fmac_f32 v9, v75, v75
    v_fmac_f32 v10, v76, v76
    v_fmac_f32 v9, v77, v77
    v_fmac_f32 v10, v78, v78
    v_fmac_f32 v9, v79, v79
    v_add_f32 v10, v10, v9
    v_mov_b32 v11, v10
    s_nop 1
    v_permlane16_swap_b32 v11, v10
    v_add_f32 v10, v10, v11
    v_mov_b32 v11, v10
    s_nop 1
    v_permlane32_swap_b32 v11, v10
    v_add_f32 v10, v10, v11
    ds_write_b32 v7, v10 offset:256
    s_waitcnt lgkmcnt(0)
    s_barrier
    ds_read_b32 v12, v8 offset:256
    ds_read_b32 v13, v8 offset:320
    ds_read_b32 v14, v8 offset:384
    ds_read_b32 v15, v8 offset:448
    s_waitcnt lgkmcnt(2)
    v_add_f32 v12, v12, v13
    s_waitcnt lgkmcnt(0)
    v_add_f32 v14, v14, v15
    v_add_f32 v10, v12, v14
    v_mov_b32 v9, 0x3727c5ac
    v_fmac_f32 v9, 0x3acccccd, v10
    v_rsq_f32 v9, v9
    s_nop 0
    v_mul_f32 v9, 0x3e0293ee, v9
    v_mul_f32 v40, v40, v9
    v_mul_f32 v41, v41, v9
    v_mul_f32 v42, v42, v9
    v_mul_f32 v43, v43, v9
    v_mul_f32 v44, v44, v9
    v_mul_f32 v45, v45, v9
    v_mul_f32 v46, v46, v9
    v_mul_f32 v47, v47, v9
    v_mul_f32 v48, v48, v9
    v_mul_f32 v49, v49, v9
    v_mul_f32 v50, v50, v9
    v_mul_f32 v51, v51, v9
    v_mul_f32 v52, v52, v9
    v_mul_f32 v53, v53, v9
    v_mul_f32 v54, v54, v9
    v_mul_f32 v55, v55, v9
    v_mul_f32 v56, v56, v9
    v_mul_f32 v57, v57, v9
    v_mul_f32 v58, v58, v9
    v_mul_f32 v59, v59, v9
    v_mul_f32 v60, v60, v9
    v_mul_f32 v61, v61, v9
    v_mul_f32 v62, v62, v9
    v_mul_f32 v63, v63, v9
    v_mul_f32 v64, v64, v9
    v_mul_f32 v65, v65, v9
    v_mul_f32 v66, v66, v9
    v_mul_f32 v67, v67, v9
    v_mul_f32 v68, v68, v9
    v_mul_f32 v69, v69, v9
    v_mul_f32 v70, v70, v9
    v_mul_f32 v71, v71, v9
    v_mul_f32 v72, v72, v9
    v_mul_f32 v73, v73, v9
    v_mul_f32 v74, v74, v9
    v_mul_f32 v75, v75, v9
    v_mul_f32 v76, v76, v9
    v_mul_f32 v77, v77, v9
    v_mul_f32 v78, v78, v9
    v_mul_f32 v79, v79, v9
    v_cvt_pk_f16_f32 v20, v40, v41
    v_cvt_pk_f16_f32 v21, v42, v43
    v_cvt_pk_f16_f32 v22, v44, v45
    v_cvt_pk_f16_f32 v23, v46, v47
    v_cvt_pk_f16_f32 v24, v48, v49
    v_cvt_pk_f16_f32 v25, v50, v51
    v_cvt_pk_f16_f32 v26, v52, v53
    v_cvt_pk_f16_f32 v27, v54, v55
    v_cvt_pk_f16_f32 v28, v56, v57
    v_cvt_pk_f16_f32 v29, v58, v59
    v_cvt_pk_f16_f32 v30, v60, v61
    v_cvt_pk_f16_f32 v31, v62, v63
    v_cvt_pk_f16_f32 v32, v64, v65
    v_cvt_pk_f16_f32 v33, v66, v67
    v_cvt_pk_f16_f32 v34, v68, v69
    v_cvt_pk_f16_f32 v35, v70, v71
    v_cvt_pk_f16_f32 v36, v72, v73
    v_cvt_pk_f16_f32 v37, v74, v75
    v_cvt_pk_f16_f32 v38, v76, v77
    v_cvt_pk_f16_f32 v39, v78, v79
    v_and_b32 v4, 63, v0
    v_lshlrev_b32 v4, 4, v4
    v_mul_u32_u24 v5, 5120, v3
    v_add_u32 v4, v4, v5
    v_add_u32 v6, 4096, v4
    s_mul_i32 s3, s2, 20480
    buffer_store_dwordx4 v[20:23], v4, s[56:59], s3 offen offset:0 sc1
    buffer_store_dwordx4 v[24:27], v4, s[56:59], s3 offen offset:1024 sc1
    buffer_store_dwordx4 v[28:31], v4, s[56:59], s3 offen offset:2048 sc1
    buffer_store_dwordx4 v[32:35], v4, s[56:59], s3 offen offset:3072 sc1
    buffer_store_dwordx4 v[36:39], v6, s[56:59], s3 offen sc1
    s_branch L_role_done
L_role_gemv:
    s_sub_u32 s3, s2, 128
    s_and_b32 s45, s3, 1
    s_lshr_b32 s44, s3, 1
    v_lshrrev_b32 v1, 3, v0
    v_and_b32 v2, 7, v0
    s_movk_i32 s3, 7680
    v_mul_lo_u32 v4, v1, s3
    v_lshl_add_u32 v4, v2, 4, v4
    s_lshl_b32 s3, s44, 7
    s_mul_i32 s46, s45, 2457600
    s_add_u32 s3, s3, s46
    v_add_u32 v4, s3, v4
    v_lshlrev_b32 v3, 3, v0
    v_min_u32 v3, 632, v3
    s_mul_i32 s46, s45, 640
    s_waitcnt lgkmcnt(0)
    s_mov_b32 s52, s26
    s_mov_b32 s53, s27
    s_and_b32 s53, s53, 0xffff
    s_mov_b32 s54, 0x4b0000
    s_mov_b32 s55, 0x20000
    s_mov_b32 s56, s24
    s_mov_b32 s57, s25
    s_and_b32 s57, s57, 0xffff
    s_mov_b32 s58, 0x500
    s_mov_b32 s59, 0x20000
    s_mov_b32 s3, 0
    buffer_load_dwordx4 v[24:27], v4, s[52:55], s3 offen
    s_mov_b32 s3, 245760
    buffer_load_dwordx4 v[28:31], v4, s[52:55], s3 offen
    buffer_load_dwordx2 v[10:11], v3, s[56:59], s46 offen
    s_mov_b32 s3, 491520
    buffer_load_dwordx4 v[32:35], v4, s[52:55], s3 offen
    s_mov_b32 s3, 737280
    buffer_load_dwordx4 v[36:39], v4, s[52:55], s3 offen
    s_mov_b32 s3, 983040
    buffer_load_dwordx4 v[40:43], v4, s[52:55], s3 offen
    s_mov_b32 s3, 1228800
    buffer_load_dwordx4 v[44:47], v4, s[52:55], s3 offen
    s_mov_b32 s3, 1474560
    buffer_load_dwordx4 v[48:51], v4, s[52:55], s3 offen
    s_mov_b32 s3, 1720320
    buffer_load_dwordx4 v[52:55], v4, s[52:55], s3 offen
    s_mov_b32 s3, 1966080
    buffer_load_dwordx4 v[56:59], v4, s[52:55], s3 offen
    s_mov_b32 s3, 2211840
    buffer_load_dwordx4 v[60:63], v4, s[52:55], s3 offen
    s_mov_b32 s48, s6
    s_mov_b32 s49, s7
    s_and_b32 s49, s49, 0xffff
    s_mov_b32 s50, 0x100
    s_mov_b32 s51, 0x20000
    s_add_u32 s92, s90, 0x28000
    s_addc_u32 s93, s91, 0
    s_and_b32 s93, s93, 0xffff
    s_mov_b32 s94, 0x5000
    s_mov_b32 s95, 0x20000
    v_mov_b32 v252, 0
    buffer_load_dword v253, v252, s[48:51], 0 offen sc1
    s_add_u32 s56, s90, 0x30000
    s_addc_u32 s57, s91, 0
    s_and_b32 s57, s57, 0xffff
    s_mov_b32 s58, 0x7800
    s_mov_b32 s59, 0x20000
    s_waitcnt vmcnt(9)
    v_lshlrev_b32 v12, 16, v10
    v_and_b32 v13, 0xffff0000, v10
    v_lshlrev_b32 v14, 16, v11
    v_and_b32 v15, 0xffff0000, v11
    v_mul_f32 v16, 0xbfb8aa3b, v12
    v_mul_f32 v17, 0xbfb8aa3b, v13
    v_mul_f32 v18, 0xbfb8aa3b, v14
    v_mul_f32 v19, 0xbfb8aa3b, v15
    v_exp_f32 v16, v16
    v_exp_f32 v17, v17
    v_exp_f32 v18, v18
    v_exp_f32 v19, v19
    v_add_f32 v16, 1.0, v16
    v_add_f32 v17, 1.0, v17
    v_add_f32 v18, 1.0, v18
    v_add_f32 v19, 1.0, v19
    v_rcp_f32 v16, v16
    v_rcp_f32 v17, v17
    v_rcp_f32 v18, v18
    v_rcp_f32 v19, v19
    v_mul_f32 v16, v12, v16
    v_mul_f32 v17, v13, v17
    v_mul_f32 v18, v14, v18
    v_mul_f32 v19, v15, v19
    v_cvt_pk_bf16_f32 v12, v16, v17
    v_cvt_pk_bf16_f32 v13, v18, v19
    v_lshlrev_b32 v16, 16, v12
    v_and_b32 v17, 0xffff0000, v12
    v_lshlrev_b32 v18, 16, v13
    v_and_b32 v19, 0xffff0000, v13
    v_lshlrev_b32 v5, 4, v0
    v_add_u32 v5, 131072, v5
    v_cmp_gt_u32 vcc, 80, v0
    s_and_saveexec_b64 s[46:47], vcc
    ds_write_b128 v5, v[16:19]
    s_mov_b64 exec, s[46:47]
    v_lshlrev_b32 v5, 2, v1
    v_add_u32 v5, 131072, v5
    s_waitcnt lgkmcnt(0)
    s_barrier
    ds_read_b32 v10, v5 offset:0
    ds_read_b32 v11, v5 offset:128
    ds_read_b32 v12, v5 offset:256
    ds_read_b32 v13, v5 offset:384
    ds_read_b32 v14, v5 offset:512
    ds_read_b32 v15, v5 offset:640
    ds_read_b32 v16, v5 offset:768
    ds_read_b32 v17, v5 offset:896
    ds_read_b32 v18, v5 offset:1024
    ds_read_b32 v19, v5 offset:1152
    v_lshlrev_b32 v21, 16, v24
    v_and_b32 v22, 0xffff0000, v24
    s_waitcnt lgkmcnt(9)
    v_mul_f32 v70, v21, v10
    v_mul_f32 v71, v22, v10
    v_lshlrev_b32 v21, 16, v25
    v_and_b32 v22, 0xffff0000, v25
    v_mul_f32 v72, v21, v10
    v_mul_f32 v73, v22, v10
    v_lshlrev_b32 v21, 16, v26
    v_and_b32 v22, 0xffff0000, v26
    v_mul_f32 v74, v21, v10
    v_mul_f32 v75, v22, v10
    v_lshlrev_b32 v21, 16, v27
    v_and_b32 v22, 0xffff0000, v27
    v_mul_f32 v76, v21, v10
    v_mul_f32 v77, v22, v10
    v_lshlrev_b32 v21, 16, v28
    v_and_b32 v22, 0xffff0000, v28
    s_waitcnt lgkmcnt(8)
    v_fmac_f32 v70, v21, v11
    v_fmac_f32 v71, v22, v11
    v_lshlrev_b32 v21, 16, v29
    v_and_b32 v22, 0xffff0000, v29
    v_fmac_f32 v72, v21, v11
    v_fmac_f32 v73, v22, v11
    v_lshlrev_b32 v21, 16, v30
    v_and_b32 v22, 0xffff0000, v30
    v_fmac_f32 v74, v21, v11
    v_fmac_f32 v75, v22, v11
    v_lshlrev_b32 v21, 16, v31
    v_and_b32 v22, 0xffff0000, v31
    v_fmac_f32 v76, v21, v11
    v_fmac_f32 v77, v22, v11
    s_waitcnt vmcnt(8)
    v_lshlrev_b32 v21, 16, v32
    v_and_b32 v22, 0xffff0000, v32
    s_waitcnt lgkmcnt(7)
    v_fmac_f32 v70, v21, v12
    v_fmac_f32 v71, v22, v12
    v_lshlrev_b32 v21, 16, v33
    v_and_b32 v22, 0xffff0000, v33
    v_fmac_f32 v72, v21, v12
    v_fmac_f32 v73, v22, v12
    v_lshlrev_b32 v21, 16, v34
    v_and_b32 v22, 0xffff0000, v34
    v_fmac_f32 v74, v21, v12
    v_fmac_f32 v75, v22, v12
    v_lshlrev_b32 v21, 16, v35
    v_and_b32 v22, 0xffff0000, v35
    v_fmac_f32 v76, v21, v12
    v_fmac_f32 v77, v22, v12
    s_waitcnt vmcnt(7)
    v_lshlrev_b32 v21, 16, v36
    v_and_b32 v22, 0xffff0000, v36
    s_waitcnt lgkmcnt(6)
    v_fmac_f32 v70, v21, v13
    v_fmac_f32 v71, v22, v13
    v_lshlrev_b32 v21, 16, v37
    v_and_b32 v22, 0xffff0000, v37
    v_fmac_f32 v72, v21, v13
    v_fmac_f32 v73, v22, v13
    v_lshlrev_b32 v21, 16, v38
    v_and_b32 v22, 0xffff0000, v38
    v_fmac_f32 v74, v21, v13
    v_fmac_f32 v75, v22, v13
    v_lshlrev_b32 v21, 16, v39
    v_and_b32 v22, 0xffff0000, v39
    v_fmac_f32 v76, v21, v13
    v_fmac_f32 v77, v22, v13
    s_waitcnt vmcnt(6)
    v_lshlrev_b32 v21, 16, v40
    v_and_b32 v22, 0xffff0000, v40
    s_waitcnt lgkmcnt(5)
    v_fmac_f32 v70, v21, v14
    v_fmac_f32 v71, v22, v14
    v_lshlrev_b32 v21, 16, v41
    v_and_b32 v22, 0xffff0000, v41
    v_fmac_f32 v72, v21, v14
    v_fmac_f32 v73, v22, v14
    v_lshlrev_b32 v21, 16, v42
    v_and_b32 v22, 0xffff0000, v42
    v_fmac_f32 v74, v21, v14
    v_fmac_f32 v75, v22, v14
    v_lshlrev_b32 v21, 16, v43
    v_and_b32 v22, 0xffff0000, v43
    v_fmac_f32 v76, v21, v14
    v_fmac_f32 v77, v22, v14
    s_waitcnt vmcnt(5)
    v_lshlrev_b32 v21, 16, v44
    v_and_b32 v22, 0xffff0000, v44
    s_waitcnt lgkmcnt(4)
    v_fmac_f32 v70, v21, v15
    v_fmac_f32 v71, v22, v15
    v_lshlrev_b32 v21, 16, v45
    v_and_b32 v22, 0xffff0000, v45
    v_fmac_f32 v72, v21, v15
    v_fmac_f32 v73, v22, v15
    v_lshlrev_b32 v21, 16, v46
    v_and_b32 v22, 0xffff0000, v46
    v_fmac_f32 v74, v21, v15
    v_fmac_f32 v75, v22, v15
    v_lshlrev_b32 v21, 16, v47
    v_and_b32 v22, 0xffff0000, v47
    v_fmac_f32 v76, v21, v15
    v_fmac_f32 v77, v22, v15
    s_waitcnt vmcnt(4)
    v_lshlrev_b32 v21, 16, v48
    v_and_b32 v22, 0xffff0000, v48
    s_waitcnt lgkmcnt(3)
    v_fmac_f32 v70, v21, v16
    v_fmac_f32 v71, v22, v16
    v_lshlrev_b32 v21, 16, v49
    v_and_b32 v22, 0xffff0000, v49
    v_fmac_f32 v72, v21, v16
    v_fmac_f32 v73, v22, v16
    v_lshlrev_b32 v21, 16, v50
    v_and_b32 v22, 0xffff0000, v50
    v_fmac_f32 v74, v21, v16
    v_fmac_f32 v75, v22, v16
    v_lshlrev_b32 v21, 16, v51
    v_and_b32 v22, 0xffff0000, v51
    v_fmac_f32 v76, v21, v16
    v_fmac_f32 v77, v22, v16
    s_waitcnt vmcnt(3)
    v_lshlrev_b32 v21, 16, v52
    v_and_b32 v22, 0xffff0000, v52
    s_waitcnt lgkmcnt(2)
    v_fmac_f32 v70, v21, v17
    v_fmac_f32 v71, v22, v17
    v_lshlrev_b32 v21, 16, v53
    v_and_b32 v22, 0xffff0000, v53
    v_fmac_f32 v72, v21, v17
    v_fmac_f32 v73, v22, v17
    v_lshlrev_b32 v21, 16, v54
    v_and_b32 v22, 0xffff0000, v54
    v_fmac_f32 v74, v21, v17
    v_fmac_f32 v75, v22, v17
    v_lshlrev_b32 v21, 16, v55
    v_and_b32 v22, 0xffff0000, v55
    v_fmac_f32 v76, v21, v17
    v_fmac_f32 v77, v22, v17
    s_waitcnt vmcnt(2)
    v_lshlrev_b32 v21, 16, v56
    v_and_b32 v22, 0xffff0000, v56
    s_waitcnt lgkmcnt(1)
    v_fmac_f32 v70, v21, v18
    v_fmac_f32 v71, v22, v18
    v_lshlrev_b32 v21, 16, v57
    v_and_b32 v22, 0xffff0000, v57
    v_fmac_f32 v72, v21, v18
    v_fmac_f32 v73, v22, v18
    v_lshlrev_b32 v21, 16, v58
    v_and_b32 v22, 0xffff0000, v58
    v_fmac_f32 v74, v21, v18
    v_fmac_f32 v75, v22, v18
    v_lshlrev_b32 v21, 16, v59
    v_and_b32 v22, 0xffff0000, v59
    v_fmac_f32 v76, v21, v18
    v_fmac_f32 v77, v22, v18
    s_waitcnt vmcnt(1)
    v_lshlrev_b32 v21, 16, v60
    v_and_b32 v22, 0xffff0000, v60
    s_waitcnt lgkmcnt(0)
    v_fmac_f32 v70, v21, v19
    v_fmac_f32 v71, v22, v19
    v_lshlrev_b32 v21, 16, v61
    v_and_b32 v22, 0xffff0000, v61
    v_fmac_f32 v72, v21, v19
    v_fmac_f32 v73, v22, v19
    v_lshlrev_b32 v21, 16, v62
    v_and_b32 v22, 0xffff0000, v62
    v_fmac_f32 v74, v21, v19
    v_fmac_f32 v75, v22, v19
    v_lshlrev_b32 v21, 16, v63
    v_and_b32 v22, 0xffff0000, v63
    v_fmac_f32 v76, v21, v19
    v_fmac_f32 v77, v22, v19
    v_add_f32_dpp v70, v70, v70 row_ror:8 row_mask:0xf bank_mask:0xf
    v_add_f32_dpp v71, v71, v71 row_ror:8 row_mask:0xf bank_mask:0xf
    v_add_f32_dpp v72, v72, v72 row_ror:8 row_mask:0xf bank_mask:0xf
    v_add_f32_dpp v73, v73, v73 row_ror:8 row_mask:0xf bank_mask:0xf
    v_add_f32_dpp v74, v74, v74 row_ror:8 row_mask:0xf bank_mask:0xf
    v_add_f32_dpp v75, v75, v75 row_ror:8 row_mask:0xf bank_mask:0xf
    v_add_f32_dpp v76, v76, v76 row_ror:8 row_mask:0xf bank_mask:0xf
    v_add_f32_dpp v77, v77, v77 row_ror:8 row_mask:0xf bank_mask:0xf
    v_mov_b32 v80, v70
    v_mov_b32 v81, v71
    v_mov_b32 v82, v72
    v_mov_b32 v83, v73
    v_mov_b32 v84, v74
    v_mov_b32 v85, v75
    v_mov_b32 v86, v76
    v_mov_b32 v87, v77
    s_nop 0
    v_permlane16_swap_b32 v80, v70
    v_permlane16_swap_b32 v81, v71
    v_permlane16_swap_b32 v82, v72
    v_permlane16_swap_b32 v83, v73
    v_permlane16_swap_b32 v84, v74
    v_permlane16_swap_b32 v85, v75
    v_permlane16_swap_b32 v86, v76
    v_permlane16_swap_b32 v87, v77
    v_add_f32 v70, v70, v80
    v_add_f32 v71, v71, v81
    v_add_f32 v72, v72, v82
    v_add_f32 v73, v73, v83
    v_add_f32 v74, v74, v84
    v_add_f32 v75, v75, v85
    v_add_f32 v76, v76, v86
    v_add_f32 v77, v77, v87
    v_mov_b32 v80, v70
    v_mov_b32 v81, v71
    v_mov_b32 v82, v72
    v_mov_b32 v83, v73
    v_mov_b32 v84, v74
    v_mov_b32 v85, v75
    v_mov_b32 v86, v76
    v_mov_b32 v87, v77
    s_nop 0
    v_permlane32_swap_b32 v80, v70
    v_permlane32_swap_b32 v81, v71
    v_permlane32_swap_b32 v82, v72
    v_permlane32_swap_b32 v83, v73
    v_permlane32_swap_b32 v84, v74
    v_permlane32_swap_b32 v85, v75
    v_permlane32_swap_b32 v86, v76
    v_permlane32_swap_b32 v87, v77
    v_add_f32 v70, v70, v80
    v_add_f32 v71, v71, v81
    v_add_f32 v72, v72, v82
    v_add_f32 v73, v73, v83
    v_add_f32 v74, v74, v84
    v_add_f32 v75, v75, v85
    v_add_f32 v76, v76, v86
    v_add_f32 v77, v77, v87
    v_lshrrev_b32 v6, 6, v0
    v_lshlrev_b32 v6, 8, v6
    v_lshl_add_u32 v6, v2, 5, v6
    v_add_u32 v6, 137216, v6
    s_mov_b64 exec, 0xff
    ds_write_b128 v6, v[70:73]
    ds_write_b128 v6, v[74:77] offset:16
    s_mov_b64 exec, -1
    s_waitcnt lgkmcnt(0)
    s_barrier
    v_and_b32 v6, 63, v0
    v_lshlrev_b32 v6, 2, v6
    v_add_u32 v7, 137216, v6
    ds_read_b32 v50, v7 offset:0
    ds_read_b32 v51, v7 offset:256
    ds_read_b32 v52, v7 offset:512
    ds_read_b32 v53, v7 offset:768
    s_waitcnt lgkmcnt(2)
    v_add_f32 v50, v50, v51
    s_waitcnt lgkmcnt(0)
    v_add_f32 v52, v52, v53
    v_add_f32 v50, v50, v52
    s_lshl_b32 s3, s44, 8
    s_mul_i32 s46, s45, 15360
    s_add_u32 s3, s3, s46
    v_cmp_gt_u32 vcc, 64, v0
    s_and_saveexec_b64 s[46:47], vcc
    buffer_store_dword v50, v6, s[56:59], s3 offen sc1
    s_mov_b64 exec, s[46:47]
    s_branch L_role_done
L_role_init:
    s_waitcnt lgkmcnt(0)
    s_mov_b32 s48, s6
    s_mov_b32 s49, s7
    s_and_b32 s49, s49, 0xffff
    s_mov_b32 s50, 0x100
    s_mov_b32 s51, 0x20000
    s_add_u32 s92, s90, 0x28000
    s_addc_u32 s93, s91, 0
    s_and_b32 s93, s93, 0xffff
    s_mov_b32 s94, 0x5000
    s_mov_b32 s95, 0x20000
    s_cmp_lg_u32 s2, 255
    s_cbranch_scc1 L_noinit
    v_lshlrev_b32 v1, 4, v0
    v_mov_b32 v4, 0
    v_mov_b32 v5, 0
    v_mov_b32 v6, 0
    v_mov_b32 v7, 0
    s_movk_i32 s3, 0
    buffer_store_dwordx4 v[4:7], v1, s[92:95], s3 offen sc1
    s_movk_i32 s3, 4096
    buffer_store_dwordx4 v[4:7], v1, s[92:95], s3 offen sc1
    s_movk_i32 s3, 8192
    buffer_store_dwordx4 v[4:7], v1, s[92:95], s3 offen sc1
    s_movk_i32 s3, 12288
    buffer_store_dwordx4 v[4:7], v1, s[92:95], s3 offen sc1
    s_movk_i32 s3, 16384
    buffer_store_dwordx4 v[4:7], v1, s[92:95], s3 offen sc1
    s_waitcnt vmcnt(0)
    s_barrier
    v_mov_b32 v1, 0
    v_mov_b32 v2, 1
    s_mov_b64 exec, 1
    buffer_store_dword v2, v1, s[48:51], 0 offen sc1
    s_mov_b64 exec, -1
L_noinit:
    s_mov_b32 s48, s6
    s_mov_b32 s49, s7
    s_and_b32 s49, s49, 0xffff
    s_mov_b32 s50, 0x100
    s_mov_b32 s51, 0x20000
    s_add_u32 s92, s90, 0x28000
    s_addc_u32 s93, s91, 0
    s_and_b32 s93, s93, 0xffff
    s_mov_b32 s94, 0x5000
    s_mov_b32 s95, 0x20000
    s_getpc_b64 s[8:9]
L_pc0:
    s_sub_u32 s8, s8, L_pc0-adaLN_cond__mha_block_cached__dense_activation_silu__prompt_kernel
    s_subb_u32 s9, s9, 0
    v_lshlrev_b32 v200, 7, v249
    v_min_u32 v200, L_done-adaLN_cond__mha_block_cached__dense_activation_silu__prompt_kernel, v200
    v_mov_b32 v203, s9
    v_add_co_u32 v202, vcc, s8, v200
    s_nop 1
    v_addc_co_u32 v203, vcc, 0, v203, vcc
    global_load_dword v250, v[202:203], off
    v_lshlrev_b32 v200, 7, v249
    v_add_u32 v200, 0x8000, v200
    v_min_u32 v200, L_done-adaLN_cond__mha_block_cached__dense_activation_silu__prompt_kernel, v200
    v_mov_b32 v203, s9
    v_add_co_u32 v202, vcc, s8, v200
    s_nop 1
    v_addc_co_u32 v203, vcc, 0, v203, vcc
    global_load_dword v251, v[202:203], off
    v_mov_b32 v252, 0
    buffer_load_dword v253, v252, s[48:51], 0 offen sc1
L_role_done:
    s_cmp_lg_u32 s32, 0
    s_cbranch_scc1 L_wi_done
    s_mov_b32 s3, 0
    s_waitcnt vmcnt(0)
L_wi_check:
    v_cmp_ne_u32 vcc, 1, v253
    s_add_u32 s3, s3, 1
    s_cmp_gt_u32 s3, 400000
    s_cbranch_scc1 L_wi_done
    s_cmp_eq_u64 vcc, 0
    s_cbranch_scc1 L_wi_done
    buffer_load_dword v253, v252, s[48:51], 0 offen sc1
    s_waitcnt vmcnt(0)
    s_branch L_wi_check
L_wi_done:
    s_waitcnt vmcnt(0) lgkmcnt(0)
    s_barrier
    s_cmp_lg_u32 s32, 0
    s_cbranch_scc1 L_arr0
    s_and_b32 s3, s2, 7
    s_lshl_b32 s3, s3, 7
    s_add_u32 s3, s3, 0
    s_mov_b64 exec, 1
    v_mov_b32 v254, s3
    v_mov_b32 v255, 1
    buffer_atomic_add v255, v254, s[92:95], 0 offen sc1
    s_mov_b64 exec, -1
L_arr0:
    s_load_dwordx2 s[4:5], s[0:1], 8
    s_load_dwordx2 s[6:7], s[0:1], 16
    s_load_dwordx2 s[40:41], s[0:1], 24
    s_and_b32 s3, s2, 7
    s_lshl_b32 s3, s3, 2
    s_bfe_u32 s33, s2, 0x20003
    s_add_u32 s33, s33, s3
    s_lshr_b32 s34, s2, 5
    s_lshl_b32 s35, s32, 12
    v_bfe_u32 v200, v249, 4, 2
    v_and_b32 v201, 15, v249
    s_lshl_b32 s3, s32, 4
    v_add_u32 v202, s3, v200
    v_add_u32 v203, 0, v200
    v_xor_b32 v203, v203, v201
    v_lshlrev_b32 v203, 4, v203
    v_lshl_add_u32 v244, v202, 8, v203
    v_add_u32 v203, 4, v200
    v_xor_b32 v203, v203, v201
    v_lshlrev_b32 v203, 4, v203
    v_lshl_add_u32 v245, v202, 8, v203
    v_add_u32 v203, 8, v200
    v_xor_b32 v203, v203, v201
    v_lshlrev_b32 v203, 4, v203
    v_lshl_add_u32 v246, v202, 8, v203
    v_add_u32 v203, 12, v200
    v_xor_b32 v203, v203, v201
    v_lshlrev_b32 v203, 4, v203
    v_lshl_add_u32 v247, v202, 8, v203
    v_add_u32 v203, 0, v200
    v_lshlrev_b32 v203, 1, v203
    v_xor_b32 v203, v203, v201
    v_lshlrev_b32 v203, 4, v203
    v_lshl_add_u32 v252, v202, 8, v203
    v_lshl_add_u32 v250, v202, 13, v203
    v_add_u32 v203, 4, v200
    v_lshlrev_b32 v203, 1, v203
    v_xor_b32 v203, v203, v201
    v_lshlrev_b32 v203, 4, v203
    v_lshl_add_u32 v253, v202, 8, v203
    v_lshl_add_u32 v251, v202, 13, v203
    s_waitcnt lgkmcnt(0)
    s_lshl_b32 s3, s33, 19
    s_mov_b32 s8, s4
    s_mov_b32 s9, s5
    s_add_u32 s8, s8, s3
    s_addc_u32 s9, s9, 0
    s_and_b32 s9, s9, 0xffff
    s_mov_b32 s10, 0x80000
    s_mov_b32 s11, 0x20000
    s_mov_b32 s12, s6
    s_mov_b32 s13, s7
    s_add_u32 s12, s12, s3
    s_addc_u32 s13, s13, 0
    s_and_b32 s13, s13, 0xffff
    s_mov_b32 s14, 0x80000
    s_mov_b32 s15, 0x20000
    s_lshl_b32 s3, s33, 8
    s_sub_u32 s39, 5242880, s3
    s_mov_b32 s16, s40
    s_mov_b32 s17, s41
    s_add_u32 s16, s16, s3
    s_addc_u32 s17, s17, 0
    s_and_b32 s17, s17, 0xffff
    s_mov_b32 s18, s39
    s_mov_b32 s19, 0x20000
    s_cmp_ge_u32 s32, 2
    s_cselect_b32 s62, 8192, 0
    s_sub_u32 s37, 520192, s35
    s_add_u32 m0, s35, 98304
    s_mov_b32 s49, 0
    buffer_load_dwordx4 v250, s[16:19], s49 offen offset:0 lds
    s_mov_b32 s49, 31744
    buffer_load_dwordx4 v251, s[16:19], s49 offen offset:1024 lds
    s_mov_b32 s49, 63488
    buffer_load_dwordx4 v250, s[16:19], s49 offen offset:2048 lds
    s_mov_b32 s49, 95232
    buffer_load_dwordx4 v251, s[16:19], s49 offen offset:3072 lds
    s_add_u32 m0, s35, 114688
    s_mov_b32 s49, 524288
    buffer_load_dwordx4 v250, s[16:19], s49 offen offset:0 lds
    s_mov_b32 s49, 556032
    buffer_load_dwordx4 v251, s[16:19], s49 offen offset:1024 lds
    s_mov_b32 s49, 587776
    buffer_load_dwordx4 v250, s[16:19], s49 offen offset:2048 lds
    s_mov_b32 s49, 619520
    buffer_load_dwordx4 v251, s[16:19], s49 offen offset:3072 lds
    s_mov_b32 m0, s35
    v_subrev_u32 v214, s62, v244
    v_subrev_u32 v215, s62, v245
    v_subrev_u32 v216, s62, v246
    v_subrev_u32 v217, s62, v247
    buffer_load_dwordx4 v214, s[8:11], 0 offen offset:0 lds
    buffer_load_dwordx4 v215, s[8:11], 0 offen offset:1024 lds
    buffer_load_dwordx4 v216, s[8:11], 0 offen offset:2048 lds
    buffer_load_dwordx4 v217, s[8:11], 0 offen offset:3072 lds
    s_add_u32 m0, s35, 16384
    s_movk_i32 s39, 8192
    buffer_load_dwordx4 v244, s[8:11], s39 offen offset:0 lds
    buffer_load_dwordx4 v245, s[8:11], s39 offen offset:1024 lds
    buffer_load_dwordx4 v246, s[8:11], s39 offen offset:2048 lds
    buffer_load_dwordx4 v247, s[8:11], s39 offen offset:3072 lds
    s_mul_i32 s3, s34, 160
    s_sub_u32 s3, s3, 64
    v_add_u32 v203, s3, v249
    v_min_u32 v203, 1279, v203
    v_and_b32 v218, 1, v203
    v_lshrrev_b32 v203, 1, v203
    v_lshlrev_b32 v203, 13, v203
    v_lshl_add_u32 v203, v218, 7, v203
    buffer_load_dword v219, v203, s[16:19], 0 offen
L_pf_skip:
    v_accvgpr_write_b32 a160, 0
    v_accvgpr_write_b32 a161, 0
    v_accvgpr_write_b32 a162, 0
    v_accvgpr_write_b32 a163, 0
    v_accvgpr_write_b32 a164, 0
    v_accvgpr_write_b32 a165, 0
    v_accvgpr_write_b32 a166, 0
    v_accvgpr_write_b32 a167, 0
    v_accvgpr_write_b32 a168, 0
    v_accvgpr_write_b32 a169, 0
    v_accvgpr_write_b32 a170, 0
    v_accvgpr_write_b32 a171, 0
    v_accvgpr_write_b32 a172, 0
    v_accvgpr_write_b32 a173, 0
    v_accvgpr_write_b32 a174, 0
    v_accvgpr_write_b32 a175, 0
    v_accvgpr_write_b32 a176, 0
    v_accvgpr_write_b32 a177, 0
    v_accvgpr_write_b32 a178, 0
    v_accvgpr_write_b32 a179, 0
    v_accvgpr_write_b32 a180, 0
    v_accvgpr_write_b32 a181, 0
    v_accvgpr_write_b32 a182, 0
    v_accvgpr_write_b32 a183, 0
    v_accvgpr_write_b32 a184, 0
    v_accvgpr_write_b32 a185, 0
    v_accvgpr_write_b32 a186, 0
    v_accvgpr_write_b32 a187, 0
    v_accvgpr_write_b32 a188, 0
    v_accvgpr_write_b32 a189, 0
    v_accvgpr_write_b32 a190, 0
    v_accvgpr_write_b32 a191, 0
    v_accvgpr_write_b32 a212, 0
    v_accvgpr_write_b32 a213, 0
    v_accvgpr_write_b32 a214, 0
    v_accvgpr_write_b32 a215, 0
    v_mov_b32 v12, 0x3f803f80
    v_and_b32 v13, 15, v249
    v_cmp_eq_u32 vcc, 0, v13
    s_nop 1
    v_cndmask_b32 v12, 0, v12, vcc
    v_accvgpr_write_b32 a208, v12
    v_accvgpr_write_b32 a209, v12
    v_accvgpr_write_b32 a210, v12
    v_accvgpr_write_b32 a211, v12
    v_accvgpr_write_b32 a192, 0
    v_accvgpr_write_b32 a193, 0
    v_accvgpr_write_b32 a194, 0
    v_accvgpr_write_b32 a195, 0
    v_accvgpr_write_b32 a196, 0
    v_accvgpr_write_b32 a197, 0
    v_accvgpr_write_b32 a198, 0
    v_accvgpr_write_b32 a199, 0
    v_accvgpr_write_b32 a200, 0
    v_accvgpr_write_b32 a201, 0
    v_accvgpr_write_b32 a202, 0
    v_accvgpr_write_b32 a203, 0
    v_accvgpr_write_b32 a204, 0
    v_accvgpr_write_b32 a205, 0
    v_accvgpr_write_b32 a206, 0
    v_accvgpr_write_b32 a207, 0
    v_and_b32 v8, 63, v249
    v_lshrrev_b32 v9, 4, v8
    v_and_b32 v10, 15, v8
    v_lshrrev_b32 v12, 2, v10
    v_lshl_add_u32 v12, v9, 2, v12
    v_and_b32 v13, 7, v12
    v_lshlrev_b32 v12, 8, v12
    v_and_b32 v14, 3, v10
    v_lshl_add_u32 v12, v14, 3, v12
    v_add_u32 v12, 98304, v12
    v_xor_b32 v14, 0, v13
    v_lshl_add_u32 v236, v14, 5, v12
    v_xor_b32 v14, 1, v13
    v_lshl_add_u32 v237, v14, 5, v12
    v_xor_b32 v14, 2, v13
    v_lshl_add_u32 v238, v14, 5, v12
    v_xor_b32 v14, 3, v13
    v_lshl_add_u32 v239, v14, 5, v12
    v_xor_b32 v14, 4, v13
    v_lshl_add_u32 v240, v14, 5, v12
    v_xor_b32 v14, 5, v13
    v_lshl_add_u32 v241, v14, 5, v12
    v_xor_b32 v14, 6, v13
    v_lshl_add_u32 v242, v14, 5, v12
    v_xor_b32 v14, 7, v13
    v_lshl_add_u32 v243, v14, 5, v12
    s_lshl_b32 s3, s34, 4
    s_lshl_b32 s39, s32, 2
    s_add_u32 s3, s3, s39
    s_mul_i32 s3, s3, 20480
    v_lshlrev_b32 v12, 4, v8
    v_add_u32 v248, s3, v12
    s_mov_b32 s44, 0
    s_mov_b32 s45, 20480
    s_mov_b32 s46, 40960
    s_mov_b32 s47, 61440
    s_add_u32 s20, s90, 0x40000
    s_addc_u32 s21, s91, 0
    s_and_b32 s21, s21, 0xffff
    s_mov_b32 s22, 0x280000
    s_mov_b32 s23, 0x20000
    s_add_u32 s24, s90, 0x2000000
    s_addc_u32 s25, s91, 0
    s_and_b32 s25, s25, 0xffff
    s_mov_b32 s26, 0x1000000
    s_mov_b32 s27, 0x20000
    s_mov_b32 s28, s90
    s_mov_b32 s29, s91
    s_and_b32 s29, s29, 0xffff
    s_mov_b32 s30, 0x3c00
    s_mov_b32 s31, 0x20000
    v_lshlrev_b32 v200, 4, v9
    v_add_u32 v200, 131072, v200
    v_lshlrev_b32 v201, 4, v249
    v_mov_b32 v0, 0
    v_mov_b32 v1, 0
    v_mov_b32 v2, 0
    v_mov_b32 v3, 0
    v_mov_b32 v4, 0
    v_mov_b32 v5, 0
    v_mov_b32 v6, 0
    v_mov_b32 v7, 0
    v_mov_b32 v8, 0
    v_mov_b32 v9, 0
    v_mov_b32 v10, 0
    v_mov_b32 v11, 0
    v_mov_b32 v12, 0
    v_mov_b32 v13, 0
    v_mov_b32 v14, 0
    v_mov_b32 v15, 0
    v_mov_b32 v16, 0
    v_mov_b32 v17, 0
    v_mov_b32 v18, 0
    v_mov_b32 v19, 0
    v_mov_b32 v20, 0
    v_mov_b32 v21, 0
    v_mov_b32 v22, 0
    v_mov_b32 v23, 0
    v_mov_b32 v24, 0
    v_mov_b32 v25, 0
    v_mov_b32 v26, 0
    v_mov_b32 v27, 0
    v_mov_b32 v28, 0
    v_mov_b32 v29, 0
    v_mov_b32 v30, 0
    v_mov_b32 v31, 0
    v_mov_b32 v32, 0
    v_mov_b32 v33, 0
    v_mov_b32 v34, 0
    v_mov_b32 v35, 0
    v_mov_b32 v36, 0
    v_mov_b32 v37, 0
    v_mov_b32 v38, 0
    v_mov_b32 v39, 0
    v_mov_b32 v40, 0
    v_mov_b32 v41, 0
    v_mov_b32 v42, 0
    v_mov_b32 v43, 0
    v_mov_b32 v44, 0
    v_mov_b32 v45, 0
    v_mov_b32 v46, 0
    v_mov_b32 v47, 0
    v_mov_b32 v48, 0
    v_mov_b32 v49, 0
    v_mov_b32 v50, 0
    v_mov_b32 v51, 0
    v_mov_b32 v52, 0
    v_mov_b32 v53, 0
    v_mov_b32 v54, 0
    v_mov_b32 v55, 0
    v_mov_b32 v56, 0
    v_mov_b32 v57, 0
    v_mov_b32 v58, 0
    v_mov_b32 v59, 0
    v_mov_b32 v60, 0
    v_mov_b32 v61, 0
    v_mov_b32 v62, 0
    v_mov_b32 v63, 0
    v_mov_b32 v64, 0
    v_mov_b32 v65, 0
    v_mov_b32 v66, 0
    v_mov_b32 v67, 0
    v_mov_b32 v68, 0
    v_mov_b32 v69, 0
    v_mov_b32 v70, 0
    v_mov_b32 v71, 0
    v_mov_b32 v72, 0
    v_mov_b32 v73, 0
    v_mov_b32 v74, 0
    v_mov_b32 v75, 0
    v_mov_b32 v76, 0
    v_mov_b32 v77, 0
    v_mov_b32 v78, 0
    v_mov_b32 v79, 0
    v_mov_b32 v80, 0
    v_mov_b32 v81, 0
    v_mov_b32 v82, 0
    v_mov_b32 v83, 0
    v_mov_b32 v84, 0
    v_mov_b32 v85, 0
    v_mov_b32 v86, 0
    v_mov_b32 v87, 0
    v_mov_b32 v88, 0
    v_mov_b32 v89, 0
    v_mov_b32 v90, 0
    v_mov_b32 v91, 0
    v_mov_b32 v92, 0
    v_mov_b32 v93, 0
    v_mov_b32 v94, 0
    v_mov_b32 v95, 0
    v_mov_b32 v96, 0
    v_mov_b32 v97, 0
    v_mov_b32 v98, 0
    v_mov_b32 v99, 0
    v_mov_b32 v100, 0
    v_mov_b32 v101, 0
    v_mov_b32 v102, 0
    v_mov_b32 v103, 0
    v_mov_b32 v104, 0
    v_mov_b32 v105, 0
    v_mov_b32 v106, 0
    v_mov_b32 v107, 0
    v_mov_b32 v108, 0
    v_mov_b32 v109, 0
    v_mov_b32 v110, 0
    v_mov_b32 v111, 0
    v_mov_b32 v112, 0
    v_mov_b32 v113, 0
    v_mov_b32 v114, 0
    v_mov_b32 v115, 0
    v_mov_b32 v116, 0
    v_mov_b32 v117, 0
    v_mov_b32 v118, 0
    v_mov_b32 v119, 0
    v_mov_b32 v120, 0
    v_mov_b32 v121, 0
    v_mov_b32 v122, 0
    v_mov_b32 v123, 0
    v_mov_b32 v124, 0
    v_mov_b32 v125, 0
    v_mov_b32 v126, 0
    v_mov_b32 v127, 0
    s_add_u32 s51, s35, 81920
    s_add_u32 s52, s35, 98304
    s_mov_b32 s48, 1572864
    s_cmp_lg_u32 s32, 0
    s_cbranch_scc1 L_pw0
    v_and_b32 v254, 7, v249
    v_lshlrev_b32 v254, 7, v254
    s_mov_b32 s3, 0
L_poll0:
    buffer_load_dword v255, v254, s[92:95], 0 offen offset:0 sc1
    s_waitcnt vmcnt(0)
    v_cmp_gt_u32 vcc, 32, v255
    s_add_u32 s3, s3, 1
    s_cmp_gt_u32 s3, 400000
    s_cbranch_scc1 L_pw0
    s_cmp_eq_u64 vcc, 0
    s_cbranch_scc0 L_poll0
L_pw0:
    s_barrier
    s_add_u32 s56, s90, 0x30000
    s_addc_u32 s57, s91, 0
    s_and_b32 s57, s57, 0xffff
    s_mov_b32 s58, 0x7800
    s_mov_b32 s59, 0x20000
    s_mul_i32 s3, s2, 10
    s_add_u32 s3, s3, 1280
    v_min_u32 v224, 9, v249
    v_add_u32 v224, s3, v224
    v_lshlrev_b32 v224, 2, v224
    s_movk_i32 s41, 15360
    buffer_load_dword v225, v224, s[56:59], 0 offen
    buffer_load_dword v226, v224, s[56:59], s41 offen
    buffer_load_dwordx4 v[204:207], v201, s[56:59], 0 offen
    buffer_load_dwordx4 v[208:211], v201, s[56:59], 0 offen offset:2560
    buffer_load_dwordx4 v[216:219], v201, s[56:59], s41 offen
    buffer_load_dwordx4 v[220:223], v201, s[56:59], s41 offen offset:2560
    buffer_load_dwordx4 v[128:131], v248, s[20:23], s44 offen offset:0
    buffer_load_dwordx4 v[132:135], v248, s[20:23], s45 offen offset:0
    buffer_load_dwordx4 v[136:139], v248, s[20:23], s46 offen offset:0
    buffer_load_dwordx4 v[140:143], v248, s[20:23], s47 offen offset:0
    v_mov_b32 v254, v200
    s_waitcnt vmcnt(5)
    v_add_f32 v204, v204, v216
    v_add_f32 v205, v205, v217
    v_add_f32 v206, v206, v218
    v_add_f32 v207, v207, v219
    s_waitcnt vmcnt(4)
    v_add_f32 v208, v208, v220
    v_add_f32 v209, v209, v221
    v_add_f32 v210, v210, v222
    v_add_f32 v211, v211, v223
    v_cvt_pk_bf16_f32 v216, v204, v205
    v_cvt_pk_bf16_f32 v217, v206, v207
    v_cvt_pk_bf16_f32 v218, v208, v209
    v_cvt_pk_bf16_f32 v219, v210, v211
    v_lshlrev_b32 v204, 16, v216
    v_and_b32 v205, 0xffff0000, v216
    v_lshlrev_b32 v206, 16, v217
    v_and_b32 v207, 0xffff0000, v217
    v_lshlrev_b32 v208, 16, v218
    v_and_b32 v209, 0xffff0000, v218
    v_lshlrev_b32 v210, 16, v219
    v_and_b32 v211, 0xffff0000, v219
    v_add_f32 v225, v225, v226
    v_cvt_pk_bf16_f32 v225, v225, v225
    v_lshlrev_b32 v225, 16, v225
    v_cmp_gt_u32 vcc, 10, v249
    s_and_saveexec_b64 s[54:55], vcc
    buffer_store_dword v225, v224, s[28:31], 0 offen sc1
    s_mov_b64 exec, s[54:55]
    v_add_f32 v208, 1.0, v208
    v_add_f32 v209, 1.0, v209
    v_add_f32 v210, 1.0, v210
    v_add_f32 v211, 1.0, v211
    v_cvt_pk_bf16_f32 v212, v208, v209
    v_cvt_pk_bf16_f32 v213, v210, v211
    v_lshlrev_b32 v208, 16, v212
    v_and_b32 v209, 0xffff0000, v212
    v_lshlrev_b32 v210, 16, v213
    v_and_b32 v211, 0xffff0000, v213
    v_mul_f32 v204, 0x3e0293ee, v204
    v_mul_f32 v205, 0x3e0293ee, v205
    v_mul_f32 v206, 0x3e0293ee, v206
    v_mul_f32 v207, 0x3e0293ee, v207
    v_add_u32 v212, 131072, v201
    v_cmp_gt_u32 vcc, 160, v249
    s_and_saveexec_b64 s[54:55], vcc
    ds_write_b128 v212, v[208:211]
    ds_write_b128 v212, v[204:207] offset:2560
    s_mov_b64 exec, s[54:55]
    buffer_load_dwordx4 v[144:147], v248, s[20:23], s44 offen offset:1024
    buffer_load_dwordx4 v[148:151], v248, s[20:23], s45 offen offset:1024
    buffer_load_dwordx4 v[152:155], v248, s[20:23], s46 offen offset:1024
    buffer_load_dwordx4 v[156:159], v248, s[20:23], s47 offen offset:1024
    buffer_load_dwordx4 v[160:163], v248, s[20:23], s44 offen offset:2048
    buffer_load_dwordx4 v[164:167], v248, s[20:23], s45 offen offset:2048
    buffer_load_dwordx4 v[168:171], v248, s[20:23], s46 offen offset:2048
    buffer_load_dwordx4 v[172:175], v248, s[20:23], s47 offen offset:2048
    buffer_load_dwordx4 v[176:179], v248, s[20:23], s44 offen offset:3072
    buffer_load_dwordx4 v[180:183], v248, s[20:23], s45 offen offset:3072
    buffer_load_dwordx4 v[184:187], v248, s[20:23], s46 offen offset:3072
    buffer_load_dwordx4 v[188:191], v248, s[20:23], s47 offen offset:3072
    s_add_u32 s44, s44, 4096
    s_add_u32 s45, s45, 4096
    s_add_u32 s46, s46, 4096
    s_add_u32 s47, s47, 4096
    s_waitcnt lgkmcnt(0)
    s_barrier
    s_add_u32 m0, s35, 65536
    s_mov_b32 s49, 1048576
    buffer_load_dwordx4 v250, s[16:19], s49 offen offset:0 lds
    s_mov_b32 s49, 1080320
    buffer_load_dwordx4 v251, s[16:19], s49 offen offset:1024 lds
    s_mov_b32 s49, 1112064
    buffer_load_dwordx4 v250, s[16:19], s49 offen offset:2048 lds
    s_mov_b32 s49, 1143808
    buffer_load_dwordx4 v251, s[16:19], s49 offen offset:3072 lds
    ds_read_b128 v[200:203], v254 offset:0
    ds_read_b128 v[208:211], v254 offset:2560
    ds_read_b128 v[204:207], v254 offset:64
    ds_read_b128 v[212:215], v254 offset:2624
    ds_read_b64_tr_b16 a[64:65], v236 offset:0
    ds_read_b64_tr_b16 a[66:67], v236 offset:4096
    ds_read_b64_tr_b16 a[68:69], v237 offset:0
    ds_read_b64_tr_b16 a[70:71], v237 offset:4096
    ds_read_b64_tr_b16 a[72:73], v238 offset:0
    ds_read_b64_tr_b16 a[74:75], v238 offset:4096
    ds_read_b64_tr_b16 a[76:77], v239 offset:0
    ds_read_b64_tr_b16 a[78:79], v239 offset:4096
    ds_read_b64_tr_b16 a[80:81], v240 offset:0
    ds_read_b64_tr_b16 a[82:83], v240 offset:4096
    ds_read_b64_tr_b16 a[84:85], v241 offset:0
    ds_read_b64_tr_b16 a[86:87], v241 offset:4096
    ds_read_b64_tr_b16 a[88:89], v242 offset:0
    ds_read_b64_tr_b16 a[90:91], v242 offset:4096
    ds_read_b64_tr_b16 a[92:93], v243 offset:0
    ds_read_b64_tr_b16 a[94:95], v243 offset:4096
    s_waitcnt vmcnt(20) lgkmcnt(15)
    v_fma_mix_f32 v232, v128, v200, v208 op_sel:[0,0,0] op_sel_hi:[1,0,0]
    v_fma_mix_f32 v233, v128, v201, v209 op_sel:[1,0,0] op_sel_hi:[1,0,0]
    v_cvt_pk_bf16_f32 v192, v232, v233
    v_fma_mix_f32 v234, v129, v202, v210 op_sel:[0,0,0] op_sel_hi:[1,0,0]
    v_fma_mix_f32 v235, v129, v203, v211 op_sel:[1,0,0] op_sel_hi:[1,0,0]
    v_cvt_pk_bf16_f32 v193, v234, v235
    v_fma_mix_f32 v232, v130, v204, v212 op_sel:[0,0,0] op_sel_hi:[1,0,0]
    v_fma_mix_f32 v233, v130, v205, v213 op_sel:[1,0,0] op_sel_hi:[1,0,0]
    v_cvt_pk_bf16_f32 v194, v232, v233
    v_fma_mix_f32 v234, v131, v206, v214 op_sel:[0,0,0] op_sel_hi:[1,0,0]
    v_fma_mix_f32 v235, v131, v207, v215 op_sel:[1,0,0] op_sel_hi:[1,0,0]
    v_cvt_pk_bf16_f32 v195, v234, v235
    s_waitcnt vmcnt(19)
    v_fma_mix_f32 v232, v132, v200, v208 op_sel:[0,0,0] op_sel_hi:[1,0,0]
    v_fma_mix_f32 v233, v132, v201, v209 op_sel:[1,0,0] op_sel_hi:[1,0,0]
    s_waitcnt lgkmcnt(0)
    s_mov_b32 s38, 3
L_attn_qp:
    s_waitcnt lgkmcnt(0)
    v_mfma_f32_16x16x32_bf16 v[0:3], a[64:67], v[192:195], v[0:3]
    ds_read_b64_tr_b16 a[96:97], v236 offset:8192
    v_cvt_pk_bf16_f32 v196, v232, v233
    v_mfma_f32_16x16x32_bf16 v[4:7], a[68:71], v[192:195], v[4:7]
    ds_read_b128 v[216:219], v254 offset:128
    v_fma_mix_f32 v234, v133, v202, v210 op_sel:[0,0,0] op_sel_hi:[1,0,0]
    v_fma_mix_f32 v235, v133, v203, v211 op_sel:[1,0,0] op_sel_hi:[1,0,0]
    v_mfma_f32_16x16x32_bf16 v[8:11], a[72:75], v[192:195], v[8:11]
    ds_read_b64_tr_b16 a[98:99], v236 offset:12288
    v_cvt_pk_bf16_f32 v197, v234, v235
    v_mfma_f32_16x16x32_bf16 v[12:15], a[76:79], v[192:195], v[12:15]
    ds_read_b128 v[224:227], v254 offset:2688
    v_fma_mix_f32 v232, v134, v204, v212 op_sel:[0,0,0] op_sel_hi:[1,0,0]
    v_fma_mix_f32 v233, v134, v205, v213 op_sel:[1,0,0] op_sel_hi:[1,0,0]
    v_mfma_f32_16x16x32_bf16 v[16:19], a[80:83], v[192:195], v[16:19]
    ds_read_b64_tr_b16 a[100:101], v237 offset:8192
    v_cvt_pk_bf16_f32 v198, v232, v233
    v_mfma_f32_16x16x32_bf16 v[20:23], a[84:87], v[192:195], v[20:23]
    v_fma_mix_f32 v234, v135, v206, v214 op_sel:[0,0,0] op_sel_hi:[1,0,0]
    v_fma_mix_f32 v235, v135, v207, v215 op_sel:[1,0,0] op_sel_hi:[1,0,0]
    v_mfma_f32_16x16x32_bf16 v[24:27], a[88:91], v[192:195], v[24:27]
    ds_read_b64_tr_b16 a[102:103], v237 offset:12288
    v_cvt_pk_bf16_f32 v199, v234, v235
    v_mfma_f32_16x16x32_bf16 v[28:31], a[92:95], v[192:195], v[28:31]
    buffer_load_dwordx4 v[128:131], v248, s[20:23], s44 offen offset:0
    s_waitcnt vmcnt(19)
    v_fma_mix_f32 v232, v136, v200, v208 op_sel:[0,0,0] op_sel_hi:[1,0,0]
    v_fma_mix_f32 v233, v136, v201, v209 op_sel:[1,0,0] op_sel_hi:[1,0,0]
    v_mfma_f32_16x16x32_bf16 v[32:35], a[64:67], v[196:199], v[32:35]
    ds_read_b64_tr_b16 a[104:105], v238 offset:8192
    v_cvt_pk_bf16_f32 v192, v232, v233
    v_mfma_f32_16x16x32_bf16 v[36:39], a[68:71], v[196:199], v[36:39]
    ds_read_b128 v[220:223], v254 offset:192
    v_fma_mix_f32 v234, v137, v202, v210 op_sel:[0,0,0] op_sel_hi:[1,0,0]
    v_fma_mix_f32 v235, v137, v203, v211 op_sel:[1,0,0] op_sel_hi:[1,0,0]
    v_mfma_f32_16x16x32_bf16 v[40:43], a[72:75], v[196:199], v[40:43]
    ds_read_b64_tr_b16 a[106:107], v238 offset:12288
    v_cvt_pk_bf16_f32 v193, v234, v235
    v_mfma_f32_16x16x32_bf16 v[44:47], a[76:79], v[196:199], v[44:47]
    ds_read_b128 v[228:231], v254 offset:2752
    v_fma_mix_f32 v232, v138, v204, v212 op_sel:[0,0,0] op_sel_hi:[1,0,0]
    v_fma_mix_f32 v233, v138, v205, v213 op_sel:[1,0,0] op_sel_hi:[1,0,0]
    v_mfma_f32_16x16x32_bf16 v[48:51], a[80:83], v[196:199], v[48:51]
    ds_read_b64_tr_b16 a[108:109], v239 offset:8192
    v_cvt_pk_bf16_f32 v194, v232, v233
    v_mfma_f32_16x16x32_bf16 v[52:55], a[84:87], v[196:199], v[52:55]
    v_fma_mix_f32 v234, v139, v206, v214 op_sel:[0,0,0] op_sel_hi:[1,0,0]
    v_fma_mix_f32 v235, v139, v207, v215 op_sel:[1,0,0] op_sel_hi:[1,0,0]
    v_mfma_f32_16x16x32_bf16 v[56:59], a[88:91], v[196:199], v[56:59]
    ds_read_b64_tr_b16 a[110:111], v239 offset:12288
    v_cvt_pk_bf16_f32 v195, v234, v235
    v_mfma_f32_16x16x32_bf16 v[60:63], a[92:95], v[196:199], v[60:63]
    buffer_load_dwordx4 v[132:135], v248, s[20:23], s45 offen offset:0
    s_waitcnt vmcnt(19)
    v_fma_mix_f32 v232, v140, v200, v208 op_sel:[0,0,0] op_sel_hi:[1,0,0]
    v_fma_mix_f32 v233, v140, v201, v209 op_sel:[1,0,0] op_sel_hi:[1,0,0]
    v_mfma_f32_16x16x32_bf16 v[64:67], a[64:67], v[192:195], v[64:67]
    ds_read_b64_tr_b16 a[112:113], v240 offset:8192
    v_cvt_pk_bf16_f32 v196, v232, v233
    v_mfma_f32_16x16x32_bf16 v[68:71], a[68:71], v[192:195], v[68:71]
    ds_read_b64_tr_b16 a[120:121], v242 offset:8192
    v_fma_mix_f32 v234, v141, v202, v210 op_sel:[0,0,0] op_sel_hi:[1,0,0]
    v_fma_mix_f32 v235, v141, v203, v211 op_sel:[1,0,0] op_sel_hi:[1,0,0]
    v_mfma_f32_16x16x32_bf16 v[72:75], a[72:75], v[192:195], v[72:75]
    ds_read_b64_tr_b16 a[114:115], v240 offset:12288
    v_cvt_pk_bf16_f32 v197, v234, v235
    v_mfma_f32_16x16x32_bf16 v[76:79], a[76:79], v[192:195], v[76:79]
    ds_read_b64_tr_b16 a[122:123], v242 offset:12288
    v_fma_mix_f32 v232, v142, v204, v212 op_sel:[0,0,0] op_sel_hi:[1,0,0]
    v_fma_mix_f32 v233, v142, v205, v213 op_sel:[1,0,0] op_sel_hi:[1,0,0]
    v_mfma_f32_16x16x32_bf16 v[80:83], a[80:83], v[192:195], v[80:83]
    ds_read_b64_tr_b16 a[116:117], v241 offset:8192
    v_cvt_pk_bf16_f32 v198, v232, v233
    v_mfma_f32_16x16x32_bf16 v[84:87], a[84:87], v[192:195], v[84:87]
    v_fma_mix_f32 v234, v143, v206, v214 op_sel:[0,0,0] op_sel_hi:[1,0,0]
    v_fma_mix_f32 v235, v143, v207, v215 op_sel:[1,0,0] op_sel_hi:[1,0,0]
    v_mfma_f32_16x16x32_bf16 v[88:91], a[88:91], v[192:195], v[88:91]
    ds_read_b64_tr_b16 a[118:119], v241 offset:12288
    v_cvt_pk_bf16_f32 v199, v234, v235
    v_mfma_f32_16x16x32_bf16 v[92:95], a[92:95], v[192:195], v[92:95]
    buffer_load_dwordx4 v[136:139], v248, s[20:23], s46 offen offset:0
    s_waitcnt vmcnt(18) lgkmcnt(14)
    v_fma_mix_f32 v232, v144, v216, v224 op_sel:[0,0,0] op_sel_hi:[1,0,0]
    v_fma_mix_f32 v233, v144, v217, v225 op_sel:[1,0,0] op_sel_hi:[1,0,0]
    v_mfma_f32_16x16x32_bf16 v[96:99], a[64:67], v[196:199], v[96:99]
    ds_read_b64_tr_b16 a[124:125], v243 offset:8192
    v_cvt_pk_bf16_f32 v192, v232, v233
    v_mfma_f32_16x16x32_bf16 v[100:103], a[68:71], v[196:199], v[100:103]
    ds_read_b64_tr_b16 a[126:127], v243 offset:12288
    v_fma_mix_f32 v234, v145, v218, v226 op_sel:[0,0,0] op_sel_hi:[1,0,0]
    v_fma_mix_f32 v235, v145, v219, v227 op_sel:[1,0,0] op_sel_hi:[1,0,0]
    v_mfma_f32_16x16x32_bf16 v[104:107], a[72:75], v[196:199], v[104:107]
    v_cvt_pk_bf16_f32 v193, v234, v235
    v_mfma_f32_16x16x32_bf16 v[108:111], a[76:79], v[196:199], v[108:111]
    s_waitcnt lgkmcnt(10)
    v_fma_mix_f32 v232, v146, v220, v228 op_sel:[0,0,0] op_sel_hi:[1,0,0]
    v_fma_mix_f32 v233, v146, v221, v229 op_sel:[1,0,0] op_sel_hi:[1,0,0]
    v_mfma_f32_16x16x32_bf16 v[112:115], a[80:83], v[196:199], v[112:115]
    v_cvt_pk_bf16_f32 v194, v232, v233
    v_mfma_f32_16x16x32_bf16 v[116:119], a[84:87], v[196:199], v[116:119]
    v_fma_mix_f32 v234, v147, v222, v230 op_sel:[0,0,0] op_sel_hi:[1,0,0]
    v_fma_mix_f32 v235, v147, v223, v231 op_sel:[1,0,0] op_sel_hi:[1,0,0]
    v_mfma_f32_16x16x32_bf16 v[120:123], a[88:91], v[196:199], v[120:123]
    v_cvt_pk_bf16_f32 v195, v234, v235
    v_mfma_f32_16x16x32_bf16 v[124:127], a[92:95], v[196:199], v[124:127]
    buffer_load_dwordx4 v[140:143], v248, s[20:23], s47 offen offset:0
    s_waitcnt vmcnt(18)
    v_fma_mix_f32 v232, v148, v216, v224 op_sel:[0,0,0] op_sel_hi:[1,0,0]
    v_fma_mix_f32 v233, v148, v217, v225 op_sel:[1,0,0] op_sel_hi:[1,0,0]
    s_waitcnt lgkmcnt(0)
    v_mfma_f32_16x16x32_bf16 v[0:3], a[96:99], v[192:195], v[0:3]
    s_waitcnt vmcnt(17)
    s_barrier
    ds_read_b64_tr_b16 a[64:65], v236 offset:16384
    v_cvt_pk_bf16_f32 v196, v232, v233
    v_mfma_f32_16x16x32_bf16 v[4:7], a[100:103], v[192:195], v[4:7]
    ds_read_b128 v[200:203], v254 offset:256
    v_fma_mix_f32 v234, v149, v218, v226 op_sel:[0,0,0] op_sel_hi:[1,0,0]
    v_fma_mix_f32 v235, v149, v219, v227 op_sel:[1,0,0] op_sel_hi:[1,0,0]
    v_mfma_f32_16x16x32_bf16 v[8:11], a[104:107], v[192:195], v[8:11]
    ds_read_b64_tr_b16 a[66:67], v236 offset:20480
    v_cvt_pk_bf16_f32 v197, v234, v235
    v_mfma_f32_16x16x32_bf16 v[12:15], a[108:111], v[192:195], v[12:15]
    ds_read_b128 v[208:211], v254 offset:2816
    v_fma_mix_f32 v232, v150, v220, v228 op_sel:[0,0,0] op_sel_hi:[1,0,0]
    v_fma_mix_f32 v233, v150, v221, v229 op_sel:[1,0,0] op_sel_hi:[1,0,0]
    v_mfma_f32_16x16x32_bf16 v[16:19], a[112:115], v[192:195], v[16:19]
    ds_read_b64_tr_b16 a[68:69], v237 offset:16384
    v_cvt_pk_bf16_f32 v198, v232, v233
    v_mfma_f32_16x16x32_bf16 v[20:23], a[116:119], v[192:195], v[20:23]
    s_mov_b32 m0, s51
    s_add_u32 s49, s48, 0
    buffer_load_dwordx4 v250, s[16:19], s49 offen offset:0 lds
    v_fma_mix_f32 v234, v151, v222, v230 op_sel:[0,0,0] op_sel_hi:[1,0,0]
    v_fma_mix_f32 v235, v151, v223, v231 op_sel:[1,0,0] op_sel_hi:[1,0,0]
    v_mfma_f32_16x16x32_bf16 v[24:27], a[120:123], v[192:195], v[24:27]
    ds_read_b64_tr_b16 a[70:71], v237 offset:20480
    v_cvt_pk_bf16_f32 v199, v234, v235
    v_mfma_f32_16x16x32_bf16 v[28:31], a[124:127], v[192:195], v[28:31]
    buffer_load_dwordx4 v[144:147], v248, s[20:23], s44 offen offset:1024
    s_waitcnt vmcnt(19)
    v_fma_mix_f32 v232, v152, v216, v224 op_sel:[0,0,0] op_sel_hi:[1,0,0]
    v_fma_mix_f32 v233, v152, v217, v225 op_sel:[1,0,0] op_sel_hi:[1,0,0]
    v_mfma_f32_16x16x32_bf16 v[32:35], a[96:99], v[196:199], v[32:35]
    ds_read_b64_tr_b16 a[72:73], v238 offset:16384
    v_cvt_pk_bf16_f32 v192, v232, v233
    v_mfma_f32_16x16x32_bf16 v[36:39], a[100:103], v[196:199], v[36:39]
    ds_read_b128 v[204:207], v254 offset:320
    v_fma_mix_f32 v234, v153, v218, v226 op_sel:[0,0,0] op_sel_hi:[1,0,0]
    v_fma_mix_f32 v235, v153, v219, v227 op_sel:[1,0,0] op_sel_hi:[1,0,0]
    v_mfma_f32_16x16x32_bf16 v[40:43], a[104:107], v[196:199], v[40:43]
    ds_read_b64_tr_b16 a[74:75], v238 offset:20480
    v_cvt_pk_bf16_f32 v193, v234, v235
    v_mfma_f32_16x16x32_bf16 v[44:47], a[108:111], v[196:199], v[44:47]
    ds_read_b128 v[212:215], v254 offset:2880
    v_fma_mix_f32 v232, v154, v220, v228 op_sel:[0,0,0] op_sel_hi:[1,0,0]
    v_fma_mix_f32 v233, v154, v221, v229 op_sel:[1,0,0] op_sel_hi:[1,0,0]
    v_mfma_f32_16x16x32_bf16 v[48:51], a[112:115], v[196:199], v[48:51]
    ds_read_b64_tr_b16 a[76:77], v239 offset:16384
    v_cvt_pk_bf16_f32 v194, v232, v233
    v_mfma_f32_16x16x32_bf16 v[52:55], a[116:119], v[196:199], v[52:55]
    s_add_u32 s49, s48, 31744
    buffer_load_dwordx4 v251, s[16:19], s49 offen offset:1024 lds
    v_fma_mix_f32 v234, v155, v222, v230 op_sel:[0,0,0] op_sel_hi:[1,0,0]
    v_fma_mix_f32 v235, v155, v223, v231 op_sel:[1,0,0] op_sel_hi:[1,0,0]
    v_mfma_f32_16x16x32_bf16 v[56:59], a[120:123], v[196:199], v[56:59]
    ds_read_b64_tr_b16 a[78:79], v239 offset:20480
    v_cvt_pk_bf16_f32 v195, v234, v235
    v_mfma_f32_16x16x32_bf16 v[60:63], a[124:127], v[196:199], v[60:63]
    buffer_load_dwordx4 v[148:151], v248, s[20:23], s45 offen offset:1024
    s_waitcnt vmcnt(20)
    v_fma_mix_f32 v232, v156, v216, v224 op_sel:[0,0,0] op_sel_hi:[1,0,0]
    v_fma_mix_f32 v233, v156, v217, v225 op_sel:[1,0,0] op_sel_hi:[1,0,0]
    v_mfma_f32_16x16x32_bf16 v[64:67], a[96:99], v[192:195], v[64:67]
    ds_read_b64_tr_b16 a[80:81], v240 offset:16384
    v_cvt_pk_bf16_f32 v196, v232, v233
    v_mfma_f32_16x16x32_bf16 v[68:71], a[100:103], v[192:195], v[68:71]
    ds_read_b64_tr_b16 a[88:89], v242 offset:16384
    v_fma_mix_f32 v234, v157, v218, v226 op_sel:[0,0,0] op_sel_hi:[1,0,0]
    v_fma_mix_f32 v235, v157, v219, v227 op_sel:[1,0,0] op_sel_hi:[1,0,0]
    v_mfma_f32_16x16x32_bf16 v[72:75], a[104:107], v[192:195], v[72:75]
    ds_read_b64_tr_b16 a[82:83], v240 offset:20480
    v_cvt_pk_bf16_f32 v197, v234, v235
    v_mfma_f32_16x16x32_bf16 v[76:79], a[108:111], v[192:195], v[76:79]
    ds_read_b64_tr_b16 a[90:91], v242 offset:20480
    v_fma_mix_f32 v232, v158, v220, v228 op_sel:[0,0,0] op_sel_hi:[1,0,0]
    v_fma_mix_f32 v233, v158, v221, v229 op_sel:[1,0,0] op_sel_hi:[1,0,0]
    v_mfma_f32_16x16x32_bf16 v[80:83], a[112:115], v[192:195], v[80:83]
    ds_read_b64_tr_b16 a[84:85], v241 offset:16384
    v_cvt_pk_bf16_f32 v198, v232, v233
    v_mfma_f32_16x16x32_bf16 v[84:87], a[116:119], v[192:195], v[84:87]
    s_add_u32 s49, s48, 63488
    buffer_load_dwordx4 v250, s[16:19], s49 offen offset:2048 lds
    v_fma_mix_f32 v234, v159, v222, v230 op_sel:[0,0,0] op_sel_hi:[1,0,0]
    v_fma_mix_f32 v235, v159, v223, v231 op_sel:[1,0,0] op_sel_hi:[1,0,0]
    v_mfma_f32_16x16x32_bf16 v[88:91], a[120:123], v[192:195], v[88:91]
    ds_read_b64_tr_b16 a[86:87], v241 offset:20480
    v_cvt_pk_bf16_f32 v199, v234, v235
    v_mfma_f32_16x16x32_bf16 v[92:95], a[124:127], v[192:195], v[92:95]
    buffer_load_dwordx4 v[152:155], v248, s[20:23], s46 offen offset:1024
    s_waitcnt vmcnt(21) lgkmcnt(14)
    v_fma_mix_f32 v232, v160, v200, v208 op_sel:[0,0,0] op_sel_hi:[1,0,0]
    v_fma_mix_f32 v233, v160, v201, v209 op_sel:[1,0,0] op_sel_hi:[1,0,0]
    v_mfma_f32_16x16x32_bf16 v[96:99], a[96:99], v[196:199], v[96:99]
    ds_read_b64_tr_b16 a[92:93], v243 offset:16384
    v_cvt_pk_bf16_f32 v192, v232, v233
    v_mfma_f32_16x16x32_bf16 v[100:103], a[100:103], v[196:199], v[100:103]
    ds_read_b64_tr_b16 a[94:95], v243 offset:20480
    v_fma_mix_f32 v234, v161, v202, v210 op_sel:[0,0,0] op_sel_hi:[1,0,0]
    v_fma_mix_f32 v235, v161, v203, v211 op_sel:[1,0,0] op_sel_hi:[1,0,0]
    v_mfma_f32_16x16x32_bf16 v[104:107], a[104:107], v[196:199], v[104:107]
    v_cvt_pk_bf16_f32 v193, v234, v235
    v_mfma_f32_16x16x32_bf16 v[108:111], a[108:111], v[196:199], v[108:111]
    s_waitcnt lgkmcnt(10)
    v_fma_mix_f32 v232, v162, v204, v212 op_sel:[0,0,0] op_sel_hi:[1,0,0]
    v_fma_mix_f32 v233, v162, v205, v213 op_sel:[1,0,0] op_sel_hi:[1,0,0]
    v_mfma_f32_16x16x32_bf16 v[112:115], a[112:115], v[196:199], v[112:115]
    v_cvt_pk_bf16_f32 v194, v232, v233
    v_mfma_f32_16x16x32_bf16 v[116:119], a[116:119], v[196:199], v[116:119]
    s_add_u32 s49, s48, 95232
    buffer_load_dwordx4 v251, s[16:19], s49 offen offset:3072 lds
    s_add_u32 s48, s48, 524288
    v_fma_mix_f32 v234, v163, v206, v214 op_sel:[0,0,0] op_sel_hi:[1,0,0]
    v_fma_mix_f32 v235, v163, v207, v215 op_sel:[1,0,0] op_sel_hi:[1,0,0]
    v_mfma_f32_16x16x32_bf16 v[120:123], a[120:123], v[196:199], v[120:123]
    v_cvt_pk_bf16_f32 v195, v234, v235
    v_mfma_f32_16x16x32_bf16 v[124:127], a[124:127], v[196:199], v[124:127]
    buffer_load_dwordx4 v[156:159], v248, s[20:23], s47 offen offset:1024
    s_waitcnt vmcnt(22)
    v_fma_mix_f32 v232, v164, v200, v208 op_sel:[0,0,0] op_sel_hi:[1,0,0]
    v_fma_mix_f32 v233, v164, v201, v209 op_sel:[1,0,0] op_sel_hi:[1,0,0]
    s_waitcnt lgkmcnt(0)
    v_mfma_f32_16x16x32_bf16 v[0:3], a[64:67], v[192:195], v[0:3]
    ds_read_b64_tr_b16 a[96:97], v236 offset:24576
    v_cvt_pk_bf16_f32 v196, v232, v233
    v_mfma_f32_16x16x32_bf16 v[4:7], a[68:71], v[192:195], v[4:7]
    ds_read_b128 v[216:219], v254 offset:384
    v_fma_mix_f32 v234, v165, v202, v210 op_sel:[0,0,0] op_sel_hi:[1,0,0]
    v_fma_mix_f32 v235, v165, v203, v211 op_sel:[1,0,0] op_sel_hi:[1,0,0]
    v_mfma_f32_16x16x32_bf16 v[8:11], a[72:75], v[192:195], v[8:11]
    ds_read_b64_tr_b16 a[98:99], v236 offset:28672
    v_cvt_pk_bf16_f32 v197, v234, v235
    v_mfma_f32_16x16x32_bf16 v[12:15], a[76:79], v[192:195], v[12:15]
    ds_read_b128 v[224:227], v254 offset:2944
    v_fma_mix_f32 v232, v166, v204, v212 op_sel:[0,0,0] op_sel_hi:[1,0,0]
    v_fma_mix_f32 v233, v166, v205, v213 op_sel:[1,0,0] op_sel_hi:[1,0,0]
    v_mfma_f32_16x16x32_bf16 v[16:19], a[80:83], v[192:195], v[16:19]
    ds_read_b64_tr_b16 a[100:101], v237 offset:24576
    v_cvt_pk_bf16_f32 v198, v232, v233
    v_mfma_f32_16x16x32_bf16 v[20:23], a[84:87], v[192:195], v[20:23]
    v_fma_mix_f32 v234, v167, v206, v214 op_sel:[0,0,0] op_sel_hi:[1,0,0]
    v_fma_mix_f32 v235, v167, v207, v215 op_sel:[1,0,0] op_sel_hi:[1,0,0]
    v_mfma_f32_16x16x32_bf16 v[24:27], a[88:91], v[192:195], v[24:27]
    ds_read_b64_tr_b16 a[102:103], v237 offset:28672
    v_cvt_pk_bf16_f32 v199, v234, v235
    v_mfma_f32_16x16x32_bf16 v[28:31], a[92:95], v[192:195], v[28:31]
    buffer_load_dwordx4 v[160:163], v248, s[20:23], s44 offen offset:2048
    s_waitcnt vmcnt(22)
    v_fma_mix_f32 v232, v168, v200, v208 op_sel:[0,0,0] op_sel_hi:[1,0,0]
    v_fma_mix_f32 v233, v168, v201, v209 op_sel:[1,0,0] op_sel_hi:[1,0,0]
    v_mfma_f32_16x16x32_bf16 v[32:35], a[64:67], v[196:199], v[32:35]
    ds_read_b64_tr_b16 a[104:105], v238 offset:24576
    v_cvt_pk_bf16_f32 v192, v232, v233
    v_mfma_f32_16x16x32_bf16 v[36:39], a[68:71], v[196:199], v[36:39]
    ds_read_b128 v[220:223], v254 offset:448
    v_fma_mix_f32 v234, v169, v202, v210 op_sel:[0,0,0] op_sel_hi:[1,0,0]
    v_fma_mix_f32 v235, v169, v203, v211 op_sel:[1,0,0] op_sel_hi:[1,0,0]
    v_mfma_f32_16x16x32_bf16 v[40:43], a[72:75], v[196:199], v[40:43]
    ds_read_b64_tr_b16 a[106:107], v238 offset:28672
    v_cvt_pk_bf16_f32 v193, v234, v235
    v_mfma_f32_16x16x32_bf16 v[44:47], a[76:79], v[196:199], v[44:47]
    ds_read_b128 v[228:231], v254 offset:3008
    v_fma_mix_f32 v232, v170, v204, v212 op_sel:[0,0,0] op_sel_hi:[1,0,0]
    v_fma_mix_f32 v233, v170, v205, v213 op_sel:[1,0,0] op_sel_hi:[1,0,0]
    v_mfma_f32_16x16x32_bf16 v[48:51], a[80:83], v[196:199], v[48:51]
    ds_read_b64_tr_b16 a[108:109], v239 offset:24576
    v_cvt_pk_bf16_f32 v194, v232, v233
    v_mfma_f32_16x16x32_bf16 v[52:55], a[84:87], v[196:199], v[52:55]
    v_fma_mix_f32 v234, v171, v206, v214 op_sel:[0,0,0] op_sel_hi:[1,0,0]
    v_fma_mix_f32 v235, v171, v207, v215 op_sel:[1,0,0] op_sel_hi:[1,0,0]
    v_mfma_f32_16x16x32_bf16 v[56:59], a[88:91], v[196:199], v[56:59]
    ds_read_b64_tr_b16 a[110:111], v239 offset:28672
    v_cvt_pk_bf16_f32 v195, v234, v235
    v_mfma_f32_16x16x32_bf16 v[60:63], a[92:95], v[196:199], v[60:63]
    buffer_load_dwordx4 v[164:167], v248, s[20:23], s45 offen offset:2048
    s_waitcnt vmcnt(22)
    v_fma_mix_f32 v232, v172, v200, v208 op_sel:[0,0,0] op_sel_hi:[1,0,0]
    v_fma_mix_f32 v233, v172, v201, v209 op_sel:[1,0,0] op_sel_hi:[1,0,0]
    v_mfma_f32_16x16x32_bf16 v[64:67], a[64:67], v[192:195], v[64:67]
    ds_read_b64_tr_b16 a[112:113], v240 offset:24576
    v_cvt_pk_bf16_f32 v196, v232, v233
    v_mfma_f32_16x16x32_bf16 v[68:71], a[68:71], v[192:195], v[68:71]
    ds_read_b64_tr_b16 a[120:121], v242 offset:24576
    v_fma_mix_f32 v234, v173, v202, v210 op_sel:[0,0,0] op_sel_hi:[1,0,0]
    v_fma_mix_f32 v235, v173, v203, v211 op_sel:[1,0,0] op_sel_hi:[1,0,0]
    v_mfma_f32_16x16x32_bf16 v[72:75], a[72:75], v[192:195], v[72:75]
    ds_read_b64_tr_b16 a[114:115], v240 offset:28672
    v_cvt_pk_bf16_f32 v197, v234, v235
    v_mfma_f32_16x16x32_bf16 v[76:79], a[76:79], v[192:195], v[76:79]
    ds_read_b64_tr_b16 a[122:123], v242 offset:28672
    v_fma_mix_f32 v232, v174, v204, v212 op_sel:[0,0,0] op_sel_hi:[1,0,0]
    v_fma_mix_f32 v233, v174, v205, v213 op_sel:[1,0,0] op_sel_hi:[1,0,0]
    v_mfma_f32_16x16x32_bf16 v[80:83], a[80:83], v[192:195], v[80:83]
    ds_read_b64_tr_b16 a[116:117], v241 offset:24576
    v_cvt_pk_bf16_f32 v198, v232, v233
    v_mfma_f32_16x16x32_bf16 v[84:87], a[84:87], v[192:195], v[84:87]
    v_fma_mix_f32 v234, v175, v206, v214 op_sel:[0,0,0] op_sel_hi:[1,0,0]
    v_fma_mix_f32 v235, v175, v207, v215 op_sel:[1,0,0] op_sel_hi:[1,0,0]
    v_mfma_f32_16x16x32_bf16 v[88:91], a[88:91], v[192:195], v[88:91]
    ds_read_b64_tr_b16 a[118:119], v241 offset:28672
    v_cvt_pk_bf16_f32 v199, v234, v235
    v_mfma_f32_16x16x32_bf16 v[92:95], a[92:95], v[192:195], v[92:95]
    buffer_load_dwordx4 v[168:171], v248, s[20:23], s46 offen offset:2048
    s_waitcnt vmcnt(21) lgkmcnt(14)
    v_fma_mix_f32 v232, v176, v216, v224 op_sel:[0,0,0] op_sel_hi:[1,0,0]
    v_fma_mix_f32 v233, v176, v217, v225 op_sel:[1,0,0] op_sel_hi:[1,0,0]
    v_mfma_f32_16x16x32_bf16 v[96:99], a[64:67], v[196:199], v[96:99]
    ds_read_b64_tr_b16 a[124:125], v243 offset:24576
    v_cvt_pk_bf16_f32 v192, v232, v233
    v_mfma_f32_16x16x32_bf16 v[100:103], a[68:71], v[196:199], v[100:103]
    ds_read_b64_tr_b16 a[126:127], v243 offset:28672
    v_fma_mix_f32 v234, v177, v218, v226 op_sel:[0,0,0] op_sel_hi:[1,0,0]
    v_fma_mix_f32 v235, v177, v219, v227 op_sel:[1,0,0] op_sel_hi:[1,0,0]
    v_mfma_f32_16x16x32_bf16 v[104:107], a[72:75], v[196:199], v[104:107]
    v_cvt_pk_bf16_f32 v193, v234, v235
    v_mfma_f32_16x16x32_bf16 v[108:111], a[76:79], v[196:199], v[108:111]
    s_waitcnt lgkmcnt(10)
    v_fma_mix_f32 v232, v178, v220, v228 op_sel:[0,0,0] op_sel_hi:[1,0,0]
    v_fma_mix_f32 v233, v178, v221, v229 op_sel:[1,0,0] op_sel_hi:[1,0,0]
    v_mfma_f32_16x16x32_bf16 v[112:115], a[80:83], v[196:199], v[112:115]
    v_cvt_pk_bf16_f32 v194, v232, v233
    v_mfma_f32_16x16x32_bf16 v[116:119], a[84:87], v[196:199], v[116:119]
    v_fma_mix_f32 v234, v179, v222, v230 op_sel:[0,0,0] op_sel_hi:[1,0,0]
    v_fma_mix_f32 v235, v179, v223, v231 op_sel:[1,0,0] op_sel_hi:[1,0,0]
    v_mfma_f32_16x16x32_bf16 v[120:123], a[88:91], v[196:199], v[120:123]
    v_cvt_pk_bf16_f32 v195, v234, v235
    v_mfma_f32_16x16x32_bf16 v[124:127], a[92:95], v[196:199], v[124:127]
    buffer_load_dwordx4 v[172:175], v248, s[20:23], s47 offen offset:2048
    s_waitcnt vmcnt(20)
    v_fma_mix_f32 v232, v180, v216, v224 op_sel:[0,0,0] op_sel_hi:[1,0,0]
    v_fma_mix_f32 v233, v180, v217, v225 op_sel:[1,0,0] op_sel_hi:[1,0,0]
    s_waitcnt lgkmcnt(0)
    v_mfma_f32_16x16x32_bf16 v[0:3], a[96:99], v[192:195], v[0:3]
    s_waitcnt vmcnt(16)
    s_barrier
    v_add_u32 v254, 512, v254
    v_xor_b32 v236, 0x8000, v236
    v_xor_b32 v237, 0x8000, v237
    v_xor_b32 v238, 0x8000, v238
    v_xor_b32 v239, 0x8000, v239
    v_xor_b32 v240, 0x8000, v240
    v_xor_b32 v241, 0x8000, v241
    v_xor_b32 v242, 0x8000, v242
    v_xor_b32 v243, 0x8000, v243
    ds_read_b64_tr_b16 a[64:65], v236 offset:0
    v_cvt_pk_bf16_f32 v196, v232, v233
    v_mfma_f32_16x16x32_bf16 v[4:7], a[100:103], v[192:195], v[4:7]
    ds_read_b128 v[200:203], v254 offset:0
    v_fma_mix_f32 v234, v181, v218, v226 op_sel:[0,0,0] op_sel_hi:[1,0,0]
    v_fma_mix_f32 v235, v181, v219, v227 op_sel:[1,0,0] op_sel_hi:[1,0,0]
    v_mfma_f32_16x16x32_bf16 v[8:11], a[104:107], v[192:195], v[8:11]
    ds_read_b64_tr_b16 a[66:67], v236 offset:4096
    v_cvt_pk_bf16_f32 v197, v234, v235
    v_mfma_f32_16x16x32_bf16 v[12:15], a[108:111], v[192:195], v[12:15]
    ds_read_b128 v[208:211], v254 offset:2560
    v_fma_mix_f32 v232, v182, v220, v228 op_sel:[0,0,0] op_sel_hi:[1,0,0]
    v_fma_mix_f32 v233, v182, v221, v229 op_sel:[1,0,0] op_sel_hi:[1,0,0]
    v_mfma_f32_16x16x32_bf16 v[16:19], a[112:115], v[192:195], v[16:19]
    ds_read_b64_tr_b16 a[68:69], v237 offset:0
    v_cvt_pk_bf16_f32 v198, v232, v233
    v_mfma_f32_16x16x32_bf16 v[20:23], a[116:119], v[192:195], v[20:23]
    s_mov_b32 m0, s52
    s_add_u32 s49, s48, 0
    buffer_load_dwordx4 v250, s[16:19], s49 offen offset:0 lds
    v_fma_mix_f32 v234, v183, v222, v230 op_sel:[0,0,0] op_sel_hi:[1,0,0]
    v_fma_mix_f32 v235, v183, v223, v231 op_sel:[1,0,0] op_sel_hi:[1,0,0]
    v_mfma_f32_16x16x32_bf16 v[24:27], a[120:123], v[192:195], v[24:27]
    ds_read_b64_tr_b16 a[70:71], v237 offset:4096
    v_cvt_pk_bf16_f32 v199, v234, v235
    v_mfma_f32_16x16x32_bf16 v[28:31], a[124:127], v[192:195], v[28:31]
    buffer_load_dwordx4 v[176:179], v248, s[20:23], s44 offen offset:3072
    v_fma_mix_f32 v232, v184, v216, v224 op_sel:[0,0,0] op_sel_hi:[1,0,0]
    v_fma_mix_f32 v233, v184, v217, v225 op_sel:[1,0,0] op_sel_hi:[1,0,0]
    v_mfma_f32_16x16x32_bf16 v[32:35], a[96:99], v[196:199], v[32:35]
    ds_read_b64_tr_b16 a[72:73], v238 offset:0
    v_cvt_pk_bf16_f32 v192, v232, v233
    v_mfma_f32_16x16x32_bf16 v[36:39], a[100:103], v[196:199], v[36:39]
    ds_read_b128 v[204:207], v254 offset:64
    v_fma_mix_f32 v234, v185, v218, v226 op_sel:[0,0,0] op_sel_hi:[1,0,0]
    v_fma_mix_f32 v235, v185, v219, v227 op_sel:[1,0,0] op_sel_hi:[1,0,0]
    v_mfma_f32_16x16x32_bf16 v[40:43], a[104:107], v[196:199], v[40:43]
    ds_read_b64_tr_b16 a[74:75], v238 offset:4096
    v_cvt_pk_bf16_f32 v193, v234, v235
    v_mfma_f32_16x16x32_bf16 v[44:47], a[108:111], v[196:199], v[44:47]
    ds_read_b128 v[212:215], v254 offset:2624
    v_fma_mix_f32 v232, v186, v220, v228 op_sel:[0,0,0] op_sel_hi:[1,0,0]
    v_fma_mix_f32 v233, v186, v221, v229 op_sel:[1,0,0] op_sel_hi:[1,0,0]
    v_mfma_f32_16x16x32_bf16 v[48:51], a[112:115], v[196:199], v[48:51]
    ds_read_b64_tr_b16 a[76:77], v239 offset:0
    v_cvt_pk_bf16_f32 v194, v232, v233
    v_mfma_f32_16x16x32_bf16 v[52:55], a[116:119], v[196:199], v[52:55]
    s_add_u32 s49, s48, 31744
    buffer_load_dwordx4 v251, s[16:19], s49 offen offset:1024 lds
    v_fma_mix_f32 v234, v187, v222, v230 op_sel:[0,0,0] op_sel_hi:[1,0,0]
    v_fma_mix_f32 v235, v187, v223, v231 op_sel:[1,0,0] op_sel_hi:[1,0,0]
    v_mfma_f32_16x16x32_bf16 v[56:59], a[120:123], v[196:199], v[56:59]
    ds_read_b64_tr_b16 a[78:79], v239 offset:4096
    v_cvt_pk_bf16_f32 v195, v234, v235
    v_mfma_f32_16x16x32_bf16 v[60:63], a[124:127], v[196:199], v[60:63]
    buffer_load_dwordx4 v[180:183], v248, s[20:23], s45 offen offset:3072
    s_waitcnt vmcnt(20)
    v_fma_mix_f32 v232, v188, v216, v224 op_sel:[0,0,0] op_sel_hi:[1,0,0]
    v_fma_mix_f32 v233, v188, v217, v225 op_sel:[1,0,0] op_sel_hi:[1,0,0]
    v_mfma_f32_16x16x32_bf16 v[64:67], a[96:99], v[192:195], v[64:67]
    ds_read_b64_tr_b16 a[80:81], v240 offset:0
    v_cvt_pk_bf16_f32 v196, v232, v233
    v_mfma_f32_16x16x32_bf16 v[68:71], a[100:103], v[192:195], v[68:71]
    ds_read_b64_tr_b16 a[88:89], v242 offset:0
    v_fma_mix_f32 v234, v189, v218, v226 op_sel:[0,0,0] op_sel_hi:[1,0,0]
    v_fma_mix_f32 v235, v189, v219, v227 op_sel:[1,0,0] op_sel_hi:[1,0,0]
    v_mfma_f32_16x16x32_bf16 v[72:75], a[104:107], v[192:195], v[72:75]
    ds_read_b64_tr_b16 a[82:83], v240 offset:4096
    v_cvt_pk_bf16_f32 v197, v234, v235
    v_mfma_f32_16x16x32_bf16 v[76:79], a[108:111], v[192:195], v[76:79]
    ds_read_b64_tr_b16 a[90:91], v242 offset:4096
    v_fma_mix_f32 v232, v190, v220, v228 op_sel:[0,0,0] op_sel_hi:[1,0,0]
    v_fma_mix_f32 v233, v190, v221, v229 op_sel:[1,0,0] op_sel_hi:[1,0,0]
    v_mfma_f32_16x16x32_bf16 v[80:83], a[112:115], v[192:195], v[80:83]
    ds_read_b64_tr_b16 a[84:85], v241 offset:0
    v_cvt_pk_bf16_f32 v198, v232, v233
    v_mfma_f32_16x16x32_bf16 v[84:87], a[116:119], v[192:195], v[84:87]
    s_add_u32 s49, s48, 63488
    buffer_load_dwordx4 v250, s[16:19], s49 offen offset:2048 lds
    v_fma_mix_f32 v234, v191, v222, v230 op_sel:[0,0,0] op_sel_hi:[1,0,0]
    v_fma_mix_f32 v235, v191, v223, v231 op_sel:[1,0,0] op_sel_hi:[1,0,0]
    v_mfma_f32_16x16x32_bf16 v[88:91], a[120:123], v[192:195], v[88:91]
    ds_read_b64_tr_b16 a[86:87], v241 offset:4096
    v_cvt_pk_bf16_f32 v199, v234, v235
    v_mfma_f32_16x16x32_bf16 v[92:95], a[124:127], v[192:195], v[92:95]
    buffer_load_dwordx4 v[184:187], v248, s[20:23], s46 offen offset:3072
    s_waitcnt vmcnt(21) lgkmcnt(14)
    v_fma_mix_f32 v232, v128, v200, v208 op_sel:[0,0,0] op_sel_hi:[1,0,0]
    v_fma_mix_f32 v233, v128, v201, v209 op_sel:[1,0,0] op_sel_hi:[1,0,0]
    v_mfma_f32_16x16x32_bf16 v[96:99], a[96:99], v[196:199], v[96:99]
    ds_read_b64_tr_b16 a[92:93], v243 offset:0
    v_cvt_pk_bf16_f32 v192, v232, v233
    v_mfma_f32_16x16x32_bf16 v[100:103], a[100:103], v[196:199], v[100:103]
    ds_read_b64_tr_b16 a[94:95], v243 offset:4096
    v_fma_mix_f32 v234, v129, v202, v210 op_sel:[0,0,0] op_sel_hi:[1,0,0]
    v_fma_mix_f32 v235, v129, v203, v211 op_sel:[1,0,0] op_sel_hi:[1,0,0]
    v_mfma_f32_16x16x32_bf16 v[104:107], a[104:107], v[196:199], v[104:107]
    v_cvt_pk_bf16_f32 v193, v234, v235
    v_mfma_f32_16x16x32_bf16 v[108:111], a[108:111], v[196:199], v[108:111]
    s_waitcnt lgkmcnt(10)
    v_fma_mix_f32 v232, v130, v204, v212 op_sel:[0,0,0] op_sel_hi:[1,0,0]
    v_fma_mix_f32 v233, v130, v205, v213 op_sel:[1,0,0] op_sel_hi:[1,0,0]
    v_mfma_f32_16x16x32_bf16 v[112:115], a[112:115], v[196:199], v[112:115]
    v_cvt_pk_bf16_f32 v194, v232, v233
    v_mfma_f32_16x16x32_bf16 v[116:119], a[116:119], v[196:199], v[116:119]
    s_add_u32 s49, s48, 95232
    buffer_load_dwordx4 v251, s[16:19], s49 offen offset:3072 lds
    s_add_u32 s48, s48, 524288
    v_fma_mix_f32 v234, v131, v206, v214 op_sel:[0,0,0] op_sel_hi:[1,0,0]
    v_fma_mix_f32 v235, v131, v207, v215 op_sel:[1,0,0] op_sel_hi:[1,0,0]
    v_mfma_f32_16x16x32_bf16 v[120:123], a[120:123], v[196:199], v[120:123]
    v_cvt_pk_bf16_f32 v195, v234, v235
    v_mfma_f32_16x16x32_bf16 v[124:127], a[124:127], v[196:199], v[124:127]
    buffer_load_dwordx4 v[188:191], v248, s[20:23], s47 offen offset:3072
    s_waitcnt vmcnt(22)
    v_fma_mix_f32 v232, v132, v200, v208 op_sel:[0,0,0] op_sel_hi:[1,0,0]
    v_fma_mix_f32 v233, v132, v201, v209 op_sel:[1,0,0] op_sel_hi:[1,0,0]
    s_add_u32 s44, s44, 4096
    s_add_u32 s45, s45, 4096
    s_add_u32 s46, s46, 4096
    s_add_u32 s47, s47, 4096
    s_xor_b32 s51, s51, 32768
    s_xor_b32 s52, s52, 32768
    s_sub_u32 s38, s38, 1
    s_cmp_lg_u32 s38, 0
    s_cbranch_scc1 L_attn_qp
    s_waitcnt lgkmcnt(0)
    v_mfma_f32_16x16x32_bf16 v[0:3], a[64:67], v[192:195], v[0:3]
    ds_read_b64_tr_b16 a[96:97], v236 offset:8192
    v_cvt_pk_bf16_f32 v196, v232, v233
    v_mfma_f32_16x16x32_bf16 v[4:7], a[68:71], v[192:195], v[4:7]
    ds_read_b128 v[216:219], v254 offset:128
    v_fma_mix_f32 v234, v133, v202, v210 op_sel:[0,0,0] op_sel_hi:[1,0,0]
    v_fma_mix_f32 v235, v133, v203, v211 op_sel:[1,0,0] op_sel_hi:[1,0,0]
    v_mfma_f32_16x16x32_bf16 v[8:11], a[72:75], v[192:195], v[8:11]
    ds_read_b64_tr_b16 a[98:99], v236 offset:12288
    v_cvt_pk_bf16_f32 v197, v234, v235
    v_mfma_f32_16x16x32_bf16 v[12:15], a[76:79], v[192:195], v[12:15]
    ds_read_b128 v[224:227], v254 offset:2688
    v_fma_mix_f32 v232, v134, v204, v212 op_sel:[0,0,0] op_sel_hi:[1,0,0]
    v_fma_mix_f32 v233, v134, v205, v213 op_sel:[1,0,0] op_sel_hi:[1,0,0]
    v_mfma_f32_16x16x32_bf16 v[16:19], a[80:83], v[192:195], v[16:19]
    ds_read_b64_tr_b16 a[100:101], v237 offset:8192
    v_cvt_pk_bf16_f32 v198, v232, v233
    v_mfma_f32_16x16x32_bf16 v[20:23], a[84:87], v[192:195], v[20:23]
    v_fma_mix_f32 v234, v135, v206, v214 op_sel:[0,0,0] op_sel_hi:[1,0,0]
    v_fma_mix_f32 v235, v135, v207, v215 op_sel:[1,0,0] op_sel_hi:[1,0,0]
    v_mfma_f32_16x16x32_bf16 v[24:27], a[88:91], v[192:195], v[24:27]
    ds_read_b64_tr_b16 a[102:103], v237 offset:12288
    v_cvt_pk_bf16_f32 v199, v234, v235
    v_mfma_f32_16x16x32_bf16 v[28:31], a[92:95], v[192:195], v[28:31]
    buffer_load_dwordx4 v[128:131], v248, s[20:23], s44 offen offset:0
    s_waitcnt vmcnt(22)
    v_fma_mix_f32 v232, v136, v200, v208 op_sel:[0,0,0] op_sel_hi:[1,0,0]
    v_fma_mix_f32 v233, v136, v201, v209 op_sel:[1,0,0] op_sel_hi:[1,0,0]
    v_mfma_f32_16x16x32_bf16 v[32:35], a[64:67], v[196:199], v[32:35]
    ds_read_b64_tr_b16 a[104:105], v238 offset:8192
    v_cvt_pk_bf16_f32 v192, v232, v233
    v_mfma_f32_16x16x32_bf16 v[36:39], a[68:71], v[196:199], v[36:39]
    ds_read_b128 v[220:223], v254 offset:192
    v_fma_mix_f32 v234, v137, v202, v210 op_sel:[0,0,0] op_sel_hi:[1,0,0]
    v_fma_mix_f32 v235, v137, v203, v211 op_sel:[1,0,0] op_sel_hi:[1,0,0]
    v_mfma_f32_16x16x32_bf16 v[40:43], a[72:75], v[196:199], v[40:43]
    ds_read_b64_tr_b16 a[106:107], v238 offset:12288
    v_cvt_pk_bf16_f32 v193, v234, v235
    v_mfma_f32_16x16x32_bf16 v[44:47], a[76:79], v[196:199], v[44:47]
    ds_read_b128 v[228:231], v254 offset:2752
    v_fma_mix_f32 v232, v138, v204, v212 op_sel:[0,0,0] op_sel_hi:[1,0,0]
    v_fma_mix_f32 v233, v138, v205, v213 op_sel:[1,0,0] op_sel_hi:[1,0,0]
    v_mfma_f32_16x16x32_bf16 v[48:51], a[80:83], v[196:199], v[48:51]
    ds_read_b64_tr_b16 a[108:109], v239 offset:8192
    v_cvt_pk_bf16_f32 v194, v232, v233
    v_mfma_f32_16x16x32_bf16 v[52:55], a[84:87], v[196:199], v[52:55]
    v_fma_mix_f32 v234, v139, v206, v214 op_sel:[0,0,0] op_sel_hi:[1,0,0]
    v_fma_mix_f32 v235, v139, v207, v215 op_sel:[1,0,0] op_sel_hi:[1,0,0]
    v_mfma_f32_16x16x32_bf16 v[56:59], a[88:91], v[196:199], v[56:59]
    ds_read_b64_tr_b16 a[110:111], v239 offset:12288
    v_cvt_pk_bf16_f32 v195, v234, v235
    v_mfma_f32_16x16x32_bf16 v[60:63], a[92:95], v[196:199], v[60:63]
    buffer_load_dwordx4 v[132:135], v248, s[20:23], s45 offen offset:0
    s_waitcnt vmcnt(22)
    v_fma_mix_f32 v232, v140, v200, v208 op_sel:[0,0,0] op_sel_hi:[1,0,0]
    v_fma_mix_f32 v233, v140, v201, v209 op_sel:[1,0,0] op_sel_hi:[1,0,0]
    v_mfma_f32_16x16x32_bf16 v[64:67], a[64:67], v[192:195], v[64:67]
    ds_read_b64_tr_b16 a[112:113], v240 offset:8192
    v_cvt_pk_bf16_f32 v196, v232, v233
    v_mfma_f32_16x16x32_bf16 v[68:71], a[68:71], v[192:195], v[68:71]
    ds_read_b64_tr_b16 a[120:121], v242 offset:8192
    v_fma_mix_f32 v234, v141, v202, v210 op_sel:[0,0,0] op_sel_hi:[1,0,0]
    v_fma_mix_f32 v235, v141, v203, v211 op_sel:[1,0,0] op_sel_hi:[1,0,0]
    v_mfma_f32_16x16x32_bf16 v[72:75], a[72:75], v[192:195], v[72:75]
    ds_read_b64_tr_b16 a[114:115], v240 offset:12288
    v_cvt_pk_bf16_f32 v197, v234, v235
    v_mfma_f32_16x16x32_bf16 v[76:79], a[76:79], v[192:195], v[76:79]
    ds_read_b64_tr_b16 a[122:123], v242 offset:12288
    v_fma_mix_f32 v232, v142, v204, v212 op_sel:[0,0,0] op_sel_hi:[1,0,0]
    v_fma_mix_f32 v233, v142, v205, v213 op_sel:[1,0,0] op_sel_hi:[1,0,0]
    v_mfma_f32_16x16x32_bf16 v[80:83], a[80:83], v[192:195], v[80:83]
    ds_read_b64_tr_b16 a[116:117], v241 offset:8192
    v_cvt_pk_bf16_f32 v198, v232, v233
    v_mfma_f32_16x16x32_bf16 v[84:87], a[84:87], v[192:195], v[84:87]
    v_fma_mix_f32 v234, v143, v206, v214 op_sel:[0,0,0] op_sel_hi:[1,0,0]
    v_fma_mix_f32 v235, v143, v207, v215 op_sel:[1,0,0] op_sel_hi:[1,0,0]
    v_mfma_f32_16x16x32_bf16 v[88:91], a[88:91], v[192:195], v[88:91]
    ds_read_b64_tr_b16 a[118:119], v241 offset:12288
    v_cvt_pk_bf16_f32 v199, v234, v235
    v_mfma_f32_16x16x32_bf16 v[92:95], a[92:95], v[192:195], v[92:95]
    buffer_load_dwordx4 v[136:139], v248, s[20:23], s46 offen offset:0
    s_waitcnt vmcnt(21) lgkmcnt(14)
    v_fma_mix_f32 v232, v144, v216, v224 op_sel:[0,0,0] op_sel_hi:[1,0,0]
    v_fma_mix_f32 v233, v144, v217, v225 op_sel:[1,0,0] op_sel_hi:[1,0,0]
    v_mfma_f32_16x16x32_bf16 v[96:99], a[64:67], v[196:199], v[96:99]
    ds_read_b64_tr_b16 a[124:125], v243 offset:8192
    v_cvt_pk_bf16_f32 v192, v232, v233
    v_mfma_f32_16x16x32_bf16 v[100:103], a[68:71], v[196:199], v[100:103]
    ds_read_b64_tr_b16 a[126:127], v243 offset:12288
    v_fma_mix_f32 v234, v145, v218, v226 op_sel:[0,0,0] op_sel_hi:[1,0,0]
    v_fma_mix_f32 v235, v145, v219, v227 op_sel:[1,0,0] op_sel_hi:[1,0,0]
    v_mfma_f32_16x16x32_bf16 v[104:107], a[72:75], v[196:199], v[104:107]
    v_cvt_pk_bf16_f32 v193, v234, v235
    v_mfma_f32_16x16x32_bf16 v[108:111], a[76:79], v[196:199], v[108:111]
    s_waitcnt lgkmcnt(10)
    v_fma_mix_f32 v232, v146, v220, v228 op_sel:[0,0,0] op_sel_hi:[1,0,0]
    v_fma_mix_f32 v233, v146, v221, v229 op_sel:[1,0,0] op_sel_hi:[1,0,0]
    v_mfma_f32_16x16x32_bf16 v[112:115], a[80:83], v[196:199], v[112:115]
    v_cvt_pk_bf16_f32 v194, v232, v233
    v_mfma_f32_16x16x32_bf16 v[116:119], a[84:87], v[196:199], v[116:119]
    v_fma_mix_f32 v234, v147, v222, v230 op_sel:[0,0,0] op_sel_hi:[1,0,0]
    v_fma_mix_f32 v235, v147, v223, v231 op_sel:[1,0,0] op_sel_hi:[1,0,0]
    v_mfma_f32_16x16x32_bf16 v[120:123], a[88:91], v[196:199], v[120:123]
    v_cvt_pk_bf16_f32 v195, v234, v235
    v_mfma_f32_16x16x32_bf16 v[124:127], a[92:95], v[196:199], v[124:127]
    buffer_load_dwordx4 v[140:143], v248, s[20:23], s47 offen offset:0
    s_waitcnt vmcnt(20)
    v_fma_mix_f32 v232, v148, v216, v224 op_sel:[0,0,0] op_sel_hi:[1,0,0]
    v_fma_mix_f32 v233, v148, v217, v225 op_sel:[1,0,0] op_sel_hi:[1,0,0]
    s_waitcnt lgkmcnt(0)
    v_mfma_f32_16x16x32_bf16 v[0:3], a[96:99], v[192:195], v[0:3]
    s_waitcnt vmcnt(17)
    s_barrier
    ds_read_b64_tr_b16 a[64:65], v236 offset:16384
    v_cvt_pk_bf16_f32 v196, v232, v233
    v_mfma_f32_16x16x32_bf16 v[4:7], a[100:103], v[192:195], v[4:7]
    ds_read_b128 v[200:203], v254 offset:256
    v_fma_mix_f32 v234, v149, v218, v226 op_sel:[0,0,0] op_sel_hi:[1,0,0]
    v_fma_mix_f32 v235, v149, v219, v227 op_sel:[1,0,0] op_sel_hi:[1,0,0]
    v_mfma_f32_16x16x32_bf16 v[8:11], a[104:107], v[192:195], v[8:11]
    ds_read_b64_tr_b16 a[66:67], v236 offset:20480
    v_cvt_pk_bf16_f32 v197, v234, v235
    v_mfma_f32_16x16x32_bf16 v[12:15], a[108:111], v[192:195], v[12:15]
    ds_read_b128 v[208:211], v254 offset:2816
    v_fma_mix_f32 v232, v150, v220, v228 op_sel:[0,0,0] op_sel_hi:[1,0,0]
    v_fma_mix_f32 v233, v150, v221, v229 op_sel:[1,0,0] op_sel_hi:[1,0,0]
    v_mfma_f32_16x16x32_bf16 v[16:19], a[112:115], v[192:195], v[16:19]
    ds_read_b64_tr_b16 a[68:69], v237 offset:16384
    v_cvt_pk_bf16_f32 v198, v232, v233
    v_mfma_f32_16x16x32_bf16 v[20:23], a[116:119], v[192:195], v[20:23]
    s_mov_b32 m0, s51
    s_add_u32 s49, s48, 0
    buffer_load_dwordx4 v250, s[16:19], s49 offen offset:0 lds
    v_fma_mix_f32 v234, v151, v222, v230 op_sel:[0,0,0] op_sel_hi:[1,0,0]
    v_fma_mix_f32 v235, v151, v223, v231 op_sel:[1,0,0] op_sel_hi:[1,0,0]
    v_mfma_f32_16x16x32_bf16 v[24:27], a[120:123], v[192:195], v[24:27]
    ds_read_b64_tr_b16 a[70:71], v237 offset:20480
    v_cvt_pk_bf16_f32 v199, v234, v235
    v_mfma_f32_16x16x32_bf16 v[28:31], a[124:127], v[192:195], v[28:31]
    buffer_load_dwordx4 v[144:147], v248, s[20:23], s44 offen offset:1024
    v_fma_mix_f32 v232, v152, v216, v224 op_sel:[0,0,0] op_sel_hi:[1,0,0]
    v_fma_mix_f32 v233, v152, v217, v225 op_sel:[1,0,0] op_sel_hi:[1,0,0]
    v_mfma_f32_16x16x32_bf16 v[32:35], a[96:99], v[196:199], v[32:35]
    ds_read_b64_tr_b16 a[72:73], v238 offset:16384
    v_cvt_pk_bf16_f32 v192, v232, v233
    v_mfma_f32_16x16x32_bf16 v[36:39], a[100:103], v[196:199], v[36:39]
    ds_read_b128 v[204:207], v254 offset:320
    v_fma_mix_f32 v234, v153, v218, v226 op_sel:[0,0,0] op_sel_hi:[1,0,0]
    v_fma_mix_f32 v235, v153, v219, v227 op_sel:[1,0,0] op_sel_hi:[1,0,0]
    v_mfma_f32_16x16x32_bf16 v[40:43], a[104:107], v[196:199], v[40:43]
    ds_read_b64_tr_b16 a[74:75], v238 offset:20480
    v_cvt_pk_bf16_f32 v193, v234, v235
    v_mfma_f32_16x16x32_bf16 v[44:47], a[108:111], v[196:199], v[44:47]
    ds_read_b128 v[212:215], v254 offset:2880
    v_fma_mix_f32 v232, v154, v220, v228 op_sel:[0,0,0] op_sel_hi:[1,0,0]
    v_fma_mix_f32 v233, v154, v221, v229 op_sel:[1,0,0] op_sel_hi:[1,0,0]
    v_mfma_f32_16x16x32_bf16 v[48:51], a[112:115], v[196:199], v[48:51]
    ds_read_b64_tr_b16 a[76:77], v239 offset:16384
    v_cvt_pk_bf16_f32 v194, v232, v233
    v_mfma_f32_16x16x32_bf16 v[52:55], a[116:119], v[196:199], v[52:55]
    s_add_u32 s49, s48, 31744
    buffer_load_dwordx4 v251, s[16:19], s49 offen offset:1024 lds
    v_fma_mix_f32 v234, v155, v222, v230 op_sel:[0,0,0] op_sel_hi:[1,0,0]
    v_fma_mix_f32 v235, v155, v223, v231 op_sel:[1,0,0] op_sel_hi:[1,0,0]
    v_mfma_f32_16x16x32_bf16 v[56:59], a[120:123], v[196:199], v[56:59]
    ds_read_b64_tr_b16 a[78:79], v239 offset:20480
    v_cvt_pk_bf16_f32 v195, v234, v235
    v_mfma_f32_16x16x32_bf16 v[60:63], a[124:127], v[196:199], v[60:63]
    buffer_load_dwordx4 v[148:151], v248, s[20:23], s45 offen offset:1024
    s_waitcnt vmcnt(20)
    v_fma_mix_f32 v232, v156, v216, v224 op_sel:[0,0,0] op_sel_hi:[1,0,0]
    v_fma_mix_f32 v233, v156, v217, v225 op_sel:[1,0,0] op_sel_hi:[1,0,0]
    v_mfma_f32_16x16x32_bf16 v[64:67], a[96:99], v[192:195], v[64:67]
    ds_read_b64_tr_b16 a[80:81], v240 offset:16384
    v_cvt_pk_bf16_f32 v196, v232, v233
    v_mfma_f32_16x16x32_bf16 v[68:71], a[100:103], v[192:195], v[68:71]
    ds_read_b64_tr_b16 a[88:89], v242 offset:16384
    v_fma_mix_f32 v234, v157, v218, v226 op_sel:[0,0,0] op_sel_hi:[1,0,0]
    v_fma_mix_f32 v235, v157, v219, v227 op_sel:[1,0,0] op_sel_hi:[1,0,0]
    v_mfma_f32_16x16x32_bf16 v[72:75], a[104:107], v[192:195], v[72:75]
    ds_read_b64_tr_b16 a[82:83], v240 offset:20480
    v_cvt_pk_bf16_f32 v197, v234, v235
    v_mfma_f32_16x16x32_bf16 v[76:79], a[108:111], v[192:195], v[76:79]
    ds_read_b64_tr_b16 a[90:91], v242 offset:20480
    v_fma_mix_f32 v232, v158, v220, v228 op_sel:[0,0,0] op_sel_hi:[1,0,0]
    v_fma_mix_f32 v233, v158, v221, v229 op_sel:[1,0,0] op_sel_hi:[1,0,0]
    v_mfma_f32_16x16x32_bf16 v[80:83], a[112:115], v[192:195], v[80:83]
    ds_read_b64_tr_b16 a[84:85], v241 offset:16384
    v_cvt_pk_bf16_f32 v198, v232, v233
    v_mfma_f32_16x16x32_bf16 v[84:87], a[116:119], v[192:195], v[84:87]
    s_add_u32 s49, s48, 63488
    buffer_load_dwordx4 v250, s[16:19], s49 offen offset:2048 lds
    v_fma_mix_f32 v234, v159, v222, v230 op_sel:[0,0,0] op_sel_hi:[1,0,0]
    v_fma_mix_f32 v235, v159, v223, v231 op_sel:[1,0,0] op_sel_hi:[1,0,0]
    v_mfma_f32_16x16x32_bf16 v[88:91], a[120:123], v[192:195], v[88:91]
    ds_read_b64_tr_b16 a[86:87], v241 offset:20480
    v_cvt_pk_bf16_f32 v199, v234, v235
    v_mfma_f32_16x16x32_bf16 v[92:95], a[124:127], v[192:195], v[92:95]
    buffer_load_dwordx4 v[152:155], v248, s[20:23], s46 offen offset:1024
    s_waitcnt vmcnt(21) lgkmcnt(14)
    v_fma_mix_f32 v232, v160, v200, v208 op_sel:[0,0,0] op_sel_hi:[1,0,0]
    v_fma_mix_f32 v233, v160, v201, v209 op_sel:[1,0,0] op_sel_hi:[1,0,0]
    v_mfma_f32_16x16x32_bf16 v[96:99], a[96:99], v[196:199], v[96:99]
    ds_read_b64_tr_b16 a[92:93], v243 offset:16384
    v_cvt_pk_bf16_f32 v192, v232, v233
    v_mfma_f32_16x16x32_bf16 v[100:103], a[100:103], v[196:199], v[100:103]
    ds_read_b64_tr_b16 a[94:95], v243 offset:20480
    v_fma_mix_f32 v234, v161, v202, v210 op_sel:[0,0,0] op_sel_hi:[1,0,0]
    v_fma_mix_f32 v235, v161, v203, v211 op_sel:[1,0,0] op_sel_hi:[1,0,0]
    v_mfma_f32_16x16x32_bf16 v[104:107], a[104:107], v[196:199], v[104:107]
    v_cvt_pk_bf16_f32 v193, v234, v235
    v_mfma_f32_16x16x32_bf16 v[108:111], a[108:111], v[196:199], v[108:111]
    s_waitcnt lgkmcnt(10)
    v_fma_mix_f32 v232, v162, v204, v212 op_sel:[0,0,0] op_sel_hi:[1,0,0]
    v_fma_mix_f32 v233, v162, v205, v213 op_sel:[1,0,0] op_sel_hi:[1,0,0]
    v_mfma_f32_16x16x32_bf16 v[112:115], a[112:115], v[196:199], v[112:115]
    v_cvt_pk_bf16_f32 v194, v232, v233
    v_mfma_f32_16x16x32_bf16 v[116:119], a[116:119], v[196:199], v[116:119]
    s_add_u32 s49, s48, 95232
    buffer_load_dwordx4 v251, s[16:19], s49 offen offset:3072 lds
    s_add_u32 s48, s48, 524288
    v_fma_mix_f32 v234, v163, v206, v214 op_sel:[0,0,0] op_sel_hi:[1,0,0]
    v_fma_mix_f32 v235, v163, v207, v215 op_sel:[1,0,0] op_sel_hi:[1,0,0]
    v_mfma_f32_16x16x32_bf16 v[120:123], a[120:123], v[196:199], v[120:123]
    v_cvt_pk_bf16_f32 v195, v234, v235
    v_mfma_f32_16x16x32_bf16 v[124:127], a[124:127], v[196:199], v[124:127]
    buffer_load_dwordx4 v[156:159], v248, s[20:23], s47 offen offset:1024
    s_waitcnt vmcnt(22)
    v_fma_mix_f32 v232, v164, v200, v208 op_sel:[0,0,0] op_sel_hi:[1,0,0]
    v_fma_mix_f32 v233, v164, v201, v209 op_sel:[1,0,0] op_sel_hi:[1,0,0]
    s_waitcnt lgkmcnt(0)
    v_mfma_f32_16x16x32_bf16 v[0:3], a[64:67], v[192:195], v[0:3]
    ds_read_b64_tr_b16 a[96:97], v236 offset:24576
    v_cvt_pk_bf16_f32 v196, v232, v233
    v_mfma_f32_16x16x32_bf16 v[4:7], a[68:71], v[192:195], v[4:7]
    ds_read_b128 v[216:219], v254 offset:384
    v_fma_mix_f32 v234, v165, v202, v210 op_sel:[0,0,0] op_sel_hi:[1,0,0]
    v_fma_mix_f32 v235, v165, v203, v211 op_sel:[1,0,0] op_sel_hi:[1,0,0]
    v_mfma_f32_16x16x32_bf16 v[8:11], a[72:75], v[192:195], v[8:11]
    ds_read_b64_tr_b16 a[98:99], v236 offset:28672
    v_cvt_pk_bf16_f32 v197, v234, v235
    v_mfma_f32_16x16x32_bf16 v[12:15], a[76:79], v[192:195], v[12:15]
    ds_read_b128 v[224:227], v254 offset:2944
    v_fma_mix_f32 v232, v166, v204, v212 op_sel:[0,0,0] op_sel_hi:[1,0,0]
    v_fma_mix_f32 v233, v166, v205, v213 op_sel:[1,0,0] op_sel_hi:[1,0,0]
    v_mfma_f32_16x16x32_bf16 v[16:19], a[80:83], v[192:195], v[16:19]
    ds_read_b64_tr_b16 a[100:101], v237 offset:24576
    v_cvt_pk_bf16_f32 v198, v232, v233
    v_mfma_f32_16x16x32_bf16 v[20:23], a[84:87], v[192:195], v[20:23]
    v_fma_mix_f32 v234, v167, v206, v214 op_sel:[0,0,0] op_sel_hi:[1,0,0]
    v_fma_mix_f32 v235, v167, v207, v215 op_sel:[1,0,0] op_sel_hi:[1,0,0]
    v_mfma_f32_16x16x32_bf16 v[24:27], a[88:91], v[192:195], v[24:27]
    ds_read_b64_tr_b16 a[102:103], v237 offset:28672
    v_cvt_pk_bf16_f32 v199, v234, v235
    v_mfma_f32_16x16x32_bf16 v[28:31], a[92:95], v[192:195], v[28:31]
    buffer_load_dwordx4 v[160:163], v248, s[20:23], s44 offen offset:2048
    s_waitcnt vmcnt(22)
    v_fma_mix_f32 v232, v168, v200, v208 op_sel:[0,0,0] op_sel_hi:[1,0,0]
    v_fma_mix_f32 v233, v168, v201, v209 op_sel:[1,0,0] op_sel_hi:[1,0,0]
    v_mfma_f32_16x16x32_bf16 v[32:35], a[64:67], v[196:199], v[32:35]
    ds_read_b64_tr_b16 a[104:105], v238 offset:24576
    v_cvt_pk_bf16_f32 v192, v232, v233
    v_mfma_f32_16x16x32_bf16 v[36:39], a[68:71], v[196:199], v[36:39]
    ds_read_b128 v[220:223], v254 offset:448
    v_fma_mix_f32 v234, v169, v202, v210 op_sel:[0,0,0] op_sel_hi:[1,0,0]
    v_fma_mix_f32 v235, v169, v203, v211 op_sel:[1,0,0] op_sel_hi:[1,0,0]
    v_mfma_f32_16x16x32_bf16 v[40:43], a[72:75], v[196:199], v[40:43]
    ds_read_b64_tr_b16 a[106:107], v238 offset:28672
    v_cvt_pk_bf16_f32 v193, v234, v235
    v_mfma_f32_16x16x32_bf16 v[44:47], a[76:79], v[196:199], v[44:47]
    ds_read_b128 v[228:231], v254 offset:3008
    v_fma_mix_f32 v232, v170, v204, v212 op_sel:[0,0,0] op_sel_hi:[1,0,0]
    v_fma_mix_f32 v233, v170, v205, v213 op_sel:[1,0,0] op_sel_hi:[1,0,0]
    v_mfma_f32_16x16x32_bf16 v[48:51], a[80:83], v[196:199], v[48:51]
    ds_read_b64_tr_b16 a[108:109], v239 offset:24576
    v_cvt_pk_bf16_f32 v194, v232, v233
    v_mfma_f32_16x16x32_bf16 v[52:55], a[84:87], v[196:199], v[52:55]
    v_fma_mix_f32 v234, v171, v206, v214 op_sel:[0,0,0] op_sel_hi:[1,0,0]
    v_fma_mix_f32 v235, v171, v207, v215 op_sel:[1,0,0] op_sel_hi:[1,0,0]
    v_mfma_f32_16x16x32_bf16 v[56:59], a[88:91], v[196:199], v[56:59]
    ds_read_b64_tr_b16 a[110:111], v239 offset:28672
    v_cvt_pk_bf16_f32 v195, v234, v235
    v_mfma_f32_16x16x32_bf16 v[60:63], a[92:95], v[196:199], v[60:63]
    buffer_load_dwordx4 v[164:167], v248, s[20:23], s45 offen offset:2048
    s_waitcnt vmcnt(22)
    v_fma_mix_f32 v232, v172, v200, v208 op_sel:[0,0,0] op_sel_hi:[1,0,0]
    v_fma_mix_f32 v233, v172, v201, v209 op_sel:[1,0,0] op_sel_hi:[1,0,0]
    v_mfma_f32_16x16x32_bf16 v[64:67], a[64:67], v[192:195], v[64:67]
    ds_read_b64_tr_b16 a[112:113], v240 offset:24576
    v_cvt_pk_bf16_f32 v196, v232, v233
    v_mfma_f32_16x16x32_bf16 v[68:71], a[68:71], v[192:195], v[68:71]
    ds_read_b64_tr_b16 a[120:121], v242 offset:24576
    v_fma_mix_f32 v234, v173, v202, v210 op_sel:[0,0,0] op_sel_hi:[1,0,0]
    v_fma_mix_f32 v235, v173, v203, v211 op_sel:[1,0,0] op_sel_hi:[1,0,0]
    v_mfma_f32_16x16x32_bf16 v[72:75], a[72:75], v[192:195], v[72:75]
    ds_read_b64_tr_b16 a[114:115], v240 offset:28672
    v_cvt_pk_bf16_f32 v197, v234, v235
    v_mfma_f32_16x16x32_bf16 v[76:79], a[76:79], v[192:195], v[76:79]
    ds_read_b64_tr_b16 a[122:123], v242 offset:28672
    v_fma_mix_f32 v232, v174, v204, v212 op_sel:[0,0,0] op_sel_hi:[1,0,0]
    v_fma_mix_f32 v233, v174, v205, v213 op_sel:[1,0,0] op_sel_hi:[1,0,0]
    v_mfma_f32_16x16x32_bf16 v[80:83], a[80:83], v[192:195], v[80:83]
    ds_read_b64_tr_b16 a[116:117], v241 offset:24576
    v_cvt_pk_bf16_f32 v198, v232, v233
    v_mfma_f32_16x16x32_bf16 v[84:87], a[84:87], v[192:195], v[84:87]
    v_fma_mix_f32 v234, v175, v206, v214 op_sel:[0,0,0] op_sel_hi:[1,0,0]
    v_fma_mix_f32 v235, v175, v207, v215 op_sel:[1,0,0] op_sel_hi:[1,0,0]
    v_mfma_f32_16x16x32_bf16 v[88:91], a[88:91], v[192:195], v[88:91]
    ds_read_b64_tr_b16 a[118:119], v241 offset:28672
    v_cvt_pk_bf16_f32 v199, v234, v235
    v_mfma_f32_16x16x32_bf16 v[92:95], a[92:95], v[192:195], v[92:95]
    buffer_load_dwordx4 v[168:171], v248, s[20:23], s46 offen offset:2048
    s_waitcnt vmcnt(21) lgkmcnt(14)
    v_fma_mix_f32 v232, v176, v216, v224 op_sel:[0,0,0] op_sel_hi:[1,0,0]
    v_fma_mix_f32 v233, v176, v217, v225 op_sel:[1,0,0] op_sel_hi:[1,0,0]
    v_mfma_f32_16x16x32_bf16 v[96:99], a[64:67], v[196:199], v[96:99]
    ds_read_b64_tr_b16 a[124:125], v243 offset:24576
    v_cvt_pk_bf16_f32 v192, v232, v233
    v_mfma_f32_16x16x32_bf16 v[100:103], a[68:71], v[196:199], v[100:103]
    ds_read_b64_tr_b16 a[126:127], v243 offset:28672
    v_fma_mix_f32 v234, v177, v218, v226 op_sel:[0,0,0] op_sel_hi:[1,0,0]
    v_fma_mix_f32 v235, v177, v219, v227 op_sel:[1,0,0] op_sel_hi:[1,0,0]
    v_mfma_f32_16x16x32_bf16 v[104:107], a[72:75], v[196:199], v[104:107]
    v_cvt_pk_bf16_f32 v193, v234, v235
    v_mfma_f32_16x16x32_bf16 v[108:111], a[76:79], v[196:199], v[108:111]
    s_waitcnt lgkmcnt(10)
    v_fma_mix_f32 v232, v178, v220, v228 op_sel:[0,0,0] op_sel_hi:[1,0,0]
    v_fma_mix_f32 v233, v178, v221, v229 op_sel:[1,0,0] op_sel_hi:[1,0,0]
    v_mfma_f32_16x16x32_bf16 v[112:115], a[80:83], v[196:199], v[112:115]
    v_cvt_pk_bf16_f32 v194, v232, v233
    v_mfma_f32_16x16x32_bf16 v[116:119], a[84:87], v[196:199], v[116:119]
    v_fma_mix_f32 v234, v179, v222, v230 op_sel:[0,0,0] op_sel_hi:[1,0,0]
    v_fma_mix_f32 v235, v179, v223, v231 op_sel:[1,0,0] op_sel_hi:[1,0,0]
    v_mfma_f32_16x16x32_bf16 v[120:123], a[88:91], v[196:199], v[120:123]
    v_cvt_pk_bf16_f32 v195, v234, v235
    v_mfma_f32_16x16x32_bf16 v[124:127], a[92:95], v[196:199], v[124:127]
    buffer_load_dwordx4 v[172:175], v248, s[20:23], s47 offen offset:2048
    s_waitcnt vmcnt(20)
    v_fma_mix_f32 v232, v180, v216, v224 op_sel:[0,0,0] op_sel_hi:[1,0,0]
    v_fma_mix_f32 v233, v180, v217, v225 op_sel:[1,0,0] op_sel_hi:[1,0,0]
    s_waitcnt lgkmcnt(0)
    v_mfma_f32_16x16x32_bf16 v[0:3], a[96:99], v[192:195], v[0:3]
    s_waitcnt vmcnt(17)
    s_barrier
    v_add_u32 v254, 512, v254
    v_xor_b32 v236, 0x8000, v236
    v_xor_b32 v237, 0x8000, v237
    v_xor_b32 v238, 0x8000, v238
    v_xor_b32 v239, 0x8000, v239
    v_xor_b32 v240, 0x8000, v240
    v_xor_b32 v241, 0x8000, v241
    v_xor_b32 v242, 0x8000, v242
    v_xor_b32 v243, 0x8000, v243
    ds_read_b64_tr_b16 a[64:65], v236 offset:0
    v_cvt_pk_bf16_f32 v196, v232, v233
    v_mfma_f32_16x16x32_bf16 v[4:7], a[100:103], v[192:195], v[4:7]
    ds_read_b128 v[200:203], v254 offset:0
    v_fma_mix_f32 v234, v181, v218, v226 op_sel:[0,0,0] op_sel_hi:[1,0,0]
    v_fma_mix_f32 v235, v181, v219, v227 op_sel:[1,0,0] op_sel_hi:[1,0,0]
    v_mfma_f32_16x16x32_bf16 v[8:11], a[104:107], v[192:195], v[8:11]
    ds_read_b64_tr_b16 a[66:67], v236 offset:4096
    v_cvt_pk_bf16_f32 v197, v234, v235
    v_mfma_f32_16x16x32_bf16 v[12:15], a[108:111], v[192:195], v[12:15]
    ds_read_b128 v[208:211], v254 offset:2560
    v_fma_mix_f32 v232, v182, v220, v228 op_sel:[0,0,0] op_sel_hi:[1,0,0]
    v_fma_mix_f32 v233, v182, v221, v229 op_sel:[1,0,0] op_sel_hi:[1,0,0]
    v_mfma_f32_16x16x32_bf16 v[16:19], a[112:115], v[192:195], v[16:19]
    ds_read_b64_tr_b16 a[68:69], v237 offset:0
    v_cvt_pk_bf16_f32 v198, v232, v233
    v_mfma_f32_16x16x32_bf16 v[20:23], a[116:119], v[192:195], v[20:23]
    s_add_u32 m0, s35, 65536
    v_subrev_u32 v255, s62, v252
    buffer_load_dwordx4 v255, s[12:15], 0 offen offset:0 lds
    v_fma_mix_f32 v234, v183, v222, v230 op_sel:[0,0,0] op_sel_hi:[1,0,0]
    v_fma_mix_f32 v235, v183, v223, v231 op_sel:[1,0,0] op_sel_hi:[1,0,0]
    v_mfma_f32_16x16x32_bf16 v[24:27], a[120:123], v[192:195], v[24:27]
    ds_read_b64_tr_b16 a[70:71], v237 offset:4096
    v_cvt_pk_bf16_f32 v199, v234, v235
    v_mfma_f32_16x16x32_bf16 v[28:31], a[124:127], v[192:195], v[28:31]
    buffer_load_dwordx4 v[176:179], v248, s[20:23], s44 offen offset:3072
    v_fma_mix_f32 v232, v184, v216, v224 op_sel:[0,0,0] op_sel_hi:[1,0,0]
    v_fma_mix_f32 v233, v184, v217, v225 op_sel:[1,0,0] op_sel_hi:[1,0,0]
    v_mfma_f32_16x16x32_bf16 v[32:35], a[96:99], v[196:199], v[32:35]
    ds_read_b64_tr_b16 a[72:73], v238 offset:0
    v_cvt_pk_bf16_f32 v192, v232, v233
    v_mfma_f32_16x16x32_bf16 v[36:39], a[100:103], v[196:199], v[36:39]
    ds_read_b128 v[204:207], v254 offset:64
    v_fma_mix_f32 v234, v185, v218, v226 op_sel:[0,0,0] op_sel_hi:[1,0,0]
    v_fma_mix_f32 v235, v185, v219, v227 op_sel:[1,0,0] op_sel_hi:[1,0,0]
    v_mfma_f32_16x16x32_bf16 v[40:43], a[104:107], v[196:199], v[40:43]
    ds_read_b64_tr_b16 a[74:75], v238 offset:4096
    v_cvt_pk_bf16_f32 v193, v234, v235
    v_mfma_f32_16x16x32_bf16 v[44:47], a[108:111], v[196:199], v[44:47]
    ds_read_b128 v[212:215], v254 offset:2624
    v_fma_mix_f32 v232, v186, v220, v228 op_sel:[0,0,0] op_sel_hi:[1,0,0]
    v_fma_mix_f32 v233, v186, v221, v229 op_sel:[1,0,0] op_sel_hi:[1,0,0]
    v_mfma_f32_16x16x32_bf16 v[48:51], a[112:115], v[196:199], v[48:51]
    ds_read_b64_tr_b16 a[76:77], v239 offset:0
    v_cvt_pk_bf16_f32 v194, v232, v233
    v_mfma_f32_16x16x32_bf16 v[52:55], a[116:119], v[196:199], v[52:55]
    v_subrev_u32 v255, s62, v253
    buffer_load_dwordx4 v255, s[12:15], 0 offen offset:1024 lds
    v_fma_mix_f32 v234, v187, v222, v230 op_sel:[0,0,0] op_sel_hi:[1,0,0]
    v_fma_mix_f32 v235, v187, v223, v231 op_sel:[1,0,0] op_sel_hi:[1,0,0]
    v_mfma_f32_16x16x32_bf16 v[56:59], a[120:123], v[196:199], v[56:59]
    ds_read_b64_tr_b16 a[78:79], v239 offset:4096
    v_cvt_pk_bf16_f32 v195, v234, v235
    v_mfma_f32_16x16x32_bf16 v[60:63], a[124:127], v[196:199], v[60:63]
    buffer_load_dwordx4 v[180:183], v248, s[20:23], s45 offen offset:3072
    s_waitcnt vmcnt(20)
    v_fma_mix_f32 v232, v188, v216, v224 op_sel:[0,0,0] op_sel_hi:[1,0,0]
    v_fma_mix_f32 v233, v188, v217, v225 op_sel:[1,0,0] op_sel_hi:[1,0,0]
    v_mfma_f32_16x16x32_bf16 v[64:67], a[96:99], v[192:195], v[64:67]
    ds_read_b64_tr_b16 a[80:81], v240 offset:0
    v_cvt_pk_bf16_f32 v196, v232, v233
    v_mfma_f32_16x16x32_bf16 v[68:71], a[100:103], v[192:195], v[68:71]
    ds_read_b64_tr_b16 a[88:89], v242 offset:0
    v_fma_mix_f32 v234, v189, v218, v226 op_sel:[0,0,0] op_sel_hi:[1,0,0]
    v_fma_mix_f32 v235, v189, v219, v227 op_sel:[1,0,0] op_sel_hi:[1,0,0]
    v_mfma_f32_16x16x32_bf16 v[72:75], a[104:107], v[192:195], v[72:75]
    ds_read_b64_tr_b16 a[82:83], v240 offset:4096
    v_cvt_pk_bf16_f32 v197, v234, v235
    v_mfma_f32_16x16x32_bf16 v[76:79], a[108:111], v[192:195], v[76:79]
    ds_read_b64_tr_b16 a[90:91], v242 offset:4096
    v_fma_mix_f32 v232, v190, v220, v228 op_sel:[0,0,0] op_sel_hi:[1,0,0]
    v_fma_mix_f32 v233, v190, v221, v229 op_sel:[1,0,0] op_sel_hi:[1,0,0]
    v_mfma_f32_16x16x32_bf16 v[80:83], a[112:115], v[192:195], v[80:83]
    ds_read_b64_tr_b16 a[84:85], v241 offset:0
    v_cvt_pk_bf16_f32 v198, v232, v233
    v_mfma_f32_16x16x32_bf16 v[84:87], a[116:119], v[192:195], v[84:87]
    v_subrev_u32 v255, s62, v252
    buffer_load_dwordx4 v255, s[12:15], 0 offen offset:2048 lds
    v_fma_mix_f32 v234, v191, v222, v230 op_sel:[0,0,0] op_sel_hi:[1,0,0]
    v_fma_mix_f32 v235, v191, v223, v231 op_sel:[1,0,0] op_sel_hi:[1,0,0]
    v_mfma_f32_16x16x32_bf16 v[88:91], a[120:123], v[192:195], v[88:91]
    ds_read_b64_tr_b16 a[86:87], v241 offset:4096
    v_cvt_pk_bf16_f32 v199, v234, v235
    v_mfma_f32_16x16x32_bf16 v[92:95], a[124:127], v[192:195], v[92:95]
    buffer_load_dwordx4 v[184:187], v248, s[20:23], s46 offen offset:3072
    s_waitcnt vmcnt(21) lgkmcnt(14)
    v_fma_mix_f32 v232, v128, v200, v208 op_sel:[0,0,0] op_sel_hi:[1,0,0]
    v_fma_mix_f32 v233, v128, v201, v209 op_sel:[1,0,0] op_sel_hi:[1,0,0]
    v_mfma_f32_16x16x32_bf16 v[96:99], a[96:99], v[196:199], v[96:99]
    ds_read_b64_tr_b16 a[92:93], v243 offset:0
    v_cvt_pk_bf16_f32 v192, v232, v233
    v_mfma_f32_16x16x32_bf16 v[100:103], a[100:103], v[196:199], v[100:103]
    ds_read_b64_tr_b16 a[94:95], v243 offset:4096
    v_fma_mix_f32 v234, v129, v202, v210 op_sel:[0,0,0] op_sel_hi:[1,0,0]
    v_fma_mix_f32 v235, v129, v203, v211 op_sel:[1,0,0] op_sel_hi:[1,0,0]
    v_mfma_f32_16x16x32_bf16 v[104:107], a[104:107], v[196:199], v[104:107]
    v_cvt_pk_bf16_f32 v193, v234, v235
    v_mfma_f32_16x16x32_bf16 v[108:111], a[108:111], v[196:199], v[108:111]
    s_waitcnt lgkmcnt(10)
    v_fma_mix_f32 v232, v130, v204, v212 op_sel:[0,0,0] op_sel_hi:[1,0,0]
    v_fma_mix_f32 v233, v130, v205, v213 op_sel:[1,0,0] op_sel_hi:[1,0,0]
    v_mfma_f32_16x16x32_bf16 v[112:115], a[112:115], v[196:199], v[112:115]
    v_cvt_pk_bf16_f32 v194, v232, v233
    v_mfma_f32_16x16x32_bf16 v[116:119], a[116:119], v[196:199], v[116:119]
    v_subrev_u32 v255, s62, v253
    buffer_load_dwordx4 v255, s[12:15], 0 offen offset:3072 lds
    v_fma_mix_f32 v234, v131, v206, v214 op_sel:[0,0,0] op_sel_hi:[1,0,0]
    v_fma_mix_f32 v235, v131, v207, v215 op_sel:[1,0,0] op_sel_hi:[1,0,0]
    v_mfma_f32_16x16x32_bf16 v[120:123], a[120:123], v[196:199], v[120:123]
    v_cvt_pk_bf16_f32 v195, v234, v235
    v_mfma_f32_16x16x32_bf16 v[124:127], a[124:127], v[196:199], v[124:127]
    buffer_load_dwordx4 v[188:191], v248, s[20:23], s47 offen offset:3072
    s_waitcnt vmcnt(22)
    v_fma_mix_f32 v232, v132, v200, v208 op_sel:[0,0,0] op_sel_hi:[1,0,0]
    v_fma_mix_f32 v233, v132, v201, v209 op_sel:[1,0,0] op_sel_hi:[1,0,0]
    s_add_u32 s44, s44, 4096
    s_add_u32 s45, s45, 4096
    s_add_u32 s46, s46, 4096
    s_add_u32 s47, s47, 4096
    s_xor_b32 s51, s51, 32768
    s_xor_b32 s52, s52, 32768
    s_waitcnt lgkmcnt(0)
    v_mfma_f32_16x16x32_bf16 v[0:3], a[64:67], v[192:195], v[0:3]
    ds_read_b64_tr_b16 a[96:97], v236 offset:8192
    v_cvt_pk_bf16_f32 v196, v232, v233
    v_mfma_f32_16x16x32_bf16 v[4:7], a[68:71], v[192:195], v[4:7]
    ds_read_b128 v[216:219], v254 offset:128
    v_fma_mix_f32 v234, v133, v202, v210 op_sel:[0,0,0] op_sel_hi:[1,0,0]
    v_fma_mix_f32 v235, v133, v203, v211 op_sel:[1,0,0] op_sel_hi:[1,0,0]
    v_mfma_f32_16x16x32_bf16 v[8:11], a[72:75], v[192:195], v[8:11]
    ds_read_b64_tr_b16 a[98:99], v236 offset:12288
    v_cvt_pk_bf16_f32 v197, v234, v235
    v_mfma_f32_16x16x32_bf16 v[12:15], a[76:79], v[192:195], v[12:15]
    ds_read_b128 v[224:227], v254 offset:2688
    v_fma_mix_f32 v232, v134, v204, v212 op_sel:[0,0,0] op_sel_hi:[1,0,0]
    v_fma_mix_f32 v233, v134, v205, v213 op_sel:[1,0,0] op_sel_hi:[1,0,0]
    v_mfma_f32_16x16x32_bf16 v[16:19], a[80:83], v[192:195], v[16:19]
    ds_read_b64_tr_b16 a[100:101], v237 offset:8192
    v_cvt_pk_bf16_f32 v198, v232, v233
    v_mfma_f32_16x16x32_bf16 v[20:23], a[84:87], v[192:195], v[20:23]
    v_fma_mix_f32 v234, v135, v206, v214 op_sel:[0,0,0] op_sel_hi:[1,0,0]
    v_fma_mix_f32 v235, v135, v207, v215 op_sel:[1,0,0] op_sel_hi:[1,0,0]
    v_mfma_f32_16x16x32_bf16 v[24:27], a[88:91], v[192:195], v[24:27]
    ds_read_b64_tr_b16 a[102:103], v237 offset:12288
    v_cvt_pk_bf16_f32 v199, v234, v235
    v_mfma_f32_16x16x32_bf16 v[28:31], a[92:95], v[192:195], v[28:31]
    s_waitcnt vmcnt(21)
    v_fma_mix_f32 v232, v136, v200, v208 op_sel:[0,0,0] op_sel_hi:[1,0,0]
    v_fma_mix_f32 v233, v136, v201, v209 op_sel:[1,0,0] op_sel_hi:[1,0,0]
    v_mfma_f32_16x16x32_bf16 v[32:35], a[64:67], v[196:199], v[32:35]
    ds_read_b64_tr_b16 a[104:105], v238 offset:8192
    v_cvt_pk_bf16_f32 v192, v232, v233
    v_mfma_f32_16x16x32_bf16 v[36:39], a[68:71], v[196:199], v[36:39]
    ds_read_b128 v[220:223], v254 offset:192
    v_fma_mix_f32 v234, v137, v202, v210 op_sel:[0,0,0] op_sel_hi:[1,0,0]
    v_fma_mix_f32 v235, v137, v203, v211 op_sel:[1,0,0] op_sel_hi:[1,0,0]
    v_mfma_f32_16x16x32_bf16 v[40:43], a[72:75], v[196:199], v[40:43]
    ds_read_b64_tr_b16 a[106:107], v238 offset:12288
    v_cvt_pk_bf16_f32 v193, v234, v235
    v_mfma_f32_16x16x32_bf16 v[44:47], a[76:79], v[196:199], v[44:47]
    ds_read_b128 v[228:231], v254 offset:2752
    v_fma_mix_f32 v232, v138, v204, v212 op_sel:[0,0,0] op_sel_hi:[1,0,0]
    v_fma_mix_f32 v233, v138, v205, v213 op_sel:[1,0,0] op_sel_hi:[1,0,0]
    v_mfma_f32_16x16x32_bf16 v[48:51], a[80:83], v[196:199], v[48:51]
    ds_read_b64_tr_b16 a[108:109], v239 offset:8192
    v_cvt_pk_bf16_f32 v194, v232, v233
    v_mfma_f32_16x16x32_bf16 v[52:55], a[84:87], v[196:199], v[52:55]
    v_fma_mix_f32 v234, v139, v206, v214 op_sel:[0,0,0] op_sel_hi:[1,0,0]
    v_fma_mix_f32 v235, v139, v207, v215 op_sel:[1,0,0] op_sel_hi:[1,0,0]
    v_mfma_f32_16x16x32_bf16 v[56:59], a[88:91], v[196:199], v[56:59]
    ds_read_b64_tr_b16 a[110:111], v239 offset:12288
    v_cvt_pk_bf16_f32 v195, v234, v235
    v_mfma_f32_16x16x32_bf16 v[60:63], a[92:95], v[196:199], v[60:63]
    s_waitcnt vmcnt(20)
    v_fma_mix_f32 v232, v140, v200, v208 op_sel:[0,0,0] op_sel_hi:[1,0,0]
    v_fma_mix_f32 v233, v140, v201, v209 op_sel:[1,0,0] op_sel_hi:[1,0,0]
    v_mfma_f32_16x16x32_bf16 v[64:67], a[64:67], v[192:195], v[64:67]
    ds_read_b64_tr_b16 a[112:113], v240 offset:8192
    v_cvt_pk_bf16_f32 v196, v232, v233
    v_mfma_f32_16x16x32_bf16 v[68:71], a[68:71], v[192:195], v[68:71]
    ds_read_b64_tr_b16 a[120:121], v242 offset:8192
    v_fma_mix_f32 v234, v141, v202, v210 op_sel:[0,0,0] op_sel_hi:[1,0,0]
    v_fma_mix_f32 v235, v141, v203, v211 op_sel:[1,0,0] op_sel_hi:[1,0,0]
    v_mfma_f32_16x16x32_bf16 v[72:75], a[72:75], v[192:195], v[72:75]
    ds_read_b64_tr_b16 a[114:115], v240 offset:12288
    v_cvt_pk_bf16_f32 v197, v234, v235
    v_mfma_f32_16x16x32_bf16 v[76:79], a[76:79], v[192:195], v[76:79]
    ds_read_b64_tr_b16 a[122:123], v242 offset:12288
    v_fma_mix_f32 v232, v142, v204, v212 op_sel:[0,0,0] op_sel_hi:[1,0,0]
    v_fma_mix_f32 v233, v142, v205, v213 op_sel:[1,0,0] op_sel_hi:[1,0,0]
    v_mfma_f32_16x16x32_bf16 v[80:83], a[80:83], v[192:195], v[80:83]
    ds_read_b64_tr_b16 a[116:117], v241 offset:8192
    v_cvt_pk_bf16_f32 v198, v232, v233
    v_mfma_f32_16x16x32_bf16 v[84:87], a[84:87], v[192:195], v[84:87]
    v_fma_mix_f32 v234, v143, v206, v214 op_sel:[0,0,0] op_sel_hi:[1,0,0]
    v_fma_mix_f32 v235, v143, v207, v215 op_sel:[1,0,0] op_sel_hi:[1,0,0]
    v_mfma_f32_16x16x32_bf16 v[88:91], a[88:91], v[192:195], v[88:91]
    ds_read_b64_tr_b16 a[118:119], v241 offset:12288
    v_cvt_pk_bf16_f32 v199, v234, v235
    v_mfma_f32_16x16x32_bf16 v[92:95], a[92:95], v[192:195], v[92:95]
    s_waitcnt vmcnt(18) lgkmcnt(14)
    v_fma_mix_f32 v232, v144, v216, v224 op_sel:[0,0,0] op_sel_hi:[1,0,0]
    v_fma_mix_f32 v233, v144, v217, v225 op_sel:[1,0,0] op_sel_hi:[1,0,0]
    v_mfma_f32_16x16x32_bf16 v[96:99], a[64:67], v[196:199], v[96:99]
    ds_read_b64_tr_b16 a[124:125], v243 offset:8192
    v_cvt_pk_bf16_f32 v192, v232, v233
    v_mfma_f32_16x16x32_bf16 v[100:103], a[68:71], v[196:199], v[100:103]
    ds_read_b64_tr_b16 a[126:127], v243 offset:12288
    v_fma_mix_f32 v234, v145, v218, v226 op_sel:[0,0,0] op_sel_hi:[1,0,0]
    v_fma_mix_f32 v235, v145, v219, v227 op_sel:[1,0,0] op_sel_hi:[1,0,0]
    v_mfma_f32_16x16x32_bf16 v[104:107], a[72:75], v[196:199], v[104:107]
    v_cvt_pk_bf16_f32 v193, v234, v235
    v_mfma_f32_16x16x32_bf16 v[108:111], a[76:79], v[196:199], v[108:111]
    s_waitcnt lgkmcnt(10)
    v_fma_mix_f32 v232, v146, v220, v228 op_sel:[0,0,0] op_sel_hi:[1,0,0]
    v_fma_mix_f32 v233, v146, v221, v229 op_sel:[1,0,0] op_sel_hi:[1,0,0]
    v_mfma_f32_16x16x32_bf16 v[112:115], a[80:83], v[196:199], v[112:115]
    v_cvt_pk_bf16_f32 v194, v232, v233
    v_mfma_f32_16x16x32_bf16 v[116:119], a[84:87], v[196:199], v[116:119]
    v_fma_mix_f32 v234, v147, v222, v230 op_sel:[0,0,0] op_sel_hi:[1,0,0]
    v_fma_mix_f32 v235, v147, v223, v231 op_sel:[1,0,0] op_sel_hi:[1,0,0]
    v_mfma_f32_16x16x32_bf16 v[120:123], a[88:91], v[196:199], v[120:123]
    v_cvt_pk_bf16_f32 v195, v234, v235
    v_mfma_f32_16x16x32_bf16 v[124:127], a[92:95], v[196:199], v[124:127]
    s_waitcnt vmcnt(16)
    v_fma_mix_f32 v232, v148, v216, v224 op_sel:[0,0,0] op_sel_hi:[1,0,0]
    v_fma_mix_f32 v233, v148, v217, v225 op_sel:[1,0,0] op_sel_hi:[1,0,0]
    s_waitcnt lgkmcnt(0)
    v_mfma_f32_16x16x32_bf16 v[0:3], a[96:99], v[192:195], v[0:3]
    s_waitcnt vmcnt(13)
    s_barrier
    ds_read_b64_tr_b16 a[64:65], v236 offset:16384
    v_cvt_pk_bf16_f32 v196, v232, v233
    v_mfma_f32_16x16x32_bf16 v[4:7], a[100:103], v[192:195], v[4:7]
    ds_read_b128 v[200:203], v254 offset:256
    v_fma_mix_f32 v234, v149, v218, v226 op_sel:[0,0,0] op_sel_hi:[1,0,0]
    v_fma_mix_f32 v235, v149, v219, v227 op_sel:[1,0,0] op_sel_hi:[1,0,0]
    v_mfma_f32_16x16x32_bf16 v[8:11], a[104:107], v[192:195], v[8:11]
    ds_read_b64_tr_b16 a[66:67], v236 offset:20480
    v_cvt_pk_bf16_f32 v197, v234, v235
    v_mfma_f32_16x16x32_bf16 v[12:15], a[108:111], v[192:195], v[12:15]
    ds_read_b128 v[208:211], v254 offset:2816
    v_fma_mix_f32 v232, v150, v220, v228 op_sel:[0,0,0] op_sel_hi:[1,0,0]
    v_fma_mix_f32 v233, v150, v221, v229 op_sel:[1,0,0] op_sel_hi:[1,0,0]
    v_mfma_f32_16x16x32_bf16 v[16:19], a[112:115], v[192:195], v[16:19]
    ds_read_b64_tr_b16 a[68:69], v237 offset:16384
    v_cvt_pk_bf16_f32 v198, v232, v233
    v_mfma_f32_16x16x32_bf16 v[20:23], a[116:119], v[192:195], v[20:23]
    s_add_u32 m0, s35, 81920
    s_movk_i32 s39, 8192
    buffer_load_dwordx4 v252, s[12:15], s39 offen offset:0 lds
    v_fma_mix_f32 v234, v151, v222, v230 op_sel:[0,0,0] op_sel_hi:[1,0,0]
    v_fma_mix_f32 v235, v151, v223, v231 op_sel:[1,0,0] op_sel_hi:[1,0,0]
    v_mfma_f32_16x16x32_bf16 v[24:27], a[120:123], v[192:195], v[24:27]
    ds_read_b64_tr_b16 a[70:71], v237 offset:20480
    v_cvt_pk_bf16_f32 v199, v234, v235
    v_mfma_f32_16x16x32_bf16 v[28:31], a[124:127], v[192:195], v[28:31]
    v_fma_mix_f32 v232, v152, v216, v224 op_sel:[0,0,0] op_sel_hi:[1,0,0]
    v_fma_mix_f32 v233, v152, v217, v225 op_sel:[1,0,0] op_sel_hi:[1,0,0]
    v_mfma_f32_16x16x32_bf16 v[32:35], a[96:99], v[196:199], v[32:35]
    ds_read_b64_tr_b16 a[72:73], v238 offset:16384
    v_cvt_pk_bf16_f32 v192, v232, v233
    v_mfma_f32_16x16x32_bf16 v[36:39], a[100:103], v[196:199], v[36:39]
    ds_read_b128 v[204:207], v254 offset:320
    v_fma_mix_f32 v234, v153, v218, v226 op_sel:[0,0,0] op_sel_hi:[1,0,0]
    v_fma_mix_f32 v235, v153, v219, v227 op_sel:[1,0,0] op_sel_hi:[1,0,0]
    v_mfma_f32_16x16x32_bf16 v[40:43], a[104:107], v[196:199], v[40:43]
    ds_read_b64_tr_b16 a[74:75], v238 offset:20480
    v_cvt_pk_bf16_f32 v193, v234, v235
    v_mfma_f32_16x16x32_bf16 v[44:47], a[108:111], v[196:199], v[44:47]
    ds_read_b128 v[212:215], v254 offset:2880
    v_fma_mix_f32 v232, v154, v220, v228 op_sel:[0,0,0] op_sel_hi:[1,0,0]
    v_fma_mix_f32 v233, v154, v221, v229 op_sel:[1,0,0] op_sel_hi:[1,0,0]
    v_mfma_f32_16x16x32_bf16 v[48:51], a[112:115], v[196:199], v[48:51]
    ds_read_b64_tr_b16 a[76:77], v239 offset:16384
    v_cvt_pk_bf16_f32 v194, v232, v233
    v_mfma_f32_16x16x32_bf16 v[52:55], a[116:119], v[196:199], v[52:55]
    buffer_load_dwordx4 v253, s[12:15], s39 offen offset:1024 lds
    v_fma_mix_f32 v234, v155, v222, v230 op_sel:[0,0,0] op_sel_hi:[1,0,0]
    v_fma_mix_f32 v235, v155, v223, v231 op_sel:[1,0,0] op_sel_hi:[1,0,0]
    v_mfma_f32_16x16x32_bf16 v[56:59], a[120:123], v[196:199], v[56:59]
    ds_read_b64_tr_b16 a[78:79], v239 offset:20480
    v_cvt_pk_bf16_f32 v195, v234, v235
    v_mfma_f32_16x16x32_bf16 v[60:63], a[124:127], v[196:199], v[60:63]
    s_waitcnt vmcnt(14)
    v_fma_mix_f32 v232, v156, v216, v224 op_sel:[0,0,0] op_sel_hi:[1,0,0]
    v_fma_mix_f32 v233, v156, v217, v225 op_sel:[1,0,0] op_sel_hi:[1,0,0]
    v_mfma_f32_16x16x32_bf16 v[64:67], a[96:99], v[192:195], v[64:67]
    ds_read_b64_tr_b16 a[80:81], v240 offset:16384
    v_cvt_pk_bf16_f32 v196, v232, v233
    v_mfma_f32_16x16x32_bf16 v[68:71], a[100:103], v[192:195], v[68:71]
    ds_read_b64_tr_b16 a[88:89], v242 offset:16384
    v_fma_mix_f32 v234, v157, v218, v226 op_sel:[0,0,0] op_sel_hi:[1,0,0]
    v_fma_mix_f32 v235, v157, v219, v227 op_sel:[1,0,0] op_sel_hi:[1,0,0]
    v_mfma_f32_16x16x32_bf16 v[72:75], a[104:107], v[192:195], v[72:75]
    ds_read_b64_tr_b16 a[82:83], v240 offset:20480
    v_cvt_pk_bf16_f32 v197, v234, v235
    v_mfma_f32_16x16x32_bf16 v[76:79], a[108:111], v[192:195], v[76:79]
    ds_read_b64_tr_b16 a[90:91], v242 offset:20480
    v_fma_mix_f32 v232, v158, v220, v228 op_sel:[0,0,0] op_sel_hi:[1,0,0]
    v_fma_mix_f32 v233, v158, v221, v229 op_sel:[1,0,0] op_sel_hi:[1,0,0]
    v_mfma_f32_16x16x32_bf16 v[80:83], a[112:115], v[192:195], v[80:83]
    ds_read_b64_tr_b16 a[84:85], v241 offset:16384
    v_cvt_pk_bf16_f32 v198, v232, v233
    v_mfma_f32_16x16x32_bf16 v[84:87], a[116:119], v[192:195], v[84:87]
    buffer_load_dwordx4 v252, s[12:15], s39 offen offset:2048 lds
    v_fma_mix_f32 v234, v159, v222, v230 op_sel:[0,0,0] op_sel_hi:[1,0,0]
    v_fma_mix_f32 v235, v159, v223, v231 op_sel:[1,0,0] op_sel_hi:[1,0,0]
    v_mfma_f32_16x16x32_bf16 v[88:91], a[120:123], v[192:195], v[88:91]
    ds_read_b64_tr_b16 a[86:87], v241 offset:20480
    v_cvt_pk_bf16_f32 v199, v234, v235
    v_mfma_f32_16x16x32_bf16 v[92:95], a[124:127], v[192:195], v[92:95]
    s_waitcnt vmcnt(14) lgkmcnt(14)
    v_fma_mix_f32 v232, v160, v200, v208 op_sel:[0,0,0] op_sel_hi:[1,0,0]
    v_fma_mix_f32 v233, v160, v201, v209 op_sel:[1,0,0] op_sel_hi:[1,0,0]
    v_mfma_f32_16x16x32_bf16 v[96:99], a[96:99], v[196:199], v[96:99]
    ds_read_b64_tr_b16 a[92:93], v243 offset:16384
    v_cvt_pk_bf16_f32 v192, v232, v233
    v_mfma_f32_16x16x32_bf16 v[100:103], a[100:103], v[196:199], v[100:103]
    ds_read_b64_tr_b16 a[94:95], v243 offset:20480
    v_fma_mix_f32 v234, v161, v202, v210 op_sel:[0,0,0] op_sel_hi:[1,0,0]
    v_fma_mix_f32 v235, v161, v203, v211 op_sel:[1,0,0] op_sel_hi:[1,0,0]
    v_mfma_f32_16x16x32_bf16 v[104:107], a[104:107], v[196:199], v[104:107]
    v_cvt_pk_bf16_f32 v193, v234, v235
    v_mfma_f32_16x16x32_bf16 v[108:111], a[108:111], v[196:199], v[108:111]
    s_waitcnt lgkmcnt(10)
    v_fma_mix_f32 v232, v162, v204, v212 op_sel:[0,0,0] op_sel_hi:[1,0,0]
    v_fma_mix_f32 v233, v162, v205, v213 op_sel:[1,0,0] op_sel_hi:[1,0,0]
    v_mfma_f32_16x16x32_bf16 v[112:115], a[112:115], v[196:199], v[112:115]
    v_cvt_pk_bf16_f32 v194, v232, v233
    v_mfma_f32_16x16x32_bf16 v[116:119], a[116:119], v[196:199], v[116:119]
    buffer_load_dwordx4 v253, s[12:15], s39 offen offset:3072 lds
    v_fma_mix_f32 v234, v163, v206, v214 op_sel:[0,0,0] op_sel_hi:[1,0,0]
    v_fma_mix_f32 v235, v163, v207, v215 op_sel:[1,0,0] op_sel_hi:[1,0,0]
    v_mfma_f32_16x16x32_bf16 v[120:123], a[120:123], v[196:199], v[120:123]
    v_cvt_pk_bf16_f32 v195, v234, v235
    v_mfma_f32_16x16x32_bf16 v[124:127], a[124:127], v[196:199], v[124:127]
    s_waitcnt vmcnt(14)
    v_fma_mix_f32 v232, v164, v200, v208 op_sel:[0,0,0] op_sel_hi:[1,0,0]
    v_fma_mix_f32 v233, v164, v201, v209 op_sel:[1,0,0] op_sel_hi:[1,0,0]
    s_waitcnt lgkmcnt(0)
    v_mfma_f32_16x16x32_bf16 v[0:3], a[64:67], v[192:195], v[0:3]
    ds_read_b64_tr_b16 a[96:97], v236 offset:24576
    v_cvt_pk_bf16_f32 v196, v232, v233
    v_mfma_f32_16x16x32_bf16 v[4:7], a[68:71], v[192:195], v[4:7]
    ds_read_b128 v[216:219], v254 offset:384
    v_fma_mix_f32 v234, v165, v202, v210 op_sel:[0,0,0] op_sel_hi:[1,0,0]
    v_fma_mix_f32 v235, v165, v203, v211 op_sel:[1,0,0] op_sel_hi:[1,0,0]
    v_mfma_f32_16x16x32_bf16 v[8:11], a[72:75], v[192:195], v[8:11]
    ds_read_b64_tr_b16 a[98:99], v236 offset:28672
    v_cvt_pk_bf16_f32 v197, v234, v235
    v_mfma_f32_16x16x32_bf16 v[12:15], a[76:79], v[192:195], v[12:15]
    ds_read_b128 v[224:227], v254 offset:2944
    v_fma_mix_f32 v232, v166, v204, v212 op_sel:[0,0,0] op_sel_hi:[1,0,0]
    v_fma_mix_f32 v233, v166, v205, v213 op_sel:[1,0,0] op_sel_hi:[1,0,0]
    v_mfma_f32_16x16x32_bf16 v[16:19], a[80:83], v[192:195], v[16:19]
    ds_read_b64_tr_b16 a[100:101], v237 offset:24576
    v_cvt_pk_bf16_f32 v198, v232, v233
    v_mfma_f32_16x16x32_bf16 v[20:23], a[84:87], v[192:195], v[20:23]
    v_fma_mix_f32 v234, v167, v206, v214 op_sel:[0,0,0] op_sel_hi:[1,0,0]
    v_fma_mix_f32 v235, v167, v207, v215 op_sel:[1,0,0] op_sel_hi:[1,0,0]
    v_mfma_f32_16x16x32_bf16 v[24:27], a[88:91], v[192:195], v[24:27]
    ds_read_b64_tr_b16 a[102:103], v237 offset:28672
    v_cvt_pk_bf16_f32 v199, v234, v235
    v_mfma_f32_16x16x32_bf16 v[28:31], a[92:95], v[192:195], v[28:31]
    s_waitcnt vmcnt(13)
    v_fma_mix_f32 v232, v168, v200, v208 op_sel:[0,0,0] op_sel_hi:[1,0,0]
    v_fma_mix_f32 v233, v168, v201, v209 op_sel:[1,0,0] op_sel_hi:[1,0,0]
    v_mfma_f32_16x16x32_bf16 v[32:35], a[64:67], v[196:199], v[32:35]
    ds_read_b64_tr_b16 a[104:105], v238 offset:24576
    v_cvt_pk_bf16_f32 v192, v232, v233
    v_mfma_f32_16x16x32_bf16 v[36:39], a[68:71], v[196:199], v[36:39]
    ds_read_b128 v[220:223], v254 offset:448
    v_fma_mix_f32 v234, v169, v202, v210 op_sel:[0,0,0] op_sel_hi:[1,0,0]
    v_fma_mix_f32 v235, v169, v203, v211 op_sel:[1,0,0] op_sel_hi:[1,0,0]
    v_mfma_f32_16x16x32_bf16 v[40:43], a[72:75], v[196:199], v[40:43]
    ds_read_b64_tr_b16 a[106:107], v238 offset:28672
    v_cvt_pk_bf16_f32 v193, v234, v235
    v_mfma_f32_16x16x32_bf16 v[44:47], a[76:79], v[196:199], v[44:47]
    ds_read_b128 v[228:231], v254 offset:3008
    v_fma_mix_f32 v232, v170, v204, v212 op_sel:[0,0,0] op_sel_hi:[1,0,0]
    v_fma_mix_f32 v233, v170, v205, v213 op_sel:[1,0,0] op_sel_hi:[1,0,0]
    v_mfma_f32_16x16x32_bf16 v[48:51], a[80:83], v[196:199], v[48:51]
    ds_read_b64_tr_b16 a[108:109], v239 offset:24576
    v_cvt_pk_bf16_f32 v194, v232, v233
    v_mfma_f32_16x16x32_bf16 v[52:55], a[84:87], v[196:199], v[52:55]
    v_fma_mix_f32 v234, v171, v206, v214 op_sel:[0,0,0] op_sel_hi:[1,0,0]
    v_fma_mix_f32 v235, v171, v207, v215 op_sel:[1,0,0] op_sel_hi:[1,0,0]
    v_mfma_f32_16x16x32_bf16 v[56:59], a[88:91], v[196:199], v[56:59]
    ds_read_b64_tr_b16 a[110:111], v239 offset:28672
    v_cvt_pk_bf16_f32 v195, v234, v235
    v_mfma_f32_16x16x32_bf16 v[60:63], a[92:95], v[196:199], v[60:63]
    s_waitcnt vmcnt(12)
    v_fma_mix_f32 v232, v172, v200, v208 op_sel:[0,0,0] op_sel_hi:[1,0,0]
    v_fma_mix_f32 v233, v172, v201, v209 op_sel:[1,0,0] op_sel_hi:[1,0,0]
    v_mfma_f32_16x16x32_bf16 v[64:67], a[64:67], v[192:195], v[64:67]
    ds_read_b64_tr_b16 a[112:113], v240 offset:24576
    v_cvt_pk_bf16_f32 v196, v232, v233
    v_mfma_f32_16x16x32_bf16 v[68:71], a[68:71], v[192:195], v[68:71]
    ds_read_b64_tr_b16 a[120:121], v242 offset:24576
    v_fma_mix_f32 v234, v173, v202, v210 op_sel:[0,0,0] op_sel_hi:[1,0,0]
    v_fma_mix_f32 v235, v173, v203, v211 op_sel:[1,0,0] op_sel_hi:[1,0,0]
    v_mfma_f32_16x16x32_bf16 v[72:75], a[72:75], v[192:195], v[72:75]
    ds_read_b64_tr_b16 a[114:115], v240 offset:28672
    v_cvt_pk_bf16_f32 v197, v234, v235
    v_mfma_f32_16x16x32_bf16 v[76:79], a[76:79], v[192:195], v[76:79]
    ds_read_b64_tr_b16 a[122:123], v242 offset:28672
    v_fma_mix_f32 v232, v174, v204, v212 op_sel:[0,0,0] op_sel_hi:[1,0,0]
    v_fma_mix_f32 v233, v174, v205, v213 op_sel:[1,0,0] op_sel_hi:[1,0,0]
    v_mfma_f32_16x16x32_bf16 v[80:83], a[80:83], v[192:195], v[80:83]
    ds_read_b64_tr_b16 a[116:117], v241 offset:24576
    v_cvt_pk_bf16_f32 v198, v232, v233
    v_mfma_f32_16x16x32_bf16 v[84:87], a[84:87], v[192:195], v[84:87]
    v_fma_mix_f32 v234, v175, v206, v214 op_sel:[0,0,0] op_sel_hi:[1,0,0]
    v_fma_mix_f32 v235, v175, v207, v215 op_sel:[1,0,0] op_sel_hi:[1,0,0]
    v_mfma_f32_16x16x32_bf16 v[88:91], a[88:91], v[192:195], v[88:91]
    ds_read_b64_tr_b16 a[118:119], v241 offset:28672
    v_cvt_pk_bf16_f32 v199, v234, v235
    v_mfma_f32_16x16x32_bf16 v[92:95], a[92:95], v[192:195], v[92:95]
    s_waitcnt vmcnt(10) lgkmcnt(14)
    v_fma_mix_f32 v232, v176, v216, v224 op_sel:[0,0,0] op_sel_hi:[1,0,0]
    v_fma_mix_f32 v233, v176, v217, v225 op_sel:[1,0,0] op_sel_hi:[1,0,0]
    v_mfma_f32_16x16x32_bf16 v[96:99], a[64:67], v[196:199], v[96:99]
    ds_read_b64_tr_b16 a[124:125], v243 offset:24576
    v_cvt_pk_bf16_f32 v192, v232, v233
    v_mfma_f32_16x16x32_bf16 v[100:103], a[68:71], v[196:199], v[100:103]
    ds_read_b64_tr_b16 a[126:127], v243 offset:28672
    v_fma_mix_f32 v234, v177, v218, v226 op_sel:[0,0,0] op_sel_hi:[1,0,0]
    v_fma_mix_f32 v235, v177, v219, v227 op_sel:[1,0,0] op_sel_hi:[1,0,0]
    v_mfma_f32_16x16x32_bf16 v[104:107], a[72:75], v[196:199], v[104:107]
    v_cvt_pk_bf16_f32 v193, v234, v235
    v_mfma_f32_16x16x32_bf16 v[108:111], a[76:79], v[196:199], v[108:111]
    s_waitcnt lgkmcnt(10)
    v_fma_mix_f32 v232, v178, v220, v228 op_sel:[0,0,0] op_sel_hi:[1,0,0]
    v_fma_mix_f32 v233, v178, v221, v229 op_sel:[1,0,0] op_sel_hi:[1,0,0]
    v_mfma_f32_16x16x32_bf16 v[112:115], a[80:83], v[196:199], v[112:115]
    v_cvt_pk_bf16_f32 v194, v232, v233
    v_mfma_f32_16x16x32_bf16 v[116:119], a[84:87], v[196:199], v[116:119]
    v_fma_mix_f32 v234, v179, v222, v230 op_sel:[0,0,0] op_sel_hi:[1,0,0]
    v_fma_mix_f32 v235, v179, v223, v231 op_sel:[1,0,0] op_sel_hi:[1,0,0]
    v_mfma_f32_16x16x32_bf16 v[120:123], a[88:91], v[196:199], v[120:123]
    v_cvt_pk_bf16_f32 v195, v234, v235
    v_mfma_f32_16x16x32_bf16 v[124:127], a[92:95], v[196:199], v[124:127]
    s_waitcnt vmcnt(8)
    v_fma_mix_f32 v232, v180, v216, v224 op_sel:[0,0,0] op_sel_hi:[1,0,0]
    v_fma_mix_f32 v233, v180, v217, v225 op_sel:[1,0,0] op_sel_hi:[1,0,0]
    v_and_b32 v168, 15, v249
    v_bfe_u32 v169, v249, 4, 2
    v_add_u32 v170, 0, v169
    v_xor_b32 v170, v170, v168
    v_lshlrev_b32 v170, 4, v170
    v_lshl_add_u32 v164, v168, 8, v170
    v_add_u32 v170, 4, v169
    v_xor_b32 v170, v170, v168
    v_lshlrev_b32 v170, 4, v170
    v_lshl_add_u32 v165, v168, 8, v170
    v_add_u32 v170, 8, v169
    v_xor_b32 v170, v170, v168
    v_lshlrev_b32 v170, 4, v170
    v_lshl_add_u32 v166, v168, 8, v170
    v_add_u32 v170, 12, v169
    v_xor_b32 v170, v170, v168
    v_lshlrev_b32 v170, 4, v170
    v_lshl_add_u32 v167, v168, 8, v170
    v_xor_b32 v236, 0x8000, v236
    v_xor_b32 v237, 0x8000, v237
    v_xor_b32 v238, 0x8000, v238
    v_xor_b32 v239, 0x8000, v239
    v_xor_b32 v240, 0x8000, v240
    v_xor_b32 v241, 0x8000, v241
    v_xor_b32 v242, 0x8000, v242
    v_xor_b32 v243, 0x8000, v243
    s_waitcnt lgkmcnt(0)
    v_mfma_f32_16x16x32_bf16 v[0:3], a[96:99], v[192:195], v[0:3]
    s_waitcnt vmcnt(5)
    s_barrier
    ds_read_b128 a[64:67], v164 offset:8192
    v_cvt_pk_bf16_f32 v196, v232, v233
    v_mfma_f32_16x16x32_bf16 v[4:7], a[100:103], v[192:195], v[4:7]
    ds_read_b128 a[80:83], v164 offset:12288
    v_fma_mix_f32 v234, v181, v218, v226 op_sel:[0,0,0] op_sel_hi:[1,0,0]
    v_fma_mix_f32 v235, v181, v219, v227 op_sel:[1,0,0] op_sel_hi:[1,0,0]
    v_mfma_f32_16x16x32_bf16 v[8:11], a[104:107], v[192:195], v[8:11]
    ds_read_b128 a[68:71], v165 offset:8192
    v_cvt_pk_bf16_f32 v197, v234, v235
    v_mfma_f32_16x16x32_bf16 v[12:15], a[108:111], v[192:195], v[12:15]
    ds_read_b128 a[84:87], v165 offset:12288
    v_fma_mix_f32 v232, v182, v220, v228 op_sel:[0,0,0] op_sel_hi:[1,0,0]
    v_fma_mix_f32 v233, v182, v221, v229 op_sel:[1,0,0] op_sel_hi:[1,0,0]
    v_mfma_f32_16x16x32_bf16 v[16:19], a[112:115], v[192:195], v[16:19]
    ds_read_b128 a[72:75], v166 offset:8192
    v_cvt_pk_bf16_f32 v198, v232, v233
    v_mfma_f32_16x16x32_bf16 v[20:23], a[116:119], v[192:195], v[20:23]
    ds_read_b128 a[88:91], v166 offset:12288
    s_add_u32 m0, s35, 32768
    s_movk_i32 s39, 24576
    buffer_load_dwordx4 v244, s[8:11], s39 offen offset:0 lds
    buffer_load_dwordx4 v245, s[8:11], s39 offen offset:1024 lds
    v_fma_mix_f32 v234, v183, v222, v230 op_sel:[0,0,0] op_sel_hi:[1,0,0]
    v_fma_mix_f32 v235, v183, v223, v231 op_sel:[1,0,0] op_sel_hi:[1,0,0]
    v_mfma_f32_16x16x32_bf16 v[24:27], a[120:123], v[192:195], v[24:27]
    ds_read_b128 a[76:79], v167 offset:8192
    v_cvt_pk_bf16_f32 v199, v234, v235
    v_mfma_f32_16x16x32_bf16 v[28:31], a[124:127], v[192:195], v[28:31]
    v_fma_mix_f32 v232, v184, v216, v224 op_sel:[0,0,0] op_sel_hi:[1,0,0]
    v_fma_mix_f32 v233, v184, v217, v225 op_sel:[1,0,0] op_sel_hi:[1,0,0]
    v_mfma_f32_16x16x32_bf16 v[32:35], a[96:99], v[196:199], v[32:35]
    ds_read_b128 a[92:95], v167 offset:12288
    v_cvt_pk_bf16_f32 v192, v232, v233
    v_mfma_f32_16x16x32_bf16 v[36:39], a[100:103], v[196:199], v[36:39]
    ds_read_b64_tr_b16 a[134:135], v237 offset:12288
    v_fma_mix_f32 v234, v185, v218, v226 op_sel:[0,0,0] op_sel_hi:[1,0,0]
    v_fma_mix_f32 v235, v185, v219, v227 op_sel:[1,0,0] op_sel_hi:[1,0,0]
    v_mfma_f32_16x16x32_bf16 v[40:43], a[104:107], v[196:199], v[40:43]
    ds_read_b64_tr_b16 a[128:129], v236 offset:8192
    v_cvt_pk_bf16_f32 v193, v234, v235
    v_mfma_f32_16x16x32_bf16 v[44:47], a[108:111], v[196:199], v[44:47]
    ds_read_b64_tr_b16 a[136:137], v238 offset:8192
    v_fma_mix_f32 v232, v186, v220, v228 op_sel:[0,0,0] op_sel_hi:[1,0,0]
    v_fma_mix_f32 v233, v186, v221, v229 op_sel:[1,0,0] op_sel_hi:[1,0,0]
    v_mfma_f32_16x16x32_bf16 v[48:51], a[112:115], v[196:199], v[48:51]
    ds_read_b64_tr_b16 a[130:131], v236 offset:12288
    v_cvt_pk_bf16_f32 v194, v232, v233
    v_mfma_f32_16x16x32_bf16 v[52:55], a[116:119], v[196:199], v[52:55]
    ds_read_b64_tr_b16 a[138:139], v238 offset:12288
    buffer_load_dwordx4 v246, s[8:11], s39 offen offset:2048 lds
    buffer_load_dwordx4 v247, s[8:11], s39 offen offset:3072 lds
    v_fma_mix_f32 v234, v187, v222, v230 op_sel:[0,0,0] op_sel_hi:[1,0,0]
    v_fma_mix_f32 v235, v187, v223, v231 op_sel:[1,0,0] op_sel_hi:[1,0,0]
    v_mfma_f32_16x16x32_bf16 v[56:59], a[120:123], v[196:199], v[56:59]
    ds_read_b64_tr_b16 a[132:133], v237 offset:8192
    v_cvt_pk_bf16_f32 v195, v234, v235
    v_mfma_f32_16x16x32_bf16 v[60:63], a[124:127], v[196:199], v[60:63]
    s_waitcnt vmcnt(8)
    v_fma_mix_f32 v232, v188, v216, v224 op_sel:[0,0,0] op_sel_hi:[1,0,0]
    v_fma_mix_f32 v233, v188, v217, v225 op_sel:[1,0,0] op_sel_hi:[1,0,0]
    v_mfma_f32_16x16x32_bf16 v[64:67], a[96:99], v[192:195], v[64:67]
    ds_read_b64_tr_b16 a[140:141], v239 offset:8192
    v_cvt_pk_bf16_f32 v196, v232, v233
    v_mfma_f32_16x16x32_bf16 v[68:71], a[100:103], v[192:195], v[68:71]
    ds_read_b64_tr_b16 a[148:149], v241 offset:8192
    v_fma_mix_f32 v234, v189, v218, v226 op_sel:[0,0,0] op_sel_hi:[1,0,0]
    v_fma_mix_f32 v235, v189, v219, v227 op_sel:[1,0,0] op_sel_hi:[1,0,0]
    v_mfma_f32_16x16x32_bf16 v[72:75], a[104:107], v[192:195], v[72:75]
    ds_read_b64_tr_b16 a[142:143], v239 offset:12288
    v_cvt_pk_bf16_f32 v197, v234, v235
    v_mfma_f32_16x16x32_bf16 v[76:79], a[108:111], v[192:195], v[76:79]
    ds_read_b64_tr_b16 a[150:151], v241 offset:12288
    v_fma_mix_f32 v232, v190, v220, v228 op_sel:[0,0,0] op_sel_hi:[1,0,0]
    v_fma_mix_f32 v233, v190, v221, v229 op_sel:[1,0,0] op_sel_hi:[1,0,0]
    v_mfma_f32_16x16x32_bf16 v[80:83], a[112:115], v[192:195], v[80:83]
    ds_read_b64_tr_b16 a[144:145], v240 offset:8192
    v_cvt_pk_bf16_f32 v198, v232, v233
    v_mfma_f32_16x16x32_bf16 v[84:87], a[116:119], v[192:195], v[84:87]
    ds_read_b64_tr_b16 a[152:153], v242 offset:8192
    s_add_u32 m0, s35, 98304
    s_nop 0
    buffer_load_dwordx4 v252, s[12:15], s39 offen offset:0 lds
    buffer_load_dwordx4 v253, s[12:15], s39 offen offset:1024 lds
    v_fma_mix_f32 v234, v191, v222, v230 op_sel:[0,0,0] op_sel_hi:[1,0,0]
    v_fma_mix_f32 v235, v191, v223, v231 op_sel:[1,0,0] op_sel_hi:[1,0,0]
    v_mfma_f32_16x16x32_bf16 v[88:91], a[120:123], v[192:195], v[88:91]
    ds_read_b64_tr_b16 a[146:147], v240 offset:12288
    v_cvt_pk_bf16_f32 v199, v234, v235
    v_mfma_f32_16x16x32_bf16 v[92:95], a[124:127], v[192:195], v[92:95]
    s_nop 1
    v_mfma_f32_16x16x32_bf16 v[96:99], a[96:99], v[196:199], v[96:99]
    ds_read_b64_tr_b16 a[154:155], v242 offset:12288
    v_mfma_f32_16x16x32_bf16 v[100:103], a[100:103], v[196:199], v[100:103]
    ds_read_b64_tr_b16 a[156:157], v243 offset:8192
    v_mfma_f32_16x16x32_bf16 v[104:107], a[104:107], v[196:199], v[104:107]
    ds_read_b64_tr_b16 a[158:159], v243 offset:12288
    v_mfma_f32_16x16x32_bf16 v[108:111], a[108:111], v[196:199], v[108:111]
    v_mfma_f32_16x16x32_bf16 v[112:115], a[112:115], v[196:199], v[112:115]
    v_mfma_f32_16x16x32_bf16 v[116:119], a[116:119], v[196:199], v[116:119]
    buffer_load_dwordx4 v252, s[12:15], s39 offen offset:2048 lds
    buffer_load_dwordx4 v253, s[12:15], s39 offen offset:3072 lds
    v_mfma_f32_16x16x32_bf16 v[120:123], a[120:123], v[196:199], v[120:123]
    v_mfma_f32_16x16x32_bf16 v[124:127], a[124:127], v[196:199], v[124:127]
    s_add_u32 s44, s44, 4096
    s_add_u32 s45, s45, 4096
    s_add_u32 s46, s46, 4096
    s_add_u32 s47, s47, 4096
    s_xor_b32 s51, s51, 32768
    s_xor_b32 s52, s52, 32768
    s_nop 7
    v_cvt_pk_bf16_f32 v176, v0, v1
    v_cvt_pk_bf16_f32 v177, v2, v3
    v_cvt_pk_bf16_f32 v178, v4, v5
    v_cvt_pk_bf16_f32 v179, v6, v7
    v_cvt_pk_bf16_f32 v180, v8, v9
    v_cvt_pk_bf16_f32 v181, v10, v11
    v_cvt_pk_bf16_f32 v182, v12, v13
    v_cvt_pk_bf16_f32 v183, v14, v15
    v_cvt_pk_bf16_f32 v184, v16, v17
    v_cvt_pk_bf16_f32 v185, v18, v19
    v_cvt_pk_bf16_f32 v186, v20, v21
    v_cvt_pk_bf16_f32 v187, v22, v23
    v_cvt_pk_bf16_f32 v188, v24, v25
    v_cvt_pk_bf16_f32 v189, v26, v27
    v_cvt_pk_bf16_f32 v190, v28, v29
    v_cvt_pk_bf16_f32 v191, v30, v31
    v_permlane32_swap_b32 v176, v178
    v_permlane32_swap_b32 v177, v179
    v_permlane32_swap_b32 v180, v182
    v_permlane32_swap_b32 v181, v183
    v_permlane32_swap_b32 v184, v186
    v_permlane32_swap_b32 v185, v187
    v_permlane32_swap_b32 v188, v190
    v_permlane32_swap_b32 v189, v191
    v_permlane16_swap_b32 v176, v178
    v_permlane16_swap_b32 v177, v179
    v_permlane16_swap_b32 v180, v182
    v_permlane16_swap_b32 v181, v183
    v_permlane16_swap_b32 v184, v186
    v_permlane16_swap_b32 v185, v187
    v_permlane16_swap_b32 v188, v190
    v_permlane16_swap_b32 v189, v191
    v_accvgpr_write_b32 a0, v176
    v_accvgpr_write_b32 a1, v177
    v_accvgpr_write_b32 a2, v178
    v_accvgpr_write_b32 a3, v179
    v_accvgpr_write_b32 a4, v180
    v_accvgpr_write_b32 a5, v181
    v_accvgpr_write_b32 a6, v182
    v_accvgpr_write_b32 a7, v183
    v_accvgpr_write_b32 a8, v184
    v_accvgpr_write_b32 a9, v185
    v_accvgpr_write_b32 a10, v186
    v_accvgpr_write_b32 a11, v187
    v_accvgpr_write_b32 a12, v188
    v_accvgpr_write_b32 a13, v189
    v_accvgpr_write_b32 a14, v190
    v_accvgpr_write_b32 a15, v191
    v_mfma_f32_32x32x16_bf16 v[0:15], a[212:215], a[212:215], 0
    v_mfma_f32_32x32x16_bf16 v[16:31], a[212:215], a[212:215], 0
    v_cvt_pk_bf16_f32 v176, v32, v33
    v_cvt_pk_bf16_f32 v177, v34, v35
    v_cvt_pk_bf16_f32 v178, v36, v37
    v_cvt_pk_bf16_f32 v179, v38, v39
    v_cvt_pk_bf16_f32 v180, v40, v41
    v_cvt_pk_bf16_f32 v181, v42, v43
    v_cvt_pk_bf16_f32 v182, v44, v45
    v_cvt_pk_bf16_f32 v183, v46, v47
    v_cvt_pk_bf16_f32 v184, v48, v49
    v_cvt_pk_bf16_f32 v185, v50, v51
    v_cvt_pk_bf16_f32 v186, v52, v53
    v_cvt_pk_bf16_f32 v187, v54, v55
    v_cvt_pk_bf16_f32 v188, v56, v57
    v_cvt_pk_bf16_f32 v189, v58, v59
    v_cvt_pk_bf16_f32 v190, v60, v61
    v_cvt_pk_bf16_f32 v191, v62, v63
    v_permlane32_swap_b32 v176, v178
    v_permlane32_swap_b32 v177, v179
    v_permlane32_swap_b32 v180, v182
    v_permlane32_swap_b32 v181, v183
    v_permlane32_swap_b32 v184, v186
    v_permlane32_swap_b32 v185, v187
    v_permlane32_swap_b32 v188, v190
    v_permlane32_swap_b32 v189, v191
    v_permlane16_swap_b32 v176, v178
    v_permlane16_swap_b32 v177, v179
    v_permlane16_swap_b32 v180, v182
    v_permlane16_swap_b32 v181, v183
    v_permlane16_swap_b32 v184, v186
    v_permlane16_swap_b32 v185, v187
    v_permlane16_swap_b32 v188, v190
    v_permlane16_swap_b32 v189, v191
    v_accvgpr_write_b32 a16, v176
    v_accvgpr_write_b32 a17, v177
    v_accvgpr_write_b32 a18, v178
    v_accvgpr_write_b32 a19, v179
    v_accvgpr_write_b32 a20, v180
    v_accvgpr_write_b32 a21, v181
    v_accvgpr_write_b32 a22, v182
    v_accvgpr_write_b32 a23, v183
    v_accvgpr_write_b32 a24, v184
    v_accvgpr_write_b32 a25, v185
    v_accvgpr_write_b32 a26, v186
    v_accvgpr_write_b32 a27, v187
    v_accvgpr_write_b32 a28, v188
    v_accvgpr_write_b32 a29, v189
    v_accvgpr_write_b32 a30, v190
    v_accvgpr_write_b32 a31, v191
    v_mfma_f32_32x32x16_bf16 v[32:47], a[212:215], a[212:215], 0
    v_mfma_f32_32x32x16_bf16 v[48:63], a[212:215], a[212:215], 0
    v_cvt_pk_bf16_f32 v176, v64, v65
    v_cvt_pk_bf16_f32 v177, v66, v67
    v_cvt_pk_bf16_f32 v178, v68, v69
    v_cvt_pk_bf16_f32 v179, v70, v71
    v_cvt_pk_bf16_f32 v180, v72, v73
    v_cvt_pk_bf16_f32 v181, v74, v75
    v_cvt_pk_bf16_f32 v182, v76, v77
    v_cvt_pk_bf16_f32 v183, v78, v79
    v_cvt_pk_bf16_f32 v184, v80, v81
    v_cvt_pk_bf16_f32 v185, v82, v83
    v_cvt_pk_bf16_f32 v186, v84, v85
    v_cvt_pk_bf16_f32 v187, v86, v87
    v_cvt_pk_bf16_f32 v188, v88, v89
    v_cvt_pk_bf16_f32 v189, v90, v91
    v_cvt_pk_bf16_f32 v190, v92, v93
    v_cvt_pk_bf16_f32 v191, v94, v95
    v_permlane32_swap_b32 v176, v178
    v_permlane32_swap_b32 v177, v179
    v_permlane32_swap_b32 v180, v182
    v_permlane32_swap_b32 v181, v183
    v_permlane32_swap_b32 v184, v186
    v_permlane32_swap_b32 v185, v187
    v_permlane32_swap_b32 v188, v190
    v_permlane32_swap_b32 v189, v191
    v_permlane16_swap_b32 v176, v178
    v_permlane16_swap_b32 v177, v179
    v_permlane16_swap_b32 v180, v182
    v_permlane16_swap_b32 v181, v183
    v_permlane16_swap_b32 v184, v186
    v_permlane16_swap_b32 v185, v187
    v_permlane16_swap_b32 v188, v190
    v_permlane16_swap_b32 v189, v191
    v_accvgpr_write_b32 a32, v176
    v_accvgpr_write_b32 a33, v177
    v_accvgpr_write_b32 a34, v178
    v_accvgpr_write_b32 a35, v179
    v_accvgpr_write_b32 a36, v180
    v_accvgpr_write_b32 a37, v181
    v_accvgpr_write_b32 a38, v182
    v_accvgpr_write_b32 a39, v183
    v_accvgpr_write_b32 a40, v184
    v_accvgpr_write_b32 a41, v185
    v_accvgpr_write_b32 a42, v186
    v_accvgpr_write_b32 a43, v187
    v_accvgpr_write_b32 a44, v188
    v_accvgpr_write_b32 a45, v189
    v_accvgpr_write_b32 a46, v190
    v_accvgpr_write_b32 a47, v191
    v_mfma_f32_32x32x16_bf16 v[64:79], a[212:215], a[212:215], 0
    v_mfma_f32_32x32x16_bf16 v[80:95], a[212:215], a[212:215], 0
    v_cvt_pk_bf16_f32 v176, v96, v97
    v_cvt_pk_bf16_f32 v177, v98, v99
    v_cvt_pk_bf16_f32 v178, v100, v101
    v_cvt_pk_bf16_f32 v179, v102, v103
    v_cvt_pk_bf16_f32 v180, v104, v105
    v_cvt_pk_bf16_f32 v181, v106, v107
    v_cvt_pk_bf16_f32 v182, v108, v109
    v_cvt_pk_bf16_f32 v183, v110, v111
    v_cvt_pk_bf16_f32 v184, v112, v113
    v_cvt_pk_bf16_f32 v185, v114, v115
    v_cvt_pk_bf16_f32 v186, v116, v117
    v_cvt_pk_bf16_f32 v187, v118, v119
    v_cvt_pk_bf16_f32 v188, v120, v121
    v_cvt_pk_bf16_f32 v189, v122, v123
    v_cvt_pk_bf16_f32 v190, v124, v125
    v_cvt_pk_bf16_f32 v191, v126, v127
    v_permlane32_swap_b32 v176, v178
    v_permlane32_swap_b32 v177, v179
    v_permlane32_swap_b32 v180, v182
    v_permlane32_swap_b32 v181, v183
    v_permlane32_swap_b32 v184, v186
    v_permlane32_swap_b32 v185, v187
    v_permlane32_swap_b32 v188, v190
    v_permlane32_swap_b32 v189, v191
    v_permlane16_swap_b32 v176, v178
    v_permlane16_swap_b32 v177, v179
    v_permlane16_swap_b32 v180, v182
    v_permlane16_swap_b32 v181, v183
    v_permlane16_swap_b32 v184, v186
    v_permlane16_swap_b32 v185, v187
    v_permlane16_swap_b32 v188, v190
    v_permlane16_swap_b32 v189, v191
    v_accvgpr_write_b32 a48, v176
    v_accvgpr_write_b32 a49, v177
    v_accvgpr_write_b32 a50, v178
    v_accvgpr_write_b32 a51, v179
    v_accvgpr_write_b32 a52, v180
    v_accvgpr_write_b32 a53, v181
    v_accvgpr_write_b32 a54, v182
    v_accvgpr_write_b32 a55, v183
    v_accvgpr_write_b32 a56, v184
    v_accvgpr_write_b32 a57, v185
    v_accvgpr_write_b32 a58, v186
    v_accvgpr_write_b32 a59, v187
    v_accvgpr_write_b32 a60, v188
    v_accvgpr_write_b32 a61, v189
    v_accvgpr_write_b32 a62, v190
    v_accvgpr_write_b32 a63, v191
    v_mfma_f32_32x32x16_bf16 v[96:111], a[212:215], a[212:215], 0
    v_mfma_f32_32x32x16_bf16 v[112:127], a[212:215], a[212:215], 0
    v_mov_b32 v144, 0
    v_mov_b32 v145, 0
    v_mov_b32 v146, 0
    v_mov_b32 v147, 0
    v_mov_b32 v148, 0
    v_mov_b32 v149, 0
    v_mov_b32 v150, 0
    v_mov_b32 v151, 0
    v_mov_b32 v160, 0
    v_mov_b32 v161, 0
    v_mov_b32 v162, 0
    v_mov_b32 v163, 0
    v_mov_b32 v152, 0
    v_mov_b32 v153, 0
    v_mov_b32 v154, 0
    v_mov_b32 v155, 0
    v_mov_b32 v156, 0
    v_mov_b32 v157, 0
    v_mov_b32 v158, 0
    v_mov_b32 v159, 0
    s_mov_b32 s36, 40960
    s_waitcnt lgkmcnt(15)
    v_mfma_f32_16x16x32_bf16 v[128:131], a[64:67], a[0:3], 0
    v_mfma_f32_16x16x32_bf16 v[128:131], a[68:71], a[4:7], v[128:131]
    v_mfma_f32_16x16x32_bf16 v[128:131], a[72:75], a[8:11], v[128:131]
    v_mfma_f32_16x16x32_bf16 v[128:131], a[76:79], a[12:15], v[128:131]
    v_mfma_f32_16x16x32_bf16 v[132:135], a[80:83], a[0:3], 0
    v_mfma_f32_16x16x32_bf16 v[132:135], a[84:87], a[4:7], v[132:135]
    v_mfma_f32_16x16x32_bf16 v[132:135], a[88:91], a[8:11], v[132:135]
    v_mfma_f32_16x16x32_bf16 v[132:135], a[92:95], a[12:15], v[132:135]
    s_nop 1
    s_mov_b32 s38, 8
L_attn_main:
    v_mfma_f32_16x16x32_bf16 v[136:139], a[64:67], a[16:19], 0
    s_waitcnt vmcnt(8)
    s_barrier
    v_exp_f32 v152, v128
    v_mfma_f32_16x16x32_bf16 v[136:139], a[68:71], a[20:23], v[136:139]
    ds_read_b128 a[96:99], v164 offset:16384
    v_add_f32 v163, v157, v163
    v_mfma_f32_16x16x32_bf16 v[136:139], a[72:75], a[24:27], v[136:139]
    v_exp_f32 v153, v129
    v_mfma_f32_16x16x32_bf16 v[136:139], a[76:79], a[28:31], v[136:139]
    ds_read_b128 a[100:103], v165 offset:16384
    v_cvt_pk_bf16_f32 v144, v152, v153
    v_mfma_f32_16x16x32_bf16 v[96:99], a[160:163], v[148:151], v[96:99]
    v_exp_f32 v154, v130
    v_mfma_f32_16x16x32_bf16 v[100:103], a[164:167], v[148:151], v[100:103]
    ds_read_b128 a[104:107], v166 offset:16384
    v_add_f32 v163, v158, v163
    v_mfma_f32_16x16x32_bf16 v[104:107], a[168:171], v[148:151], v[104:107]
    v_exp_f32 v155, v131
    v_mfma_f32_16x16x32_bf16 v[108:111], a[172:175], v[148:151], v[108:111]
    ds_read_b128 a[108:111], v167 offset:16384
    v_cvt_pk_bf16_f32 v145, v154, v155
    v_mfma_f32_16x16x32_bf16 v[140:143], a[80:83], a[16:19], 0
    v_exp_f32 v156, v132
    v_mfma_f32_16x16x32_bf16 v[140:143], a[84:87], a[20:23], v[140:143]
    ds_read_b128 a[112:115], v164 offset:20480
    v_add_f32 v163, v159, v163
    v_mfma_f32_16x16x32_bf16 v[140:143], a[88:91], a[24:27], v[140:143]
    s_min_u32 s39, s36, s37
    v_exp_f32 v157, v133
    v_mfma_f32_16x16x32_bf16 v[140:143], a[92:95], a[28:31], v[140:143]
    ds_read_b128 a[116:119], v165 offset:20480
    v_cvt_pk_bf16_f32 v146, v156, v157
    v_mfma_f32_16x16x32_bf16 v[112:115], a[176:179], v[148:151], v[112:115]
    s_add_u32 m0, s35, 49152
    v_exp_f32 v158, v134
    v_mfma_f32_16x16x32_bf16 v[116:119], a[180:183], v[148:151], v[116:119]
    buffer_load_dwordx4 v244, s[8:11], s39 offen offset:0 lds
    v_mfma_f32_16x16x32_bf16 v[120:123], a[184:187], v[148:151], v[120:123]
    v_exp_f32 v159, v135
    v_mfma_f32_16x16x32_bf16 v[124:127], a[188:191], v[148:151], v[124:127]
    v_cvt_pk_bf16_f32 v147, v158, v159
    v_mfma_f32_16x16x32_bf16 v[128:131], a[64:67], a[32:35], 0
    v_exp_f32 v152, v136
    v_mfma_f32_16x16x32_bf16 v[128:131], a[68:71], a[36:39], v[128:131]
    ds_read_b128 a[120:123], v166 offset:20480
    v_add_f32 v161, v152, v161
    v_mfma_f32_16x16x32_bf16 v[128:131], a[72:75], a[40:43], v[128:131]
    v_exp_f32 v153, v137
    v_mfma_f32_16x16x32_bf16 v[128:131], a[76:79], a[44:47], v[128:131]
    ds_read_b128 a[124:127], v167 offset:20480
    v_cvt_pk_bf16_f32 v148, v152, v153
    s_waitcnt lgkmcnt(8)
    v_mfma_f32_16x16x32_bf16 v[0:3], a[128:131], v[144:147], v[0:3]
    v_exp_f32 v154, v138
    v_mfma_f32_16x16x32_bf16 v[4:7], a[132:135], v[144:147], v[4:7]
    ds_read_b64_tr_b16 a[160:161], v236 offset:16384
    v_add_f32 v161, v153, v161
    v_mfma_f32_16x16x32_bf16 v[8:11], a[136:139], v[144:147], v[8:11]
    v_exp_f32 v155, v139
    v_mfma_f32_16x16x32_bf16 v[12:15], a[140:143], v[144:147], v[12:15]
    ds_read_b64_tr_b16 a[162:163], v236 offset:20480
    v_cvt_pk_bf16_f32 v149, v154, v155
    v_mfma_f32_16x16x32_bf16 a[192:195], a[208:211], v[144:147], a[192:195]
    v_mfma_f32_16x16x32_bf16 v[132:135], a[80:83], a[32:35], 0
    v_exp_f32 v156, v140
    v_mfma_f32_16x16x32_bf16 v[132:135], a[84:87], a[36:39], v[132:135]
    ds_read_b64_tr_b16 a[164:165], v237 offset:16384
    v_add_f32 v161, v154, v161
    v_mfma_f32_16x16x32_bf16 v[132:135], a[88:91], a[40:43], v[132:135]
    v_exp_f32 v157, v141
    v_mfma_f32_16x16x32_bf16 v[132:135], a[92:95], a[44:47], v[132:135]
    ds_read_b64_tr_b16 a[166:167], v237 offset:20480
    v_cvt_pk_bf16_f32 v150, v156, v157
    v_mfma_f32_16x16x32_bf16 v[16:19], a[144:147], v[144:147], v[16:19]
    v_exp_f32 v158, v142
    v_mfma_f32_16x16x32_bf16 v[20:23], a[148:151], v[144:147], v[20:23]
    buffer_load_dwordx4 v245, s[8:11], s39 offen offset:1024 lds
    v_add_f32 v161, v155, v161
    v_mfma_f32_16x16x32_bf16 v[24:27], a[152:155], v[144:147], v[24:27]
    v_exp_f32 v159, v143
    v_mfma_f32_16x16x32_bf16 v[28:31], a[156:159], v[144:147], v[28:31]
    v_cvt_pk_bf16_f32 v151, v158, v159
    v_add_f32 v161, v156, v161
    v_mfma_f32_16x16x32_bf16 v[136:139], a[64:67], a[48:51], 0
    v_exp_f32 v152, v128
    v_mfma_f32_16x16x32_bf16 v[136:139], a[68:71], a[52:55], v[136:139]
    ds_read_b64_tr_b16 a[168:169], v238 offset:16384
    v_add_f32 v161, v157, v161
    v_mfma_f32_16x16x32_bf16 v[136:139], a[72:75], a[56:59], v[136:139]
    v_exp_f32 v153, v129
    v_mfma_f32_16x16x32_bf16 v[136:139], a[76:79], a[60:63], v[136:139]
    ds_read_b64_tr_b16 a[170:171], v238 offset:20480
    v_cvt_pk_bf16_f32 v144, v152, v153
    v_mfma_f32_16x16x32_bf16 v[32:35], a[128:131], v[148:151], v[32:35]
    v_exp_f32 v154, v130
    v_mfma_f32_16x16x32_bf16 v[36:39], a[132:135], v[148:151], v[36:39]
    ds_read_b64_tr_b16 a[172:173], v239 offset:16384
    v_add_f32 v161, v158, v161
    v_mfma_f32_16x16x32_bf16 v[40:43], a[136:139], v[148:151], v[40:43]
    v_exp_f32 v155, v131
    v_mfma_f32_16x16x32_bf16 v[44:47], a[140:143], v[148:151], v[44:47]
    ds_read_b64_tr_b16 a[174:175], v239 offset:20480
    v_cvt_pk_bf16_f32 v145, v154, v155
    v_mfma_f32_16x16x32_bf16 v[140:143], a[80:83], a[48:51], 0
    v_exp_f32 v156, v132
    v_mfma_f32_16x16x32_bf16 v[140:143], a[84:87], a[52:55], v[140:143]
    ds_read_b64_tr_b16 a[176:177], v240 offset:16384
    v_add_f32 v161, v159, v161
    v_mfma_f32_16x16x32_bf16 v[140:143], a[88:91], a[56:59], v[140:143]
    v_exp_f32 v157, v133
    v_mfma_f32_16x16x32_bf16 v[140:143], a[92:95], a[60:63], v[140:143]
    ds_read_b64_tr_b16 a[178:179], v240 offset:20480
    v_cvt_pk_bf16_f32 v146, v156, v157
    v_mfma_f32_16x16x32_bf16 v[48:51], a[144:147], v[148:151], v[48:51]
    v_exp_f32 v158, v134
    v_mfma_f32_16x16x32_bf16 v[52:55], a[148:151], v[148:151], v[52:55]
    buffer_load_dwordx4 v246, s[8:11], s39 offen offset:2048 lds
    v_mfma_f32_16x16x32_bf16 v[56:59], a[152:155], v[148:151], v[56:59]
    v_exp_f32 v159, v135
    v_mfma_f32_16x16x32_bf16 v[60:63], a[156:159], v[148:151], v[60:63]
    v_cvt_pk_bf16_f32 v147, v158, v159
    s_waitcnt lgkmcnt(10)
    v_mfma_f32_16x16x32_bf16 v[128:131], a[96:99], a[0:3], 0
    v_exp_f32 v152, v136
    v_mfma_f32_16x16x32_bf16 v[128:131], a[100:103], a[4:7], v[128:131]
    ds_read_b64_tr_b16 a[180:181], v241 offset:16384
    v_add_f32 v163, v152, v163
    v_mfma_f32_16x16x32_bf16 v[128:131], a[104:107], a[8:11], v[128:131]
    v_exp_f32 v153, v137
    v_mfma_f32_16x16x32_bf16 v[128:131], a[108:111], a[12:15], v[128:131]
    ds_read_b64_tr_b16 a[182:183], v241 offset:20480
    v_cvt_pk_bf16_f32 v148, v152, v153
    v_mfma_f32_16x16x32_bf16 v[64:67], a[128:131], v[144:147], v[64:67]
    v_exp_f32 v154, v138
    v_mfma_f32_16x16x32_bf16 v[68:71], a[132:135], v[144:147], v[68:71]
    ds_read_b64_tr_b16 a[184:185], v242 offset:16384
    v_add_f32 v163, v153, v163
    v_mfma_f32_16x16x32_bf16 v[72:75], a[136:139], v[144:147], v[72:75]
    v_exp_f32 v155, v139
    v_mfma_f32_16x16x32_bf16 v[76:79], a[140:143], v[144:147], v[76:79]
    ds_read_b64_tr_b16 a[186:187], v242 offset:20480
    v_cvt_pk_bf16_f32 v149, v154, v155
    v_mfma_f32_16x16x32_bf16 a[200:203], a[208:211], v[144:147], a[200:203]
    v_mfma_f32_16x16x32_bf16 v[132:135], a[112:115], a[0:3], 0
    v_exp_f32 v156, v140
    v_mfma_f32_16x16x32_bf16 v[132:135], a[116:119], a[4:7], v[132:135]
    ds_read_b64_tr_b16 a[188:189], v243 offset:16384
    v_add_f32 v163, v154, v163
    v_mfma_f32_16x16x32_bf16 v[132:135], a[120:123], a[8:11], v[132:135]
    v_exp_f32 v157, v141
    v_mfma_f32_16x16x32_bf16 v[132:135], a[124:127], a[12:15], v[132:135]
    ds_read_b64_tr_b16 a[190:191], v243 offset:20480
    v_cvt_pk_bf16_f32 v150, v156, v157
    v_mfma_f32_16x16x32_bf16 v[80:83], a[144:147], v[144:147], v[80:83]
    v_exp_f32 v158, v142
    v_mfma_f32_16x16x32_bf16 v[84:87], a[148:151], v[144:147], v[84:87]
    buffer_load_dwordx4 v247, s[8:11], s39 offen offset:3072 lds
    v_add_f32 v163, v155, v163
    v_mfma_f32_16x16x32_bf16 v[88:91], a[152:155], v[144:147], v[88:91]
    v_exp_f32 v159, v143
    v_mfma_f32_16x16x32_bf16 v[92:95], a[156:159], v[144:147], v[92:95]
    v_cvt_pk_bf16_f32 v151, v158, v159
    v_add_f32 v163, v156, v163
    v_mfma_f32_16x16x32_bf16 v[136:139], a[96:99], a[16:19], 0
    v_exp_f32 v152, v128
    v_mfma_f32_16x16x32_bf16 v[136:139], a[100:103], a[20:23], v[136:139]
    ds_read_b128 a[64:67], v164 offset:24576
    v_add_f32 v163, v157, v163
    v_mfma_f32_16x16x32_bf16 v[136:139], a[104:107], a[24:27], v[136:139]
    v_exp_f32 v153, v129
    v_mfma_f32_16x16x32_bf16 v[136:139], a[108:111], a[28:31], v[136:139]
    ds_read_b128 a[68:71], v165 offset:24576
    v_cvt_pk_bf16_f32 v144, v152, v153
    v_mfma_f32_16x16x32_bf16 v[96:99], a[128:131], v[148:151], v[96:99]
    v_exp_f32 v154, v130
    v_mfma_f32_16x16x32_bf16 v[100:103], a[132:135], v[148:151], v[100:103]
    ds_read_b128 a[72:75], v166 offset:24576
    v_add_f32 v163, v158, v163
    v_mfma_f32_16x16x32_bf16 v[104:107], a[136:139], v[148:151], v[104:107]
    v_exp_f32 v155, v131
    v_mfma_f32_16x16x32_bf16 v[108:111], a[140:143], v[148:151], v[108:111]
    ds_read_b128 a[76:79], v167 offset:24576
    v_cvt_pk_bf16_f32 v145, v154, v155
    v_mfma_f32_16x16x32_bf16 v[140:143], a[112:115], a[16:19], 0
    v_exp_f32 v156, v132
    v_mfma_f32_16x16x32_bf16 v[140:143], a[116:119], a[20:23], v[140:143]
    ds_read_b128 a[80:83], v164 offset:28672
    v_add_f32 v163, v159, v163
    v_mfma_f32_16x16x32_bf16 v[140:143], a[120:123], a[24:27], v[140:143]
    s_add_u32 m0, s35, 114688
    v_exp_f32 v157, v133
    v_mfma_f32_16x16x32_bf16 v[140:143], a[124:127], a[28:31], v[140:143]
    ds_read_b128 a[84:87], v165 offset:28672
    v_cvt_pk_bf16_f32 v146, v156, v157
    v_mfma_f32_16x16x32_bf16 v[112:115], a[144:147], v[148:151], v[112:115]
    v_exp_f32 v158, v134
    v_mfma_f32_16x16x32_bf16 v[116:119], a[148:151], v[148:151], v[116:119]
    buffer_load_dwordx4 v252, s[12:15], s39 offen offset:0 lds
    v_mfma_f32_16x16x32_bf16 v[120:123], a[152:155], v[148:151], v[120:123]
    v_exp_f32 v159, v135
    v_mfma_f32_16x16x32_bf16 v[124:127], a[156:159], v[148:151], v[124:127]
    v_cvt_pk_bf16_f32 v147, v158, v159
    v_mfma_f32_16x16x32_bf16 v[128:131], a[96:99], a[32:35], 0
    v_exp_f32 v152, v136
    v_mfma_f32_16x16x32_bf16 v[128:131], a[100:103], a[36:39], v[128:131]
    ds_read_b128 a[88:91], v166 offset:28672
    v_add_f32 v161, v152, v161
    v_mfma_f32_16x16x32_bf16 v[128:131], a[104:107], a[40:43], v[128:131]
    v_exp_f32 v153, v137
    v_mfma_f32_16x16x32_bf16 v[128:131], a[108:111], a[44:47], v[128:131]
    ds_read_b128 a[92:95], v167 offset:28672
    v_cvt_pk_bf16_f32 v148, v152, v153
    s_waitcnt lgkmcnt(8)
    v_mfma_f32_16x16x32_bf16 v[0:3], a[160:163], v[144:147], v[0:3]
    v_exp_f32 v154, v138
    v_mfma_f32_16x16x32_bf16 v[4:7], a[164:167], v[144:147], v[4:7]
    ds_read_b64_tr_b16 a[128:129], v236 offset:24576
    v_add_f32 v161, v153, v161
    v_mfma_f32_16x16x32_bf16 v[8:11], a[168:171], v[144:147], v[8:11]
    v_exp_f32 v155, v139
    v_mfma_f32_16x16x32_bf16 v[12:15], a[172:175], v[144:147], v[12:15]
    ds_read_b64_tr_b16 a[130:131], v236 offset:28672
    v_cvt_pk_bf16_f32 v149, v154, v155
    v_mfma_f32_16x16x32_bf16 a[192:195], a[208:211], v[144:147], a[192:195]
    v_mfma_f32_16x16x32_bf16 v[132:135], a[112:115], a[32:35], 0
    v_exp_f32 v156, v140
    v_mfma_f32_16x16x32_bf16 v[132:135], a[116:119], a[36:39], v[132:135]
    ds_read_b64_tr_b16 a[132:133], v237 offset:24576
    v_add_f32 v161, v154, v161
    v_mfma_f32_16x16x32_bf16 v[132:135], a[120:123], a[40:43], v[132:135]
    v_exp_f32 v157, v141
    v_mfma_f32_16x16x32_bf16 v[132:135], a[124:127], a[44:47], v[132:135]
    ds_read_b64_tr_b16 a[134:135], v237 offset:28672
    v_cvt_pk_bf16_f32 v150, v156, v157
    v_mfma_f32_16x16x32_bf16 v[16:19], a[176:179], v[144:147], v[16:19]
    v_exp_f32 v158, v142
    v_mfma_f32_16x16x32_bf16 v[20:23], a[180:183], v[144:147], v[20:23]
    buffer_load_dwordx4 v253, s[12:15], s39 offen offset:1024 lds
    v_add_f32 v161, v155, v161
    v_mfma_f32_16x16x32_bf16 v[24:27], a[184:187], v[144:147], v[24:27]
    v_exp_f32 v159, v143
    v_mfma_f32_16x16x32_bf16 v[28:31], a[188:191], v[144:147], v[28:31]
    v_cvt_pk_bf16_f32 v151, v158, v159
    v_add_f32 v161, v156, v161
    v_mfma_f32_16x16x32_bf16 v[136:139], a[96:99], a[48:51], 0
    v_exp_f32 v152, v128
    v_mfma_f32_16x16x32_bf16 v[136:139], a[100:103], a[52:55], v[136:139]
    ds_read_b64_tr_b16 a[136:137], v238 offset:24576
    v_add_f32 v161, v157, v161
    v_mfma_f32_16x16x32_bf16 v[136:139], a[104:107], a[56:59], v[136:139]
    v_exp_f32 v153, v129
    v_mfma_f32_16x16x32_bf16 v[136:139], a[108:111], a[60:63], v[136:139]
    ds_read_b64_tr_b16 a[138:139], v238 offset:28672
    v_cvt_pk_bf16_f32 v144, v152, v153
    v_mfma_f32_16x16x32_bf16 v[32:35], a[160:163], v[148:151], v[32:35]
    v_exp_f32 v154, v130
    v_mfma_f32_16x16x32_bf16 v[36:39], a[164:167], v[148:151], v[36:39]
    ds_read_b64_tr_b16 a[140:141], v239 offset:24576
    v_add_f32 v161, v158, v161
    v_mfma_f32_16x16x32_bf16 v[40:43], a[168:171], v[148:151], v[40:43]
    v_exp_f32 v155, v131
    v_mfma_f32_16x16x32_bf16 v[44:47], a[172:175], v[148:151], v[44:47]
    ds_read_b64_tr_b16 a[142:143], v239 offset:28672
    v_cvt_pk_bf16_f32 v145, v154, v155
    v_mfma_f32_16x16x32_bf16 v[140:143], a[112:115], a[48:51], 0
    v_exp_f32 v156, v132
    v_mfma_f32_16x16x32_bf16 v[140:143], a[116:119], a[52:55], v[140:143]
    ds_read_b64_tr_b16 a[144:145], v240 offset:24576
    v_add_f32 v161, v159, v161
    v_mfma_f32_16x16x32_bf16 v[140:143], a[120:123], a[56:59], v[140:143]
    v_exp_f32 v157, v133
    v_mfma_f32_16x16x32_bf16 v[140:143], a[124:127], a[60:63], v[140:143]
    ds_read_b64_tr_b16 a[146:147], v240 offset:28672
    v_cvt_pk_bf16_f32 v146, v156, v157
    v_mfma_f32_16x16x32_bf16 v[48:51], a[176:179], v[148:151], v[48:51]
    v_exp_f32 v158, v134
    v_mfma_f32_16x16x32_bf16 v[52:55], a[180:183], v[148:151], v[52:55]
    buffer_load_dwordx4 v252, s[12:15], s39 offen offset:2048 lds
    v_mfma_f32_16x16x32_bf16 v[56:59], a[184:187], v[148:151], v[56:59]
    v_exp_f32 v159, v135
    v_mfma_f32_16x16x32_bf16 v[60:63], a[188:191], v[148:151], v[60:63]
    v_cvt_pk_bf16_f32 v147, v158, v159
    s_waitcnt lgkmcnt(10)
    v_mfma_f32_16x16x32_bf16 v[128:131], a[64:67], a[0:3], 0
    v_exp_f32 v152, v136
    v_mfma_f32_16x16x32_bf16 v[128:131], a[68:71], a[4:7], v[128:131]
    ds_read_b64_tr_b16 a[148:149], v241 offset:24576
    v_add_f32 v163, v152, v163
    v_mfma_f32_16x16x32_bf16 v[128:131], a[72:75], a[8:11], v[128:131]
    v_exp_f32 v153, v137
    v_mfma_f32_16x16x32_bf16 v[128:131], a[76:79], a[12:15], v[128:131]
    ds_read_b64_tr_b16 a[150:151], v241 offset:28672
    v_cvt_pk_bf16_f32 v148, v152, v153
    v_mfma_f32_16x16x32_bf16 v[64:67], a[160:163], v[144:147], v[64:67]
    v_exp_f32 v154, v138
    v_mfma_f32_16x16x32_bf16 v[68:71], a[164:167], v[144:147], v[68:71]
    ds_read_b64_tr_b16 a[152:153], v242 offset:24576
    v_add_f32 v163, v153, v163
    v_mfma_f32_16x16x32_bf16 v[72:75], a[168:171], v[144:147], v[72:75]
    v_exp_f32 v155, v139
    v_mfma_f32_16x16x32_bf16 v[76:79], a[172:175], v[144:147], v[76:79]
    ds_read_b64_tr_b16 a[154:155], v242 offset:28672
    v_cvt_pk_bf16_f32 v149, v154, v155
    v_mfma_f32_16x16x32_bf16 a[200:203], a[208:211], v[144:147], a[200:203]
    v_mfma_f32_16x16x32_bf16 v[132:135], a[80:83], a[0:3], 0
    v_exp_f32 v156, v140
    v_mfma_f32_16x16x32_bf16 v[132:135], a[84:87], a[4:7], v[132:135]
    ds_read_b64_tr_b16 a[156:157], v243 offset:24576
    v_add_f32 v163, v154, v163
    v_mfma_f32_16x16x32_bf16 v[132:135], a[88:91], a[8:11], v[132:135]
    v_exp_f32 v157, v141
    v_mfma_f32_16x16x32_bf16 v[132:135], a[92:95], a[12:15], v[132:135]
    ds_read_b64_tr_b16 a[158:159], v243 offset:28672
    v_cvt_pk_bf16_f32 v150, v156, v157
    v_mfma_f32_16x16x32_bf16 v[80:83], a[176:179], v[144:147], v[80:83]
    v_exp_f32 v158, v142
    v_mfma_f32_16x16x32_bf16 v[84:87], a[180:183], v[144:147], v[84:87]
    buffer_load_dwordx4 v253, s[12:15], s39 offen offset:3072 lds
    v_add_f32 v163, v155, v163
    v_mfma_f32_16x16x32_bf16 v[88:91], a[184:187], v[144:147], v[88:91]
    s_add_u32 s36, s36, 16384
    v_exp_f32 v159, v143
    v_mfma_f32_16x16x32_bf16 v[92:95], a[188:191], v[144:147], v[92:95]
    v_cvt_pk_bf16_f32 v151, v158, v159
    v_add_f32 v163, v156, v163
    v_mfma_f32_16x16x32_bf16 v[136:139], a[64:67], a[16:19], 0
    s_waitcnt vmcnt(8)
    s_barrier
    v_exp_f32 v152, v128
    v_mfma_f32_16x16x32_bf16 v[136:139], a[68:71], a[20:23], v[136:139]
    ds_read_b128 a[96:99], v164 offset:32768
    v_add_f32 v163, v157, v163
    v_mfma_f32_16x16x32_bf16 v[136:139], a[72:75], a[24:27], v[136:139]
    v_exp_f32 v153, v129
    v_mfma_f32_16x16x32_bf16 v[136:139], a[76:79], a[28:31], v[136:139]
    ds_read_b128 a[100:103], v165 offset:32768
    v_cvt_pk_bf16_f32 v144, v152, v153
    v_mfma_f32_16x16x32_bf16 v[96:99], a[160:163], v[148:151], v[96:99]
    v_exp_f32 v154, v130
    v_mfma_f32_16x16x32_bf16 v[100:103], a[164:167], v[148:151], v[100:103]
    ds_read_b128 a[104:107], v166 offset:32768
    v_add_f32 v163, v158, v163
    v_mfma_f32_16x16x32_bf16 v[104:107], a[168:171], v[148:151], v[104:107]
    v_exp_f32 v155, v131
    v_mfma_f32_16x16x32_bf16 v[108:111], a[172:175], v[148:151], v[108:111]
    ds_read_b128 a[108:111], v167 offset:32768
    v_cvt_pk_bf16_f32 v145, v154, v155
    v_mfma_f32_16x16x32_bf16 v[140:143], a[80:83], a[16:19], 0
    v_exp_f32 v156, v132
    v_mfma_f32_16x16x32_bf16 v[140:143], a[84:87], a[20:23], v[140:143]
    ds_read_b128 a[112:115], v164 offset:36864
    v_add_f32 v163, v159, v163
    v_mfma_f32_16x16x32_bf16 v[140:143], a[88:91], a[24:27], v[140:143]
    s_min_u32 s39, s36, s37
    v_exp_f32 v157, v133
    v_mfma_f32_16x16x32_bf16 v[140:143], a[92:95], a[28:31], v[140:143]
    ds_read_b128 a[116:119], v165 offset:36864
    v_cvt_pk_bf16_f32 v146, v156, v157
    v_mfma_f32_16x16x32_bf16 v[112:115], a[176:179], v[148:151], v[112:115]
    s_add_u32 m0, s35, 0
    v_exp_f32 v158, v134
    v_mfma_f32_16x16x32_bf16 v[116:119], a[180:183], v[148:151], v[116:119]
    buffer_load_dwordx4 v244, s[8:11], s39 offen offset:0 lds
    v_mfma_f32_16x16x32_bf16 v[120:123], a[184:187], v[148:151], v[120:123]
    v_exp_f32 v159, v135
    v_mfma_f32_16x16x32_bf16 v[124:127], a[188:191], v[148:151], v[124:127]
    v_cvt_pk_bf16_f32 v147, v158, v159
    v_mfma_f32_16x16x32_bf16 v[128:131], a[64:67], a[32:35], 0
    v_exp_f32 v152, v136
    v_mfma_f32_16x16x32_bf16 v[128:131], a[68:71], a[36:39], v[128:131]
    ds_read_b128 a[120:123], v166 offset:36864
    v_add_f32 v161, v152, v161
    v_mfma_f32_16x16x32_bf16 v[128:131], a[72:75], a[40:43], v[128:131]
    v_exp_f32 v153, v137
    v_mfma_f32_16x16x32_bf16 v[128:131], a[76:79], a[44:47], v[128:131]
    ds_read_b128 a[124:127], v167 offset:36864
    v_cvt_pk_bf16_f32 v148, v152, v153
    s_waitcnt lgkmcnt(8)
    v_mfma_f32_16x16x32_bf16 v[0:3], a[128:131], v[144:147], v[0:3]
    v_exp_f32 v154, v138
    v_mfma_f32_16x16x32_bf16 v[4:7], a[132:135], v[144:147], v[4:7]
    ds_read_b64_tr_b16 a[160:161], v236 offset:32768
    v_add_f32 v161, v153, v161
    v_mfma_f32_16x16x32_bf16 v[8:11], a[136:139], v[144:147], v[8:11]
    v_exp_f32 v155, v139
    v_mfma_f32_16x16x32_bf16 v[12:15], a[140:143], v[144:147], v[12:15]
    ds_read_b64_tr_b16 a[162:163], v236 offset:36864
    v_cvt_pk_bf16_f32 v149, v154, v155
    v_mfma_f32_16x16x32_bf16 a[192:195], a[208:211], v[144:147], a[192:195]
    v_mfma_f32_16x16x32_bf16 v[132:135], a[80:83], a[32:35], 0
    v_exp_f32 v156, v140
    v_mfma_f32_16x16x32_bf16 v[132:135], a[84:87], a[36:39], v[132:135]
    ds_read_b64_tr_b16 a[164:165], v237 offset:32768
    v_add_f32 v161, v154, v161
    v_mfma_f32_16x16x32_bf16 v[132:135], a[88:91], a[40:43], v[132:135]
    v_exp_f32 v157, v141
    v_mfma_f32_16x16x32_bf16 v[132:135], a[92:95], a[44:47], v[132:135]
    ds_read_b64_tr_b16 a[166:167], v237 offset:36864
    v_cvt_pk_bf16_f32 v150, v156, v157
    v_mfma_f32_16x16x32_bf16 v[16:19], a[144:147], v[144:147], v[16:19]
    v_exp_f32 v158, v142
    v_mfma_f32_16x16x32_bf16 v[20:23], a[148:151], v[144:147], v[20:23]
    buffer_load_dwordx4 v245, s[8:11], s39 offen offset:1024 lds
    v_add_f32 v161, v155, v161
    v_mfma_f32_16x16x32_bf16 v[24:27], a[152:155], v[144:147], v[24:27]
    v_exp_f32 v159, v143
    v_mfma_f32_16x16x32_bf16 v[28:31], a[156:159], v[144:147], v[28:31]
    v_cvt_pk_bf16_f32 v151, v158, v159
    v_add_f32 v161, v156, v161
    v_mfma_f32_16x16x32_bf16 v[136:139], a[64:67], a[48:51], 0
    v_exp_f32 v152, v128
    v_mfma_f32_16x16x32_bf16 v[136:139], a[68:71], a[52:55], v[136:139]
    ds_read_b64_tr_b16 a[168:169], v238 offset:32768
    v_add_f32 v161, v157, v161
    v_mfma_f32_16x16x32_bf16 v[136:139], a[72:75], a[56:59], v[136:139]
    v_exp_f32 v153, v129
    v_mfma_f32_16x16x32_bf16 v[136:139], a[76:79], a[60:63], v[136:139]
    ds_read_b64_tr_b16 a[170:171], v238 offset:36864
    v_cvt_pk_bf16_f32 v144, v152, v153
    v_mfma_f32_16x16x32_bf16 v[32:35], a[128:131], v[148:151], v[32:35]
    v_exp_f32 v154, v130
    v_mfma_f32_16x16x32_bf16 v[36:39], a[132:135], v[148:151], v[36:39]
    ds_read_b64_tr_b16 a[172:173], v239 offset:32768
    v_add_f32 v161, v158, v161
    v_mfma_f32_16x16x32_bf16 v[40:43], a[136:139], v[148:151], v[40:43]
    v_exp_f32 v155, v131
    v_mfma_f32_16x16x32_bf16 v[44:47], a[140:143], v[148:151], v[44:47]
    ds_read_b64_tr_b16 a[174:175], v239 offset:36864
    v_cvt_pk_bf16_f32 v145, v154, v155
    v_mfma_f32_16x16x32_bf16 v[140:143], a[80:83], a[48:51], 0
    v_exp_f32 v156, v132
    v_mfma_f32_16x16x32_bf16 v[140:143], a[84:87], a[52:55], v[140:143]
    ds_read_b64_tr_b16 a[176:177], v240 offset:32768
    v_add_f32 v161, v159, v161
    v_mfma_f32_16x16x32_bf16 v[140:143], a[88:91], a[56:59], v[140:143]
    v_exp_f32 v157, v133
    v_mfma_f32_16x16x32_bf16 v[140:143], a[92:95], a[60:63], v[140:143]
    ds_read_b64_tr_b16 a[178:179], v240 offset:36864
    v_cvt_pk_bf16_f32 v146, v156, v157
    v_mfma_f32_16x16x32_bf16 v[48:51], a[144:147], v[148:151], v[48:51]
    v_exp_f32 v158, v134
    v_mfma_f32_16x16x32_bf16 v[52:55], a[148:151], v[148:151], v[52:55]
    buffer_load_dwordx4 v246, s[8:11], s39 offen offset:2048 lds
    v_mfma_f32_16x16x32_bf16 v[56:59], a[152:155], v[148:151], v[56:59]
    v_exp_f32 v159, v135
    v_mfma_f32_16x16x32_bf16 v[60:63], a[156:159], v[148:151], v[60:63]
    v_cvt_pk_bf16_f32 v147, v158, v159
    s_waitcnt lgkmcnt(10)
    v_mfma_f32_16x16x32_bf16 v[128:131], a[96:99], a[0:3], 0
    v_exp_f32 v152, v136
    v_mfma_f32_16x16x32_bf16 v[128:131], a[100:103], a[4:7], v[128:131]
    ds_read_b64_tr_b16 a[180:181], v241 offset:32768
    v_add_f32 v163, v152, v163
    v_mfma_f32_16x16x32_bf16 v[128:131], a[104:107], a[8:11], v[128:131]
    v_exp_f32 v153, v137
    v_mfma_f32_16x16x32_bf16 v[128:131], a[108:111], a[12:15], v[128:131]
    ds_read_b64_tr_b16 a[182:183], v241 offset:36864
    v_cvt_pk_bf16_f32 v148, v152, v153
    v_mfma_f32_16x16x32_bf16 v[64:67], a[128:131], v[144:147], v[64:67]
    v_exp_f32 v154, v138
    v_mfma_f32_16x16x32_bf16 v[68:71], a[132:135], v[144:147], v[68:71]
    ds_read_b64_tr_b16 a[184:185], v242 offset:32768
    v_add_f32 v163, v153, v163
    v_mfma_f32_16x16x32_bf16 v[72:75], a[136:139], v[144:147], v[72:75]
    v_exp_f32 v155, v139
    v_mfma_f32_16x16x32_bf16 v[76:79], a[140:143], v[144:147], v[76:79]
    ds_read_b64_tr_b16 a[186:187], v242 offset:36864
    v_cvt_pk_bf16_f32 v149, v154, v155
    v_mfma_f32_16x16x32_bf16 a[200:203], a[208:211], v[144:147], a[200:203]
    v_mfma_f32_16x16x32_bf16 v[132:135], a[112:115], a[0:3], 0
    v_exp_f32 v156, v140
    v_mfma_f32_16x16x32_bf16 v[132:135], a[116:119], a[4:7], v[132:135]
    ds_read_b64_tr_b16 a[188:189], v243 offset:32768
    v_add_f32 v163, v154, v163
    v_mfma_f32_16x16x32_bf16 v[132:135], a[120:123], a[8:11], v[132:135]
    v_exp_f32 v157, v141
    v_mfma_f32_16x16x32_bf16 v[132:135], a[124:127], a[12:15], v[132:135]
    ds_read_b64_tr_b16 a[190:191], v243 offset:36864
    v_cvt_pk_bf16_f32 v150, v156, v157
    v_mfma_f32_16x16x32_bf16 v[80:83], a[144:147], v[144:147], v[80:83]
    v_exp_f32 v158, v142
    v_mfma_f32_16x16x32_bf16 v[84:87], a[148:151], v[144:147], v[84:87]
    buffer_load_dwordx4 v247, s[8:11], s39 offen offset:3072 lds
    v_add_f32 v163, v155, v163
    v_mfma_f32_16x16x32_bf16 v[88:91], a[152:155], v[144:147], v[88:91]
    v_exp_f32 v159, v143
    v_mfma_f32_16x16x32_bf16 v[92:95], a[156:159], v[144:147], v[92:95]
    v_cvt_pk_bf16_f32 v151, v158, v159
    v_add_f32 v163, v156, v163
    v_mfma_f32_16x16x32_bf16 v[136:139], a[96:99], a[16:19], 0
    v_exp_f32 v152, v128
    v_mfma_f32_16x16x32_bf16 v[136:139], a[100:103], a[20:23], v[136:139]
    ds_read_b128 a[64:67], v164 offset:40960
    v_add_f32 v163, v157, v163
    v_mfma_f32_16x16x32_bf16 v[136:139], a[104:107], a[24:27], v[136:139]
    v_exp_f32 v153, v129
    v_mfma_f32_16x16x32_bf16 v[136:139], a[108:111], a[28:31], v[136:139]
    ds_read_b128 a[68:71], v165 offset:40960
    v_cvt_pk_bf16_f32 v144, v152, v153
    v_mfma_f32_16x16x32_bf16 v[96:99], a[128:131], v[148:151], v[96:99]
    v_exp_f32 v154, v130
    v_mfma_f32_16x16x32_bf16 v[100:103], a[132:135], v[148:151], v[100:103]
    ds_read_b128 a[72:75], v166 offset:40960
    v_add_f32 v163, v158, v163
    v_mfma_f32_16x16x32_bf16 v[104:107], a[136:139], v[148:151], v[104:107]
    v_exp_f32 v155, v131
    v_mfma_f32_16x16x32_bf16 v[108:111], a[140:143], v[148:151], v[108:111]
    ds_read_b128 a[76:79], v167 offset:40960
    v_cvt_pk_bf16_f32 v145, v154, v155
    v_mfma_f32_16x16x32_bf16 v[140:143], a[112:115], a[16:19], 0
    v_exp_f32 v156, v132
    v_mfma_f32_16x16x32_bf16 v[140:143], a[116:119], a[20:23], v[140:143]
    ds_read_b128 a[80:83], v164 offset:45056
    v_add_f32 v163, v159, v163
    v_mfma_f32_16x16x32_bf16 v[140:143], a[120:123], a[24:27], v[140:143]
    s_add_u32 m0, s35, 65536
    v_exp_f32 v157, v133
    v_mfma_f32_16x16x32_bf16 v[140:143], a[124:127], a[28:31], v[140:143]
    ds_read_b128 a[84:87], v165 offset:45056
    v_cvt_pk_bf16_f32 v146, v156, v157
    v_mfma_f32_16x16x32_bf16 v[112:115], a[144:147], v[148:151], v[112:115]
    v_exp_f32 v158, v134
    v_mfma_f32_16x16x32_bf16 v[116:119], a[148:151], v[148:151], v[116:119]
    buffer_load_dwordx4 v252, s[12:15], s39 offen offset:0 lds
    v_mfma_f32_16x16x32_bf16 v[120:123], a[152:155], v[148:151], v[120:123]
    v_exp_f32 v159, v135
    v_mfma_f32_16x16x32_bf16 v[124:127], a[156:159], v[148:151], v[124:127]
    v_cvt_pk_bf16_f32 v147, v158, v159
    v_mfma_f32_16x16x32_bf16 v[128:131], a[96:99], a[32:35], 0
    v_exp_f32 v152, v136
    v_mfma_f32_16x16x32_bf16 v[128:131], a[100:103], a[36:39], v[128:131]
    ds_read_b128 a[88:91], v166 offset:45056
    v_add_f32 v161, v152, v161
    v_mfma_f32_16x16x32_bf16 v[128:131], a[104:107], a[40:43], v[128:131]
    v_exp_f32 v153, v137
    v_mfma_f32_16x16x32_bf16 v[128:131], a[108:111], a[44:47], v[128:131]
    ds_read_b128 a[92:95], v167 offset:45056
    v_cvt_pk_bf16_f32 v148, v152, v153
    s_waitcnt lgkmcnt(8)
    v_mfma_f32_16x16x32_bf16 v[0:3], a[160:163], v[144:147], v[0:3]
    v_exp_f32 v154, v138
    v_mfma_f32_16x16x32_bf16 v[4:7], a[164:167], v[144:147], v[4:7]
    ds_read_b64_tr_b16 a[128:129], v236 offset:40960
    v_add_f32 v161, v153, v161
    v_mfma_f32_16x16x32_bf16 v[8:11], a[168:171], v[144:147], v[8:11]
    v_exp_f32 v155, v139
    v_mfma_f32_16x16x32_bf16 v[12:15], a[172:175], v[144:147], v[12:15]
    ds_read_b64_tr_b16 a[130:131], v236 offset:45056
    v_cvt_pk_bf16_f32 v149, v154, v155
    v_mfma_f32_16x16x32_bf16 a[192:195], a[208:211], v[144:147], a[192:195]
    v_mfma_f32_16x16x32_bf16 v[132:135], a[112:115], a[32:35], 0
    v_exp_f32 v156, v140
    v_mfma_f32_16x16x32_bf16 v[132:135], a[116:119], a[36:39], v[132:135]
    ds_read_b64_tr_b16 a[132:133], v237 offset:40960
    v_add_f32 v161, v154, v161
    v_mfma_f32_16x16x32_bf16 v[132:135], a[120:123], a[40:43], v[132:135]
    v_exp_f32 v157, v141
    v_mfma_f32_16x16x32_bf16 v[132:135], a[124:127], a[44:47], v[132:135]
    ds_read_b64_tr_b16 a[134:135], v237 offset:45056
    v_cvt_pk_bf16_f32 v150, v156, v157
    v_mfma_f32_16x16x32_bf16 v[16:19], a[176:179], v[144:147], v[16:19]
    v_exp_f32 v158, v142
    v_mfma_f32_16x16x32_bf16 v[20:23], a[180:183], v[144:147], v[20:23]
    buffer_load_dwordx4 v253, s[12:15], s39 offen offset:1024 lds
    v_add_f32 v161, v155, v161
    v_mfma_f32_16x16x32_bf16 v[24:27], a[184:187], v[144:147], v[24:27]
    v_exp_f32 v159, v143
    v_mfma_f32_16x16x32_bf16 v[28:31], a[188:191], v[144:147], v[28:31]
    v_cvt_pk_bf16_f32 v151, v158, v159
    v_add_f32 v161, v156, v161
    v_mfma_f32_16x16x32_bf16 v[136:139], a[96:99], a[48:51], 0
    v_exp_f32 v152, v128
    v_mfma_f32_16x16x32_bf16 v[136:139], a[100:103], a[52:55], v[136:139]
    ds_read_b64_tr_b16 a[136:137], v238 offset:40960
    v_add_f32 v161, v157, v161
    v_mfma_f32_16x16x32_bf16 v[136:139], a[104:107], a[56:59], v[136:139]
    v_exp_f32 v153, v129
    v_mfma_f32_16x16x32_bf16 v[136:139], a[108:111], a[60:63], v[136:139]
    ds_read_b64_tr_b16 a[138:139], v238 offset:45056
    v_cvt_pk_bf16_f32 v144, v152, v153
    v_mfma_f32_16x16x32_bf16 v[32:35], a[160:163], v[148:151], v[32:35]
    v_exp_f32 v154, v130
    v_mfma_f32_16x16x32_bf16 v[36:39], a[164:167], v[148:151], v[36:39]
    ds_read_b64_tr_b16 a[140:141], v239 offset:40960
    v_add_f32 v161, v158, v161
    v_mfma_f32_16x16x32_bf16 v[40:43], a[168:171], v[148:151], v[40:43]
    v_exp_f32 v155, v131
    v_mfma_f32_16x16x32_bf16 v[44:47], a[172:175], v[148:151], v[44:47]
    ds_read_b64_tr_b16 a[142:143], v239 offset:45056
    v_cvt_pk_bf16_f32 v145, v154, v155
    v_mfma_f32_16x16x32_bf16 v[140:143], a[112:115], a[48:51], 0
    v_exp_f32 v156, v132
    v_mfma_f32_16x16x32_bf16 v[140:143], a[116:119], a[52:55], v[140:143]
    ds_read_b64_tr_b16 a[144:145], v240 offset:40960
    v_add_f32 v161, v159, v161
    v_mfma_f32_16x16x32_bf16 v[140:143], a[120:123], a[56:59], v[140:143]
    v_exp_f32 v157, v133
    v_mfma_f32_16x16x32_bf16 v[140:143], a[124:127], a[60:63], v[140:143]
    ds_read_b64_tr_b16 a[146:147], v240 offset:45056
    v_cvt_pk_bf16_f32 v146, v156, v157
    v_mfma_f32_16x16x32_bf16 v[48:51], a[176:179], v[148:151], v[48:51]
    v_exp_f32 v158, v134
    v_mfma_f32_16x16x32_bf16 v[52:55], a[180:183], v[148:151], v[52:55]
    buffer_load_dwordx4 v252, s[12:15], s39 offen offset:2048 lds
    v_mfma_f32_16x16x32_bf16 v[56:59], a[184:187], v[148:151], v[56:59]
    v_exp_f32 v159, v135
    v_mfma_f32_16x16x32_bf16 v[60:63], a[188:191], v[148:151], v[60:63]
    v_cvt_pk_bf16_f32 v147, v158, v159
    s_waitcnt lgkmcnt(10)
    v_mfma_f32_16x16x32_bf16 v[128:131], a[64:67], a[0:3], 0
    v_exp_f32 v152, v136
    v_mfma_f32_16x16x32_bf16 v[128:131], a[68:71], a[4:7], v[128:131]
    ds_read_b64_tr_b16 a[148:149], v241 offset:40960
    v_add_f32 v163, v152, v163
    v_mfma_f32_16x16x32_bf16 v[128:131], a[72:75], a[8:11], v[128:131]
    v_exp_f32 v153, v137
    v_mfma_f32_16x16x32_bf16 v[128:131], a[76:79], a[12:15], v[128:131]
    ds_read_b64_tr_b16 a[150:151], v241 offset:45056
    v_cvt_pk_bf16_f32 v148, v152, v153
    v_mfma_f32_16x16x32_bf16 v[64:67], a[160:163], v[144:147], v[64:67]
    v_exp_f32 v154, v138
    v_mfma_f32_16x16x32_bf16 v[68:71], a[164:167], v[144:147], v[68:71]
    ds_read_b64_tr_b16 a[152:153], v242 offset:40960
    v_add_f32 v163, v153, v163
    v_mfma_f32_16x16x32_bf16 v[72:75], a[168:171], v[144:147], v[72:75]
    v_exp_f32 v155, v139
    v_mfma_f32_16x16x32_bf16 v[76:79], a[172:175], v[144:147], v[76:79]
    ds_read_b64_tr_b16 a[154:155], v242 offset:45056
    v_cvt_pk_bf16_f32 v149, v154, v155
    v_mfma_f32_16x16x32_bf16 a[200:203], a[208:211], v[144:147], a[200:203]
    v_mfma_f32_16x16x32_bf16 v[132:135], a[80:83], a[0:3], 0
    v_exp_f32 v156, v140
    v_mfma_f32_16x16x32_bf16 v[132:135], a[84:87], a[4:7], v[132:135]
    ds_read_b64_tr_b16 a[156:157], v243 offset:40960
    v_add_f32 v163, v154, v163
    v_mfma_f32_16x16x32_bf16 v[132:135], a[88:91], a[8:11], v[132:135]
    v_exp_f32 v157, v141
    v_mfma_f32_16x16x32_bf16 v[132:135], a[92:95], a[12:15], v[132:135]
    ds_read_b64_tr_b16 a[158:159], v243 offset:45056
    v_cvt_pk_bf16_f32 v150, v156, v157
    v_mfma_f32_16x16x32_bf16 v[80:83], a[176:179], v[144:147], v[80:83]
    v_exp_f32 v158, v142
    v_mfma_f32_16x16x32_bf16 v[84:87], a[180:183], v[144:147], v[84:87]
    buffer_load_dwordx4 v253, s[12:15], s39 offen offset:3072 lds
    v_add_f32 v163, v155, v163
    v_mfma_f32_16x16x32_bf16 v[88:91], a[184:187], v[144:147], v[88:91]
    s_add_u32 s36, s36, 16384
    v_exp_f32 v159, v143
    v_mfma_f32_16x16x32_bf16 v[92:95], a[188:191], v[144:147], v[92:95]
    v_cvt_pk_bf16_f32 v151, v158, v159
    v_add_f32 v163, v156, v163
    v_mfma_f32_16x16x32_bf16 v[136:139], a[64:67], a[16:19], 0
    s_waitcnt vmcnt(8)
    s_barrier
    v_exp_f32 v152, v128
    v_mfma_f32_16x16x32_bf16 v[136:139], a[68:71], a[20:23], v[136:139]
    ds_read_b128 a[96:99], v164 offset:49152
    v_add_f32 v163, v157, v163
    v_mfma_f32_16x16x32_bf16 v[136:139], a[72:75], a[24:27], v[136:139]
    v_exp_f32 v153, v129
    v_mfma_f32_16x16x32_bf16 v[136:139], a[76:79], a[28:31], v[136:139]
    ds_read_b128 a[100:103], v165 offset:49152
    v_cvt_pk_bf16_f32 v144, v152, v153
    v_mfma_f32_16x16x32_bf16 v[96:99], a[160:163], v[148:151], v[96:99]
    v_exp_f32 v154, v130
    v_mfma_f32_16x16x32_bf16 v[100:103], a[164:167], v[148:151], v[100:103]
    ds_read_b128 a[104:107], v166 offset:49152
    v_add_f32 v163, v158, v163
    v_mfma_f32_16x16x32_bf16 v[104:107], a[168:171], v[148:151], v[104:107]
    v_exp_f32 v155, v131
    v_mfma_f32_16x16x32_bf16 v[108:111], a[172:175], v[148:151], v[108:111]
    ds_read_b128 a[108:111], v167 offset:49152
    v_cvt_pk_bf16_f32 v145, v154, v155
    v_mfma_f32_16x16x32_bf16 v[140:143], a[80:83], a[16:19], 0
    v_exp_f32 v156, v132
    v_mfma_f32_16x16x32_bf16 v[140:143], a[84:87], a[20:23], v[140:143]
    ds_read_b128 a[112:115], v164 offset:53248
    v_add_f32 v163, v159, v163
    v_mfma_f32_16x16x32_bf16 v[140:143], a[88:91], a[24:27], v[140:143]
    s_min_u32 s39, s36, s37
    v_exp_f32 v157, v133
    v_mfma_f32_16x16x32_bf16 v[140:143], a[92:95], a[28:31], v[140:143]
    ds_read_b128 a[116:119], v165 offset:53248
    v_cvt_pk_bf16_f32 v146, v156, v157
    v_mfma_f32_16x16x32_bf16 v[112:115], a[176:179], v[148:151], v[112:115]
    s_add_u32 m0, s35, 16384
    v_exp_f32 v158, v134
    v_mfma_f32_16x16x32_bf16 v[116:119], a[180:183], v[148:151], v[116:119]
    buffer_load_dwordx4 v244, s[8:11], s39 offen offset:0 lds
    v_mfma_f32_16x16x32_bf16 v[120:123], a[184:187], v[148:151], v[120:123]
    v_exp_f32 v159, v135
    v_mfma_f32_16x16x32_bf16 v[124:127], a[188:191], v[148:151], v[124:127]
    v_cvt_pk_bf16_f32 v147, v158, v159
    v_mfma_f32_16x16x32_bf16 v[128:131], a[64:67], a[32:35], 0
    v_exp_f32 v152, v136
    v_mfma_f32_16x16x32_bf16 v[128:131], a[68:71], a[36:39], v[128:131]
    ds_read_b128 a[120:123], v166 offset:53248
    v_add_f32 v161, v152, v161
    v_mfma_f32_16x16x32_bf16 v[128:131], a[72:75], a[40:43], v[128:131]
    v_exp_f32 v153, v137
    v_mfma_f32_16x16x32_bf16 v[128:131], a[76:79], a[44:47], v[128:131]
    ds_read_b128 a[124:127], v167 offset:53248
    v_cvt_pk_bf16_f32 v148, v152, v153
    s_waitcnt lgkmcnt(8)
    v_mfma_f32_16x16x32_bf16 v[0:3], a[128:131], v[144:147], v[0:3]
    v_exp_f32 v154, v138
    v_mfma_f32_16x16x32_bf16 v[4:7], a[132:135], v[144:147], v[4:7]
    ds_read_b64_tr_b16 a[160:161], v236 offset:49152
    v_add_f32 v161, v153, v161
    v_mfma_f32_16x16x32_bf16 v[8:11], a[136:139], v[144:147], v[8:11]
    v_exp_f32 v155, v139
    v_mfma_f32_16x16x32_bf16 v[12:15], a[140:143], v[144:147], v[12:15]
    ds_read_b64_tr_b16 a[162:163], v236 offset:53248
    v_cvt_pk_bf16_f32 v149, v154, v155
    v_mfma_f32_16x16x32_bf16 a[192:195], a[208:211], v[144:147], a[192:195]
    v_mfma_f32_16x16x32_bf16 v[132:135], a[80:83], a[32:35], 0
    v_exp_f32 v156, v140
    v_mfma_f32_16x16x32_bf16 v[132:135], a[84:87], a[36:39], v[132:135]
    ds_read_b64_tr_b16 a[164:165], v237 offset:49152
    v_add_f32 v161, v154, v161
    v_mfma_f32_16x16x32_bf16 v[132:135], a[88:91], a[40:43], v[132:135]
    v_exp_f32 v157, v141
    v_mfma_f32_16x16x32_bf16 v[132:135], a[92:95], a[44:47], v[132:135]
    ds_read_b64_tr_b16 a[166:167], v237 offset:53248
    v_cvt_pk_bf16_f32 v150, v156, v157
    v_mfma_f32_16x16x32_bf16 v[16:19], a[144:147], v[144:147], v[16:19]
    v_exp_f32 v158, v142
    v_mfma_f32_16x16x32_bf16 v[20:23], a[148:151], v[144:147], v[20:23]
    buffer_load_dwordx4 v245, s[8:11], s39 offen offset:1024 lds
    v_add_f32 v161, v155, v161
    v_mfma_f32_16x16x32_bf16 v[24:27], a[152:155], v[144:147], v[24:27]
    v_exp_f32 v159, v143
    v_mfma_f32_16x16x32_bf16 v[28:31], a[156:159], v[144:147], v[28:31]
    v_cvt_pk_bf16_f32 v151, v158, v159
    v_add_f32 v161, v156, v161
    v_mfma_f32_16x16x32_bf16 v[136:139], a[64:67], a[48:51], 0
    v_exp_f32 v152, v128
    v_mfma_f32_16x16x32_bf16 v[136:139], a[68:71], a[52:55], v[136:139]
    ds_read_b64_tr_b16 a[168:169], v238 offset:49152
    v_add_f32 v161, v157, v161
    v_mfma_f32_16x16x32_bf16 v[136:139], a[72:75], a[56:59], v[136:139]
    v_exp_f32 v153, v129
    v_mfma_f32_16x16x32_bf16 v[136:139], a[76:79], a[60:63], v[136:139]
    ds_read_b64_tr_b16 a[170:171], v238 offset:53248
    v_cvt_pk_bf16_f32 v144, v152, v153
    v_mfma_f32_16x16x32_bf16 v[32:35], a[128:131], v[148:151], v[32:35]
    v_exp_f32 v154, v130
    v_mfma_f32_16x16x32_bf16 v[36:39], a[132:135], v[148:151], v[36:39]
    ds_read_b64_tr_b16 a[172:173], v239 offset:49152
    v_add_f32 v161, v158, v161
    v_mfma_f32_16x16x32_bf16 v[40:43], a[136:139], v[148:151], v[40:43]
    v_exp_f32 v155, v131
    v_mfma_f32_16x16x32_bf16 v[44:47], a[140:143], v[148:151], v[44:47]
    ds_read_b64_tr_b16 a[174:175], v239 offset:53248
    v_cvt_pk_bf16_f32 v145, v154, v155
    v_mfma_f32_16x16x32_bf16 v[140:143], a[80:83], a[48:51], 0
    v_exp_f32 v156, v132
    v_mfma_f32_16x16x32_bf16 v[140:143], a[84:87], a[52:55], v[140:143]
    ds_read_b64_tr_b16 a[176:177], v240 offset:49152
    v_add_f32 v161, v159, v161
    v_mfma_f32_16x16x32_bf16 v[140:143], a[88:91], a[56:59], v[140:143]
    v_exp_f32 v157, v133
    v_mfma_f32_16x16x32_bf16 v[140:143], a[92:95], a[60:63], v[140:143]
    ds_read_b64_tr_b16 a[178:179], v240 offset:53248
    v_cvt_pk_bf16_f32 v146, v156, v157
    v_mfma_f32_16x16x32_bf16 v[48:51], a[144:147], v[148:151], v[48:51]
    v_exp_f32 v158, v134
    v_mfma_f32_16x16x32_bf16 v[52:55], a[148:151], v[148:151], v[52:55]
    buffer_load_dwordx4 v246, s[8:11], s39 offen offset:2048 lds
    v_mfma_f32_16x16x32_bf16 v[56:59], a[152:155], v[148:151], v[56:59]
    v_exp_f32 v159, v135
    v_mfma_f32_16x16x32_bf16 v[60:63], a[156:159], v[148:151], v[60:63]
    v_cvt_pk_bf16_f32 v147, v158, v159
    s_waitcnt lgkmcnt(10)
    v_mfma_f32_16x16x32_bf16 v[128:131], a[96:99], a[0:3], 0
    v_exp_f32 v152, v136
    v_mfma_f32_16x16x32_bf16 v[128:131], a[100:103], a[4:7], v[128:131]
    ds_read_b64_tr_b16 a[180:181], v241 offset:49152
    v_add_f32 v163, v152, v163
    v_mfma_f32_16x16x32_bf16 v[128:131], a[104:107], a[8:11], v[128:131]
    v_exp_f32 v153, v137
    v_mfma_f32_16x16x32_bf16 v[128:131], a[108:111], a[12:15], v[128:131]
    ds_read_b64_tr_b16 a[182:183], v241 offset:53248
    v_cvt_pk_bf16_f32 v148, v152, v153
    v_mfma_f32_16x16x32_bf16 v[64:67], a[128:131], v[144:147], v[64:67]
    v_exp_f32 v154, v138
    v_mfma_f32_16x16x32_bf16 v[68:71], a[132:135], v[144:147], v[68:71]
    ds_read_b64_tr_b16 a[184:185], v242 offset:49152
    v_add_f32 v163, v153, v163
    v_mfma_f32_16x16x32_bf16 v[72:75], a[136:139], v[144:147], v[72:75]
    v_exp_f32 v155, v139
    v_mfma_f32_16x16x32_bf16 v[76:79], a[140:143], v[144:147], v[76:79]
    ds_read_b64_tr_b16 a[186:187], v242 offset:53248
    v_cvt_pk_bf16_f32 v149, v154, v155
    v_mfma_f32_16x16x32_bf16 a[200:203], a[208:211], v[144:147], a[200:203]
    v_mfma_f32_16x16x32_bf16 v[132:135], a[112:115], a[0:3], 0
    v_exp_f32 v156, v140
    v_mfma_f32_16x16x32_bf16 v[132:135], a[116:119], a[4:7], v[132:135]
    ds_read_b64_tr_b16 a[188:189], v243 offset:49152
    v_add_f32 v163, v154, v163
    v_mfma_f32_16x16x32_bf16 v[132:135], a[120:123], a[8:11], v[132:135]
    v_exp_f32 v157, v141
    v_mfma_f32_16x16x32_bf16 v[132:135], a[124:127], a[12:15], v[132:135]
    ds_read_b64_tr_b16 a[190:191], v243 offset:53248
    v_cvt_pk_bf16_f32 v150, v156, v157
    v_mfma_f32_16x16x32_bf16 v[80:83], a[144:147], v[144:147], v[80:83]
    v_exp_f32 v158, v142
    v_mfma_f32_16x16x32_bf16 v[84:87], a[148:151], v[144:147], v[84:87]
    buffer_load_dwordx4 v247, s[8:11], s39 offen offset:3072 lds
    v_add_f32 v163, v155, v163
    v_mfma_f32_16x16x32_bf16 v[88:91], a[152:155], v[144:147], v[88:91]
    v_exp_f32 v159, v143
    v_mfma_f32_16x16x32_bf16 v[92:95], a[156:159], v[144:147], v[92:95]
    v_cvt_pk_bf16_f32 v151, v158, v159
    v_add_f32 v163, v156, v163
    v_mfma_f32_16x16x32_bf16 v[136:139], a[96:99], a[16:19], 0
    v_exp_f32 v152, v128
    v_mfma_f32_16x16x32_bf16 v[136:139], a[100:103], a[20:23], v[136:139]
    ds_read_b128 a[64:67], v164 offset:57344
    v_add_f32 v163, v157, v163
    v_mfma_f32_16x16x32_bf16 v[136:139], a[104:107], a[24:27], v[136:139]
    v_exp_f32 v153, v129
    v_mfma_f32_16x16x32_bf16 v[136:139], a[108:111], a[28:31], v[136:139]
    ds_read_b128 a[68:71], v165 offset:57344
    v_cvt_pk_bf16_f32 v144, v152, v153
    v_mfma_f32_16x16x32_bf16 v[96:99], a[128:131], v[148:151], v[96:99]
    v_exp_f32 v154, v130
    v_mfma_f32_16x16x32_bf16 v[100:103], a[132:135], v[148:151], v[100:103]
    ds_read_b128 a[72:75], v166 offset:57344
    v_add_f32 v163, v158, v163
    v_mfma_f32_16x16x32_bf16 v[104:107], a[136:139], v[148:151], v[104:107]
    v_exp_f32 v155, v131
    v_mfma_f32_16x16x32_bf16 v[108:111], a[140:143], v[148:151], v[108:111]
    ds_read_b128 a[76:79], v167 offset:57344
    v_cvt_pk_bf16_f32 v145, v154, v155
    v_mfma_f32_16x16x32_bf16 v[140:143], a[112:115], a[16:19], 0
    v_exp_f32 v156, v132
    v_mfma_f32_16x16x32_bf16 v[140:143], a[116:119], a[20:23], v[140:143]
    ds_read_b128 a[80:83], v164 offset:61440
    v_add_f32 v163, v159, v163
    v_mfma_f32_16x16x32_bf16 v[140:143], a[120:123], a[24:27], v[140:143]
    s_add_u32 m0, s35, 81920
    v_exp_f32 v157, v133
    v_mfma_f32_16x16x32_bf16 v[140:143], a[124:127], a[28:31], v[140:143]
    ds_read_b128 a[84:87], v165 offset:61440
    v_cvt_pk_bf16_f32 v146, v156, v157
    v_mfma_f32_16x16x32_bf16 v[112:115], a[144:147], v[148:151], v[112:115]
    v_exp_f32 v158, v134
    v_mfma_f32_16x16x32_bf16 v[116:119], a[148:151], v[148:151], v[116:119]
    buffer_load_dwordx4 v252, s[12:15], s39 offen offset:0 lds
    v_mfma_f32_16x16x32_bf16 v[120:123], a[152:155], v[148:151], v[120:123]
    v_exp_f32 v159, v135
    v_mfma_f32_16x16x32_bf16 v[124:127], a[156:159], v[148:151], v[124:127]
    v_cvt_pk_bf16_f32 v147, v158, v159
    v_mfma_f32_16x16x32_bf16 v[128:131], a[96:99], a[32:35], 0
    v_exp_f32 v152, v136
    v_mfma_f32_16x16x32_bf16 v[128:131], a[100:103], a[36:39], v[128:131]
    ds_read_b128 a[88:91], v166 offset:61440
    v_add_f32 v161, v152, v161
    v_mfma_f32_16x16x32_bf16 v[128:131], a[104:107], a[40:43], v[128:131]
    v_exp_f32 v153, v137
    v_mfma_f32_16x16x32_bf16 v[128:131], a[108:111], a[44:47], v[128:131]
    ds_read_b128 a[92:95], v167 offset:61440
    v_cvt_pk_bf16_f32 v148, v152, v153
    s_waitcnt lgkmcnt(8)
    v_mfma_f32_16x16x32_bf16 v[0:3], a[160:163], v[144:147], v[0:3]
    v_exp_f32 v154, v138
    v_mfma_f32_16x16x32_bf16 v[4:7], a[164:167], v[144:147], v[4:7]
    ds_read_b64_tr_b16 a[128:129], v236 offset:57344
    v_add_f32 v161, v153, v161
    v_mfma_f32_16x16x32_bf16 v[8:11], a[168:171], v[144:147], v[8:11]
    v_exp_f32 v155, v139
    v_mfma_f32_16x16x32_bf16 v[12:15], a[172:175], v[144:147], v[12:15]
    ds_read_b64_tr_b16 a[130:131], v236 offset:61440
    v_cvt_pk_bf16_f32 v149, v154, v155
    v_mfma_f32_16x16x32_bf16 a[192:195], a[208:211], v[144:147], a[192:195]
    v_mfma_f32_16x16x32_bf16 v[132:135], a[112:115], a[32:35], 0
    v_exp_f32 v156, v140
    v_mfma_f32_16x16x32_bf16 v[132:135], a[116:119], a[36:39], v[132:135]
    ds_read_b64_tr_b16 a[132:133], v237 offset:57344
    v_add_f32 v161, v154, v161
    v_mfma_f32_16x16x32_bf16 v[132:135], a[120:123], a[40:43], v[132:135]
    v_exp_f32 v157, v141
    v_mfma_f32_16x16x32_bf16 v[132:135], a[124:127], a[44:47], v[132:135]
    ds_read_b64_tr_b16 a[134:135], v237 offset:61440
    v_cvt_pk_bf16_f32 v150, v156, v157
    v_mfma_f32_16x16x32_bf16 v[16:19], a[176:179], v[144:147], v[16:19]
    v_exp_f32 v158, v142
    v_mfma_f32_16x16x32_bf16 v[20:23], a[180:183], v[144:147], v[20:23]
    buffer_load_dwordx4 v253, s[12:15], s39 offen offset:1024 lds
    v_add_f32 v161, v155, v161
    v_mfma_f32_16x16x32_bf16 v[24:27], a[184:187], v[144:147], v[24:27]
    v_exp_f32 v159, v143
    v_mfma_f32_16x16x32_bf16 v[28:31], a[188:191], v[144:147], v[28:31]
    v_cvt_pk_bf16_f32 v151, v158, v159
    v_add_f32 v161, v156, v161
    v_mfma_f32_16x16x32_bf16 v[136:139], a[96:99], a[48:51], 0
    v_exp_f32 v152, v128
    v_mfma_f32_16x16x32_bf16 v[136:139], a[100:103], a[52:55], v[136:139]
    ds_read_b64_tr_b16 a[136:137], v238 offset:57344
    v_add_f32 v161, v157, v161
    v_mfma_f32_16x16x32_bf16 v[136:139], a[104:107], a[56:59], v[136:139]
    v_exp_f32 v153, v129
    v_mfma_f32_16x16x32_bf16 v[136:139], a[108:111], a[60:63], v[136:139]
    ds_read_b64_tr_b16 a[138:139], v238 offset:61440
    v_cvt_pk_bf16_f32 v144, v152, v153
    v_mfma_f32_16x16x32_bf16 v[32:35], a[160:163], v[148:151], v[32:35]
    v_exp_f32 v154, v130
    v_mfma_f32_16x16x32_bf16 v[36:39], a[164:167], v[148:151], v[36:39]
    ds_read_b64_tr_b16 a[140:141], v239 offset:57344
    v_add_f32 v161, v158, v161
    v_mfma_f32_16x16x32_bf16 v[40:43], a[168:171], v[148:151], v[40:43]
    v_exp_f32 v155, v131
    v_mfma_f32_16x16x32_bf16 v[44:47], a[172:175], v[148:151], v[44:47]
    ds_read_b64_tr_b16 a[142:143], v239 offset:61440
    v_cvt_pk_bf16_f32 v145, v154, v155
    v_mfma_f32_16x16x32_bf16 v[140:143], a[112:115], a[48:51], 0
    v_exp_f32 v156, v132
    v_mfma_f32_16x16x32_bf16 v[140:143], a[116:119], a[52:55], v[140:143]
    ds_read_b64_tr_b16 a[144:145], v240 offset:57344
    v_add_f32 v161, v159, v161
    v_mfma_f32_16x16x32_bf16 v[140:143], a[120:123], a[56:59], v[140:143]
    v_exp_f32 v157, v133
    v_mfma_f32_16x16x32_bf16 v[140:143], a[124:127], a[60:63], v[140:143]
    ds_read_b64_tr_b16 a[146:147], v240 offset:61440
    v_cvt_pk_bf16_f32 v146, v156, v157
    v_mfma_f32_16x16x32_bf16 v[48:51], a[176:179], v[148:151], v[48:51]
    v_exp_f32 v158, v134
    v_mfma_f32_16x16x32_bf16 v[52:55], a[180:183], v[148:151], v[52:55]
    buffer_load_dwordx4 v252, s[12:15], s39 offen offset:2048 lds
    v_mfma_f32_16x16x32_bf16 v[56:59], a[184:187], v[148:151], v[56:59]
    v_exp_f32 v159, v135
    v_mfma_f32_16x16x32_bf16 v[60:63], a[188:191], v[148:151], v[60:63]
    v_cvt_pk_bf16_f32 v147, v158, v159
    s_waitcnt lgkmcnt(10)
    v_mfma_f32_16x16x32_bf16 v[128:131], a[64:67], a[0:3], 0
    v_exp_f32 v152, v136
    v_mfma_f32_16x16x32_bf16 v[128:131], a[68:71], a[4:7], v[128:131]
    ds_read_b64_tr_b16 a[148:149], v241 offset:57344
    v_add_f32 v163, v152, v163
    v_mfma_f32_16x16x32_bf16 v[128:131], a[72:75], a[8:11], v[128:131]
    v_exp_f32 v153, v137
    v_mfma_f32_16x16x32_bf16 v[128:131], a[76:79], a[12:15], v[128:131]
    ds_read_b64_tr_b16 a[150:151], v241 offset:61440
    v_cvt_pk_bf16_f32 v148, v152, v153
    v_mfma_f32_16x16x32_bf16 v[64:67], a[160:163], v[144:147], v[64:67]
    v_exp_f32 v154, v138
    v_mfma_f32_16x16x32_bf16 v[68:71], a[164:167], v[144:147], v[68:71]
    ds_read_b64_tr_b16 a[152:153], v242 offset:57344
    v_add_f32 v163, v153, v163
    v_mfma_f32_16x16x32_bf16 v[72:75], a[168:171], v[144:147], v[72:75]
    v_exp_f32 v155, v139
    v_mfma_f32_16x16x32_bf16 v[76:79], a[172:175], v[144:147], v[76:79]
    ds_read_b64_tr_b16 a[154:155], v242 offset:61440
    v_cvt_pk_bf16_f32 v149, v154, v155
    v_mfma_f32_16x16x32_bf16 a[200:203], a[208:211], v[144:147], a[200:203]
    v_mfma_f32_16x16x32_bf16 v[132:135], a[80:83], a[0:3], 0
    v_exp_f32 v156, v140
    v_mfma_f32_16x16x32_bf16 v[132:135], a[84:87], a[4:7], v[132:135]
    ds_read_b64_tr_b16 a[156:157], v243 offset:57344
    v_add_f32 v163, v154, v163
    v_mfma_f32_16x16x32_bf16 v[132:135], a[88:91], a[8:11], v[132:135]
    v_exp_f32 v157, v141
    v_mfma_f32_16x16x32_bf16 v[132:135], a[92:95], a[12:15], v[132:135]
    ds_read_b64_tr_b16 a[158:159], v243 offset:61440
    v_cvt_pk_bf16_f32 v150, v156, v157
    v_mfma_f32_16x16x32_bf16 v[80:83], a[176:179], v[144:147], v[80:83]
    v_exp_f32 v158, v142
    v_mfma_f32_16x16x32_bf16 v[84:87], a[180:183], v[144:147], v[84:87]
    buffer_load_dwordx4 v253, s[12:15], s39 offen offset:3072 lds
    v_add_f32 v163, v155, v163
    v_mfma_f32_16x16x32_bf16 v[88:91], a[184:187], v[144:147], v[88:91]
    s_add_u32 s36, s36, 16384
    v_exp_f32 v159, v143
    v_mfma_f32_16x16x32_bf16 v[92:95], a[188:191], v[144:147], v[92:95]
    v_cvt_pk_bf16_f32 v151, v158, v159
    v_add_f32 v163, v156, v163
    v_mfma_f32_16x16x32_bf16 v[136:139], a[64:67], a[16:19], 0
    s_waitcnt vmcnt(8)
    s_barrier
    v_exp_f32 v152, v128
    v_mfma_f32_16x16x32_bf16 v[136:139], a[68:71], a[20:23], v[136:139]
    ds_read_b128 a[96:99], v164 offset:0
    v_add_f32 v163, v157, v163
    v_mfma_f32_16x16x32_bf16 v[136:139], a[72:75], a[24:27], v[136:139]
    v_exp_f32 v153, v129
    v_mfma_f32_16x16x32_bf16 v[136:139], a[76:79], a[28:31], v[136:139]
    ds_read_b128 a[100:103], v165 offset:0
    v_cvt_pk_bf16_f32 v144, v152, v153
    v_mfma_f32_16x16x32_bf16 v[96:99], a[160:163], v[148:151], v[96:99]
    v_exp_f32 v154, v130
    v_mfma_f32_16x16x32_bf16 v[100:103], a[164:167], v[148:151], v[100:103]
    ds_read_b128 a[104:107], v166 offset:0
    v_add_f32 v163, v158, v163
    v_mfma_f32_16x16x32_bf16 v[104:107], a[168:171], v[148:151], v[104:107]
    v_exp_f32 v155, v131
    v_mfma_f32_16x16x32_bf16 v[108:111], a[172:175], v[148:151], v[108:111]
    ds_read_b128 a[108:111], v167 offset:0
    v_cvt_pk_bf16_f32 v145, v154, v155
    v_mfma_f32_16x16x32_bf16 v[140:143], a[80:83], a[16:19], 0
    v_exp_f32 v156, v132
    v_mfma_f32_16x16x32_bf16 v[140:143], a[84:87], a[20:23], v[140:143]
    ds_read_b128 a[112:115], v164 offset:4096
    v_add_f32 v163, v159, v163
    v_mfma_f32_16x16x32_bf16 v[140:143], a[88:91], a[24:27], v[140:143]
    s_min_u32 s39, s36, s37
    v_exp_f32 v157, v133
    v_mfma_f32_16x16x32_bf16 v[140:143], a[92:95], a[28:31], v[140:143]
    ds_read_b128 a[116:119], v165 offset:4096
    v_cvt_pk_bf16_f32 v146, v156, v157
    v_mfma_f32_16x16x32_bf16 v[112:115], a[176:179], v[148:151], v[112:115]
    s_add_u32 m0, s35, 32768
    v_exp_f32 v158, v134
    v_mfma_f32_16x16x32_bf16 v[116:119], a[180:183], v[148:151], v[116:119]
    buffer_load_dwordx4 v244, s[8:11], s39 offen offset:0 lds
    v_mfma_f32_16x16x32_bf16 v[120:123], a[184:187], v[148:151], v[120:123]
    v_exp_f32 v159, v135
    v_mfma_f32_16x16x32_bf16 v[124:127], a[188:191], v[148:151], v[124:127]
    v_cvt_pk_bf16_f32 v147, v158, v159
    v_mfma_f32_16x16x32_bf16 v[128:131], a[64:67], a[32:35], 0
    v_exp_f32 v152, v136
    v_mfma_f32_16x16x32_bf16 v[128:131], a[68:71], a[36:39], v[128:131]
    ds_read_b128 a[120:123], v166 offset:4096
    v_add_f32 v161, v152, v161
    v_mfma_f32_16x16x32_bf16 v[128:131], a[72:75], a[40:43], v[128:131]
    v_exp_f32 v153, v137
    v_mfma_f32_16x16x32_bf16 v[128:131], a[76:79], a[44:47], v[128:131]
    ds_read_b128 a[124:127], v167 offset:4096
    v_cvt_pk_bf16_f32 v148, v152, v153
    s_waitcnt lgkmcnt(8)
    v_mfma_f32_16x16x32_bf16 v[0:3], a[128:131], v[144:147], v[0:3]
    v_exp_f32 v154, v138
    v_mfma_f32_16x16x32_bf16 v[4:7], a[132:135], v[144:147], v[4:7]
    ds_read_b64_tr_b16 a[160:161], v236 offset:0
    v_add_f32 v161, v153, v161
    v_mfma_f32_16x16x32_bf16 v[8:11], a[136:139], v[144:147], v[8:11]
    v_exp_f32 v155, v139
    v_mfma_f32_16x16x32_bf16 v[12:15], a[140:143], v[144:147], v[12:15]
    ds_read_b64_tr_b16 a[162:163], v236 offset:4096
    v_cvt_pk_bf16_f32 v149, v154, v155
    v_mfma_f32_16x16x32_bf16 a[192:195], a[208:211], v[144:147], a[192:195]
    v_mfma_f32_16x16x32_bf16 v[132:135], a[80:83], a[32:35], 0
    v_exp_f32 v156, v140
    v_mfma_f32_16x16x32_bf16 v[132:135], a[84:87], a[36:39], v[132:135]
    ds_read_b64_tr_b16 a[164:165], v237 offset:0
    v_add_f32 v161, v154, v161
    v_mfma_f32_16x16x32_bf16 v[132:135], a[88:91], a[40:43], v[132:135]
    v_exp_f32 v157, v141
    v_mfma_f32_16x16x32_bf16 v[132:135], a[92:95], a[44:47], v[132:135]
    ds_read_b64_tr_b16 a[166:167], v237 offset:4096
    v_cvt_pk_bf16_f32 v150, v156, v157
    v_mfma_f32_16x16x32_bf16 v[16:19], a[144:147], v[144:147], v[16:19]
    v_exp_f32 v158, v142
    v_mfma_f32_16x16x32_bf16 v[20:23], a[148:151], v[144:147], v[20:23]
    buffer_load_dwordx4 v245, s[8:11], s39 offen offset:1024 lds
    v_add_f32 v161, v155, v161
    v_mfma_f32_16x16x32_bf16 v[24:27], a[152:155], v[144:147], v[24:27]
    v_exp_f32 v159, v143
    v_mfma_f32_16x16x32_bf16 v[28:31], a[156:159], v[144:147], v[28:31]
    v_cvt_pk_bf16_f32 v151, v158, v159
    v_add_f32 v161, v156, v161
    v_mfma_f32_16x16x32_bf16 v[136:139], a[64:67], a[48:51], 0
    v_exp_f32 v152, v128
    v_mfma_f32_16x16x32_bf16 v[136:139], a[68:71], a[52:55], v[136:139]
    ds_read_b64_tr_b16 a[168:169], v238 offset:0
    v_add_f32 v161, v157, v161
    v_mfma_f32_16x16x32_bf16 v[136:139], a[72:75], a[56:59], v[136:139]
    v_exp_f32 v153, v129
    v_mfma_f32_16x16x32_bf16 v[136:139], a[76:79], a[60:63], v[136:139]
    ds_read_b64_tr_b16 a[170:171], v238 offset:4096
    v_cvt_pk_bf16_f32 v144, v152, v153
    v_mfma_f32_16x16x32_bf16 v[32:35], a[128:131], v[148:151], v[32:35]
    v_exp_f32 v154, v130
    v_mfma_f32_16x16x32_bf16 v[36:39], a[132:135], v[148:151], v[36:39]
    ds_read_b64_tr_b16 a[172:173], v239 offset:0
    v_add_f32 v161, v158, v161
    v_mfma_f32_16x16x32_bf16 v[40:43], a[136:139], v[148:151], v[40:43]
    v_exp_f32 v155, v131
    v_mfma_f32_16x16x32_bf16 v[44:47], a[140:143], v[148:151], v[44:47]
    ds_read_b64_tr_b16 a[174:175], v239 offset:4096
    v_cvt_pk_bf16_f32 v145, v154, v155
    v_mfma_f32_16x16x32_bf16 v[140:143], a[80:83], a[48:51], 0
    v_exp_f32 v156, v132
    v_mfma_f32_16x16x32_bf16 v[140:143], a[84:87], a[52:55], v[140:143]
    ds_read_b64_tr_b16 a[176:177], v240 offset:0
    v_add_f32 v161, v159, v161
    v_mfma_f32_16x16x32_bf16 v[140:143], a[88:91], a[56:59], v[140:143]
    v_exp_f32 v157, v133
    v_mfma_f32_16x16x32_bf16 v[140:143], a[92:95], a[60:63], v[140:143]
    ds_read_b64_tr_b16 a[178:179], v240 offset:4096
    v_cvt_pk_bf16_f32 v146, v156, v157
    v_mfma_f32_16x16x32_bf16 v[48:51], a[144:147], v[148:151], v[48:51]
    v_exp_f32 v158, v134
    v_mfma_f32_16x16x32_bf16 v[52:55], a[148:151], v[148:151], v[52:55]
    buffer_load_dwordx4 v246, s[8:11], s39 offen offset:2048 lds
    v_mfma_f32_16x16x32_bf16 v[56:59], a[152:155], v[148:151], v[56:59]
    v_exp_f32 v159, v135
    v_mfma_f32_16x16x32_bf16 v[60:63], a[156:159], v[148:151], v[60:63]
    v_cvt_pk_bf16_f32 v147, v158, v159
    s_waitcnt lgkmcnt(10)
    v_mfma_f32_16x16x32_bf16 v[128:131], a[96:99], a[0:3], 0
    v_exp_f32 v152, v136
    v_mfma_f32_16x16x32_bf16 v[128:131], a[100:103], a[4:7], v[128:131]
    ds_read_b64_tr_b16 a[180:181], v241 offset:0
    v_add_f32 v163, v152, v163
    v_mfma_f32_16x16x32_bf16 v[128:131], a[104:107], a[8:11], v[128:131]
    v_exp_f32 v153, v137
    v_mfma_f32_16x16x32_bf16 v[128:131], a[108:111], a[12:15], v[128:131]
    ds_read_b64_tr_b16 a[182:183], v241 offset:4096
    v_cvt_pk_bf16_f32 v148, v152, v153
    v_mfma_f32_16x16x32_bf16 v[64:67], a[128:131], v[144:147], v[64:67]
    v_exp_f32 v154, v138
    v_mfma_f32_16x16x32_bf16 v[68:71], a[132:135], v[144:147], v[68:71]
    ds_read_b64_tr_b16 a[184:185], v242 offset:0
    v_add_f32 v163, v153, v163
    v_mfma_f32_16x16x32_bf16 v[72:75], a[136:139], v[144:147], v[72:75]
    v_exp_f32 v155, v139
    v_mfma_f32_16x16x32_bf16 v[76:79], a[140:143], v[144:147], v[76:79]
    ds_read_b64_tr_b16 a[186:187], v242 offset:4096
    v_cvt_pk_bf16_f32 v149, v154, v155
    v_mfma_f32_16x16x32_bf16 a[200:203], a[208:211], v[144:147], a[200:203]
    v_mfma_f32_16x16x32_bf16 v[132:135], a[112:115], a[0:3], 0
    v_exp_f32 v156, v140
    v_mfma_f32_16x16x32_bf16 v[132:135], a[116:119], a[4:7], v[132:135]
    ds_read_b64_tr_b16 a[188:189], v243 offset:0
    v_add_f32 v163, v154, v163
    v_mfma_f32_16x16x32_bf16 v[132:135], a[120:123], a[8:11], v[132:135]
    v_exp_f32 v157, v141
    v_mfma_f32_16x16x32_bf16 v[132:135], a[124:127], a[12:15], v[132:135]
    ds_read_b64_tr_b16 a[190:191], v243 offset:4096
    v_cvt_pk_bf16_f32 v150, v156, v157
    v_mfma_f32_16x16x32_bf16 v[80:83], a[144:147], v[144:147], v[80:83]
    v_exp_f32 v158, v142
    v_mfma_f32_16x16x32_bf16 v[84:87], a[148:151], v[144:147], v[84:87]
    buffer_load_dwordx4 v247, s[8:11], s39 offen offset:3072 lds
    v_add_f32 v163, v155, v163
    v_mfma_f32_16x16x32_bf16 v[88:91], a[152:155], v[144:147], v[88:91]
    v_exp_f32 v159, v143
    v_mfma_f32_16x16x32_bf16 v[92:95], a[156:159], v[144:147], v[92:95]
    v_cvt_pk_bf16_f32 v151, v158, v159
    v_add_f32 v163, v156, v163
    v_mfma_f32_16x16x32_bf16 v[136:139], a[96:99], a[16:19], 0
    v_exp_f32 v152, v128
    v_mfma_f32_16x16x32_bf16 v[136:139], a[100:103], a[20:23], v[136:139]
    ds_read_b128 a[64:67], v164 offset:8192
    v_add_f32 v163, v157, v163
    v_mfma_f32_16x16x32_bf16 v[136:139], a[104:107], a[24:27], v[136:139]
    v_exp_f32 v153, v129
    v_mfma_f32_16x16x32_bf16 v[136:139], a[108:111], a[28:31], v[136:139]
    ds_read_b128 a[68:71], v165 offset:8192
    v_cvt_pk_bf16_f32 v144, v152, v153
    v_mfma_f32_16x16x32_bf16 v[96:99], a[128:131], v[148:151], v[96:99]
    v_exp_f32 v154, v130
    v_mfma_f32_16x16x32_bf16 v[100:103], a[132:135], v[148:151], v[100:103]
    ds_read_b128 a[72:75], v166 offset:8192
    v_add_f32 v163, v158, v163
    v_mfma_f32_16x16x32_bf16 v[104:107], a[136:139], v[148:151], v[104:107]
    v_exp_f32 v155, v131
    v_mfma_f32_16x16x32_bf16 v[108:111], a[140:143], v[148:151], v[108:111]
    ds_read_b128 a[76:79], v167 offset:8192
    v_cvt_pk_bf16_f32 v145, v154, v155
    v_mfma_f32_16x16x32_bf16 v[140:143], a[112:115], a[16:19], 0
    v_exp_f32 v156, v132
    v_mfma_f32_16x16x32_bf16 v[140:143], a[116:119], a[20:23], v[140:143]
    ds_read_b128 a[80:83], v164 offset:12288
    v_add_f32 v163, v159, v163
    v_mfma_f32_16x16x32_bf16 v[140:143], a[120:123], a[24:27], v[140:143]
    s_add_u32 m0, s35, 98304
    v_exp_f32 v157, v133
    v_mfma_f32_16x16x32_bf16 v[140:143], a[124:127], a[28:31], v[140:143]
    ds_read_b128 a[84:87], v165 offset:12288
    v_cvt_pk_bf16_f32 v146, v156, v157
    v_mfma_f32_16x16x32_bf16 v[112:115], a[144:147], v[148:151], v[112:115]
    v_exp_f32 v158, v134
    v_mfma_f32_16x16x32_bf16 v[116:119], a[148:151], v[148:151], v[116:119]
    buffer_load_dwordx4 v252, s[12:15], s39 offen offset:0 lds
    v_mfma_f32_16x16x32_bf16 v[120:123], a[152:155], v[148:151], v[120:123]
    v_exp_f32 v159, v135
    v_mfma_f32_16x16x32_bf16 v[124:127], a[156:159], v[148:151], v[124:127]
    v_cvt_pk_bf16_f32 v147, v158, v159
    v_mfma_f32_16x16x32_bf16 v[128:131], a[96:99], a[32:35], 0
    v_exp_f32 v152, v136
    v_mfma_f32_16x16x32_bf16 v[128:131], a[100:103], a[36:39], v[128:131]
    ds_read_b128 a[88:91], v166 offset:12288
    v_add_f32 v161, v152, v161
    v_mfma_f32_16x16x32_bf16 v[128:131], a[104:107], a[40:43], v[128:131]
    v_exp_f32 v153, v137
    v_mfma_f32_16x16x32_bf16 v[128:131], a[108:111], a[44:47], v[128:131]
    ds_read_b128 a[92:95], v167 offset:12288
    v_cvt_pk_bf16_f32 v148, v152, v153
    s_waitcnt lgkmcnt(8)
    v_mfma_f32_16x16x32_bf16 v[0:3], a[160:163], v[144:147], v[0:3]
    v_exp_f32 v154, v138
    v_mfma_f32_16x16x32_bf16 v[4:7], a[164:167], v[144:147], v[4:7]
    ds_read_b64_tr_b16 a[128:129], v236 offset:8192
    v_add_f32 v161, v153, v161
    v_mfma_f32_16x16x32_bf16 v[8:11], a[168:171], v[144:147], v[8:11]
    v_exp_f32 v155, v139
    v_mfma_f32_16x16x32_bf16 v[12:15], a[172:175], v[144:147], v[12:15]
    ds_read_b64_tr_b16 a[130:131], v236 offset:12288
    v_cvt_pk_bf16_f32 v149, v154, v155
    v_mfma_f32_16x16x32_bf16 a[192:195], a[208:211], v[144:147], a[192:195]
    v_mfma_f32_16x16x32_bf16 v[132:135], a[112:115], a[32:35], 0
    v_exp_f32 v156, v140
    v_mfma_f32_16x16x32_bf16 v[132:135], a[116:119], a[36:39], v[132:135]
    ds_read_b64_tr_b16 a[132:133], v237 offset:8192
    v_add_f32 v161, v154, v161
    v_mfma_f32_16x16x32_bf16 v[132:135], a[120:123], a[40:43], v[132:135]
    v_exp_f32 v157, v141
    v_mfma_f32_16x16x32_bf16 v[132:135], a[124:127], a[44:47], v[132:135]
    ds_read_b64_tr_b16 a[134:135], v237 offset:12288
    v_cvt_pk_bf16_f32 v150, v156, v157
    v_mfma_f32_16x16x32_bf16 v[16:19], a[176:179], v[144:147], v[16:19]
    v_exp_f32 v158, v142
    v_mfma_f32_16x16x32_bf16 v[20:23], a[180:183], v[144:147], v[20:23]
    buffer_load_dwordx4 v253, s[12:15], s39 offen offset:1024 lds
    v_add_f32 v161, v155, v161
    v_mfma_f32_16x16x32_bf16 v[24:27], a[184:187], v[144:147], v[24:27]
    v_exp_f32 v159, v143
    v_mfma_f32_16x16x32_bf16 v[28:31], a[188:191], v[144:147], v[28:31]
    v_cvt_pk_bf16_f32 v151, v158, v159
    v_add_f32 v161, v156, v161
    v_mfma_f32_16x16x32_bf16 v[136:139], a[96:99], a[48:51], 0
    v_exp_f32 v152, v128
    v_mfma_f32_16x16x32_bf16 v[136:139], a[100:103], a[52:55], v[136:139]
    ds_read_b64_tr_b16 a[136:137], v238 offset:8192
    v_add_f32 v161, v157, v161
    v_mfma_f32_16x16x32_bf16 v[136:139], a[104:107], a[56:59], v[136:139]
    v_exp_f32 v153, v129
    v_mfma_f32_16x16x32_bf16 v[136:139], a[108:111], a[60:63], v[136:139]
    ds_read_b64_tr_b16 a[138:139], v238 offset:12288
    v_cvt_pk_bf16_f32 v144, v152, v153
    v_mfma_f32_16x16x32_bf16 v[32:35], a[160:163], v[148:151], v[32:35]
    v_exp_f32 v154, v130
    v_mfma_f32_16x16x32_bf16 v[36:39], a[164:167], v[148:151], v[36:39]
    ds_read_b64_tr_b16 a[140:141], v239 offset:8192
    v_add_f32 v161, v158, v161
    v_mfma_f32_16x16x32_bf16 v[40:43], a[168:171], v[148:151], v[40:43]
    v_exp_f32 v155, v131
    v_mfma_f32_16x16x32_bf16 v[44:47], a[172:175], v[148:151], v[44:47]
    ds_read_b64_tr_b16 a[142:143], v239 offset:12288
    v_cvt_pk_bf16_f32 v145, v154, v155
    v_mfma_f32_16x16x32_bf16 v[140:143], a[112:115], a[48:51], 0
    v_exp_f32 v156, v132
    v_mfma_f32_16x16x32_bf16 v[140:143], a[116:119], a[52:55], v[140:143]
    ds_read_b64_tr_b16 a[144:145], v240 offset:8192
    v_add_f32 v161, v159, v161
    v_mfma_f32_16x16x32_bf16 v[140:143], a[120:123], a[56:59], v[140:143]
    v_exp_f32 v157, v133
    v_mfma_f32_16x16x32_bf16 v[140:143], a[124:127], a[60:63], v[140:143]
    ds_read_b64_tr_b16 a[146:147], v240 offset:12288
    v_cvt_pk_bf16_f32 v146, v156, v157
    v_mfma_f32_16x16x32_bf16 v[48:51], a[176:179], v[148:151], v[48:51]
    v_exp_f32 v158, v134
    v_mfma_f32_16x16x32_bf16 v[52:55], a[180:183], v[148:151], v[52:55]
    buffer_load_dwordx4 v252, s[12:15], s39 offen offset:2048 lds
    v_mfma_f32_16x16x32_bf16 v[56:59], a[184:187], v[148:151], v[56:59]
    v_exp_f32 v159, v135
    v_mfma_f32_16x16x32_bf16 v[60:63], a[188:191], v[148:151], v[60:63]
    v_cvt_pk_bf16_f32 v147, v158, v159
    s_waitcnt lgkmcnt(10)
    v_mfma_f32_16x16x32_bf16 v[128:131], a[64:67], a[0:3], 0
    v_exp_f32 v152, v136
    v_mfma_f32_16x16x32_bf16 v[128:131], a[68:71], a[4:7], v[128:131]
    ds_read_b64_tr_b16 a[148:149], v241 offset:8192
    v_add_f32 v163, v152, v163
    v_mfma_f32_16x16x32_bf16 v[128:131], a[72:75], a[8:11], v[128:131]
    v_exp_f32 v153, v137
    v_mfma_f32_16x16x32_bf16 v[128:131], a[76:79], a[12:15], v[128:131]
    ds_read_b64_tr_b16 a[150:151], v241 offset:12288
    v_cvt_pk_bf16_f32 v148, v152, v153
    v_mfma_f32_16x16x32_bf16 v[64:67], a[160:163], v[144:147], v[64:67]
    v_exp_f32 v154, v138
    v_mfma_f32_16x16x32_bf16 v[68:71], a[164:167], v[144:147], v[68:71]
    ds_read_b64_tr_b16 a[152:153], v242 offset:8192
    v_add_f32 v163, v153, v163
    v_mfma_f32_16x16x32_bf16 v[72:75], a[168:171], v[144:147], v[72:75]
    v_exp_f32 v155, v139
    v_mfma_f32_16x16x32_bf16 v[76:79], a[172:175], v[144:147], v[76:79]
    ds_read_b64_tr_b16 a[154:155], v242 offset:12288
    v_cvt_pk_bf16_f32 v149, v154, v155
    v_mfma_f32_16x16x32_bf16 a[200:203], a[208:211], v[144:147], a[200:203]
    v_mfma_f32_16x16x32_bf16 v[132:135], a[80:83], a[0:3], 0
    v_exp_f32 v156, v140
    v_mfma_f32_16x16x32_bf16 v[132:135], a[84:87], a[4:7], v[132:135]
    ds_read_b64_tr_b16 a[156:157], v243 offset:8192
    v_add_f32 v163, v154, v163
    v_mfma_f32_16x16x32_bf16 v[132:135], a[88:91], a[8:11], v[132:135]
    v_exp_f32 v157, v141
    v_mfma_f32_16x16x32_bf16 v[132:135], a[92:95], a[12:15], v[132:135]
    ds_read_b64_tr_b16 a[158:159], v243 offset:12288
    v_cvt_pk_bf16_f32 v150, v156, v157
    v_mfma_f32_16x16x32_bf16 v[80:83], a[176:179], v[144:147], v[80:83]
    v_exp_f32 v158, v142
    v_mfma_f32_16x16x32_bf16 v[84:87], a[180:183], v[144:147], v[84:87]
    buffer_load_dwordx4 v253, s[12:15], s39 offen offset:3072 lds
    v_add_f32 v163, v155, v163
    v_mfma_f32_16x16x32_bf16 v[88:91], a[184:187], v[144:147], v[88:91]
    s_add_u32 s36, s36, 16384
    v_exp_f32 v159, v143
    v_mfma_f32_16x16x32_bf16 v[92:95], a[188:191], v[144:147], v[92:95]
    v_cvt_pk_bf16_f32 v151, v158, v159
    v_add_f32 v163, v156, v163
    s_cmp_eq_u32 s38, 4
    s_cbranch_scc1 L_side0
L_side_ret:
    s_sub_u32 s38, s38, 1
    s_cmp_lg_u32 s38, 0
    s_cbranch_scc1 L_attn_main
    s_nop 1
    v_mfma_f32_16x16x32_bf16 v[96:99], a[160:163], v[148:151], v[96:99]
    v_mfma_f32_16x16x32_bf16 v[100:103], a[164:167], v[148:151], v[100:103]
    v_mfma_f32_16x16x32_bf16 v[104:107], a[168:171], v[148:151], v[104:107]
    v_mfma_f32_16x16x32_bf16 v[108:111], a[172:175], v[148:151], v[108:111]
    v_mfma_f32_16x16x32_bf16 v[112:115], a[176:179], v[148:151], v[112:115]
    v_mfma_f32_16x16x32_bf16 v[116:119], a[180:183], v[148:151], v[116:119]
    v_mfma_f32_16x16x32_bf16 v[120:123], a[184:187], v[148:151], v[120:123]
    v_mfma_f32_16x16x32_bf16 v[124:127], a[188:191], v[148:151], v[124:127]
    v_add_f32 v163, v157, v163
    v_add_f32 v163, v158, v163
    v_add_f32 v163, v159, v163
    s_waitcnt vmcnt(0) lgkmcnt(0)
    s_barrier
    s_nop 7
    v_accvgpr_read_b32 v160, a192
    v_mov_b32 v176, v160
    s_nop 1
    v_permlane16_swap_b32 v176, v160
    v_add_f32 v160, v160, v176
    v_mov_b32 v176, v160
    s_nop 1
    v_permlane32_swap_b32 v176, v160
    v_add_f32 v160, v160, v176
    v_mov_b32 v176, v161
    s_nop 1
    v_permlane16_swap_b32 v176, v161
    v_add_f32 v161, v161, v176
    v_mov_b32 v176, v161
    s_nop 1
    v_permlane32_swap_b32 v176, v161
    v_add_f32 v161, v161, v176
    v_accvgpr_read_b32 v162, a200
    v_mov_b32 v176, v162
    s_nop 1
    v_permlane16_swap_b32 v176, v162
    v_add_f32 v162, v162, v176
    v_mov_b32 v176, v162
    s_nop 1
    v_permlane32_swap_b32 v176, v162
    v_add_f32 v162, v162, v176
    v_mov_b32 v176, v163
    s_nop 1
    v_permlane16_swap_b32 v176, v163
    v_add_f32 v163, v163, v176
    v_mov_b32 v176, v163
    s_nop 1
    v_permlane32_swap_b32 v176, v163
    v_add_f32 v163, v163, v176
    s_mov_b64 s[40:41], 0
    v_cmp_nle_f32 vcc, 0x21800000, v160
    s_or_b64 s[40:41], s[40:41], vcc
    v_cmp_nge_f32 vcc, 0x5d800000, v160
    s_or_b64 s[40:41], s[40:41], vcc
    v_cmp_nle_f32 vcc, 0x21800000, v161
    s_or_b64 s[40:41], s[40:41], vcc
    v_cmp_nge_f32 vcc, 0x5d800000, v161
    s_or_b64 s[40:41], s[40:41], vcc
    v_cmp_nle_f32 vcc, 0x21800000, v162
    s_or_b64 s[40:41], s[40:41], vcc
    v_cmp_nge_f32 vcc, 0x5d800000, v162
    s_or_b64 s[40:41], s[40:41], vcc
    v_cmp_nle_f32 vcc, 0x21800000, v163
    s_or_b64 s[40:41], s[40:41], vcc
    v_cmp_nge_f32 vcc, 0x5d800000, v163
    s_or_b64 s[40:41], s[40:41], vcc
    s_cmp_lg_u64 s[40:41], 0
    s_cbranch_scc1 L_exact
L_exact_ret:
    v_rcp_f32 v160, v160
    v_rcp_f32 v161, v161
    v_rcp_f32 v162, v162
    v_rcp_f32 v163, v163
    v_and_b32 v178, 63, v249
    v_lshlrev_b32 v178, 4, v178
    s_lshl_b32 s3, s34, 4
    s_lshl_b32 s39, s32, 2
    s_add_u32 s3, s3, s39
    s_lshl_b32 s3, s3, 17
    s_lshl_b32 s39, s33, 12
    s_add_u32 s3, s3, s39
    s_add_u32 s49, s3, 0
    v_mul_f32 v0, v0, v160
    v_mul_f32 v1, v1, v160
    v_mul_f32 v2, v2, v160
    v_mul_f32 v3, v3, v160
    v_mul_f32 v4, v4, v160
    v_mul_f32 v5, v5, v160
    v_mul_f32 v6, v6, v160
    v_mul_f32 v7, v7, v160
    v_cvt_pk_bf16_f32 v180, v0, v1
    v_cvt_pk_bf16_f32 v181, v2, v3
    v_cvt_pk_bf16_f32 v182, v4, v5
    v_cvt_pk_bf16_f32 v183, v6, v7
    buffer_store_dwordx4 v[180:183], v178, s[24:27], s49 offen offset:0 sc1
    v_mul_f32 v8, v8, v160
    v_mul_f32 v9, v9, v160
    v_mul_f32 v10, v10, v160
    v_mul_f32 v11, v11, v160
    v_mul_f32 v12, v12, v160
    v_mul_f32 v13, v13, v160
    v_mul_f32 v14, v14, v160
    v_mul_f32 v15, v15, v160
    v_cvt_pk_bf16_f32 v184, v8, v9
    v_cvt_pk_bf16_f32 v185, v10, v11
    v_cvt_pk_bf16_f32 v186, v12, v13
    v_cvt_pk_bf16_f32 v187, v14, v15
    buffer_store_dwordx4 v[184:187], v178, s[24:27], s49 offen offset:1024 sc1
    v_mul_f32 v16, v16, v160
    v_mul_f32 v17, v17, v160
    v_mul_f32 v18, v18, v160
    v_mul_f32 v19, v19, v160
    v_mul_f32 v20, v20, v160
    v_mul_f32 v21, v21, v160
    v_mul_f32 v22, v22, v160
    v_mul_f32 v23, v23, v160
    v_cvt_pk_bf16_f32 v180, v16, v17
    v_cvt_pk_bf16_f32 v181, v18, v19
    v_cvt_pk_bf16_f32 v182, v20, v21
    v_cvt_pk_bf16_f32 v183, v22, v23
    buffer_store_dwordx4 v[180:183], v178, s[24:27], s49 offen offset:2048 sc1
    v_mul_f32 v24, v24, v160
    v_mul_f32 v25, v25, v160
    v_mul_f32 v26, v26, v160
    v_mul_f32 v27, v27, v160
    v_mul_f32 v28, v28, v160
    v_mul_f32 v29, v29, v160
    v_mul_f32 v30, v30, v160
    v_mul_f32 v31, v31, v160
    v_cvt_pk_bf16_f32 v184, v24, v25
    v_cvt_pk_bf16_f32 v185, v26, v27
    v_cvt_pk_bf16_f32 v186, v28, v29
    v_cvt_pk_bf16_f32 v187, v30, v31
    buffer_store_dwordx4 v[184:187], v178, s[24:27], s49 offen offset:3072 sc1
    s_add_u32 s49, s3, 131072
    v_mul_f32 v32, v32, v161
    v_mul_f32 v33, v33, v161
    v_mul_f32 v34, v34, v161
    v_mul_f32 v35, v35, v161
    v_mul_f32 v36, v36, v161
    v_mul_f32 v37, v37, v161
    v_mul_f32 v38, v38, v161
    v_mul_f32 v39, v39, v161
    v_cvt_pk_bf16_f32 v180, v32, v33
    v_cvt_pk_bf16_f32 v181, v34, v35
    v_cvt_pk_bf16_f32 v182, v36, v37
    v_cvt_pk_bf16_f32 v183, v38, v39
    buffer_store_dwordx4 v[180:183], v178, s[24:27], s49 offen offset:0 sc1
    v_mul_f32 v40, v40, v161
    v_mul_f32 v41, v41, v161
    v_mul_f32 v42, v42, v161
    v_mul_f32 v43, v43, v161
    v_mul_f32 v44, v44, v161
    v_mul_f32 v45, v45, v161
    v_mul_f32 v46, v46, v161
    v_mul_f32 v47, v47, v161
    v_cvt_pk_bf16_f32 v184, v40, v41
    v_cvt_pk_bf16_f32 v185, v42, v43
    v_cvt_pk_bf16_f32 v186, v44, v45
    v_cvt_pk_bf16_f32 v187, v46, v47
    buffer_store_dwordx4 v[184:187], v178, s[24:27], s49 offen offset:1024 sc1
    v_mul_f32 v48, v48, v161
    v_mul_f32 v49, v49, v161
    v_mul_f32 v50, v50, v161
    v_mul_f32 v51, v51, v161
    v_mul_f32 v52, v52, v161
    v_mul_f32 v53, v53, v161
    v_mul_f32 v54, v54, v161
    v_mul_f32 v55, v55, v161
    v_cvt_pk_bf16_f32 v180, v48, v49
    v_cvt_pk_bf16_f32 v181, v50, v51
    v_cvt_pk_bf16_f32 v182, v52, v53
    v_cvt_pk_bf16_f32 v183, v54, v55
    buffer_store_dwordx4 v[180:183], v178, s[24:27], s49 offen offset:2048 sc1
    v_mul_f32 v56, v56, v161
    v_mul_f32 v57, v57, v161
    v_mul_f32 v58, v58, v161
    v_mul_f32 v59, v59, v161
    v_mul_f32 v60, v60, v161
    v_mul_f32 v61, v61, v161
    v_mul_f32 v62, v62, v161
    v_mul_f32 v63, v63, v161
    v_cvt_pk_bf16_f32 v184, v56, v57
    v_cvt_pk_bf16_f32 v185, v58, v59
    v_cvt_pk_bf16_f32 v186, v60, v61
    v_cvt_pk_bf16_f32 v187, v62, v63
    buffer_store_dwordx4 v[184:187], v178, s[24:27], s49 offen offset:3072 sc1
    s_add_u32 s49, s3, 262144
    v_mul_f32 v64, v64, v162
    v_mul_f32 v65, v65, v162
    v_mul_f32 v66, v66, v162
    v_mul_f32 v67, v67, v162
    v_mul_f32 v68, v68, v162
    v_mul_f32 v69, v69, v162
    v_mul_f32 v70, v70, v162
    v_mul_f32 v71, v71, v162
    v_cvt_pk_bf16_f32 v180, v64, v65
    v_cvt_pk_bf16_f32 v181, v66, v67
    v_cvt_pk_bf16_f32 v182, v68, v69
    v_cvt_pk_bf16_f32 v183, v70, v71
    buffer_store_dwordx4 v[180:183], v178, s[24:27], s49 offen offset:0 sc1
    v_mul_f32 v72, v72, v162
    v_mul_f32 v73, v73, v162
    v_mul_f32 v74, v74, v162
    v_mul_f32 v75, v75, v162
    v_mul_f32 v76, v76, v162
    v_mul_f32 v77, v77, v162
    v_mul_f32 v78, v78, v162
    v_mul_f32 v79, v79, v162
    v_cvt_pk_bf16_f32 v184, v72, v73
    v_cvt_pk_bf16_f32 v185, v74, v75
    v_cvt_pk_bf16_f32 v186, v76, v77
    v_cvt_pk_bf16_f32 v187, v78, v79
    buffer_store_dwordx4 v[184:187], v178, s[24:27], s49 offen offset:1024 sc1
    v_mul_f32 v80, v80, v162
    v_mul_f32 v81, v81, v162
    v_mul_f32 v82, v82, v162
    v_mul_f32 v83, v83, v162
    v_mul_f32 v84, v84, v162
    v_mul_f32 v85, v85, v162
    v_mul_f32 v86, v86, v162
    v_mul_f32 v87, v87, v162
    v_cvt_pk_bf16_f32 v180, v80, v81
    v_cvt_pk_bf16_f32 v181, v82, v83
    v_cvt_pk_bf16_f32 v182, v84, v85
    v_cvt_pk_bf16_f32 v183, v86, v87
    buffer_store_dwordx4 v[180:183], v178, s[24:27], s49 offen offset:2048 sc1
    v_mul_f32 v88, v88, v162
    v_mul_f32 v89, v89, v162
    v_mul_f32 v90, v90, v162
    v_mul_f32 v91, v91, v162
    v_mul_f32 v92, v92, v162
    v_mul_f32 v93, v93, v162
    v_mul_f32 v94, v94, v162
    v_mul_f32 v95, v95, v162
    v_cvt_pk_bf16_f32 v184, v88, v89
    v_cvt_pk_bf16_f32 v185, v90, v91
    v_cvt_pk_bf16_f32 v186, v92, v93
    v_cvt_pk_bf16_f32 v187, v94, v95
    buffer_store_dwordx4 v[184:187], v178, s[24:27], s49 offen offset:3072 sc1
    s_add_u32 s49, s3, 393216
    v_mul_f32 v96, v96, v163
    v_mul_f32 v97, v97, v163
    v_mul_f32 v98, v98, v163
    v_mul_f32 v99, v99, v163
    v_mul_f32 v100, v100, v163
    v_mul_f32 v101, v101, v163
    v_mul_f32 v102, v102, v163
    v_mul_f32 v103, v103, v163
    v_cvt_pk_bf16_f32 v180, v96, v97
    v_cvt_pk_bf16_f32 v181, v98, v99
    v_cvt_pk_bf16_f32 v182, v100, v101
    v_cvt_pk_bf16_f32 v183, v102, v103
    buffer_store_dwordx4 v[180:183], v178, s[24:27], s49 offen offset:0 sc1
    v_mul_f32 v104, v104, v163
    v_mul_f32 v105, v105, v163
    v_mul_f32 v106, v106, v163
    v_mul_f32 v107, v107, v163
    v_mul_f32 v108, v108, v163
    v_mul_f32 v109, v109, v163
    v_mul_f32 v110, v110, v163
    v_mul_f32 v111, v111, v163
    v_cvt_pk_bf16_f32 v184, v104, v105
    v_cvt_pk_bf16_f32 v185, v106, v107
    v_cvt_pk_bf16_f32 v186, v108, v109
    v_cvt_pk_bf16_f32 v187, v110, v111
    buffer_store_dwordx4 v[184:187], v178, s[24:27], s49 offen offset:1024 sc1
    v_mul_f32 v112, v112, v163
    v_mul_f32 v113, v113, v163
    v_mul_f32 v114, v114, v163
    v_mul_f32 v115, v115, v163
    v_mul_f32 v116, v116, v163
    v_mul_f32 v117, v117, v163
    v_mul_f32 v118, v118, v163
    v_mul_f32 v119, v119, v163
    v_cvt_pk_bf16_f32 v180, v112, v113
    v_cvt_pk_bf16_f32 v181, v114, v115
    v_cvt_pk_bf16_f32 v182, v116, v117
    v_cvt_pk_bf16_f32 v183, v118, v119
    buffer_store_dwordx4 v[180:183], v178, s[24:27], s49 offen offset:2048 sc1
    v_mul_f32 v120, v120, v163
    v_mul_f32 v121, v121, v163
    v_mul_f32 v122, v122, v163
    v_mul_f32 v123, v123, v163
    v_mul_f32 v124, v124, v163
    v_mul_f32 v125, v125, v163
    v_mul_f32 v126, v126, v163
    v_mul_f32 v127, v127, v163
    v_cvt_pk_bf16_f32 v184, v120, v121
    v_cvt_pk_bf16_f32 v185, v122, v123
    v_cvt_pk_bf16_f32 v186, v124, v125
    v_cvt_pk_bf16_f32 v187, v126, v127
    buffer_store_dwordx4 v[184:187], v178, s[24:27], s49 offen offset:3072 sc1
    s_waitcnt vmcnt(0) lgkmcnt(0)
    s_barrier
    s_cmp_lg_u32 s32, 0
    s_cbranch_scc1 L_arr1
    s_and_b32 s3, s2, 7
    s_lshl_b32 s3, s3, 7
    s_add_u32 s3, s3, 1024
    s_mov_b64 exec, 1
    v_mov_b32 v254, s3
    v_mov_b32 v255, 1
    buffer_atomic_add v255, v254, s[92:95], 0 offen sc1
    s_mov_b64 exec, -1
L_arr1:
    s_bfe_u32 s3, s2, 0x30003
    s_mul_i32 s3, s3, 3
    s_add_u32 s3, s3, s32
    s_sub_u32 s3, s3, 1
    s_max_i32 s98, s3, 0
    s_lshl_b32 s3, s98, 7
    s_add_u32 s3, s3, 12288
    s_cmp_eq_u32 s32, 0
    s_cbranch_scc1 L_draw_skip
    s_mov_b64 exec, 1
    v_mov_b32 v224, s3
    v_mov_b32 v223, 1
    buffer_atomic_add v223, v224, s[92:95], 0 offen sc0 sc1
    s_mov_b64 exec, -1
L_draw_skip:
    s_load_dwordx2 s[6:7], s[0:1], 0
    s_and_b32 s3, s2, 7
    s_lshr_b32 s36, s2, 3
    s_and_b32 s37, s3, 1
    s_lshl_b32 s37, s37, 3
    s_and_b32 s33, s36, 7
    s_add_u32 s33, s33, s37
    s_lshl_b32 s33, s33, 1
    s_lshr_b32 s37, s3, 2
    s_add_u32 s33, s33, s37
    s_lshr_b32 s34, s36, 3
    s_lshl_b32 s34, s34, 1
    s_bfe_u32 s37, s3, 0x10001
    s_add_u32 s34, s34, s37
    s_waitcnt lgkmcnt(0)
    s_mov_b32 s8, s90
    s_mov_b32 s9, s91
    s_and_b32 s9, s9, 0xffff
    s_mov_b32 s10, 0x3000000
    s_mov_b32 s11, 0x20000
    s_add_u32 s12, s90, 0x4000000
    s_addc_u32 s13, s91, 0
    s_and_b32 s13, s13, 0xffff
    s_mov_b32 s14, 0x1400000
    s_mov_b32 s15, 0x20000
    s_mov_b32 s16, s6
    s_mov_b32 s17, s7
    s_and_b32 s17, s17, 0xffff
    s_mov_b32 s18, 0x280000
    s_mov_b32 s19, 0x20000
    s_add_u32 s24, s90, 0x300000
    s_addc_u32 s25, s91, 0
    s_and_b32 s25, s25, 0xffff
    s_mov_b32 s26, 0x280000
    s_mov_b32 s27, 0x20000
    s_add_u32 s52, s90, 0x4000
    s_addc_u32 s53, s91, 0
    s_and_b32 s53, s53, 0xffff
    s_mov_b32 s54, 0x20000
    s_mov_b32 s55, 0x20000
    s_mov_b32 s20, s90
    s_mov_b32 s21, s91
    s_and_b32 s21, s21, 0xffff
    s_mov_b32 s22, 0x3c00
    s_mov_b32 s23, 0x20000
    v_and_b32 v2, 63, v249
    v_lshlrev_b32 v3, 4, v2
    v_and_b32 v5, 15, v2
    v_lshrrev_b32 v6, 4, v2
    s_mul_i32 s39, s34, 320
    v_lshl_add_u32 v7, v6, 4, s39
    s_lshl_b32 s40, s33, 2
    s_add_u32 s40, s40, s32
    s_lshl_b32 s41, s40, 4
    v_add_u32 v8, s41, v5
    s_movk_i32 s41, 1280
    v_mul_lo_u32 v9, v8, s41
    v_lshrrev_b32 v10, 1, v7
    v_add_u32 v9, v9, v10
    buffer_load_dwordx2 v[80:81], v9, s[16:19], 0 offen offset:0
    buffer_load_dwordx2 v[82:83], v9, s[16:19], 0 offen offset:32
    buffer_load_dwordx2 v[84:85], v9, s[16:19], 0 offen offset:64
    buffer_load_dwordx2 v[86:87], v9, s[16:19], 0 offen offset:96
    buffer_load_dwordx2 v[88:89], v9, s[16:19], 0 offen offset:128
    v_mov_b32 v232, v7
    v_mov_b32 v236, v3
    v_mov_b32 v237, v8
    v_mov_b32 v238, v6
    v_mov_b32 v239, v5
    s_lshr_b32 s39, s32, 1
    s_lshl_b32 s39, s39, 12
    v_add_u32 v241, s39, v3
    v_add_u32 v242, 73728, v241
    v_lshrrev_b32 v11, 2, v5
    v_lshl_add_u32 v11, v6, 2, v11
    v_mul_u32_u24 v11, 320, v11
    v_and_b32 v12, 3, v5
    v_lshl_add_u32 v11, v12, 3, v11
    v_add_u32 v11, 8192, v11
    v_and_b32 v12, 1, v6
    s_and_b32 s39, s32, 1
    s_mul_i32 s39, s39, 5
    s_add_u32 s40, s39, 0
    v_add_u32 v13, s40, v12
    v_cmp_eq_u32 vcc, 10, v13
    s_nop 1
    v_cndmask_b32_e64 v13, v13, 0, vcc
    v_lshl_add_u32 v150, v13, 5, v11
    v_add_u32 v155, 73728, v150
    s_add_u32 s40, s39, 1
    v_add_u32 v13, s40, v12
    v_cmp_eq_u32 vcc, 10, v13
    s_nop 1
    v_cndmask_b32_e64 v13, v13, 0, vcc
    v_lshl_add_u32 v151, v13, 5, v11
    v_add_u32 v156, 73728, v151
    s_add_u32 s40, s39, 2
    v_add_u32 v13, s40, v12
    v_cmp_eq_u32 vcc, 10, v13
    s_nop 1
    v_cndmask_b32_e64 v13, v13, 0, vcc
    v_lshl_add_u32 v152, v13, 5, v11
    v_add_u32 v157, 73728, v152
    s_add_u32 s40, s39, 3
    v_add_u32 v13, s40, v12
    v_cmp_eq_u32 vcc, 10, v13
    s_nop 1
    v_cndmask_b32_e64 v13, v13, 0, vcc
    v_lshl_add_u32 v153, v13, 5, v11
    v_add_u32 v158, 73728, v153
    s_add_u32 s40, s39, 4
    v_add_u32 v13, s40, v12
    v_cmp_eq_u32 vcc, 10, v13
    s_nop 1
    v_cndmask_b32_e64 v13, v13, 0, vcc
    v_lshl_add_u32 v154, v13, 5, v11
    v_add_u32 v159, 73728, v154
    s_mov_b32 s39, 64
    v_add_u32 v11, s39, v2
    v_mul_u32_u24 v12, 3277, v11
    v_lshrrev_b32 v12, 16, v12
    v_mul_u32_u24 v13, 20, v12
    v_sub_u32 v13, v11, v13
    v_bfe_u32 v14, v12, 2, 1
    v_lshlrev_b32 v14, 1, v14
    v_sub_u32 v13, v13, v14
    v_add_u32 v14, 20, v13
    v_cmp_gt_i32 vcc, 0, v13
    s_nop 1
    v_cndmask_b32 v13, v13, v14, vcc
    v_mul_u32_u24 v12, 1280, v12
    v_lshl_add_u32 v140, v13, 4, v12
    s_bitcmp1_b32 s32, 0
    s_cbranch_scc1 L_oproj_pat0
    v_mov_b32 v140, v3
L_oproj_pat0:
    s_mov_b32 s39, 128
    v_add_u32 v11, s39, v2
    v_mul_u32_u24 v12, 3277, v11
    v_lshrrev_b32 v12, 16, v12
    v_mul_u32_u24 v13, 20, v12
    v_sub_u32 v13, v11, v13
    v_bfe_u32 v14, v12, 2, 1
    v_lshlrev_b32 v14, 1, v14
    v_sub_u32 v13, v13, v14
    v_add_u32 v14, 20, v13
    v_cmp_gt_i32 vcc, 0, v13
    s_nop 1
    v_cndmask_b32 v13, v13, v14, vcc
    v_mul_u32_u24 v12, 1280, v12
    v_lshl_add_u32 v141, v13, 4, v12
    s_bitcmp1_b32 s32, 0
    s_cbranch_scc1 L_oproj_pat1
    v_mov_b32 v141, v3
L_oproj_pat1:
    s_mov_b32 s39, 192
    v_add_u32 v11, s39, v2
    v_mul_u32_u24 v12, 3277, v11
    v_lshrrev_b32 v12, 16, v12
    v_mul_u32_u24 v13, 20, v12
    v_sub_u32 v13, v11, v13
    v_bfe_u32 v14, v12, 2, 1
    v_lshlrev_b32 v14, 1, v14
    v_sub_u32 v13, v13, v14
    v_add_u32 v14, 20, v13
    v_cmp_gt_i32 vcc, 0, v13
    s_nop 1
    v_cndmask_b32 v13, v13, v14, vcc
    v_mul_u32_u24 v12, 1280, v12
    v_lshl_add_u32 v142, v13, 4, v12
    s_bitcmp1_b32 s32, 0
    s_cbranch_scc1 L_oproj_pat2
    v_mov_b32 v142, v3
L_oproj_pat2:
    s_mov_b32 s39, 256
    v_add_u32 v11, s39, v2
    v_mul_u32_u24 v12, 3277, v11
    v_lshrrev_b32 v12, 16, v12
    v_mul_u32_u24 v13, 20, v12
    v_sub_u32 v13, v11, v13
    v_bfe_u32 v14, v12, 2, 1
    v_lshlrev_b32 v14, 1, v14
    v_sub_u32 v13, v13, v14
    v_add_u32 v14, 20, v13
    v_cmp_gt_i32 vcc, 0, v13
    s_nop 1
    v_cndmask_b32 v13, v13, v14, vcc
    v_mul_u32_u24 v12, 1280, v12
    v_lshl_add_u32 v143, v13, 4, v12
    s_bitcmp1_b32 s32, 0
    s_cbranch_scc1 L_oproj_pat3
    v_mov_b32 v143, v3
L_oproj_pat3:
    s_mov_b32 s39, 320
    v_add_u32 v11, s39, v2
    v_mul_u32_u24 v12, 3277, v11
    v_lshrrev_b32 v12, 16, v12
    v_mul_u32_u24 v13, 20, v12
    v_sub_u32 v13, v11, v13
    v_bfe_u32 v14, v12, 2, 1
    v_lshlrev_b32 v14, 1, v14
    v_sub_u32 v13, v13, v14
    v_add_u32 v14, 20, v13
    v_cmp_gt_i32 vcc, 0, v13
    s_nop 1
    v_cndmask_b32 v13, v13, v14, vcc
    v_mul_u32_u24 v12, 1280, v12
    v_lshl_add_u32 v144, v13, 4, v12
    s_bitcmp1_b32 s32, 0
    s_cbranch_scc1 L_oproj_pat4
    v_mov_b32 v144, v3
L_oproj_pat4:
    s_mov_b32 s39, 384
    v_add_u32 v11, s39, v2
    v_mul_u32_u24 v12, 3277, v11
    v_lshrrev_b32 v12, 16, v12
    v_mul_u32_u24 v13, 20, v12
    v_sub_u32 v13, v11, v13
    v_bfe_u32 v14, v12, 2, 1
    v_lshlrev_b32 v14, 1, v14
    v_sub_u32 v13, v13, v14
    v_add_u32 v14, 20, v13
    v_cmp_gt_i32 vcc, 0, v13
    s_nop 1
    v_cndmask_b32 v13, v13, v14, vcc
    v_mul_u32_u24 v12, 1280, v12
    v_lshl_add_u32 v145, v13, 4, v12
    s_bitcmp1_b32 s32, 0
    s_cbranch_scc1 L_oproj_pat5
    v_mov_b32 v145, v3
L_oproj_pat5:
    s_mov_b32 s39, 448
    v_add_u32 v11, s39, v2
    v_mul_u32_u24 v12, 3277, v11
    v_lshrrev_b32 v12, 16, v12
    v_mul_u32_u24 v13, 20, v12
    v_sub_u32 v13, v11, v13
    v_bfe_u32 v14, v12, 2, 1
    v_lshlrev_b32 v14, 1, v14
    v_sub_u32 v13, v13, v14
    v_add_u32 v14, 20, v13
    v_cmp_gt_i32 vcc, 0, v13
    s_nop 1
    v_cndmask_b32 v13, v13, v14, vcc
    v_mul_u32_u24 v12, 1280, v12
    v_lshl_add_u32 v146, v13, 4, v12
    s_bitcmp1_b32 s32, 0
    s_cbranch_scc1 L_oproj_pat6
    v_mov_b32 v146, v3
L_oproj_pat6:
    s_mov_b32 s39, 512
    v_add_u32 v11, s39, v2
    v_mul_u32_u24 v12, 3277, v11
    v_lshrrev_b32 v12, 16, v12
    v_mul_u32_u24 v13, 20, v12
    v_sub_u32 v13, v11, v13
    v_bfe_u32 v14, v12, 2, 1
    v_lshlrev_b32 v14, 1, v14
    v_sub_u32 v13, v13, v14
    v_add_u32 v14, 20, v13
    v_cmp_gt_i32 vcc, 0, v13
    s_nop 1
    v_cndmask_b32 v13, v13, v14, vcc
    v_mul_u32_u24 v12, 1280, v12
    v_lshl_add_u32 v147, v13, 4, v12
    s_bitcmp1_b32 s32, 0
    s_cbranch_scc1 L_oproj_pat7
    v_mov_b32 v147, v3
L_oproj_pat7:
    s_and_b32 s39, s32, 1
    s_mul_i32 s39, s39, 576
    v_add_u32 v11, s39, v2
    v_mul_u32_u24 v12, 3277, v11
    v_lshrrev_b32 v12, 16, v12
    v_mul_u32_u24 v13, 20, v12
    v_sub_u32 v13, v11, v13
    v_bfe_u32 v14, v12, 2, 1
    v_lshlrev_b32 v14, 1, v14
    v_sub_u32 v13, v13, v14
    v_add_u32 v14, 20, v13
    v_cmp_gt_i32 vcc, 0, v13
    s_nop 1
    v_cndmask_b32 v13, v13, v14, vcc
    v_mul_u32_u24 v12, 1280, v12
    v_lshl_add_u32 v148, v13, 4, v12
    v_mov_b32 v0, 0
    v_mov_b32 v1, 0
    v_mov_b32 v2, 0
    v_mov_b32 v3, 0
    v_mov_b32 v4, 0
    v_mov_b32 v5, 0
    v_mov_b32 v6, 0
    v_mov_b32 v7, 0
    v_mov_b32 v8, 0
    v_mov_b32 v9, 0
    v_mov_b32 v10, 0
    v_mov_b32 v11, 0
    v_mov_b32 v12, 0
    v_mov_b32 v13, 0
    v_mov_b32 v14, 0
    v_mov_b32 v15, 0
    v_mov_b32 v16, 0
    v_mov_b32 v17, 0
    v_mov_b32 v18, 0
    v_mov_b32 v19, 0
    v_mov_b32 v20, 0
    v_mov_b32 v21, 0
    v_mov_b32 v22, 0
    v_mov_b32 v23, 0
    v_mov_b32 v24, 0
    v_mov_b32 v25, 0
    v_mov_b32 v26, 0
    v_mov_b32 v27, 0
    v_mov_b32 v28, 0
    v_mov_b32 v29, 0
    v_mov_b32 v30, 0
    v_mov_b32 v31, 0
    v_mov_b32 v32, 0
    v_mov_b32 v33, 0
    v_mov_b32 v34, 0
    v_mov_b32 v35, 0
    v_mov_b32 v36, 0
    v_mov_b32 v37, 0
    v_mov_b32 v38, 0
    v_mov_b32 v39, 0
    v_mov_b32 v40, 0
    v_mov_b32 v41, 0
    v_mov_b32 v42, 0
    v_mov_b32 v43, 0
    v_mov_b32 v44, 0
    v_mov_b32 v45, 0
    v_mov_b32 v46, 0
    v_mov_b32 v47, 0
    v_mov_b32 v48, 0
    v_mov_b32 v49, 0
    v_mov_b32 v50, 0
    v_mov_b32 v51, 0
    v_mov_b32 v52, 0
    v_mov_b32 v53, 0
    v_mov_b32 v54, 0
    v_mov_b32 v55, 0
    v_mov_b32 v56, 0
    v_mov_b32 v57, 0
    v_mov_b32 v58, 0
    v_mov_b32 v59, 0
    v_mov_b32 v60, 0
    v_mov_b32 v61, 0
    v_mov_b32 v62, 0
    v_mov_b32 v63, 0
    v_mov_b32 v64, 0
    v_mov_b32 v65, 0
    v_mov_b32 v66, 0
    v_mov_b32 v67, 0
    v_mov_b32 v68, 0
    v_mov_b32 v69, 0
    v_mov_b32 v70, 0
    v_mov_b32 v71, 0
    v_mov_b32 v72, 0
    v_mov_b32 v73, 0
    v_mov_b32 v74, 0
    v_mov_b32 v75, 0
    v_mov_b32 v76, 0
    v_mov_b32 v77, 0
    v_mov_b32 v78, 0
    v_mov_b32 v79, 0
    s_and_b32 s3, s2, 7
    s_lshr_b32 s62, s3, 1
    s_lshr_b32 s36, s33, 1
    s_lshr_b32 s37, s34, 1
    s_lshl_b32 s63, s36, 2
    s_add_u32 s63, s63, s37
    s_lshl_b32 s38, s62, 5
    s_lshr_b32 s39, s32, 1
    s_add_u32 s38, s38, s39
    s_lshl_b32 s39, s38, 10
    s_lshl_b32 s36, s36, 20
    s_add_u32 s36, s36, 33554432
    s_add_u32 s36, s36, s39
    s_mul_i32 s37, s37, 320
    s_mul_i32 s38, s38, 40960
    s_add_u32 s37, s37, s38
    s_add_u32 s39, s36, 0
    s_bitcmp1_b32 s32, 0
    s_cselect_b32 s43, s37, s39
    s_add_u32 s39, s36, 131072
    s_bitcmp1_b32 s32, 0
    s_cselect_b32 s44, s37, s39
    s_add_u32 s39, s36, 262144
    s_bitcmp1_b32 s32, 0
    s_cselect_b32 s45, s37, s39
    s_add_u32 s39, s36, 393216
    s_bitcmp1_b32 s32, 0
    s_cselect_b32 s46, s37, s39
    s_add_u32 s39, s36, 524288
    s_bitcmp1_b32 s32, 0
    s_cselect_b32 s47, s37, s39
    s_add_u32 s39, s36, 655360
    s_bitcmp1_b32 s32, 0
    s_cselect_b32 s48, s37, s39
    s_add_u32 s39, s36, 786432
    s_bitcmp1_b32 s32, 0
    s_cselect_b32 s49, s37, s39
    s_add_u32 s39, s36, 917504
    s_bitcmp1_b32 s32, 0
    s_cselect_b32 s50, s37, s39
    s_mov_b32 s51, s37
    s_bitcmp1_b32 s32, 0
    s_mov_b32 s39, 81920
    s_cselect_b32 s97, s39, 2048
    s_mul_i32 s35, s32, 9216
    s_load_dwordx2 s[4:5], s[0:1], 32
    s_waitcnt lgkmcnt(0)
    s_mov_b32 s16, s4
    s_mov_b32 s17, s5
    s_and_b32 s17, s17, 0xffff
    s_mov_b32 s18, 0x500000
    s_mov_b32 s19, 0x20000
    s_cmp_eq_u32 s32, 0
    s_cbranch_scc1 L_two_skip
    s_load_dwordx2 s[4:5], s[0:1], 32
    s_bfe_u32 s40, s2, 0x20001
    s_mul_i32 s40, s40, 10240
    s_lshr_b32 s41, s2, 3
    s_mul_i32 s41, s41, 320
    s_add_u32 s40, s40, s41
    s_sub_u32 s41, s32, 1
    s_mul_i32 s41, s41, 107
    s_add_u32 s40, s40, s41
    v_and_b32 v224, 63, v249
    v_add_u32 v224, s40, v224
    v_lshlrev_b32 v226, 7, v224
    v_add_u32 v224, 43, v224
    v_lshlrev_b32 v224, 7, v224
    s_waitcnt lgkmcnt(0)
    s_mov_b32 s56, s4
    s_mov_b32 s57, s5
    s_and_b32 s57, s57, 0xffff
    s_mov_b32 s58, 0x500000
    s_mov_b32 s59, 0x20000
    buffer_load_dword v225, v226, s[56:59], 0 offen
    buffer_load_dword v227, v224, s[56:59], 0 offen
L_two_skip:
    s_cmp_eq_u32 s32, 0
    s_cbranch_scc1 L_tw1_skip
    s_load_dwordx2 s[4:5], s[0:1], 48
    s_mul_i32 s40, s2, 3
    s_add_u32 s40, s40, s32
    s_sub_u32 s40, s40, 1
    s_mul_i32 s40, s40, 23
    v_and_b32 v224, 63, v249
    v_min_u32 v224, 22, v224
    v_add_u32 v224, s40, v224
    v_lshlrev_b32 v224, 7, v224
    s_waitcnt lgkmcnt(0)
    s_mov_b32 s56, s4
    s_mov_b32 s57, s5
    s_and_b32 s57, s57, 0xffff
    s_mov_b32 s58, 0x21c000
    s_mov_b32 s59, 0x20000
    buffer_load_dword v225, v224, s[56:59], 0 offen
L_tw1_skip:
    s_cmp_eq_u32 s32, 0
    s_cbranch_scc1 L_w2_skip0
    s_waitcnt vmcnt(5)
    v_readfirstlane_b32 s99, v223
    s_cmp_ge_u32 s99, 12
    s_cbranch_scc1 L_w2_skip0
    s_mul_i32 s100, s98, 18
    s_add_u32 s100, s100, s99
L_w2_again:
    s_mov_b32 s60, s100
    s_load_dwordx2 s[4:5], s[0:1], 56
    s_mov_b32 s42, s60
    s_lshr_b32 s40, s42, 3
    s_and_b32 s42, s42, 7
    s_mul_i32 s41, s40, 40960
    s_mul_i32 s60, s42, 160
    s_add_u32 s41, s41, s60
    s_mul_i32 s60, s42, 5
    s_mul_i32 s60, s60, 54
    s_add_u32 s60, s60, s40
    s_lshl_b32 s96, s60, 10
    s_mul_i32 s61, s32, 5120
    v_and_b32 v220, 63, v249
    s_waitcnt lgkmcnt(0)
    s_mov_b32 s56, s4
    s_mov_b32 s57, s5
    s_and_b32 s57, s57, 0xffff
    s_mov_b32 s58, 0x21c000
    s_mov_b32 s59, 0x20000
    v_mul_u32_u24 v221, 6554, v220
    v_lshrrev_b32 v221, 16, v221
    v_mul_u32_u24 v222, 10, v221
    v_sub_u32 v222, v220, v222
    v_mul_u32_u24 v221, 1280, v221
    v_lshl_add_u32 v221, v222, 4, v221
    s_add_u32 m0, s61, 139264
    s_nop 0
    buffer_load_dwordx4 v221, s[56:59], s41 offen lds
    v_add_u32 v220, 64, v220
    v_mul_u32_u24 v221, 6554, v220
    v_lshrrev_b32 v221, 16, v221
    v_mul_u32_u24 v222, 10, v221
    v_sub_u32 v222, v220, v222
    v_mul_u32_u24 v221, 1280, v221
    v_lshl_add_u32 v221, v222, 4, v221
    s_add_u32 m0, s61, 140288
    s_nop 0
    buffer_load_dwordx4 v221, s[56:59], s41 offen lds
    v_add_u32 v220, 64, v220
    v_mul_u32_u24 v221, 6554, v220
    v_lshrrev_b32 v221, 16, v221
    v_mul_u32_u24 v222, 10, v221
    v_sub_u32 v222, v220, v222
    v_mul_u32_u24 v221, 1280, v221
    v_lshl_add_u32 v221, v222, 4, v221
    s_add_u32 m0, s61, 141312
    s_nop 0
    buffer_load_dwordx4 v221, s[56:59], s41 offen lds
    v_add_u32 v220, 64, v220
    v_mul_u32_u24 v221, 6554, v220
    v_lshrrev_b32 v221, 16, v221
    v_mul_u32_u24 v222, 10, v221
    v_sub_u32 v222, v220, v222
    v_mul_u32_u24 v221, 1280, v221
    v_lshl_add_u32 v221, v222, 4, v221
    s_add_u32 m0, s61, 142336
    s_nop 0
    buffer_load_dwordx4 v221, s[56:59], s41 offen lds
    v_add_u32 v220, 64, v220
    v_mul_u32_u24 v221, 6554, v220
    v_lshrrev_b32 v221, 16, v221
    v_mul_u32_u24 v222, 10, v221
    v_sub_u32 v222, v220, v222
    v_mul_u32_u24 v221, 1280, v221
    v_lshl_add_u32 v221, v222, 4, v221
    s_add_u32 m0, s61, 143360
    s_nop 0
    buffer_load_dwordx4 v221, s[56:59], s41 offen lds
    s_waitcnt vmcnt(0)
    s_add_u32 s56, s90, 0x1300000
    s_addc_u32 s57, s91, 0
    s_and_b32 s57, s57, 0xffff
    s_mov_b32 s58, 0x21c000
    s_mov_b32 s59, 0x20000
    v_and_b32 v221, 63, v249
    v_lshlrev_b32 v220, 4, v221
    v_lshrrev_b32 v222, 4, v221
    v_bfe_u32 v223, v221, 2, 2
    v_lshl_add_u32 v222, v222, 2, v223
    v_mul_u32_u24 v222, 160, v222
    v_and_b32 v223, 3, v221
    v_lshl_add_u32 v222, v223, 3, v222
    s_mul_i32 s3, s32, 5120
    s_add_u32 s3, s3, 139264
    v_add_u32 v222, s3, v222
    ds_read_b64_tr_b16 a[0:1], v222 offset:0
    ds_read_b64_tr_b16 a[2:3], v222 offset:2560
    ds_read_b64_tr_b16 a[4:5], v222 offset:32
    ds_read_b64_tr_b16 a[6:7], v222 offset:2592
    ds_read_b64_tr_b16 a[8:9], v222 offset:64
    ds_read_b64_tr_b16 a[10:11], v222 offset:2624
    ds_read_b64_tr_b16 a[12:13], v222 offset:96
    ds_read_b64_tr_b16 a[14:15], v222 offset:2656
    ds_read_b64_tr_b16 a[16:17], v222 offset:128
    ds_read_b64_tr_b16 a[18:19], v222 offset:2688
    s_mov_b32 s3, s96
    s_waitcnt lgkmcnt(8)
    buffer_store_dwordx4 a[0:3], v220, s[56:59], s3 offen sc1
    s_add_u32 s3, s3, 55296
    s_waitcnt lgkmcnt(6)
    buffer_store_dwordx4 a[4:7], v220, s[56:59], s3 offen sc1
    s_add_u32 s3, s3, 55296
    s_waitcnt lgkmcnt(4)
    buffer_store_dwordx4 a[8:11], v220, s[56:59], s3 offen sc1
    s_add_u32 s3, s3, 55296
    s_waitcnt lgkmcnt(2)
    buffer_store_dwordx4 a[12:15], v220, s[56:59], s3 offen sc1
    s_add_u32 s3, s3, 55296
    s_waitcnt lgkmcnt(0)
    buffer_store_dwordx4 a[16:19], v220, s[56:59], s3 offen sc1
    s_cmp_ge_u32 s99, 6
    s_cbranch_scc1 L_w2_skip0
    s_add_u32 s100, s100, 12
    s_mov_b32 s99, 6
    s_branch L_w2_again
L_w2_skip0:
    s_bitcmp1_b32 s32, 0
    s_cbranch_scc1 L_oproj_prea_odd
    s_add_u32 m0, s35, 8192
    s_nop 0
    buffer_load_dwordx4 v148, s[16:19], s51 offen lds
    s_add_u32 s51, s51, 81920
    s_add_u32 m0, s35, 45056
    s_nop 0
    buffer_load_dwordx4 v148, s[16:19], s51 offen lds
    s_add_u32 s51, s51, 81920
    s_branch L_oproj_prea_done
L_oproj_prea_odd:
    s_add_u32 m0, s35, 0
    s_nop 0
    buffer_load_dwordx4 v140, s[16:19], s43 offen lds
    s_add_u32 s43, s43, 81920
    s_add_u32 m0, s35, 1024
    s_nop 0
    buffer_load_dwordx4 v141, s[16:19], s44 offen lds
    s_add_u32 s44, s44, 81920
    s_add_u32 m0, s35, 2048
    s_nop 0
    buffer_load_dwordx4 v142, s[16:19], s45 offen lds
    s_add_u32 s45, s45, 81920
    s_add_u32 m0, s35, 3072
    s_nop 0
    buffer_load_dwordx4 v143, s[16:19], s46 offen lds
    s_add_u32 s46, s46, 81920
    s_add_u32 m0, s35, 4096
    s_nop 0
    buffer_load_dwordx4 v144, s[16:19], s47 offen lds
    s_add_u32 s47, s47, 81920
    s_add_u32 m0, s35, 5120
    s_nop 0
    buffer_load_dwordx4 v145, s[16:19], s48 offen lds
    s_add_u32 s48, s48, 81920
    s_add_u32 m0, s35, 6144
    s_nop 0
    buffer_load_dwordx4 v146, s[16:19], s49 offen lds
    s_add_u32 s49, s49, 81920
    s_add_u32 m0, s35, 7168
    s_nop 0
    buffer_load_dwordx4 v147, s[16:19], s50 offen lds
    s_add_u32 s50, s50, 81920
    s_add_u32 m0, s35, 8192
    s_nop 0
    buffer_load_dwordx4 v148, s[16:19], s51 offen lds
    s_add_u32 s51, s51, 81920
    s_add_u32 m0, s35, 36864
    s_nop 0
    buffer_load_dwordx4 v140, s[16:19], s43 offen lds
    s_add_u32 s43, s43, 81920
    s_add_u32 m0, s35, 37888
    s_nop 0
    buffer_load_dwordx4 v141, s[16:19], s44 offen lds
    s_add_u32 s44, s44, 81920
    s_add_u32 m0, s35, 38912
    s_nop 0
    buffer_load_dwordx4 v142, s[16:19], s45 offen lds
    s_add_u32 s45, s45, 81920
    s_add_u32 m0, s35, 39936
    s_nop 0
    buffer_load_dwordx4 v143, s[16:19], s46 offen lds
    s_add_u32 s46, s46, 81920
    s_add_u32 m0, s35, 40960
    s_nop 0
    buffer_load_dwordx4 v144, s[16:19], s47 offen lds
    s_add_u32 s47, s47, 81920
    s_add_u32 m0, s35, 41984
    s_nop 0
    buffer_load_dwordx4 v145, s[16:19], s48 offen lds
    s_add_u32 s48, s48, 81920
    s_add_u32 m0, s35, 43008
    s_nop 0
    buffer_load_dwordx4 v146, s[16:19], s49 offen lds
    s_add_u32 s49, s49, 81920
    s_add_u32 m0, s35, 44032
    s_nop 0
    buffer_load_dwordx4 v147, s[16:19], s50 offen lds
    s_add_u32 s50, s50, 81920
    s_add_u32 m0, s35, 45056
    s_nop 0
    buffer_load_dwordx4 v148, s[16:19], s51 offen lds
    s_add_u32 s51, s51, 81920
L_oproj_prea_done:
    s_cmp_lg_u32 s32, 0
    s_cbranch_scc1 L_pw1
    v_and_b32 v254, 7, v249
    v_lshlrev_b32 v254, 7, v254
    s_mov_b32 s3, 0
L_poll1:
    buffer_load_dword v255, v254, s[92:95], 0 offen offset:1024 sc1
    s_waitcnt vmcnt(0)
    v_cmp_gt_u32 vcc, 32, v255
    s_add_u32 s3, s3, 1
    s_cmp_gt_u32 s3, 400000
    s_cbranch_scc1 L_pw1
    s_cmp_eq_u64 vcc, 0
    s_cbranch_scc0 L_poll1
L_pw1:
    s_barrier
    s_cmp_lg_u32 s2, 255
    s_cbranch_scc1 L_clr_skip
    s_cmp_lg_u32 s32, 0
    s_cbranch_scc1 L_clr_skip
    s_load_dwordx2 s[4:5], s[0:1], 88
    s_waitcnt lgkmcnt(0)
    s_mov_b32 s56, s4
    s_mov_b32 s57, s5
    s_and_b32 s57, s57, 0xffff
    s_mov_b32 s58, 0x100
    s_mov_b32 s59, 0x20000
    v_mov_b32 v254, 0
    s_mov_b64 exec, 1
    buffer_store_dword v254, v254, s[56:59], 0 offen sc1
    s_mov_b64 exec, -1
L_clr_skip:
    s_bitcmp1_b32 s32, 0
    s_cselect_b32 s56, s16, s8
    s_cselect_b32 s57, s17, s9
    s_cselect_b32 s58, s18, s10
    s_mov_b32 s59, 0x20000
    s_bitcmp1_b32 s32, 0
    s_cbranch_scc1 L_oproj_preb_done
    s_add_u32 m0, s35, 0
    s_nop 0
    buffer_load_dwordx4 v140, s[8:11], s43 offen lds
    s_add_u32 s43, s43, 2048
    s_add_u32 m0, s35, 1024
    s_nop 0
    buffer_load_dwordx4 v141, s[8:11], s44 offen lds
    s_add_u32 s44, s44, 2048
    s_add_u32 m0, s35, 2048
    s_nop 0
    buffer_load_dwordx4 v142, s[8:11], s45 offen lds
    s_add_u32 s45, s45, 2048
    s_add_u32 m0, s35, 3072
    s_nop 0
    buffer_load_dwordx4 v143, s[8:11], s46 offen lds
    s_add_u32 s46, s46, 2048
    s_add_u32 m0, s35, 4096
    s_nop 0
    buffer_load_dwordx4 v144, s[8:11], s47 offen lds
    s_add_u32 s47, s47, 2048
    s_add_u32 m0, s35, 5120
    s_nop 0
    buffer_load_dwordx4 v145, s[8:11], s48 offen lds
    s_add_u32 s48, s48, 2048
    s_add_u32 m0, s35, 6144
    s_nop 0
    buffer_load_dwordx4 v146, s[8:11], s49 offen lds
    s_add_u32 s49, s49, 2048
    s_add_u32 m0, s35, 7168
    s_nop 0
    buffer_load_dwordx4 v147, s[8:11], s50 offen lds
    s_add_u32 s50, s50, 2048
    s_add_u32 m0, s35, 36864
    s_nop 0
    buffer_load_dwordx4 v140, s[8:11], s43 offen lds
    s_add_u32 s43, s43, 2048
    s_add_u32 m0, s35, 37888
    s_nop 0
    buffer_load_dwordx4 v141, s[8:11], s44 offen lds
    s_add_u32 s44, s44, 2048
    s_add_u32 m0, s35, 38912
    s_nop 0
    buffer_load_dwordx4 v142, s[8:11], s45 offen lds
    s_add_u32 s45, s45, 2048
    s_add_u32 m0, s35, 39936
    s_nop 0
    buffer_load_dwordx4 v143, s[8:11], s46 offen lds
    s_add_u32 s46, s46, 2048
    s_add_u32 m0, s35, 40960
    s_nop 0
    buffer_load_dwordx4 v144, s[8:11], s47 offen lds
    s_add_u32 s47, s47, 2048
    s_add_u32 m0, s35, 41984
    s_nop 0
    buffer_load_dwordx4 v145, s[8:11], s48 offen lds
    s_add_u32 s48, s48, 2048
    s_add_u32 m0, s35, 43008
    s_nop 0
    buffer_load_dwordx4 v146, s[8:11], s49 offen lds
    s_add_u32 s49, s49, 2048
    s_add_u32 m0, s35, 44032
    s_nop 0
    buffer_load_dwordx4 v147, s[8:11], s50 offen lds
    s_add_u32 s50, s50, 2048
L_oproj_preb_done:
    s_movk_i32 s41, 5120
    s_movk_i32 s42, 10240
    buffer_load_dwordx4 v[92:95], v232, s[20:23], s41 offen offset:0
    buffer_load_dwordx4 v[96:99], v232, s[20:23], s41 offen offset:64
    buffer_load_dwordx4 v[100:103], v232, s[20:23], s41 offen offset:128
    buffer_load_dwordx4 v[104:107], v232, s[20:23], s41 offen offset:192
    buffer_load_dwordx4 v[108:111], v232, s[20:23], s41 offen offset:256
    buffer_load_dwordx4 v[112:115], v232, s[20:23], s42 offen offset:0
    buffer_load_dwordx4 v[116:119], v232, s[20:23], s42 offen offset:64
    buffer_load_dwordx4 v[120:123], v232, s[20:23], s42 offen offset:128
    buffer_load_dwordx4 v[124:127], v232, s[20:23], s42 offen offset:192
    buffer_load_dwordx4 v[128:131], v232, s[20:23], s42 offen offset:256
    s_waitcnt vmcnt(18)
    s_barrier
    ds_read_b128 a[0:3], v241 offset:0
    ds_read_b128 a[4:7], v241 offset:1024
    ds_read_b128 a[8:11], v241 offset:2048
    ds_read_b128 a[12:15], v241 offset:3072
    ds_read_b64_tr_b16 a[16:17], v150 offset:0
    ds_read_b64_tr_b16 a[18:19], v150 offset:5120
    ds_read_b64_tr_b16 a[20:21], v151 offset:0
    ds_read_b64_tr_b16 a[22:23], v151 offset:5120
    ds_read_b64_tr_b16 a[24:25], v152 offset:0
    ds_read_b64_tr_b16 a[26:27], v152 offset:5120
    ds_read_b64_tr_b16 a[28:29], v153 offset:0
    ds_read_b64_tr_b16 a[30:31], v153 offset:5120
    ds_read_b64_tr_b16 a[32:33], v154 offset:0
    ds_read_b64_tr_b16 a[34:35], v154 offset:5120
    s_waitcnt lgkmcnt(0)
    v_mfma_f32_16x16x32_bf16 v[0:3], a[16:19], a[0:3], v[0:3]
    s_add_u32 m0, s35, 73728
    ds_read_b128 a[36:39], v241 offset:18432
    ds_read_b64_tr_b16 a[66:67], v153 offset:23552
    v_mfma_f32_16x16x32_bf16 v[20:23], a[16:19], a[4:7], v[20:23]
    s_nop 0
    buffer_load_dwordx4 v140, s[56:59], s43 offen lds
    v_mfma_f32_16x16x32_bf16 v[40:43], a[16:19], a[8:11], v[40:43]
    s_add_u32 m0, s35, 74752
    ds_read_b128 a[40:43], v241 offset:19456
    ds_read_b64_tr_b16 a[68:69], v154 offset:18432
    v_mfma_f32_16x16x32_bf16 v[60:63], a[16:19], a[12:15], v[60:63]
    s_add_u32 s43, s43, s97
    buffer_load_dwordx4 v141, s[56:59], s44 offen lds
    v_mfma_f32_16x16x32_bf16 v[4:7], a[20:23], a[0:3], v[4:7]
    s_add_u32 m0, s35, 75776
    ds_read_b128 a[44:47], v241 offset:20480
    ds_read_b64_tr_b16 a[70:71], v154 offset:23552
    v_mfma_f32_16x16x32_bf16 v[24:27], a[20:23], a[4:7], v[24:27]
    s_add_u32 s44, s44, s97
    buffer_load_dwordx4 v142, s[56:59], s45 offen lds
    v_mfma_f32_16x16x32_bf16 v[44:47], a[20:23], a[8:11], v[44:47]
    s_add_u32 m0, s35, 76800
    ds_read_b128 a[48:51], v241 offset:21504
    v_mfma_f32_16x16x32_bf16 v[64:67], a[20:23], a[12:15], v[64:67]
    s_add_u32 s45, s45, s97
    buffer_load_dwordx4 v143, s[56:59], s46 offen lds
    v_mfma_f32_16x16x32_bf16 v[8:11], a[24:27], a[0:3], v[8:11]
    s_add_u32 m0, s35, 77824
    ds_read_b64_tr_b16 a[52:53], v150 offset:18432
    v_mfma_f32_16x16x32_bf16 v[28:31], a[24:27], a[4:7], v[28:31]
    s_add_u32 s46, s46, s97
    buffer_load_dwordx4 v144, s[56:59], s47 offen lds
    v_mfma_f32_16x16x32_bf16 v[48:51], a[24:27], a[8:11], v[48:51]
    s_add_u32 m0, s35, 78848
    ds_read_b64_tr_b16 a[54:55], v150 offset:23552
    v_mfma_f32_16x16x32_bf16 v[68:71], a[24:27], a[12:15], v[68:71]
    s_add_u32 s47, s47, s97
    buffer_load_dwordx4 v145, s[56:59], s48 offen lds
    v_mfma_f32_16x16x32_bf16 v[12:15], a[28:31], a[0:3], v[12:15]
    s_add_u32 m0, s35, 79872
    ds_read_b64_tr_b16 a[56:57], v151 offset:18432
    v_mfma_f32_16x16x32_bf16 v[32:35], a[28:31], a[4:7], v[32:35]
    s_add_u32 s48, s48, s97
    buffer_load_dwordx4 v146, s[56:59], s49 offen lds
    v_mfma_f32_16x16x32_bf16 v[52:55], a[28:31], a[8:11], v[52:55]
    s_add_u32 m0, s35, 80896
    ds_read_b64_tr_b16 a[58:59], v151 offset:23552
    v_mfma_f32_16x16x32_bf16 v[72:75], a[28:31], a[12:15], v[72:75]
    s_add_u32 s49, s49, s97
    buffer_load_dwordx4 v147, s[56:59], s50 offen lds
    v_mfma_f32_16x16x32_bf16 v[16:19], a[32:35], a[0:3], v[16:19]
    s_add_u32 m0, s35, 81920
    ds_read_b64_tr_b16 a[60:61], v152 offset:18432
    v_mfma_f32_16x16x32_bf16 v[36:39], a[32:35], a[4:7], v[36:39]
    s_add_u32 s50, s50, s97
    buffer_load_dwordx4 v148, s[16:19], s51 offen lds
    s_add_u32 s51, s51, 81920
    v_mfma_f32_16x16x32_bf16 v[56:59], a[32:35], a[8:11], v[56:59]
    ds_read_b64_tr_b16 a[62:63], v152 offset:23552
    v_mfma_f32_16x16x32_bf16 v[76:79], a[32:35], a[12:15], v[76:79]
    ds_read_b64_tr_b16 a[64:65], v153 offset:18432
    s_waitcnt lgkmcnt(0)
    s_waitcnt vmcnt(19)
    s_barrier
    v_mfma_f32_16x16x32_bf16 v[0:3], a[52:55], a[36:39], v[0:3]
    ds_read_b128 a[0:3], v241 offset:36864
    ds_read_b64_tr_b16 a[20:21], v151 offset:36864
    ds_read_b64_tr_b16 a[32:33], v154 offset:36864
    v_mfma_f32_16x16x32_bf16 v[20:23], a[52:55], a[40:43], v[20:23]
    s_add_u32 m0, s35, 110592
    ds_read_b128 a[4:7], v241 offset:37888
    ds_read_b64_tr_b16 a[22:23], v151 offset:41984
    ds_read_b64_tr_b16 a[34:35], v154 offset:41984
    v_mfma_f32_16x16x32_bf16 v[40:43], a[52:55], a[44:47], v[40:43]
    s_nop 0
    buffer_load_dwordx4 v140, s[56:59], s43 offen lds
    s_add_u32 m0, s35, 111616
    v_mfma_f32_16x16x32_bf16 v[60:63], a[52:55], a[48:51], v[60:63]
    s_add_u32 s43, s43, s97
    buffer_load_dwordx4 v141, s[56:59], s44 offen lds
    s_add_u32 m0, s35, 112640
    v_mfma_f32_16x16x32_bf16 v[4:7], a[56:59], a[36:39], v[4:7]
    s_add_u32 s44, s44, s97
    buffer_load_dwordx4 v142, s[56:59], s45 offen lds
    s_add_u32 m0, s35, 113664
    v_mfma_f32_16x16x32_bf16 v[24:27], a[56:59], a[40:43], v[24:27]
    s_add_u32 s45, s45, s97
    buffer_load_dwordx4 v143, s[56:59], s46 offen lds
    s_add_u32 m0, s35, 114688
    v_mfma_f32_16x16x32_bf16 v[44:47], a[56:59], a[44:47], v[44:47]
    s_add_u32 s46, s46, s97
    buffer_load_dwordx4 v144, s[56:59], s47 offen lds
    s_add_u32 m0, s35, 115712
    v_mfma_f32_16x16x32_bf16 v[64:67], a[56:59], a[48:51], v[64:67]
    s_add_u32 s47, s47, s97
    buffer_load_dwordx4 v145, s[56:59], s48 offen lds
    s_add_u32 m0, s35, 116736
    v_mfma_f32_16x16x32_bf16 v[8:11], a[60:63], a[36:39], v[8:11]
    s_add_u32 s48, s48, s97
    buffer_load_dwordx4 v146, s[56:59], s49 offen lds
    s_add_u32 m0, s35, 117760
    v_mfma_f32_16x16x32_bf16 v[28:31], a[60:63], a[40:43], v[28:31]
    s_add_u32 s49, s49, s97
    buffer_load_dwordx4 v147, s[56:59], s50 offen lds
    s_add_u32 m0, s35, 118784
    v_mfma_f32_16x16x32_bf16 v[48:51], a[60:63], a[44:47], v[48:51]
    s_add_u32 s50, s50, s97
    buffer_load_dwordx4 v148, s[16:19], s51 offen lds
    s_add_u32 s51, s51, 81920
    s_add_u32 m0, s35, 0
    v_mfma_f32_16x16x32_bf16 v[68:71], a[60:63], a[48:51], v[68:71]
    s_nop 0
    buffer_load_dwordx4 v140, s[56:59], s43 offen lds
    s_add_u32 m0, s35, 1024
    v_mfma_f32_16x16x32_bf16 v[12:15], a[64:67], a[36:39], v[12:15]
    s_add_u32 s43, s43, s97
    buffer_load_dwordx4 v141, s[56:59], s44 offen lds
    s_add_u32 m0, s35, 2048
    v_mfma_f32_16x16x32_bf16 v[32:35], a[64:67], a[40:43], v[32:35]
    s_add_u32 s44, s44, s97
    buffer_load_dwordx4 v142, s[56:59], s45 offen lds
    s_add_u32 m0, s35, 3072
    v_mfma_f32_16x16x32_bf16 v[52:55], a[64:67], a[44:47], v[52:55]
    s_add_u32 s45, s45, s97
    buffer_load_dwordx4 v143, s[56:59], s46 offen lds
    s_add_u32 m0, s35, 4096
    v_mfma_f32_16x16x32_bf16 v[72:75], a[64:67], a[48:51], v[72:75]
    s_add_u32 s46, s46, s97
    buffer_load_dwordx4 v144, s[56:59], s47 offen lds
    v_mfma_f32_16x16x32_bf16 v[16:19], a[68:71], a[36:39], v[16:19]
    ds_read_b128 a[8:11], v241 offset:38912
    ds_read_b64_tr_b16 a[24:25], v152 offset:36864
    v_mfma_f32_16x16x32_bf16 v[36:39], a[68:71], a[40:43], v[36:39]
    ds_read_b128 a[12:15], v241 offset:39936
    ds_read_b64_tr_b16 a[26:27], v152 offset:41984
    v_mfma_f32_16x16x32_bf16 v[56:59], a[68:71], a[44:47], v[56:59]
    ds_read_b64_tr_b16 a[16:17], v150 offset:36864
    ds_read_b64_tr_b16 a[28:29], v153 offset:36864
    v_mfma_f32_16x16x32_bf16 v[76:79], a[68:71], a[48:51], v[76:79]
    ds_read_b64_tr_b16 a[18:19], v150 offset:41984
    ds_read_b64_tr_b16 a[30:31], v153 offset:41984
    s_waitcnt lgkmcnt(0)
    v_mfma_f32_16x16x32_bf16 v[0:3], a[16:19], a[0:3], v[0:3]
    ds_read_b128 a[36:39], v241 offset:55296
    v_mfma_f32_16x16x32_bf16 v[20:23], a[16:19], a[4:7], v[20:23]
    ds_read_b128 a[40:43], v241 offset:56320
    v_mfma_f32_16x16x32_bf16 v[40:43], a[16:19], a[8:11], v[40:43]
    s_add_u32 m0, s35, 5120
    ds_read_b128 a[44:47], v241 offset:57344
    v_mfma_f32_16x16x32_bf16 v[60:63], a[16:19], a[12:15], v[60:63]
    s_add_u32 s47, s47, s97
    buffer_load_dwordx4 v145, s[56:59], s48 offen lds
    v_mfma_f32_16x16x32_bf16 v[4:7], a[20:23], a[0:3], v[4:7]
    ds_read_b128 a[48:51], v241 offset:58368
    v_mfma_f32_16x16x32_bf16 v[24:27], a[20:23], a[4:7], v[24:27]
    ds_read_b64_tr_b16 a[52:53], v150 offset:55296
    v_mfma_f32_16x16x32_bf16 v[44:47], a[20:23], a[8:11], v[44:47]
    s_add_u32 m0, s35, 6144
    ds_read_b64_tr_b16 a[54:55], v150 offset:60416
    v_mfma_f32_16x16x32_bf16 v[64:67], a[20:23], a[12:15], v[64:67]
    s_add_u32 s48, s48, s97
    buffer_load_dwordx4 v146, s[56:59], s49 offen lds
    v_mfma_f32_16x16x32_bf16 v[8:11], a[24:27], a[0:3], v[8:11]
    ds_read_b64_tr_b16 a[56:57], v151 offset:55296
    v_mfma_f32_16x16x32_bf16 v[28:31], a[24:27], a[4:7], v[28:31]
    ds_read_b64_tr_b16 a[58:59], v151 offset:60416
    v_mfma_f32_16x16x32_bf16 v[48:51], a[24:27], a[8:11], v[48:51]
    s_add_u32 m0, s35, 7168
    ds_read_b64_tr_b16 a[60:61], v152 offset:55296
    v_mfma_f32_16x16x32_bf16 v[68:71], a[24:27], a[12:15], v[68:71]
    s_add_u32 s49, s49, s97
    buffer_load_dwordx4 v147, s[56:59], s50 offen lds
    v_mfma_f32_16x16x32_bf16 v[12:15], a[28:31], a[0:3], v[12:15]
    ds_read_b64_tr_b16 a[62:63], v152 offset:60416
    v_mfma_f32_16x16x32_bf16 v[32:35], a[28:31], a[4:7], v[32:35]
    ds_read_b64_tr_b16 a[64:65], v153 offset:55296
    v_mfma_f32_16x16x32_bf16 v[52:55], a[28:31], a[8:11], v[52:55]
    s_add_u32 m0, s35, 8192
    ds_read_b64_tr_b16 a[66:67], v153 offset:60416
    v_mfma_f32_16x16x32_bf16 v[72:75], a[28:31], a[12:15], v[72:75]
    s_add_u32 s50, s50, s97
    buffer_load_dwordx4 v148, s[16:19], s51 offen lds
    s_add_u32 s51, s51, 81920
    v_mfma_f32_16x16x32_bf16 v[16:19], a[32:35], a[0:3], v[16:19]
    ds_read_b64_tr_b16 a[68:69], v154 offset:55296
    v_mfma_f32_16x16x32_bf16 v[36:39], a[32:35], a[4:7], v[36:39]
    ds_read_b64_tr_b16 a[70:71], v154 offset:60416
    v_mfma_f32_16x16x32_bf16 v[56:59], a[32:35], a[8:11], v[56:59]
    v_mfma_f32_16x16x32_bf16 v[76:79], a[32:35], a[12:15], v[76:79]
    s_waitcnt lgkmcnt(0)
    s_waitcnt vmcnt(18)
    s_barrier
    v_mfma_f32_16x16x32_bf16 v[0:3], a[52:55], a[36:39], v[0:3]
    ds_read_b128 a[0:3], v242 offset:0
    v_mfma_f32_16x16x32_bf16 v[20:23], a[52:55], a[40:43], v[20:23]
    ds_read_b128 a[4:7], v242 offset:1024
    v_mfma_f32_16x16x32_bf16 v[40:43], a[52:55], a[44:47], v[40:43]
    s_add_u32 m0, s35, 36864
    ds_read_b128 a[8:11], v242 offset:2048
    v_mfma_f32_16x16x32_bf16 v[60:63], a[52:55], a[48:51], v[60:63]
    s_nop 0
    buffer_load_dwordx4 v140, s[56:59], s43 offen lds
    v_mfma_f32_16x16x32_bf16 v[4:7], a[56:59], a[36:39], v[4:7]
    ds_read_b128 a[12:15], v242 offset:3072
    v_mfma_f32_16x16x32_bf16 v[24:27], a[56:59], a[40:43], v[24:27]
    ds_read_b64_tr_b16 a[16:17], v155 offset:0
    v_mfma_f32_16x16x32_bf16 v[44:47], a[56:59], a[44:47], v[44:47]
    s_add_u32 m0, s35, 37888
    ds_read_b64_tr_b16 a[18:19], v155 offset:5120
    v_mfma_f32_16x16x32_bf16 v[64:67], a[56:59], a[48:51], v[64:67]
    s_add_u32 s43, s43, s97
    buffer_load_dwordx4 v141, s[56:59], s44 offen lds
    v_mfma_f32_16x16x32_bf16 v[8:11], a[60:63], a[36:39], v[8:11]
    ds_read_b64_tr_b16 a[20:21], v156 offset:0
    v_mfma_f32_16x16x32_bf16 v[28:31], a[60:63], a[40:43], v[28:31]
    ds_read_b64_tr_b16 a[22:23], v156 offset:5120
    v_mfma_f32_16x16x32_bf16 v[48:51], a[60:63], a[44:47], v[48:51]
    s_add_u32 m0, s35, 38912
    ds_read_b64_tr_b16 a[24:25], v157 offset:0
    v_mfma_f32_16x16x32_bf16 v[68:71], a[60:63], a[48:51], v[68:71]
    s_add_u32 s44, s44, s97
    buffer_load_dwordx4 v142, s[56:59], s45 offen lds
    v_mfma_f32_16x16x32_bf16 v[12:15], a[64:67], a[36:39], v[12:15]
    ds_read_b64_tr_b16 a[26:27], v157 offset:5120
    v_mfma_f32_16x16x32_bf16 v[32:35], a[64:67], a[40:43], v[32:35]
    ds_read_b64_tr_b16 a[28:29], v158 offset:0
    v_mfma_f32_16x16x32_bf16 v[52:55], a[64:67], a[44:47], v[52:55]
    s_add_u32 m0, s35, 39936
    ds_read_b64_tr_b16 a[30:31], v158 offset:5120
    v_mfma_f32_16x16x32_bf16 v[72:75], a[64:67], a[48:51], v[72:75]
    s_add_u32 s45, s45, s97
    buffer_load_dwordx4 v143, s[56:59], s46 offen lds
    v_mfma_f32_16x16x32_bf16 v[16:19], a[68:71], a[36:39], v[16:19]
    ds_read_b64_tr_b16 a[32:33], v159 offset:0
    v_mfma_f32_16x16x32_bf16 v[36:39], a[68:71], a[40:43], v[36:39]
    ds_read_b64_tr_b16 a[34:35], v159 offset:5120
    v_mfma_f32_16x16x32_bf16 v[56:59], a[68:71], a[44:47], v[56:59]
    s_add_u32 m0, s35, 40960
    v_mfma_f32_16x16x32_bf16 v[76:79], a[68:71], a[48:51], v[76:79]
    s_add_u32 s46, s46, s97
    buffer_load_dwordx4 v144, s[56:59], s47 offen lds
    s_waitcnt lgkmcnt(0)
    v_mfma_f32_16x16x32_bf16 v[0:3], a[16:19], a[0:3], v[0:3]
    ds_read_b128 a[36:39], v242 offset:18432
    v_mfma_f32_16x16x32_bf16 v[20:23], a[16:19], a[4:7], v[20:23]
    ds_read_b128 a[40:43], v242 offset:19456
    v_mfma_f32_16x16x32_bf16 v[40:43], a[16:19], a[8:11], v[40:43]
    s_add_u32 m0, s35, 41984
    ds_read_b128 a[44:47], v242 offset:20480
    v_mfma_f32_16x16x32_bf16 v[60:63], a[16:19], a[12:15], v[60:63]
    s_add_u32 s47, s47, s97
    buffer_load_dwordx4 v145, s[56:59], s48 offen lds
    v_mfma_f32_16x16x32_bf16 v[4:7], a[20:23], a[0:3], v[4:7]
    ds_read_b128 a[48:51], v242 offset:21504
    v_mfma_f32_16x16x32_bf16 v[24:27], a[20:23], a[4:7], v[24:27]
    ds_read_b64_tr_b16 a[52:53], v155 offset:18432
    v_mfma_f32_16x16x32_bf16 v[44:47], a[20:23], a[8:11], v[44:47]
    s_add_u32 m0, s35, 43008
    ds_read_b64_tr_b16 a[54:55], v155 offset:23552
    v_mfma_f32_16x16x32_bf16 v[64:67], a[20:23], a[12:15], v[64:67]
    s_add_u32 s48, s48, s97
    buffer_load_dwordx4 v146, s[56:59], s49 offen lds
    v_mfma_f32_16x16x32_bf16 v[8:11], a[24:27], a[0:3], v[8:11]
    ds_read_b64_tr_b16 a[56:57], v156 offset:18432
    v_mfma_f32_16x16x32_bf16 v[28:31], a[24:27], a[4:7], v[28:31]
    ds_read_b64_tr_b16 a[58:59], v156 offset:23552
    v_mfma_f32_16x16x32_bf16 v[48:51], a[24:27], a[8:11], v[48:51]
    s_add_u32 m0, s35, 44032
    ds_read_b64_tr_b16 a[60:61], v157 offset:18432
    v_mfma_f32_16x16x32_bf16 v[68:71], a[24:27], a[12:15], v[68:71]
    s_add_u32 s49, s49, s97
    buffer_load_dwordx4 v147, s[56:59], s50 offen lds
    v_mfma_f32_16x16x32_bf16 v[12:15], a[28:31], a[0:3], v[12:15]
    ds_read_b64_tr_b16 a[62:63], v157 offset:23552
    v_mfma_f32_16x16x32_bf16 v[32:35], a[28:31], a[4:7], v[32:35]
    ds_read_b64_tr_b16 a[64:65], v158 offset:18432
    v_mfma_f32_16x16x32_bf16 v[52:55], a[28:31], a[8:11], v[52:55]
    s_add_u32 m0, s35, 45056
    ds_read_b64_tr_b16 a[66:67], v158 offset:23552
    v_mfma_f32_16x16x32_bf16 v[72:75], a[28:31], a[12:15], v[72:75]
    s_add_u32 s50, s50, s97
    buffer_load_dwordx4 v148, s[16:19], s51 offen lds
    s_add_u32 s51, s51, 81920
    v_mfma_f32_16x16x32_bf16 v[16:19], a[32:35], a[0:3], v[16:19]
    ds_read_b64_tr_b16 a[68:69], v159 offset:18432
    v_mfma_f32_16x16x32_bf16 v[36:39], a[32:35], a[4:7], v[36:39]
    ds_read_b64_tr_b16 a[70:71], v159 offset:23552
    v_mfma_f32_16x16x32_bf16 v[56:59], a[32:35], a[8:11], v[56:59]
    v_mfma_f32_16x16x32_bf16 v[76:79], a[32:35], a[12:15], v[76:79]
    s_waitcnt lgkmcnt(0)
    s_waitcnt vmcnt(18)
    s_barrier
    v_mfma_f32_16x16x32_bf16 v[0:3], a[52:55], a[36:39], v[0:3]
    ds_read_b128 a[0:3], v242 offset:36864
    v_mfma_f32_16x16x32_bf16 v[20:23], a[52:55], a[40:43], v[20:23]
    ds_read_b128 a[4:7], v242 offset:37888
    v_mfma_f32_16x16x32_bf16 v[40:43], a[52:55], a[44:47], v[40:43]
    s_add_u32 m0, s35, 73728
    ds_read_b128 a[8:11], v242 offset:38912
    v_mfma_f32_16x16x32_bf16 v[60:63], a[52:55], a[48:51], v[60:63]
    s_nop 0
    buffer_load_dwordx4 v140, s[56:59], s43 offen lds
    v_mfma_f32_16x16x32_bf16 v[4:7], a[56:59], a[36:39], v[4:7]
    ds_read_b128 a[12:15], v242 offset:39936
    v_mfma_f32_16x16x32_bf16 v[24:27], a[56:59], a[40:43], v[24:27]
    ds_read_b64_tr_b16 a[16:17], v155 offset:36864
    v_mfma_f32_16x16x32_bf16 v[44:47], a[56:59], a[44:47], v[44:47]
    s_add_u32 m0, s35, 74752
    ds_read_b64_tr_b16 a[18:19], v155 offset:41984
    v_mfma_f32_16x16x32_bf16 v[64:67], a[56:59], a[48:51], v[64:67]
    s_add_u32 s43, s43, s97
    buffer_load_dwordx4 v141, s[56:59], s44 offen lds
    v_mfma_f32_16x16x32_bf16 v[8:11], a[60:63], a[36:39], v[8:11]
    ds_read_b64_tr_b16 a[20:21], v156 offset:36864
    v_mfma_f32_16x16x32_bf16 v[28:31], a[60:63], a[40:43], v[28:31]
    ds_read_b64_tr_b16 a[22:23], v156 offset:41984
    v_mfma_f32_16x16x32_bf16 v[48:51], a[60:63], a[44:47], v[48:51]
    s_add_u32 m0, s35, 75776
    ds_read_b64_tr_b16 a[24:25], v157 offset:36864
    v_mfma_f32_16x16x32_bf16 v[68:71], a[60:63], a[48:51], v[68:71]
    s_add_u32 s44, s44, s97
    buffer_load_dwordx4 v142, s[56:59], s45 offen lds
    v_mfma_f32_16x16x32_bf16 v[12:15], a[64:67], a[36:39], v[12:15]
    ds_read_b64_tr_b16 a[26:27], v157 offset:41984
    v_mfma_f32_16x16x32_bf16 v[32:35], a[64:67], a[40:43], v[32:35]
    ds_read_b64_tr_b16 a[28:29], v158 offset:36864
    v_mfma_f32_16x16x32_bf16 v[52:55], a[64:67], a[44:47], v[52:55]
    s_add_u32 m0, s35, 76800
    ds_read_b64_tr_b16 a[30:31], v158 offset:41984
    v_mfma_f32_16x16x32_bf16 v[72:75], a[64:67], a[48:51], v[72:75]
    s_add_u32 s45, s45, s97
    buffer_load_dwordx4 v143, s[56:59], s46 offen lds
    v_mfma_f32_16x16x32_bf16 v[16:19], a[68:71], a[36:39], v[16:19]
    ds_read_b64_tr_b16 a[32:33], v159 offset:36864
    v_mfma_f32_16x16x32_bf16 v[36:39], a[68:71], a[40:43], v[36:39]
    ds_read_b64_tr_b16 a[34:35], v159 offset:41984
    v_mfma_f32_16x16x32_bf16 v[56:59], a[68:71], a[44:47], v[56:59]
    s_add_u32 m0, s35, 77824
    v_mfma_f32_16x16x32_bf16 v[76:79], a[68:71], a[48:51], v[76:79]
    s_add_u32 s46, s46, s97
    buffer_load_dwordx4 v144, s[56:59], s47 offen lds
    s_waitcnt lgkmcnt(0)
    v_mfma_f32_16x16x32_bf16 v[0:3], a[16:19], a[0:3], v[0:3]
    ds_read_b128 a[36:39], v242 offset:55296
    v_mfma_f32_16x16x32_bf16 v[20:23], a[16:19], a[4:7], v[20:23]
    ds_read_b128 a[40:43], v242 offset:56320
    v_mfma_f32_16x16x32_bf16 v[40:43], a[16:19], a[8:11], v[40:43]
    s_add_u32 m0, s35, 78848
    ds_read_b128 a[44:47], v242 offset:57344
    v_mfma_f32_16x16x32_bf16 v[60:63], a[16:19], a[12:15], v[60:63]
    s_add_u32 s47, s47, s97
    buffer_load_dwordx4 v145, s[56:59], s48 offen lds
    v_mfma_f32_16x16x32_bf16 v[4:7], a[20:23], a[0:3], v[4:7]
    ds_read_b128 a[48:51], v242 offset:58368
    v_mfma_f32_16x16x32_bf16 v[24:27], a[20:23], a[4:7], v[24:27]
    ds_read_b64_tr_b16 a[52:53], v155 offset:55296
    v_mfma_f32_16x16x32_bf16 v[44:47], a[20:23], a[8:11], v[44:47]
    s_add_u32 m0, s35, 79872
    ds_read_b64_tr_b16 a[54:55], v155 offset:60416
    v_mfma_f32_16x16x32_bf16 v[64:67], a[20:23], a[12:15], v[64:67]
    s_add_u32 s48, s48, s97
    buffer_load_dwordx4 v146, s[56:59], s49 offen lds
    v_mfma_f32_16x16x32_bf16 v[8:11], a[24:27], a[0:3], v[8:11]
    ds_read_b64_tr_b16 a[56:57], v156 offset:55296
    v_mfma_f32_16x16x32_bf16 v[28:31], a[24:27], a[4:7], v[28:31]
    ds_read_b64_tr_b16 a[58:59], v156 offset:60416
    v_mfma_f32_16x16x32_bf16 v[48:51], a[24:27], a[8:11], v[48:51]
    s_add_u32 m0, s35, 80896
    ds_read_b64_tr_b16 a[60:61], v157 offset:55296
    v_mfma_f32_16x16x32_bf16 v[68:71], a[24:27], a[12:15], v[68:71]
    s_add_u32 s49, s49, s97
    buffer_load_dwordx4 v147, s[56:59], s50 offen lds
    v_mfma_f32_16x16x32_bf16 v[12:15], a[28:31], a[0:3], v[12:15]
    ds_read_b64_tr_b16 a[62:63], v157 offset:60416
    v_mfma_f32_16x16x32_bf16 v[32:35], a[28:31], a[4:7], v[32:35]
    ds_read_b64_tr_b16 a[64:65], v158 offset:55296
    v_mfma_f32_16x16x32_bf16 v[52:55], a[28:31], a[8:11], v[52:55]
    s_add_u32 m0, s35, 81920
    ds_read_b64_tr_b16 a[66:67], v158 offset:60416
    v_mfma_f32_16x16x32_bf16 v[72:75], a[28:31], a[12:15], v[72:75]
    s_add_u32 s50, s50, s97
    buffer_load_dwordx4 v148, s[16:19], s51 offen lds
    s_add_u32 s51, s51, 81920
    v_mfma_f32_16x16x32_bf16 v[16:19], a[32:35], a[0:3], v[16:19]
    ds_read_b64_tr_b16 a[68:69], v159 offset:55296
    v_mfma_f32_16x16x32_bf16 v[36:39], a[32:35], a[4:7], v[36:39]
    ds_read_b64_tr_b16 a[70:71], v159 offset:60416
    v_mfma_f32_16x16x32_bf16 v[56:59], a[32:35], a[8:11], v[56:59]
    v_mfma_f32_16x16x32_bf16 v[76:79], a[32:35], a[12:15], v[76:79]
    s_waitcnt lgkmcnt(0)
    s_waitcnt vmcnt(18)
    s_barrier
    v_mfma_f32_16x16x32_bf16 v[0:3], a[52:55], a[36:39], v[0:3]
    ds_read_b128 a[0:3], v241 offset:0
    v_mfma_f32_16x16x32_bf16 v[20:23], a[52:55], a[40:43], v[20:23]
    ds_read_b128 a[4:7], v241 offset:1024
    v_mfma_f32_16x16x32_bf16 v[40:43], a[52:55], a[44:47], v[40:43]
    s_add_u32 m0, s35, 110592
    ds_read_b128 a[8:11], v241 offset:2048
    v_mfma_f32_16x16x32_bf16 v[60:63], a[52:55], a[48:51], v[60:63]
    s_nop 0
    buffer_load_dwordx4 v140, s[56:59], s43 offen lds
    v_mfma_f32_16x16x32_bf16 v[4:7], a[56:59], a[36:39], v[4:7]
    ds_read_b128 a[12:15], v241 offset:3072
    v_mfma_f32_16x16x32_bf16 v[24:27], a[56:59], a[40:43], v[24:27]
    ds_read_b64_tr_b16 a[16:17], v150 offset:0
    v_mfma_f32_16x16x32_bf16 v[44:47], a[56:59], a[44:47], v[44:47]
    s_add_u32 m0, s35, 111616
    ds_read_b64_tr_b16 a[18:19], v150 offset:5120
    v_mfma_f32_16x16x32_bf16 v[64:67], a[56:59], a[48:51], v[64:67]
    s_add_u32 s43, s43, s97
    buffer_load_dwordx4 v141, s[56:59], s44 offen lds
    v_mfma_f32_16x16x32_bf16 v[8:11], a[60:63], a[36:39], v[8:11]
    ds_read_b64_tr_b16 a[20:21], v151 offset:0
    v_mfma_f32_16x16x32_bf16 v[28:31], a[60:63], a[40:43], v[28:31]
    ds_read_b64_tr_b16 a[22:23], v151 offset:5120
    v_mfma_f32_16x16x32_bf16 v[48:51], a[60:63], a[44:47], v[48:51]
    s_add_u32 m0, s35, 112640
    ds_read_b64_tr_b16 a[24:25], v152 offset:0
    v_mfma_f32_16x16x32_bf16 v[68:71], a[60:63], a[48:51], v[68:71]
    s_add_u32 s44, s44, s97
    buffer_load_dwordx4 v142, s[56:59], s45 offen lds
    v_mfma_f32_16x16x32_bf16 v[12:15], a[64:67], a[36:39], v[12:15]
    ds_read_b64_tr_b16 a[26:27], v152 offset:5120
    v_mfma_f32_16x16x32_bf16 v[32:35], a[64:67], a[40:43], v[32:35]
    ds_read_b64_tr_b16 a[28:29], v153 offset:0
    v_mfma_f32_16x16x32_bf16 v[52:55], a[64:67], a[44:47], v[52:55]
    s_add_u32 m0, s35, 113664
    ds_read_b64_tr_b16 a[30:31], v153 offset:5120
    v_mfma_f32_16x16x32_bf16 v[72:75], a[64:67], a[48:51], v[72:75]
    s_add_u32 s45, s45, s97
    buffer_load_dwordx4 v143, s[56:59], s46 offen lds
    v_mfma_f32_16x16x32_bf16 v[16:19], a[68:71], a[36:39], v[16:19]
    ds_read_b64_tr_b16 a[32:33], v154 offset:0
    v_mfma_f32_16x16x32_bf16 v[36:39], a[68:71], a[40:43], v[36:39]
    ds_read_b64_tr_b16 a[34:35], v154 offset:5120
    v_mfma_f32_16x16x32_bf16 v[56:59], a[68:71], a[44:47], v[56:59]
    s_add_u32 m0, s35, 114688
    v_mfma_f32_16x16x32_bf16 v[76:79], a[68:71], a[48:51], v[76:79]
    s_add_u32 s46, s46, s97
    buffer_load_dwordx4 v144, s[56:59], s47 offen lds
    s_mov_b32 s38, 2
L_oproj_loop:
    s_waitcnt lgkmcnt(0)
    v_mfma_f32_16x16x32_bf16 v[0:3], a[16:19], a[0:3], v[0:3]
    ds_read_b128 a[36:39], v241 offset:18432
    v_mfma_f32_16x16x32_bf16 v[20:23], a[16:19], a[4:7], v[20:23]
    ds_read_b128 a[40:43], v241 offset:19456
    v_mfma_f32_16x16x32_bf16 v[40:43], a[16:19], a[8:11], v[40:43]
    s_add_u32 m0, s35, 115712
    ds_read_b128 a[44:47], v241 offset:20480
    v_mfma_f32_16x16x32_bf16 v[60:63], a[16:19], a[12:15], v[60:63]
    s_add_u32 s47, s47, s97
    buffer_load_dwordx4 v145, s[56:59], s48 offen lds
    v_mfma_f32_16x16x32_bf16 v[4:7], a[20:23], a[0:3], v[4:7]
    ds_read_b128 a[48:51], v241 offset:21504
    v_mfma_f32_16x16x32_bf16 v[24:27], a[20:23], a[4:7], v[24:27]
    ds_read_b64_tr_b16 a[52:53], v150 offset:18432
    v_mfma_f32_16x16x32_bf16 v[44:47], a[20:23], a[8:11], v[44:47]
    s_add_u32 m0, s35, 116736
    ds_read_b64_tr_b16 a[54:55], v150 offset:23552
    v_mfma_f32_16x16x32_bf16 v[64:67], a[20:23], a[12:15], v[64:67]
    s_add_u32 s48, s48, s97
    buffer_load_dwordx4 v146, s[56:59], s49 offen lds
    v_mfma_f32_16x16x32_bf16 v[8:11], a[24:27], a[0:3], v[8:11]
    ds_read_b64_tr_b16 a[56:57], v151 offset:18432
    v_mfma_f32_16x16x32_bf16 v[28:31], a[24:27], a[4:7], v[28:31]
    ds_read_b64_tr_b16 a[58:59], v151 offset:23552
    v_mfma_f32_16x16x32_bf16 v[48:51], a[24:27], a[8:11], v[48:51]
    s_add_u32 m0, s35, 117760
    ds_read_b64_tr_b16 a[60:61], v152 offset:18432
    v_mfma_f32_16x16x32_bf16 v[68:71], a[24:27], a[12:15], v[68:71]
    s_add_u32 s49, s49, s97
    buffer_load_dwordx4 v147, s[56:59], s50 offen lds
    v_mfma_f32_16x16x32_bf16 v[12:15], a[28:31], a[0:3], v[12:15]
    ds_read_b64_tr_b16 a[62:63], v152 offset:23552
    v_mfma_f32_16x16x32_bf16 v[32:35], a[28:31], a[4:7], v[32:35]
    ds_read_b64_tr_b16 a[64:65], v153 offset:18432
    v_mfma_f32_16x16x32_bf16 v[52:55], a[28:31], a[8:11], v[52:55]
    s_add_u32 m0, s35, 118784
    ds_read_b64_tr_b16 a[66:67], v153 offset:23552
    v_mfma_f32_16x16x32_bf16 v[72:75], a[28:31], a[12:15], v[72:75]
    s_add_u32 s50, s50, s97
    buffer_load_dwordx4 v148, s[16:19], s51 offen lds
    s_add_u32 s51, s51, 81920
    v_mfma_f32_16x16x32_bf16 v[16:19], a[32:35], a[0:3], v[16:19]
    ds_read_b64_tr_b16 a[68:69], v154 offset:18432
    v_mfma_f32_16x16x32_bf16 v[36:39], a[32:35], a[4:7], v[36:39]
    ds_read_b64_tr_b16 a[70:71], v154 offset:23552
    v_mfma_f32_16x16x32_bf16 v[56:59], a[32:35], a[8:11], v[56:59]
    v_mfma_f32_16x16x32_bf16 v[76:79], a[32:35], a[12:15], v[76:79]
    s_waitcnt vmcnt(18) lgkmcnt(0)
    s_barrier
    v_mfma_f32_16x16x32_bf16 v[0:3], a[52:55], a[36:39], v[0:3]
    ds_read_b128 a[0:3], v241 offset:36864
    v_mfma_f32_16x16x32_bf16 v[20:23], a[52:55], a[40:43], v[20:23]
    ds_read_b128 a[4:7], v241 offset:37888
    v_mfma_f32_16x16x32_bf16 v[40:43], a[52:55], a[44:47], v[40:43]
    s_add_u32 m0, s35, 0
    ds_read_b128 a[8:11], v241 offset:38912
    v_mfma_f32_16x16x32_bf16 v[60:63], a[52:55], a[48:51], v[60:63]
    s_nop 0
    buffer_load_dwordx4 v140, s[56:59], s43 offen lds
    v_mfma_f32_16x16x32_bf16 v[4:7], a[56:59], a[36:39], v[4:7]
    ds_read_b128 a[12:15], v241 offset:39936
    v_mfma_f32_16x16x32_bf16 v[24:27], a[56:59], a[40:43], v[24:27]
    ds_read_b64_tr_b16 a[16:17], v150 offset:36864
    v_mfma_f32_16x16x32_bf16 v[44:47], a[56:59], a[44:47], v[44:47]
    s_add_u32 m0, s35, 1024
    ds_read_b64_tr_b16 a[18:19], v150 offset:41984
    v_mfma_f32_16x16x32_bf16 v[64:67], a[56:59], a[48:51], v[64:67]
    s_add_u32 s43, s43, s97
    buffer_load_dwordx4 v141, s[56:59], s44 offen lds
    v_mfma_f32_16x16x32_bf16 v[8:11], a[60:63], a[36:39], v[8:11]
    ds_read_b64_tr_b16 a[20:21], v151 offset:36864
    v_mfma_f32_16x16x32_bf16 v[28:31], a[60:63], a[40:43], v[28:31]
    ds_read_b64_tr_b16 a[22:23], v151 offset:41984
    v_mfma_f32_16x16x32_bf16 v[48:51], a[60:63], a[44:47], v[48:51]
    s_add_u32 m0, s35, 2048
    ds_read_b64_tr_b16 a[24:25], v152 offset:36864
    v_mfma_f32_16x16x32_bf16 v[68:71], a[60:63], a[48:51], v[68:71]
    s_add_u32 s44, s44, s97
    buffer_load_dwordx4 v142, s[56:59], s45 offen lds
    v_mfma_f32_16x16x32_bf16 v[12:15], a[64:67], a[36:39], v[12:15]
    ds_read_b64_tr_b16 a[26:27], v152 offset:41984
    v_mfma_f32_16x16x32_bf16 v[32:35], a[64:67], a[40:43], v[32:35]
    ds_read_b64_tr_b16 a[28:29], v153 offset:36864
    v_mfma_f32_16x16x32_bf16 v[52:55], a[64:67], a[44:47], v[52:55]
    s_add_u32 m0, s35, 3072
    ds_read_b64_tr_b16 a[30:31], v153 offset:41984
    v_mfma_f32_16x16x32_bf16 v[72:75], a[64:67], a[48:51], v[72:75]
    s_add_u32 s45, s45, s97
    buffer_load_dwordx4 v143, s[56:59], s46 offen lds
    v_mfma_f32_16x16x32_bf16 v[16:19], a[68:71], a[36:39], v[16:19]
    ds_read_b64_tr_b16 a[32:33], v154 offset:36864
    v_mfma_f32_16x16x32_bf16 v[36:39], a[68:71], a[40:43], v[36:39]
    ds_read_b64_tr_b16 a[34:35], v154 offset:41984
    v_mfma_f32_16x16x32_bf16 v[56:59], a[68:71], a[44:47], v[56:59]
    s_add_u32 m0, s35, 4096
    v_mfma_f32_16x16x32_bf16 v[76:79], a[68:71], a[48:51], v[76:79]
    s_add_u32 s46, s46, s97
    buffer_load_dwordx4 v144, s[56:59], s47 offen lds
    s_waitcnt lgkmcnt(0)
    v_mfma_f32_16x16x32_bf16 v[0:3], a[16:19], a[0:3], v[0:3]
    ds_read_b128 a[36:39], v241 offset:55296
    v_mfma_f32_16x16x32_bf16 v[20:23], a[16:19], a[4:7], v[20:23]
    ds_read_b128 a[40:43], v241 offset:56320
    v_mfma_f32_16x16x32_bf16 v[40:43], a[16:19], a[8:11], v[40:43]
    s_add_u32 m0, s35, 5120
    ds_read_b128 a[44:47], v241 offset:57344
    v_mfma_f32_16x16x32_bf16 v[60:63], a[16:19], a[12:15], v[60:63]
    s_add_u32 s47, s47, s97
    buffer_load_dwordx4 v145, s[56:59], s48 offen lds
    v_mfma_f32_16x16x32_bf16 v[4:7], a[20:23], a[0:3], v[4:7]
    ds_read_b128 a[48:51], v241 offset:58368
    v_mfma_f32_16x16x32_bf16 v[24:27], a[20:23], a[4:7], v[24:27]
    ds_read_b64_tr_b16 a[52:53], v150 offset:55296
    v_mfma_f32_16x16x32_bf16 v[44:47], a[20:23], a[8:11], v[44:47]
    s_add_u32 m0, s35, 6144
    ds_read_b64_tr_b16 a[54:55], v150 offset:60416
    v_mfma_f32_16x16x32_bf16 v[64:67], a[20:23], a[12:15], v[64:67]
    s_add_u32 s48, s48, s97
    buffer_load_dwordx4 v146, s[56:59], s49 offen lds
    v_mfma_f32_16x16x32_bf16 v[8:11], a[24:27], a[0:3], v[8:11]
    ds_read_b64_tr_b16 a[56:57], v151 offset:55296
    v_mfma_f32_16x16x32_bf16 v[28:31], a[24:27], a[4:7], v[28:31]
    ds_read_b64_tr_b16 a[58:59], v151 offset:60416
    v_mfma_f32_16x16x32_bf16 v[48:51], a[24:27], a[8:11], v[48:51]
    s_add_u32 m0, s35, 7168
    ds_read_b64_tr_b16 a[60:61], v152 offset:55296
    v_mfma_f32_16x16x32_bf16 v[68:71], a[24:27], a[12:15], v[68:71]
    s_add_u32 s49, s49, s97
    buffer_load_dwordx4 v147, s[56:59], s50 offen lds
    v_mfma_f32_16x16x32_bf16 v[12:15], a[28:31], a[0:3], v[12:15]
    ds_read_b64_tr_b16 a[62:63], v152 offset:60416
    v_mfma_f32_16x16x32_bf16 v[32:35], a[28:31], a[4:7], v[32:35]
    ds_read_b64_tr_b16 a[64:65], v153 offset:55296
    v_mfma_f32_16x16x32_bf16 v[52:55], a[28:31], a[8:11], v[52:55]
    s_add_u32 m0, s35, 8192
    ds_read_b64_tr_b16 a[66:67], v153 offset:60416
    v_mfma_f32_16x16x32_bf16 v[72:75], a[28:31], a[12:15], v[72:75]
    s_add_u32 s50, s50, s97
    buffer_load_dwordx4 v148, s[16:19], s51 offen lds
    s_add_u32 s51, s51, 81920
    v_mfma_f32_16x16x32_bf16 v[16:19], a[32:35], a[0:3], v[16:19]
    ds_read_b64_tr_b16 a[68:69], v154 offset:55296
    v_mfma_f32_16x16x32_bf16 v[36:39], a[32:35], a[4:7], v[36:39]
    ds_read_b64_tr_b16 a[70:71], v154 offset:60416
    v_mfma_f32_16x16x32_bf16 v[56:59], a[32:35], a[8:11], v[56:59]
    v_mfma_f32_16x16x32_bf16 v[76:79], a[32:35], a[12:15], v[76:79]
    s_waitcnt vmcnt(18) lgkmcnt(0)
    s_barrier
    v_mfma_f32_16x16x32_bf16 v[0:3], a[52:55], a[36:39], v[0:3]
    ds_read_b128 a[0:3], v242 offset:0
    v_mfma_f32_16x16x32_bf16 v[20:23], a[52:55], a[40:43], v[20:23]
    ds_read_b128 a[4:7], v242 offset:1024
    v_mfma_f32_16x16x32_bf16 v[40:43], a[52:55], a[44:47], v[40:43]
    s_add_u32 m0, s35, 36864
    ds_read_b128 a[8:11], v242 offset:2048
    v_mfma_f32_16x16x32_bf16 v[60:63], a[52:55], a[48:51], v[60:63]
    s_nop 0
    buffer_load_dwordx4 v140, s[56:59], s43 offen lds
    v_mfma_f32_16x16x32_bf16 v[4:7], a[56:59], a[36:39], v[4:7]
    ds_read_b128 a[12:15], v242 offset:3072
    v_mfma_f32_16x16x32_bf16 v[24:27], a[56:59], a[40:43], v[24:27]
    ds_read_b64_tr_b16 a[16:17], v155 offset:0
    v_mfma_f32_16x16x32_bf16 v[44:47], a[56:59], a[44:47], v[44:47]
    s_add_u32 m0, s35, 37888
    ds_read_b64_tr_b16 a[18:19], v155 offset:5120
    v_mfma_f32_16x16x32_bf16 v[64:67], a[56:59], a[48:51], v[64:67]
    s_add_u32 s43, s43, s97
    buffer_load_dwordx4 v141, s[56:59], s44 offen lds
    v_mfma_f32_16x16x32_bf16 v[8:11], a[60:63], a[36:39], v[8:11]
    ds_read_b64_tr_b16 a[20:21], v156 offset:0
    v_mfma_f32_16x16x32_bf16 v[28:31], a[60:63], a[40:43], v[28:31]
    ds_read_b64_tr_b16 a[22:23], v156 offset:5120
    v_mfma_f32_16x16x32_bf16 v[48:51], a[60:63], a[44:47], v[48:51]
    s_add_u32 m0, s35, 38912
    ds_read_b64_tr_b16 a[24:25], v157 offset:0
    v_mfma_f32_16x16x32_bf16 v[68:71], a[60:63], a[48:51], v[68:71]
    s_add_u32 s44, s44, s97
    buffer_load_dwordx4 v142, s[56:59], s45 offen lds
    v_mfma_f32_16x16x32_bf16 v[12:15], a[64:67], a[36:39], v[12:15]
    ds_read_b64_tr_b16 a[26:27], v157 offset:5120
    v_mfma_f32_16x16x32_bf16 v[32:35], a[64:67], a[40:43], v[32:35]
    ds_read_b64_tr_b16 a[28:29], v158 offset:0
    v_mfma_f32_16x16x32_bf16 v[52:55], a[64:67], a[44:47], v[52:55]
    s_add_u32 m0, s35, 39936
    ds_read_b64_tr_b16 a[30:31], v158 offset:5120
    v_mfma_f32_16x16x32_bf16 v[72:75], a[64:67], a[48:51], v[72:75]
    s_add_u32 s45, s45, s97
    buffer_load_dwordx4 v143, s[56:59], s46 offen lds
    v_mfma_f32_16x16x32_bf16 v[16:19], a[68:71], a[36:39], v[16:19]
    ds_read_b64_tr_b16 a[32:33], v159 offset:0
    v_mfma_f32_16x16x32_bf16 v[36:39], a[68:71], a[40:43], v[36:39]
    ds_read_b64_tr_b16 a[34:35], v159 offset:5120
    v_mfma_f32_16x16x32_bf16 v[56:59], a[68:71], a[44:47], v[56:59]
    s_add_u32 m0, s35, 40960
    v_mfma_f32_16x16x32_bf16 v[76:79], a[68:71], a[48:51], v[76:79]
    s_add_u32 s46, s46, s97
    buffer_load_dwordx4 v144, s[56:59], s47 offen lds
    s_waitcnt lgkmcnt(0)
    v_mfma_f32_16x16x32_bf16 v[0:3], a[16:19], a[0:3], v[0:3]
    ds_read_b128 a[36:39], v242 offset:18432
    v_mfma_f32_16x16x32_bf16 v[20:23], a[16:19], a[4:7], v[20:23]
    ds_read_b128 a[40:43], v242 offset:19456
    v_mfma_f32_16x16x32_bf16 v[40:43], a[16:19], a[8:11], v[40:43]
    s_add_u32 m0, s35, 41984
    ds_read_b128 a[44:47], v242 offset:20480
    v_mfma_f32_16x16x32_bf16 v[60:63], a[16:19], a[12:15], v[60:63]
    s_add_u32 s47, s47, s97
    buffer_load_dwordx4 v145, s[56:59], s48 offen lds
    v_mfma_f32_16x16x32_bf16 v[4:7], a[20:23], a[0:3], v[4:7]
    ds_read_b128 a[48:51], v242 offset:21504
    v_mfma_f32_16x16x32_bf16 v[24:27], a[20:23], a[4:7], v[24:27]
    ds_read_b64_tr_b16 a[52:53], v155 offset:18432
    v_mfma_f32_16x16x32_bf16 v[44:47], a[20:23], a[8:11], v[44:47]
    s_add_u32 m0, s35, 43008
    ds_read_b64_tr_b16 a[54:55], v155 offset:23552
    v_mfma_f32_16x16x32_bf16 v[64:67], a[20:23], a[12:15], v[64:67]
    s_add_u32 s48, s48, s97
    buffer_load_dwordx4 v146, s[56:59], s49 offen lds
    v_mfma_f32_16x16x32_bf16 v[8:11], a[24:27], a[0:3], v[8:11]
    ds_read_b64_tr_b16 a[56:57], v156 offset:18432
    v_mfma_f32_16x16x32_bf16 v[28:31], a[24:27], a[4:7], v[28:31]
    ds_read_b64_tr_b16 a[58:59], v156 offset:23552
    v_mfma_f32_16x16x32_bf16 v[48:51], a[24:27], a[8:11], v[48:51]
    s_add_u32 m0, s35, 44032
    ds_read_b64_tr_b16 a[60:61], v157 offset:18432
    v_mfma_f32_16x16x32_bf16 v[68:71], a[24:27], a[12:15], v[68:71]
    s_add_u32 s49, s49, s97
    buffer_load_dwordx4 v147, s[56:59], s50 offen lds
    v_mfma_f32_16x16x32_bf16 v[12:15], a[28:31], a[0:3], v[12:15]
    ds_read_b64_tr_b16 a[62:63], v157 offset:23552
    v_mfma_f32_16x16x32_bf16 v[32:35], a[28:31], a[4:7], v[32:35]
    ds_read_b64_tr_b16 a[64:65], v158 offset:18432
    v_mfma_f32_16x16x32_bf16 v[52:55], a[28:31], a[8:11], v[52:55]
    s_add_u32 m0, s35, 45056
    ds_read_b64_tr_b16 a[66:67], v158 offset:23552
    v_mfma_f32_16x16x32_bf16 v[72:75], a[28:31], a[12:15], v[72:75]
    s_add_u32 s50, s50, s97
    buffer_load_dwordx4 v148, s[16:19], s51 offen lds
    s_add_u32 s51, s51, 81920
    v_mfma_f32_16x16x32_bf16 v[16:19], a[32:35], a[0:3], v[16:19]
    ds_read_b64_tr_b16 a[68:69], v159 offset:18432
    v_mfma_f32_16x16x32_bf16 v[36:39], a[32:35], a[4:7], v[36:39]
    ds_read_b64_tr_b16 a[70:71], v159 offset:23552
    v_mfma_f32_16x16x32_bf16 v[56:59], a[32:35], a[8:11], v[56:59]
    v_mfma_f32_16x16x32_bf16 v[76:79], a[32:35], a[12:15], v[76:79]
    s_waitcnt vmcnt(18) lgkmcnt(0)
    s_barrier
    v_mfma_f32_16x16x32_bf16 v[0:3], a[52:55], a[36:39], v[0:3]
    ds_read_b128 a[0:3], v242 offset:36864
    v_mfma_f32_16x16x32_bf16 v[20:23], a[52:55], a[40:43], v[20:23]
    ds_read_b128 a[4:7], v242 offset:37888
    v_mfma_f32_16x16x32_bf16 v[40:43], a[52:55], a[44:47], v[40:43]
    s_add_u32 m0, s35, 73728
    ds_read_b128 a[8:11], v242 offset:38912
    v_mfma_f32_16x16x32_bf16 v[60:63], a[52:55], a[48:51], v[60:63]
    s_nop 0
    buffer_load_dwordx4 v140, s[56:59], s43 offen lds
    v_mfma_f32_16x16x32_bf16 v[4:7], a[56:59], a[36:39], v[4:7]
    ds_read_b128 a[12:15], v242 offset:39936
    v_mfma_f32_16x16x32_bf16 v[24:27], a[56:59], a[40:43], v[24:27]
    ds_read_b64_tr_b16 a[16:17], v155 offset:36864
    v_mfma_f32_16x16x32_bf16 v[44:47], a[56:59], a[44:47], v[44:47]
    s_add_u32 m0, s35, 74752
    ds_read_b64_tr_b16 a[18:19], v155 offset:41984
    v_mfma_f32_16x16x32_bf16 v[64:67], a[56:59], a[48:51], v[64:67]
    s_add_u32 s43, s43, s97
    buffer_load_dwordx4 v141, s[56:59], s44 offen lds
    v_mfma_f32_16x16x32_bf16 v[8:11], a[60:63], a[36:39], v[8:11]
    ds_read_b64_tr_b16 a[20:21], v156 offset:36864
    v_mfma_f32_16x16x32_bf16 v[28:31], a[60:63], a[40:43], v[28:31]
    ds_read_b64_tr_b16 a[22:23], v156 offset:41984
    v_mfma_f32_16x16x32_bf16 v[48:51], a[60:63], a[44:47], v[48:51]
    s_add_u32 m0, s35, 75776
    ds_read_b64_tr_b16 a[24:25], v157 offset:36864
    v_mfma_f32_16x16x32_bf16 v[68:71], a[60:63], a[48:51], v[68:71]
    s_add_u32 s44, s44, s97
    buffer_load_dwordx4 v142, s[56:59], s45 offen lds
    v_mfma_f32_16x16x32_bf16 v[12:15], a[64:67], a[36:39], v[12:15]
    ds_read_b64_tr_b16 a[26:27], v157 offset:41984
    v_mfma_f32_16x16x32_bf16 v[32:35], a[64:67], a[40:43], v[32:35]
    ds_read_b64_tr_b16 a[28:29], v158 offset:36864
    v_mfma_f32_16x16x32_bf16 v[52:55], a[64:67], a[44:47], v[52:55]
    s_add_u32 m0, s35, 76800
    ds_read_b64_tr_b16 a[30:31], v158 offset:41984
    v_mfma_f32_16x16x32_bf16 v[72:75], a[64:67], a[48:51], v[72:75]
    s_add_u32 s45, s45, s97
    buffer_load_dwordx4 v143, s[56:59], s46 offen lds
    v_mfma_f32_16x16x32_bf16 v[16:19], a[68:71], a[36:39], v[16:19]
    ds_read_b64_tr_b16 a[32:33], v159 offset:36864
    v_mfma_f32_16x16x32_bf16 v[36:39], a[68:71], a[40:43], v[36:39]
    ds_read_b64_tr_b16 a[34:35], v159 offset:41984
    v_mfma_f32_16x16x32_bf16 v[56:59], a[68:71], a[44:47], v[56:59]
    s_add_u32 m0, s35, 77824
    v_mfma_f32_16x16x32_bf16 v[76:79], a[68:71], a[48:51], v[76:79]
    s_add_u32 s46, s46, s97
    buffer_load_dwordx4 v144, s[56:59], s47 offen lds
    s_waitcnt lgkmcnt(0)
    v_mfma_f32_16x16x32_bf16 v[0:3], a[16:19], a[0:3], v[0:3]
    ds_read_b128 a[36:39], v242 offset:55296
    v_mfma_f32_16x16x32_bf16 v[20:23], a[16:19], a[4:7], v[20:23]
    ds_read_b128 a[40:43], v242 offset:56320
    v_mfma_f32_16x16x32_bf16 v[40:43], a[16:19], a[8:11], v[40:43]
    s_add_u32 m0, s35, 78848
    ds_read_b128 a[44:47], v242 offset:57344
    v_mfma_f32_16x16x32_bf16 v[60:63], a[16:19], a[12:15], v[60:63]
    s_add_u32 s47, s47, s97
    buffer_load_dwordx4 v145, s[56:59], s48 offen lds
    v_mfma_f32_16x16x32_bf16 v[4:7], a[20:23], a[0:3], v[4:7]
    ds_read_b128 a[48:51], v242 offset:58368
    v_mfma_f32_16x16x32_bf16 v[24:27], a[20:23], a[4:7], v[24:27]
    ds_read_b64_tr_b16 a[52:53], v155 offset:55296
    v_mfma_f32_16x16x32_bf16 v[44:47], a[20:23], a[8:11], v[44:47]
    s_add_u32 m0, s35, 79872
    ds_read_b64_tr_b16 a[54:55], v155 offset:60416
    v_mfma_f32_16x16x32_bf16 v[64:67], a[20:23], a[12:15], v[64:67]
    s_add_u32 s48, s48, s97
    buffer_load_dwordx4 v146, s[56:59], s49 offen lds
    v_mfma_f32_16x16x32_bf16 v[8:11], a[24:27], a[0:3], v[8:11]
    ds_read_b64_tr_b16 a[56:57], v156 offset:55296
    v_mfma_f32_16x16x32_bf16 v[28:31], a[24:27], a[4:7], v[28:31]
    ds_read_b64_tr_b16 a[58:59], v156 offset:60416
    v_mfma_f32_16x16x32_bf16 v[48:51], a[24:27], a[8:11], v[48:51]
    s_add_u32 m0, s35, 80896
    ds_read_b64_tr_b16 a[60:61], v157 offset:55296
    v_mfma_f32_16x16x32_bf16 v[68:71], a[24:27], a[12:15], v[68:71]
    s_add_u32 s49, s49, s97
    buffer_load_dwordx4 v147, s[56:59], s50 offen lds
    v_mfma_f32_16x16x32_bf16 v[12:15], a[28:31], a[0:3], v[12:15]
    ds_read_b64_tr_b16 a[62:63], v157 offset:60416
    v_mfma_f32_16x16x32_bf16 v[32:35], a[28:31], a[4:7], v[32:35]
    ds_read_b64_tr_b16 a[64:65], v158 offset:55296
    v_mfma_f32_16x16x32_bf16 v[52:55], a[28:31], a[8:11], v[52:55]
    s_add_u32 m0, s35, 81920
    ds_read_b64_tr_b16 a[66:67], v158 offset:60416
    v_mfma_f32_16x16x32_bf16 v[72:75], a[28:31], a[12:15], v[72:75]
    s_add_u32 s50, s50, s97
    buffer_load_dwordx4 v148, s[16:19], s51 offen lds
    s_add_u32 s51, s51, 81920
    v_mfma_f32_16x16x32_bf16 v[16:19], a[32:35], a[0:3], v[16:19]
    ds_read_b64_tr_b16 a[68:69], v159 offset:55296
    v_mfma_f32_16x16x32_bf16 v[36:39], a[32:35], a[4:7], v[36:39]
    ds_read_b64_tr_b16 a[70:71], v159 offset:60416
    v_mfma_f32_16x16x32_bf16 v[56:59], a[32:35], a[8:11], v[56:59]
    v_mfma_f32_16x16x32_bf16 v[76:79], a[32:35], a[12:15], v[76:79]
    s_waitcnt vmcnt(18) lgkmcnt(0)
    s_barrier
    v_mfma_f32_16x16x32_bf16 v[0:3], a[52:55], a[36:39], v[0:3]
    ds_read_b128 a[0:3], v241 offset:0
    v_mfma_f32_16x16x32_bf16 v[20:23], a[52:55], a[40:43], v[20:23]
    ds_read_b128 a[4:7], v241 offset:1024
    v_mfma_f32_16x16x32_bf16 v[40:43], a[52:55], a[44:47], v[40:43]
    s_add_u32 m0, s35, 110592
    ds_read_b128 a[8:11], v241 offset:2048
    v_mfma_f32_16x16x32_bf16 v[60:63], a[52:55], a[48:51], v[60:63]
    s_nop 0
    buffer_load_dwordx4 v140, s[56:59], s43 offen lds
    v_mfma_f32_16x16x32_bf16 v[4:7], a[56:59], a[36:39], v[4:7]
    ds_read_b128 a[12:15], v241 offset:3072
    v_mfma_f32_16x16x32_bf16 v[24:27], a[56:59], a[40:43], v[24:27]
    ds_read_b64_tr_b16 a[16:17], v150 offset:0
    v_mfma_f32_16x16x32_bf16 v[44:47], a[56:59], a[44:47], v[44:47]
    s_add_u32 m0, s35, 111616
    ds_read_b64_tr_b16 a[18:19], v150 offset:5120
    v_mfma_f32_16x16x32_bf16 v[64:67], a[56:59], a[48:51], v[64:67]
    s_add_u32 s43, s43, s97
    buffer_load_dwordx4 v141, s[56:59], s44 offen lds
    v_mfma_f32_16x16x32_bf16 v[8:11], a[60:63], a[36:39], v[8:11]
    ds_read_b64_tr_b16 a[20:21], v151 offset:0
    v_mfma_f32_16x16x32_bf16 v[28:31], a[60:63], a[40:43], v[28:31]
    ds_read_b64_tr_b16 a[22:23], v151 offset:5120
    v_mfma_f32_16x16x32_bf16 v[48:51], a[60:63], a[44:47], v[48:51]
    s_add_u32 m0, s35, 112640
    ds_read_b64_tr_b16 a[24:25], v152 offset:0
    v_mfma_f32_16x16x32_bf16 v[68:71], a[60:63], a[48:51], v[68:71]
    s_add_u32 s44, s44, s97
    buffer_load_dwordx4 v142, s[56:59], s45 offen lds
    v_mfma_f32_16x16x32_bf16 v[12:15], a[64:67], a[36:39], v[12:15]
    ds_read_b64_tr_b16 a[26:27], v152 offset:5120
    v_mfma_f32_16x16x32_bf16 v[32:35], a[64:67], a[40:43], v[32:35]
    ds_read_b64_tr_b16 a[28:29], v153 offset:0
    v_mfma_f32_16x16x32_bf16 v[52:55], a[64:67], a[44:47], v[52:55]
    s_add_u32 m0, s35, 113664
    ds_read_b64_tr_b16 a[30:31], v153 offset:5120
    v_mfma_f32_16x16x32_bf16 v[72:75], a[64:67], a[48:51], v[72:75]
    s_add_u32 s45, s45, s97
    buffer_load_dwordx4 v143, s[56:59], s46 offen lds
    v_mfma_f32_16x16x32_bf16 v[16:19], a[68:71], a[36:39], v[16:19]
    ds_read_b64_tr_b16 a[32:33], v154 offset:0
    v_mfma_f32_16x16x32_bf16 v[36:39], a[68:71], a[40:43], v[36:39]
    ds_read_b64_tr_b16 a[34:35], v154 offset:5120
    v_mfma_f32_16x16x32_bf16 v[56:59], a[68:71], a[44:47], v[56:59]
    s_add_u32 m0, s35, 114688
    v_mfma_f32_16x16x32_bf16 v[76:79], a[68:71], a[48:51], v[76:79]
    s_add_u32 s46, s46, s97
    buffer_load_dwordx4 v144, s[56:59], s47 offen lds
    s_sub_u32 s38, s38, 1
    s_cmp_lg_u32 s38, 0
    s_cbranch_scc1 L_oproj_loop
    s_add_u32 m0, s35, 115712
    s_add_u32 s47, s47, s97
    buffer_load_dwordx4 v145, s[56:59], s48 offen lds
    s_add_u32 m0, s35, 116736
    s_add_u32 s48, s48, s97
    buffer_load_dwordx4 v146, s[56:59], s49 offen lds
    s_add_u32 m0, s35, 117760
    s_add_u32 s49, s49, s97
    buffer_load_dwordx4 v147, s[56:59], s50 offen lds
    s_add_u32 m0, s35, 118784
    s_add_u32 s50, s50, s97
    buffer_load_dwordx4 v148, s[16:19], s51 offen lds
    s_add_u32 s51, s51, 81920
    s_load_dwordx2 s[6:7], s[0:1], 48
    s_and_b32 s3, s2, 7
    s_lshr_b32 s60, s2, 3
    s_lshr_b32 s46, s3, 1
    s_lshl_b32 s46, s46, 2
    s_and_b32 s61, s60, 3
    s_add_u32 s46, s46, s61
    s_and_b32 s47, s3, 1
    s_lshl_b32 s47, s47, 3
    s_lshr_b32 s61, s60, 2
    s_add_u32 s47, s47, s61
    v_and_b32 v227, 63, v249
    s_cmp_eq_u32 s47, 15
    s_cselect_b32 s61, 5, 13
    v_add_u32 v228, 0, v227
    v_mul_u32_u24 v229, 4682, v228
    v_lshrrev_b32 v229, 16, v229
    v_mul_u32_u24 v220, 14, v229
    v_sub_u32 v220, v228, v220
    v_min_u32 v220, s61, v220
    v_mul_u32_u24 v229, 3456, v229
    v_lshl_add_u32 v220, v220, 4, v229
    v_add_u32 v228, 64, v227
    v_mul_u32_u24 v229, 4682, v228
    v_lshrrev_b32 v229, 16, v229
    v_mul_u32_u24 v221, 14, v229
    v_sub_u32 v221, v228, v221
    v_min_u32 v221, s61, v221
    v_mul_u32_u24 v229, 3456, v229
    v_lshl_add_u32 v221, v221, 4, v229
    v_add_u32 v228, 128, v227
    v_mul_u32_u24 v229, 4682, v228
    v_lshrrev_b32 v229, 16, v229
    v_mul_u32_u24 v222, 14, v229
    v_sub_u32 v222, v228, v222
    v_min_u32 v222, s61, v222
    v_mul_u32_u24 v229, 3456, v229
    v_lshl_add_u32 v222, v222, 4, v229
    v_add_u32 v228, 192, v227
    v_mul_u32_u24 v229, 4682, v228
    v_lshrrev_b32 v229, 16, v229
    v_mul_u32_u24 v223, 14, v229
    v_sub_u32 v223, v228, v223
    v_min_u32 v223, s61, v223
    v_mul_u32_u24 v229, 3456, v229
    v_lshl_add_u32 v223, v223, 4, v229
    v_add_u32 v228, 256, v227
    v_mul_u32_u24 v229, 4682, v228
    v_lshrrev_b32 v229, 16, v229
    v_mul_u32_u24 v224, 14, v229
    v_sub_u32 v224, v228, v224
    v_min_u32 v224, s61, v224
    v_mul_u32_u24 v229, 3456, v229
    v_lshl_add_u32 v224, v224, 4, v229
    v_add_u32 v228, 320, v227
    v_mul_u32_u24 v229, 4682, v228
    v_lshrrev_b32 v229, 16, v229
    v_mul_u32_u24 v225, 14, v229
    v_sub_u32 v225, v228, v225
    v_min_u32 v225, s61, v225
    v_mul_u32_u24 v229, 3456, v229
    v_lshl_add_u32 v225, v225, 4, v229
    v_add_u32 v228, 384, v227
    v_mul_u32_u24 v229, 4682, v228
    v_lshrrev_b32 v229, 16, v229
    v_mul_u32_u24 v226, 14, v229
    v_sub_u32 v226, v228, v226
    v_min_u32 v226, s61, v226
    v_mul_u32_u24 v229, 3456, v229
    v_lshl_add_u32 v226, v226, 4, v229
    s_waitcnt lgkmcnt(0)
    s_mov_b32 s48, s6
    s_mov_b32 s49, s7
    s_and_b32 s49, s49, 0xffff
    s_mov_b32 s50, 0x21c000
    s_mov_b32 s51, 0x20000
    s_mul_i32 s44, s32, 110592
    s_mul_i32 s61, s47, 224
    s_add_u32 s44, s44, s61
    s_mul_i32 s45, s32, 7168
    v_mfma_f32_16x16x32_bf16 v[0:3], a[16:19], a[0:3], v[0:3]
    ds_read_b128 a[36:39], v241 offset:18432
    v_mfma_f32_16x16x32_bf16 v[20:23], a[16:19], a[4:7], v[20:23]
    ds_read_b128 a[40:43], v241 offset:19456
    v_mfma_f32_16x16x32_bf16 v[40:43], a[16:19], a[8:11], v[40:43]
    ds_read_b128 a[44:47], v241 offset:20480
    v_mfma_f32_16x16x32_bf16 v[60:63], a[16:19], a[12:15], v[60:63]
    ds_read_b128 a[48:51], v241 offset:21504
    v_mfma_f32_16x16x32_bf16 v[4:7], a[20:23], a[0:3], v[4:7]
    ds_read_b64_tr_b16 a[52:53], v150 offset:18432
    v_mfma_f32_16x16x32_bf16 v[24:27], a[20:23], a[4:7], v[24:27]
    ds_read_b64_tr_b16 a[54:55], v150 offset:23552
    v_mfma_f32_16x16x32_bf16 v[44:47], a[20:23], a[8:11], v[44:47]
    ds_read_b64_tr_b16 a[56:57], v151 offset:18432
    v_mfma_f32_16x16x32_bf16 v[64:67], a[20:23], a[12:15], v[64:67]
    ds_read_b64_tr_b16 a[58:59], v151 offset:23552
    v_mfma_f32_16x16x32_bf16 v[8:11], a[24:27], a[0:3], v[8:11]
    ds_read_b64_tr_b16 a[60:61], v152 offset:18432
    v_mfma_f32_16x16x32_bf16 v[28:31], a[24:27], a[4:7], v[28:31]
    ds_read_b64_tr_b16 a[62:63], v152 offset:23552
    v_mfma_f32_16x16x32_bf16 v[48:51], a[24:27], a[8:11], v[48:51]
    ds_read_b64_tr_b16 a[64:65], v153 offset:18432
    v_mfma_f32_16x16x32_bf16 v[68:71], a[24:27], a[12:15], v[68:71]
    ds_read_b64_tr_b16 a[66:67], v153 offset:23552
    v_mfma_f32_16x16x32_bf16 v[12:15], a[28:31], a[0:3], v[12:15]
    ds_read_b64_tr_b16 a[68:69], v154 offset:18432
    v_mfma_f32_16x16x32_bf16 v[32:35], a[28:31], a[4:7], v[32:35]
    ds_read_b64_tr_b16 a[70:71], v154 offset:23552
    v_mfma_f32_16x16x32_bf16 v[52:55], a[28:31], a[8:11], v[52:55]
    v_mfma_f32_16x16x32_bf16 v[72:75], a[28:31], a[12:15], v[72:75]
    v_mfma_f32_16x16x32_bf16 v[16:19], a[32:35], a[0:3], v[16:19]
    v_mfma_f32_16x16x32_bf16 v[36:39], a[32:35], a[4:7], v[36:39]
    v_mfma_f32_16x16x32_bf16 v[56:59], a[32:35], a[8:11], v[56:59]
    v_mfma_f32_16x16x32_bf16 v[76:79], a[32:35], a[12:15], v[76:79]
    s_waitcnt lgkmcnt(0)
    s_waitcnt vmcnt(18)
    s_barrier
    v_mfma_f32_16x16x32_bf16 v[0:3], a[52:55], a[36:39], v[0:3]
    ds_read_b128 a[0:3], v241 offset:36864
    v_mfma_f32_16x16x32_bf16 v[20:23], a[52:55], a[40:43], v[20:23]
    ds_read_b128 a[4:7], v241 offset:37888
    v_mfma_f32_16x16x32_bf16 v[40:43], a[52:55], a[44:47], v[40:43]
    s_add_u32 m0, s45, 0
    ds_read_b128 a[8:11], v241 offset:38912
    v_mfma_f32_16x16x32_bf16 v[60:63], a[52:55], a[48:51], v[60:63]
    s_add_u32 s61, s44, 0
    buffer_load_dwordx4 v220, s[48:51], s61 offen lds
    v_mfma_f32_16x16x32_bf16 v[4:7], a[56:59], a[36:39], v[4:7]
    ds_read_b128 a[12:15], v241 offset:39936
    v_mfma_f32_16x16x32_bf16 v[24:27], a[56:59], a[40:43], v[24:27]
    ds_read_b64_tr_b16 a[16:17], v150 offset:36864
    v_mfma_f32_16x16x32_bf16 v[44:47], a[56:59], a[44:47], v[44:47]
    s_add_u32 m0, s45, 1024
    ds_read_b64_tr_b16 a[18:19], v150 offset:41984
    v_mfma_f32_16x16x32_bf16 v[64:67], a[56:59], a[48:51], v[64:67]
    s_add_u32 s61, s44, 0
    buffer_load_dwordx4 v221, s[48:51], s61 offen lds
    v_mfma_f32_16x16x32_bf16 v[8:11], a[60:63], a[36:39], v[8:11]
    ds_read_b64_tr_b16 a[20:21], v151 offset:36864
    v_mfma_f32_16x16x32_bf16 v[28:31], a[60:63], a[40:43], v[28:31]
    ds_read_b64_tr_b16 a[22:23], v151 offset:41984
    v_mfma_f32_16x16x32_bf16 v[48:51], a[60:63], a[44:47], v[48:51]
    s_add_u32 m0, s45, 2048
    ds_read_b64_tr_b16 a[24:25], v152 offset:36864
    v_mfma_f32_16x16x32_bf16 v[68:71], a[60:63], a[48:51], v[68:71]
    s_add_u32 s61, s44, 0
    buffer_load_dwordx4 v222, s[48:51], s61 offen lds
    v_mfma_f32_16x16x32_bf16 v[12:15], a[64:67], a[36:39], v[12:15]
    ds_read_b64_tr_b16 a[26:27], v152 offset:41984
    v_mfma_f32_16x16x32_bf16 v[32:35], a[64:67], a[40:43], v[32:35]
    ds_read_b64_tr_b16 a[28:29], v153 offset:36864
    v_mfma_f32_16x16x32_bf16 v[52:55], a[64:67], a[44:47], v[52:55]
    s_add_u32 m0, s45, 3072
    ds_read_b64_tr_b16 a[30:31], v153 offset:41984
    v_mfma_f32_16x16x32_bf16 v[72:75], a[64:67], a[48:51], v[72:75]
    s_add_u32 s61, s44, 0
    buffer_load_dwordx4 v223, s[48:51], s61 offen lds
    v_mfma_f32_16x16x32_bf16 v[16:19], a[68:71], a[36:39], v[16:19]
    ds_read_b64_tr_b16 a[32:33], v154 offset:36864
    v_mfma_f32_16x16x32_bf16 v[36:39], a[68:71], a[40:43], v[36:39]
    ds_read_b64_tr_b16 a[34:35], v154 offset:41984
    v_mfma_f32_16x16x32_bf16 v[56:59], a[68:71], a[44:47], v[56:59]
    s_add_u32 m0, s45, 4096
    v_mfma_f32_16x16x32_bf16 v[76:79], a[68:71], a[48:51], v[76:79]
    s_add_u32 s61, s44, 0
    buffer_load_dwordx4 v224, s[48:51], s61 offen lds
    s_waitcnt lgkmcnt(0)
    v_mfma_f32_16x16x32_bf16 v[0:3], a[16:19], a[0:3], v[0:3]
    ds_read_b128 a[36:39], v241 offset:55296
    v_mfma_f32_16x16x32_bf16 v[20:23], a[16:19], a[4:7], v[20:23]
    ds_read_b128 a[40:43], v241 offset:56320
    v_mfma_f32_16x16x32_bf16 v[40:43], a[16:19], a[8:11], v[40:43]
    s_add_u32 m0, s45, 5120
    ds_read_b128 a[44:47], v241 offset:57344
    v_mfma_f32_16x16x32_bf16 v[60:63], a[16:19], a[12:15], v[60:63]
    s_add_u32 s61, s44, 0
    buffer_load_dwordx4 v225, s[48:51], s61 offen lds
    v_mfma_f32_16x16x32_bf16 v[4:7], a[20:23], a[0:3], v[4:7]
    ds_read_b128 a[48:51], v241 offset:58368
    v_mfma_f32_16x16x32_bf16 v[24:27], a[20:23], a[4:7], v[24:27]
    ds_read_b64_tr_b16 a[52:53], v150 offset:55296
    v_mfma_f32_16x16x32_bf16 v[44:47], a[20:23], a[8:11], v[44:47]
    s_add_u32 m0, s45, 6144
    ds_read_b64_tr_b16 a[54:55], v150 offset:60416
    v_mfma_f32_16x16x32_bf16 v[64:67], a[20:23], a[12:15], v[64:67]
    s_add_u32 s61, s44, 0
    buffer_load_dwordx4 v226, s[48:51], s61 offen lds
    v_mfma_f32_16x16x32_bf16 v[8:11], a[24:27], a[0:3], v[8:11]
    ds_read_b64_tr_b16 a[56:57], v151 offset:55296
    v_mfma_f32_16x16x32_bf16 v[28:31], a[24:27], a[4:7], v[28:31]
    ds_read_b64_tr_b16 a[58:59], v151 offset:60416
    v_mfma_f32_16x16x32_bf16 v[48:51], a[24:27], a[8:11], v[48:51]
    ds_read_b64_tr_b16 a[60:61], v152 offset:55296
    v_mfma_f32_16x16x32_bf16 v[68:71], a[24:27], a[12:15], v[68:71]
    ds_read_b64_tr_b16 a[62:63], v152 offset:60416
    v_mfma_f32_16x16x32_bf16 v[12:15], a[28:31], a[0:3], v[12:15]
    ds_read_b64_tr_b16 a[64:65], v153 offset:55296
    v_mfma_f32_16x16x32_bf16 v[32:35], a[28:31], a[4:7], v[32:35]
    ds_read_b64_tr_b16 a[66:67], v153 offset:60416
    v_mfma_f32_16x16x32_bf16 v[52:55], a[28:31], a[8:11], v[52:55]
    ds_read_b64_tr_b16 a[68:69], v154 offset:55296
    v_mfma_f32_16x16x32_bf16 v[72:75], a[28:31], a[12:15], v[72:75]
    ds_read_b64_tr_b16 a[70:71], v154 offset:60416
    v_mfma_f32_16x16x32_bf16 v[16:19], a[32:35], a[0:3], v[16:19]
    v_mfma_f32_16x16x32_bf16 v[36:39], a[32:35], a[4:7], v[36:39]
    v_mfma_f32_16x16x32_bf16 v[56:59], a[32:35], a[8:11], v[56:59]
    v_mfma_f32_16x16x32_bf16 v[76:79], a[32:35], a[12:15], v[76:79]
    s_waitcnt lgkmcnt(0)
    s_waitcnt vmcnt(16)
    s_barrier
    v_mfma_f32_16x16x32_bf16 v[0:3], a[52:55], a[36:39], v[0:3]
    ds_read_b128 a[0:3], v242 offset:0
    v_mfma_f32_16x16x32_bf16 v[20:23], a[52:55], a[40:43], v[20:23]
    ds_read_b128 a[4:7], v242 offset:1024
    v_mfma_f32_16x16x32_bf16 v[40:43], a[52:55], a[44:47], v[40:43]
    s_add_u32 m0, s45, 28672
    ds_read_b128 a[8:11], v242 offset:2048
    v_mfma_f32_16x16x32_bf16 v[60:63], a[52:55], a[48:51], v[60:63]
    s_add_u32 s61, s44, 442368
    buffer_load_dwordx4 v220, s[48:51], s61 offen lds
    v_mfma_f32_16x16x32_bf16 v[4:7], a[56:59], a[36:39], v[4:7]
    ds_read_b128 a[12:15], v242 offset:3072
    v_mfma_f32_16x16x32_bf16 v[24:27], a[56:59], a[40:43], v[24:27]
    ds_read_b64_tr_b16 a[16:17], v155 offset:0
    v_mfma_f32_16x16x32_bf16 v[44:47], a[56:59], a[44:47], v[44:47]
    s_add_u32 m0, s45, 29696
    ds_read_b64_tr_b16 a[18:19], v155 offset:5120
    v_mfma_f32_16x16x32_bf16 v[64:67], a[56:59], a[48:51], v[64:67]
    s_add_u32 s61, s44, 442368
    buffer_load_dwordx4 v221, s[48:51], s61 offen lds
    v_mfma_f32_16x16x32_bf16 v[8:11], a[60:63], a[36:39], v[8:11]
    ds_read_b64_tr_b16 a[20:21], v156 offset:0
    v_mfma_f32_16x16x32_bf16 v[28:31], a[60:63], a[40:43], v[28:31]
    ds_read_b64_tr_b16 a[22:23], v156 offset:5120
    v_mfma_f32_16x16x32_bf16 v[48:51], a[60:63], a[44:47], v[48:51]
    s_add_u32 m0, s45, 30720
    ds_read_b64_tr_b16 a[24:25], v157 offset:0
    v_mfma_f32_16x16x32_bf16 v[68:71], a[60:63], a[48:51], v[68:71]
    s_add_u32 s61, s44, 442368
    buffer_load_dwordx4 v222, s[48:51], s61 offen lds
    v_mfma_f32_16x16x32_bf16 v[12:15], a[64:67], a[36:39], v[12:15]
    ds_read_b64_tr_b16 a[26:27], v157 offset:5120
    v_mfma_f32_16x16x32_bf16 v[32:35], a[64:67], a[40:43], v[32:35]
    ds_read_b64_tr_b16 a[28:29], v158 offset:0
    v_mfma_f32_16x16x32_bf16 v[52:55], a[64:67], a[44:47], v[52:55]
    s_add_u32 m0, s45, 31744
    ds_read_b64_tr_b16 a[30:31], v158 offset:5120
    v_mfma_f32_16x16x32_bf16 v[72:75], a[64:67], a[48:51], v[72:75]
    s_add_u32 s61, s44, 442368
    buffer_load_dwordx4 v223, s[48:51], s61 offen lds
    v_mfma_f32_16x16x32_bf16 v[16:19], a[68:71], a[36:39], v[16:19]
    ds_read_b64_tr_b16 a[32:33], v159 offset:0
    v_mfma_f32_16x16x32_bf16 v[36:39], a[68:71], a[40:43], v[36:39]
    ds_read_b64_tr_b16 a[34:35], v159 offset:5120
    v_mfma_f32_16x16x32_bf16 v[56:59], a[68:71], a[44:47], v[56:59]
    s_add_u32 m0, s45, 32768
    v_mfma_f32_16x16x32_bf16 v[76:79], a[68:71], a[48:51], v[76:79]
    s_add_u32 s61, s44, 442368
    buffer_load_dwordx4 v224, s[48:51], s61 offen lds
    s_waitcnt lgkmcnt(0)
    v_mfma_f32_16x16x32_bf16 v[0:3], a[16:19], a[0:3], v[0:3]
    ds_read_b128 a[36:39], v242 offset:18432
    v_mfma_f32_16x16x32_bf16 v[20:23], a[16:19], a[4:7], v[20:23]
    ds_read_b128 a[40:43], v242 offset:19456
    v_mfma_f32_16x16x32_bf16 v[40:43], a[16:19], a[8:11], v[40:43]
    s_add_u32 m0, s45, 33792
    ds_read_b128 a[44:47], v242 offset:20480
    v_mfma_f32_16x16x32_bf16 v[60:63], a[16:19], a[12:15], v[60:63]
    s_add_u32 s61, s44, 442368
    buffer_load_dwordx4 v225, s[48:51], s61 offen lds
    v_mfma_f32_16x16x32_bf16 v[4:7], a[20:23], a[0:3], v[4:7]
    ds_read_b128 a[48:51], v242 offset:21504
    v_mfma_f32_16x16x32_bf16 v[24:27], a[20:23], a[4:7], v[24:27]
    ds_read_b64_tr_b16 a[52:53], v155 offset:18432
    v_mfma_f32_16x16x32_bf16 v[44:47], a[20:23], a[8:11], v[44:47]
    s_add_u32 m0, s45, 34816
    ds_read_b64_tr_b16 a[54:55], v155 offset:23552
    v_mfma_f32_16x16x32_bf16 v[64:67], a[20:23], a[12:15], v[64:67]
    s_add_u32 s61, s44, 442368
    buffer_load_dwordx4 v226, s[48:51], s61 offen lds
    v_mfma_f32_16x16x32_bf16 v[8:11], a[24:27], a[0:3], v[8:11]
    ds_read_b64_tr_b16 a[56:57], v156 offset:18432
    v_mfma_f32_16x16x32_bf16 v[28:31], a[24:27], a[4:7], v[28:31]
    ds_read_b64_tr_b16 a[58:59], v156 offset:23552
    v_mfma_f32_16x16x32_bf16 v[48:51], a[24:27], a[8:11], v[48:51]
    ds_read_b64_tr_b16 a[60:61], v157 offset:18432
    v_mfma_f32_16x16x32_bf16 v[68:71], a[24:27], a[12:15], v[68:71]
    ds_read_b64_tr_b16 a[62:63], v157 offset:23552
    v_mfma_f32_16x16x32_bf16 v[12:15], a[28:31], a[0:3], v[12:15]
    ds_read_b64_tr_b16 a[64:65], v158 offset:18432
    v_mfma_f32_16x16x32_bf16 v[32:35], a[28:31], a[4:7], v[32:35]
    ds_read_b64_tr_b16 a[66:67], v158 offset:23552
    v_mfma_f32_16x16x32_bf16 v[52:55], a[28:31], a[8:11], v[52:55]
    ds_read_b64_tr_b16 a[68:69], v159 offset:18432
    v_mfma_f32_16x16x32_bf16 v[72:75], a[28:31], a[12:15], v[72:75]
    ds_read_b64_tr_b16 a[70:71], v159 offset:23552
    v_mfma_f32_16x16x32_bf16 v[16:19], a[32:35], a[0:3], v[16:19]
    v_mfma_f32_16x16x32_bf16 v[36:39], a[32:35], a[4:7], v[36:39]
    v_mfma_f32_16x16x32_bf16 v[56:59], a[32:35], a[8:11], v[56:59]
    v_mfma_f32_16x16x32_bf16 v[76:79], a[32:35], a[12:15], v[76:79]
    s_waitcnt lgkmcnt(0)
    s_waitcnt vmcnt(14)
    s_barrier
    v_mfma_f32_16x16x32_bf16 v[0:3], a[52:55], a[36:39], v[0:3]
    ds_read_b128 a[0:3], v242 offset:36864
    v_mfma_f32_16x16x32_bf16 v[20:23], a[52:55], a[40:43], v[20:23]
    ds_read_b128 a[4:7], v242 offset:37888
    v_mfma_f32_16x16x32_bf16 v[40:43], a[52:55], a[44:47], v[40:43]
    s_add_u32 m0, s45, 57344
    ds_read_b128 a[8:11], v242 offset:38912
    v_mfma_f32_16x16x32_bf16 v[60:63], a[52:55], a[48:51], v[60:63]
    s_add_u32 s61, s44, 884736
    buffer_load_dwordx4 v220, s[48:51], s61 offen lds
    v_mfma_f32_16x16x32_bf16 v[4:7], a[56:59], a[36:39], v[4:7]
    ds_read_b128 a[12:15], v242 offset:39936
    v_mfma_f32_16x16x32_bf16 v[24:27], a[56:59], a[40:43], v[24:27]
    ds_read_b64_tr_b16 a[16:17], v155 offset:36864
    v_mfma_f32_16x16x32_bf16 v[44:47], a[56:59], a[44:47], v[44:47]
    s_add_u32 m0, s45, 58368
    ds_read_b64_tr_b16 a[18:19], v155 offset:41984
    v_mfma_f32_16x16x32_bf16 v[64:67], a[56:59], a[48:51], v[64:67]
    s_add_u32 s61, s44, 884736
    buffer_load_dwordx4 v221, s[48:51], s61 offen lds
    v_mfma_f32_16x16x32_bf16 v[8:11], a[60:63], a[36:39], v[8:11]
    ds_read_b64_tr_b16 a[20:21], v156 offset:36864
    v_mfma_f32_16x16x32_bf16 v[28:31], a[60:63], a[40:43], v[28:31]
    ds_read_b64_tr_b16 a[22:23], v156 offset:41984
    v_mfma_f32_16x16x32_bf16 v[48:51], a[60:63], a[44:47], v[48:51]
    s_add_u32 m0, s45, 59392
    ds_read_b64_tr_b16 a[24:25], v157 offset:36864
    v_mfma_f32_16x16x32_bf16 v[68:71], a[60:63], a[48:51], v[68:71]
    s_add_u32 s61, s44, 884736
    buffer_load_dwordx4 v222, s[48:51], s61 offen lds
    v_mfma_f32_16x16x32_bf16 v[12:15], a[64:67], a[36:39], v[12:15]
    ds_read_b64_tr_b16 a[26:27], v157 offset:41984
    v_mfma_f32_16x16x32_bf16 v[32:35], a[64:67], a[40:43], v[32:35]
    ds_read_b64_tr_b16 a[28:29], v158 offset:36864
    v_mfma_f32_16x16x32_bf16 v[52:55], a[64:67], a[44:47], v[52:55]
    s_add_u32 m0, s45, 60416
    ds_read_b64_tr_b16 a[30:31], v158 offset:41984
    v_mfma_f32_16x16x32_bf16 v[72:75], a[64:67], a[48:51], v[72:75]
    s_add_u32 s61, s44, 884736
    buffer_load_dwordx4 v223, s[48:51], s61 offen lds
    v_mfma_f32_16x16x32_bf16 v[16:19], a[68:71], a[36:39], v[16:19]
    ds_read_b64_tr_b16 a[32:33], v159 offset:36864
    v_mfma_f32_16x16x32_bf16 v[36:39], a[68:71], a[40:43], v[36:39]
    ds_read_b64_tr_b16 a[34:35], v159 offset:41984
    v_mfma_f32_16x16x32_bf16 v[56:59], a[68:71], a[44:47], v[56:59]
    s_add_u32 m0, s45, 61440
    v_mfma_f32_16x16x32_bf16 v[76:79], a[68:71], a[48:51], v[76:79]
    s_add_u32 s61, s44, 884736
    buffer_load_dwordx4 v224, s[48:51], s61 offen lds
    s_waitcnt lgkmcnt(0)
    v_mfma_f32_16x16x32_bf16 v[0:3], a[16:19], a[0:3], v[0:3]
    ds_read_b128 a[36:39], v242 offset:55296
    v_mfma_f32_16x16x32_bf16 v[20:23], a[16:19], a[4:7], v[20:23]
    ds_read_b128 a[40:43], v242 offset:56320
    v_mfma_f32_16x16x32_bf16 v[40:43], a[16:19], a[8:11], v[40:43]
    s_add_u32 m0, s45, 62464
    ds_read_b128 a[44:47], v242 offset:57344
    v_mfma_f32_16x16x32_bf16 v[60:63], a[16:19], a[12:15], v[60:63]
    s_add_u32 s61, s44, 884736
    buffer_load_dwordx4 v225, s[48:51], s61 offen lds
    v_mfma_f32_16x16x32_bf16 v[4:7], a[20:23], a[0:3], v[4:7]
    ds_read_b128 a[48:51], v242 offset:58368
    v_mfma_f32_16x16x32_bf16 v[24:27], a[20:23], a[4:7], v[24:27]
    ds_read_b64_tr_b16 a[52:53], v155 offset:55296
    v_mfma_f32_16x16x32_bf16 v[44:47], a[20:23], a[8:11], v[44:47]
    s_add_u32 m0, s45, 63488
    ds_read_b64_tr_b16 a[54:55], v155 offset:60416
    v_mfma_f32_16x16x32_bf16 v[64:67], a[20:23], a[12:15], v[64:67]
    s_add_u32 s61, s44, 884736
    buffer_load_dwordx4 v226, s[48:51], s61 offen lds
    v_mfma_f32_16x16x32_bf16 v[8:11], a[24:27], a[0:3], v[8:11]
    ds_read_b64_tr_b16 a[56:57], v156 offset:55296
    v_mfma_f32_16x16x32_bf16 v[28:31], a[24:27], a[4:7], v[28:31]
    ds_read_b64_tr_b16 a[58:59], v156 offset:60416
    v_mfma_f32_16x16x32_bf16 v[48:51], a[24:27], a[8:11], v[48:51]
    ds_read_b64_tr_b16 a[60:61], v157 offset:55296
    v_mfma_f32_16x16x32_bf16 v[68:71], a[24:27], a[12:15], v[68:71]
    ds_read_b64_tr_b16 a[62:63], v157 offset:60416
    v_mfma_f32_16x16x32_bf16 v[12:15], a[28:31], a[0:3], v[12:15]
    ds_read_b64_tr_b16 a[64:65], v158 offset:55296
    v_mfma_f32_16x16x32_bf16 v[32:35], a[28:31], a[4:7], v[32:35]
    ds_read_b64_tr_b16 a[66:67], v158 offset:60416
    v_mfma_f32_16x16x32_bf16 v[52:55], a[28:31], a[8:11], v[52:55]
    ds_read_b64_tr_b16 a[68:69], v159 offset:55296
    v_mfma_f32_16x16x32_bf16 v[72:75], a[28:31], a[12:15], v[72:75]
    ds_read_b64_tr_b16 a[70:71], v159 offset:60416
    v_mfma_f32_16x16x32_bf16 v[16:19], a[32:35], a[0:3], v[16:19]
    v_mfma_f32_16x16x32_bf16 v[36:39], a[32:35], a[4:7], v[36:39]
    v_mfma_f32_16x16x32_bf16 v[56:59], a[32:35], a[8:11], v[56:59]
    v_mfma_f32_16x16x32_bf16 v[76:79], a[32:35], a[12:15], v[76:79]
    s_waitcnt lgkmcnt(0)
    v_mfma_f32_16x16x32_bf16 v[0:3], a[52:55], a[36:39], v[0:3]
    v_mfma_f32_16x16x32_bf16 v[20:23], a[52:55], a[40:43], v[20:23]
    v_mfma_f32_16x16x32_bf16 v[40:43], a[52:55], a[44:47], v[40:43]
    v_mfma_f32_16x16x32_bf16 v[60:63], a[52:55], a[48:51], v[60:63]
    v_mfma_f32_16x16x32_bf16 v[4:7], a[56:59], a[36:39], v[4:7]
    v_mfma_f32_16x16x32_bf16 v[24:27], a[56:59], a[40:43], v[24:27]
    v_mfma_f32_16x16x32_bf16 v[44:47], a[56:59], a[44:47], v[44:47]
    v_mfma_f32_16x16x32_bf16 v[64:67], a[56:59], a[48:51], v[64:67]
    v_mfma_f32_16x16x32_bf16 v[8:11], a[60:63], a[36:39], v[8:11]
    v_mfma_f32_16x16x32_bf16 v[28:31], a[60:63], a[40:43], v[28:31]
    v_mfma_f32_16x16x32_bf16 v[48:51], a[60:63], a[44:47], v[48:51]
    v_mfma_f32_16x16x32_bf16 v[68:71], a[60:63], a[48:51], v[68:71]
    v_mfma_f32_16x16x32_bf16 v[12:15], a[64:67], a[36:39], v[12:15]
    v_mfma_f32_16x16x32_bf16 v[32:35], a[64:67], a[40:43], v[32:35]
    v_mfma_f32_16x16x32_bf16 v[52:55], a[64:67], a[44:47], v[52:55]
    v_mfma_f32_16x16x32_bf16 v[72:75], a[64:67], a[48:51], v[72:75]
    v_mfma_f32_16x16x32_bf16 v[16:19], a[68:71], a[36:39], v[16:19]
    v_mfma_f32_16x16x32_bf16 v[36:39], a[68:71], a[40:43], v[36:39]
    v_mfma_f32_16x16x32_bf16 v[56:59], a[68:71], a[44:47], v[56:59]
    v_mfma_f32_16x16x32_bf16 v[76:79], a[68:71], a[48:51], v[76:79]
    s_barrier
    s_cmp_eq_u32 s32, s62
    s_nop 4
    s_cbranch_scc1 L_oproj_own
    s_lshl_b32 s39, s63, 2
    s_add_u32 s39, s39, s32
    s_lshl_b32 s39, s39, 2
    s_add_u32 s39, s39, s62
    s_mul_i32 s39, s39, 10240
    v_lshrrev_b32 v231, 1, v236
    v_cvt_pk_bf16_f32 v160, v0, v1
    v_cvt_pk_bf16_f32 v161, v2, v3
    v_cvt_pk_bf16_f32 v162, v4, v5
    v_cvt_pk_bf16_f32 v163, v6, v7
    v_cvt_pk_bf16_f32 v164, v8, v9
    v_cvt_pk_bf16_f32 v165, v10, v11
    v_cvt_pk_bf16_f32 v166, v12, v13
    v_cvt_pk_bf16_f32 v167, v14, v15
    v_cvt_pk_bf16_f32 v168, v16, v17
    v_cvt_pk_bf16_f32 v169, v18, v19
    buffer_store_dwordx4 v[160:163], v236, s[12:15], s39 offen sc1
    buffer_store_dwordx4 v[164:167], v236, s[12:15], s39 offen offset:1024 sc1
    buffer_store_dwordx2 v[168:169], v231, s[12:15], s39 offen offset:2048 sc1
    s_add_u32 s39, s39, 2560
    v_cvt_pk_bf16_f32 v170, v20, v21
    v_cvt_pk_bf16_f32 v171, v22, v23
    v_cvt_pk_bf16_f32 v172, v24, v25
    v_cvt_pk_bf16_f32 v173, v26, v27
    v_cvt_pk_bf16_f32 v174, v28, v29
    v_cvt_pk_bf16_f32 v175, v30, v31
    v_cvt_pk_bf16_f32 v176, v32, v33
    v_cvt_pk_bf16_f32 v177, v34, v35
    v_cvt_pk_bf16_f32 v178, v36, v37
    v_cvt_pk_bf16_f32 v179, v38, v39
    buffer_store_dwordx4 v[170:173], v236, s[12:15], s39 offen sc1
    buffer_store_dwordx4 v[174:177], v236, s[12:15], s39 offen offset:1024 sc1
    buffer_store_dwordx2 v[178:179], v231, s[12:15], s39 offen offset:2048 sc1
    s_add_u32 s39, s39, 2560
    v_cvt_pk_bf16_f32 v180, v40, v41
    v_cvt_pk_bf16_f32 v181, v42, v43
    v_cvt_pk_bf16_f32 v182, v44, v45
    v_cvt_pk_bf16_f32 v183, v46, v47
    v_cvt_pk_bf16_f32 v184, v48, v49
    v_cvt_pk_bf16_f32 v185, v50, v51
    v_cvt_pk_bf16_f32 v186, v52, v53
    v_cvt_pk_bf16_f32 v187, v54, v55
    v_cvt_pk_bf16_f32 v188, v56, v57
    v_cvt_pk_bf16_f32 v189, v58, v59
    buffer_store_dwordx4 v[180:183], v236, s[12:15], s39 offen sc1
    buffer_store_dwordx4 v[184:187], v236, s[12:15], s39 offen offset:1024 sc1
    buffer_store_dwordx2 v[188:189], v231, s[12:15], s39 offen offset:2048 sc1
    s_add_u32 s39, s39, 2560
    v_cvt_pk_bf16_f32 v190, v60, v61
    v_cvt_pk_bf16_f32 v191, v62, v63
    v_cvt_pk_bf16_f32 v192, v64, v65
    v_cvt_pk_bf16_f32 v193, v66, v67
    v_cvt_pk_bf16_f32 v194, v68, v69
    v_cvt_pk_bf16_f32 v195, v70, v71
    v_cvt_pk_bf16_f32 v196, v72, v73
    v_cvt_pk_bf16_f32 v197, v74, v75
    v_cvt_pk_bf16_f32 v198, v76, v77
    v_cvt_pk_bf16_f32 v199, v78, v79
    buffer_store_dwordx4 v[190:193], v236, s[12:15], s39 offen sc1
    buffer_store_dwordx4 v[194:197], v236, s[12:15], s39 offen offset:1024 sc1
    buffer_store_dwordx2 v[198:199], v231, s[12:15], s39 offen offset:2048 sc1
    s_branch L_oproj_sent
L_oproj_own:
    v_add_u32 v230, 143360, v236
    ds_write_b128 v230, v[0:3] offset:0
    ds_write_b128 v230, v[4:7] offset:1024
    ds_write_b128 v230, v[8:11] offset:2048
    ds_write_b128 v230, v[12:15] offset:3072
    ds_write_b128 v230, v[16:19] offset:4096
    ds_write_b128 v230, v[20:23] offset:5120
    ds_write_b128 v230, v[24:27] offset:6144
    ds_write_b128 v230, v[28:31] offset:7168
    ds_write_b128 v230, v[32:35] offset:8192
    ds_write_b128 v230, v[36:39] offset:9216
    ds_write_b128 v230, v[40:43] offset:10240
    ds_write_b128 v230, v[44:47] offset:11264
    ds_write_b128 v230, v[48:51] offset:12288
    ds_write_b128 v230, v[52:55] offset:13312
    ds_write_b128 v230, v[56:59] offset:14336
    ds_write_b128 v230, v[60:63] offset:15360
    ds_write_b128 v230, v[64:67] offset:16384
    ds_write_b128 v230, v[68:71] offset:17408
    ds_write_b128 v230, v[72:75] offset:18432
    ds_write_b128 v230, v[76:79] offset:19456
L_oproj_sent:
    s_waitcnt vmcnt(0) lgkmcnt(0)
    s_barrier
    s_cmp_lg_u32 s32, 0
    s_cbranch_scc1 L_grp_wait
    s_lshl_b32 s3, s63, 7
    s_add_u32 s3, s3, 4096
    s_mov_b64 exec, 1
    v_mov_b32 v254, s3
    v_mov_b32 v255, 1
    buffer_atomic_add v255, v254, s[92:95], 0 offen sc1
    s_mov_b64 exec, -1
    v_mov_b32 v254, s3
    s_mov_b32 s3, 0
L_grp_poll:
    buffer_load_dword v255, v254, s[92:95], 0 offen sc1
    s_waitcnt vmcnt(0)
    v_cmp_gt_u32 vcc, 4, v255
    s_add_u32 s3, s3, 1
    s_cmp_gt_u32 s3, 400000
    s_cbranch_scc1 L_grp_wait
    s_cmp_eq_u64 vcc, 0
    s_cbranch_scc0 L_grp_poll
L_grp_wait:
    s_barrier
    s_mul_i32 s39, s32, 5120
    s_add_u32 s40, s39, 143360
    v_add_u32 v230, s40, v236
    v_lshrrev_b32 v231, 1, v236
    s_mul_i32 s39, s32, 2560
    s_add_u32 s40, s62, 1
    s_and_b32 s40, s40, 3
    s_lshl_b32 s41, s63, 2
    s_add_u32 s41, s41, s62
    s_lshl_b32 s41, s41, 2
    s_add_u32 s41, s41, s40
    s_mul_i32 s41, s41, 10240
    s_add_u32 s41, s41, s39
    buffer_load_dwordx4 v[20:23], v236, s[12:15], s41 offen
    buffer_load_dwordx4 v[24:27], v236, s[12:15], s41 offen offset:1024
    buffer_load_dwordx2 v[28:29], v231, s[12:15], s41 offen offset:2048
    s_add_u32 s40, s62, 2
    s_and_b32 s40, s40, 3
    s_lshl_b32 s41, s63, 2
    s_add_u32 s41, s41, s62
    s_lshl_b32 s41, s41, 2
    s_add_u32 s41, s41, s40
    s_mul_i32 s41, s41, 10240
    s_add_u32 s41, s41, s39
    buffer_load_dwordx4 v[30:33], v236, s[12:15], s41 offen
    buffer_load_dwordx4 v[34:37], v236, s[12:15], s41 offen offset:1024
    buffer_load_dwordx2 v[38:39], v231, s[12:15], s41 offen offset:2048
    s_add_u32 s40, s62, 3
    s_and_b32 s40, s40, 3
    s_lshl_b32 s41, s63, 2
    s_add_u32 s41, s41, s62
    s_lshl_b32 s41, s41, 2
    s_add_u32 s41, s41, s40
    s_mul_i32 s41, s41, 10240
    s_add_u32 s41, s41, s39
    buffer_load_dwordx4 v[40:43], v236, s[12:15], s41 offen
    buffer_load_dwordx4 v[44:47], v236, s[12:15], s41 offen offset:1024
    buffer_load_dwordx2 v[48:49], v231, s[12:15], s41 offen offset:2048
    ds_read_b128 v[0:3], v230 offset:0
    ds_read_b128 v[4:7], v230 offset:1024
    ds_read_b128 v[8:11], v230 offset:2048
    ds_read_b128 v[12:15], v230 offset:3072
    ds_read_b128 v[16:19], v230 offset:4096
    s_waitcnt vmcnt(8)
    v_lshlrev_b32 v60, 16, v20
    s_waitcnt lgkmcnt(4)
    v_add_f32 v0, v0, v60
    v_and_b32 v60, 0xffff0000, v20
    v_add_f32 v1, v1, v60
    v_lshlrev_b32 v60, 16, v21
    v_add_f32 v2, v2, v60
    v_and_b32 v60, 0xffff0000, v21
    v_add_f32 v3, v3, v60
    s_add_u32 m0, s45, 86016
    s_add_u32 s61, s44, 1327104
    buffer_load_dwordx4 v220, s[48:51], s61 offen lds
    v_lshlrev_b32 v60, 16, v22
    s_waitcnt lgkmcnt(3)
    v_add_f32 v4, v4, v60
    v_and_b32 v60, 0xffff0000, v22
    v_add_f32 v5, v5, v60
    v_lshlrev_b32 v60, 16, v23
    v_add_f32 v6, v6, v60
    v_and_b32 v60, 0xffff0000, v23
    v_add_f32 v7, v7, v60
    s_add_u32 m0, s45, 87040
    s_add_u32 s61, s44, 1327104
    buffer_load_dwordx4 v221, s[48:51], s61 offen lds
    s_waitcnt vmcnt(9)
    v_lshlrev_b32 v60, 16, v24
    s_waitcnt lgkmcnt(2)
    v_add_f32 v8, v8, v60
    v_and_b32 v60, 0xffff0000, v24
    v_add_f32 v9, v9, v60
    v_lshlrev_b32 v60, 16, v25
    v_add_f32 v10, v10, v60
    v_and_b32 v60, 0xffff0000, v25
    v_add_f32 v11, v11, v60
    s_add_u32 m0, s45, 88064
    s_add_u32 s61, s44, 1327104
    buffer_load_dwordx4 v222, s[48:51], s61 offen lds
    v_lshlrev_b32 v60, 16, v26
    s_waitcnt lgkmcnt(1)
    v_add_f32 v12, v12, v60
    v_and_b32 v60, 0xffff0000, v26
    v_add_f32 v13, v13, v60
    v_lshlrev_b32 v60, 16, v27
    v_add_f32 v14, v14, v60
    v_and_b32 v60, 0xffff0000, v27
    v_add_f32 v15, v15, v60
    s_add_u32 m0, s45, 89088
    s_add_u32 s61, s44, 1327104
    buffer_load_dwordx4 v223, s[48:51], s61 offen lds
    s_waitcnt vmcnt(10)
    v_lshlrev_b32 v60, 16, v28
    s_waitcnt lgkmcnt(0)
    v_add_f32 v16, v16, v60
    v_and_b32 v60, 0xffff0000, v28
    v_add_f32 v17, v17, v60
    v_lshlrev_b32 v60, 16, v29
    v_add_f32 v18, v18, v60
    v_and_b32 v60, 0xffff0000, v29
    v_add_f32 v19, v19, v60
    s_add_u32 m0, s45, 90112
    s_add_u32 s61, s44, 1327104
    buffer_load_dwordx4 v224, s[48:51], s61 offen lds
    s_waitcnt vmcnt(10)
    v_lshlrev_b32 v60, 16, v30
    v_add_f32 v0, v0, v60
    v_and_b32 v60, 0xffff0000, v30
    v_add_f32 v1, v1, v60
    v_lshlrev_b32 v60, 16, v31
    v_add_f32 v2, v2, v60
    v_and_b32 v60, 0xffff0000, v31
    v_add_f32 v3, v3, v60
    s_add_u32 m0, s45, 91136
    s_add_u32 s61, s44, 1327104
    buffer_load_dwordx4 v225, s[48:51], s61 offen lds
    v_lshlrev_b32 v60, 16, v32
    v_add_f32 v4, v4, v60
    v_and_b32 v60, 0xffff0000, v32
    v_add_f32 v5, v5, v60
    v_lshlrev_b32 v60, 16, v33
    v_add_f32 v6, v6, v60
    v_and_b32 v60, 0xffff0000, v33
    v_add_f32 v7, v7, v60
    s_add_u32 m0, s45, 92160
    s_add_u32 s61, s44, 1327104
    buffer_load_dwordx4 v226, s[48:51], s61 offen lds
    s_waitcnt vmcnt(11)
    v_lshlrev_b32 v60, 16, v34
    v_add_f32 v8, v8, v60
    v_and_b32 v60, 0xffff0000, v34
    v_add_f32 v9, v9, v60
    v_lshlrev_b32 v60, 16, v35
    v_add_f32 v10, v10, v60
    v_and_b32 v60, 0xffff0000, v35
    v_add_f32 v11, v11, v60
    s_add_u32 m0, s45, 114688
    s_add_u32 s61, s44, 1769472
    buffer_load_dwordx4 v220, s[48:51], s61 offen lds
    v_lshlrev_b32 v60, 16, v36
    v_add_f32 v12, v12, v60
    v_and_b32 v60, 0xffff0000, v36
    v_add_f32 v13, v13, v60
    v_lshlrev_b32 v60, 16, v37
    v_add_f32 v14, v14, v60
    v_and_b32 v60, 0xffff0000, v37
    v_add_f32 v15, v15, v60
    s_add_u32 m0, s45, 115712
    s_add_u32 s61, s44, 1769472
    buffer_load_dwordx4 v221, s[48:51], s61 offen lds
    s_waitcnt vmcnt(12)
    v_lshlrev_b32 v60, 16, v38
    v_add_f32 v16, v16, v60
    v_and_b32 v60, 0xffff0000, v38
    v_add_f32 v17, v17, v60
    v_lshlrev_b32 v60, 16, v39
    v_add_f32 v18, v18, v60
    v_and_b32 v60, 0xffff0000, v39
    v_add_f32 v19, v19, v60
    s_add_u32 m0, s45, 116736
    s_add_u32 s61, s44, 1769472
    buffer_load_dwordx4 v222, s[48:51], s61 offen lds
    s_waitcnt vmcnt(12)
    v_lshlrev_b32 v60, 16, v40
    v_add_f32 v0, v0, v60
    v_and_b32 v60, 0xffff0000, v40
    v_add_f32 v1, v1, v60
    v_lshlrev_b32 v60, 16, v41
    v_add_f32 v2, v2, v60
    v_and_b32 v60, 0xffff0000, v41
    v_add_f32 v3, v3, v60
    s_add_u32 m0, s45, 117760
    s_add_u32 s61, s44, 1769472
    buffer_load_dwordx4 v223, s[48:51], s61 offen lds
    v_lshlrev_b32 v60, 16, v42
    v_add_f32 v4, v4, v60
    v_and_b32 v60, 0xffff0000, v42
    v_add_f32 v5, v5, v60
    v_lshlrev_b32 v60, 16, v43
    v_add_f32 v6, v6, v60
    v_and_b32 v60, 0xffff0000, v43
    v_add_f32 v7, v7, v60
    s_add_u32 m0, s45, 118784
    s_add_u32 s61, s44, 1769472
    buffer_load_dwordx4 v224, s[48:51], s61 offen lds
    s_waitcnt vmcnt(13)
    v_lshlrev_b32 v60, 16, v44
    v_add_f32 v8, v8, v60
    v_and_b32 v60, 0xffff0000, v44
    v_add_f32 v9, v9, v60
    v_lshlrev_b32 v60, 16, v45
    v_add_f32 v10, v10, v60
    v_and_b32 v60, 0xffff0000, v45
    v_add_f32 v11, v11, v60
    s_add_u32 m0, s45, 119808
    s_add_u32 s61, s44, 1769472
    buffer_load_dwordx4 v225, s[48:51], s61 offen lds
    v_lshlrev_b32 v60, 16, v46
    v_add_f32 v12, v12, v60
    v_and_b32 v60, 0xffff0000, v46
    v_add_f32 v13, v13, v60
    v_lshlrev_b32 v60, 16, v47
    v_add_f32 v14, v14, v60
    v_and_b32 v60, 0xffff0000, v47
    v_add_f32 v15, v15, v60
    s_add_u32 m0, s45, 120832
    s_add_u32 s61, s44, 1769472
    buffer_load_dwordx4 v226, s[48:51], s61 offen lds
    s_waitcnt vmcnt(14)
    v_lshlrev_b32 v60, 16, v48
    v_add_f32 v16, v16, v60
    v_and_b32 v60, 0xffff0000, v48
    v_add_f32 v17, v17, v60
    v_lshlrev_b32 v60, 16, v49
    v_add_f32 v18, v18, v60
    v_and_b32 v60, 0xffff0000, v49
    v_add_f32 v19, v19, v60
    v_lshlrev_b32 v20, 16, v80
    v_fma_f32 v200, v92, v0, v20
    v_and_b32 v20, 0xffff0000, v80
    v_fma_f32 v201, v93, v1, v20
    v_lshlrev_b32 v20, 16, v81
    v_fma_f32 v202, v94, v2, v20
    v_and_b32 v20, 0xffff0000, v81
    v_fma_f32 v203, v95, v3, v20
    v_lshlrev_b32 v20, 16, v82
    v_fma_f32 v204, v96, v4, v20
    v_and_b32 v20, 0xffff0000, v82
    v_fma_f32 v205, v97, v5, v20
    v_lshlrev_b32 v20, 16, v83
    v_fma_f32 v206, v98, v6, v20
    v_and_b32 v20, 0xffff0000, v83
    v_fma_f32 v207, v99, v7, v20
    v_lshlrev_b32 v20, 16, v84
    v_fma_f32 v208, v100, v8, v20
    v_and_b32 v20, 0xffff0000, v84
    v_fma_f32 v209, v101, v9, v20
    v_lshlrev_b32 v20, 16, v85
    v_fma_f32 v210, v102, v10, v20
    v_and_b32 v20, 0xffff0000, v85
    v_fma_f32 v211, v103, v11, v20
    v_lshlrev_b32 v20, 16, v86
    v_fma_f32 v212, v104, v12, v20
    v_and_b32 v20, 0xffff0000, v86
    v_fma_f32 v213, v105, v13, v20
    v_lshlrev_b32 v20, 16, v87
    v_fma_f32 v214, v106, v14, v20
    v_and_b32 v20, 0xffff0000, v87
    v_fma_f32 v215, v107, v15, v20
    v_lshlrev_b32 v20, 16, v88
    v_fma_f32 v216, v108, v16, v20
    v_and_b32 v20, 0xffff0000, v88
    v_fma_f32 v217, v109, v17, v20
    v_lshlrev_b32 v20, 16, v89
    v_fma_f32 v218, v110, v18, v20
    v_and_b32 v20, 0xffff0000, v89
    v_fma_f32 v219, v111, v19, v20
    v_add_f32 v112, 1.0, v112
    v_add_f32 v113, 1.0, v113
    v_add_f32 v114, 1.0, v114
    v_add_f32 v115, 1.0, v115
    v_cvt_pk_bf16_f32 v20, v112, v113
    v_cvt_pk_bf16_f32 v21, v114, v115
    v_lshlrev_b32 v112, 16, v20
    v_and_b32 v113, 0xffff0000, v20
    v_lshlrev_b32 v114, 16, v21
    v_and_b32 v115, 0xffff0000, v21
    v_mul_f32 v112, v112, v200
    v_mul_f32 v113, v113, v201
    v_mul_f32 v114, v114, v202
    v_mul_f32 v115, v115, v203
    v_cvt_pk_bf16_f32 v24, v112, v113
    v_cvt_pk_bf16_f32 v25, v114, v115
    v_add_f32 v116, 1.0, v116
    v_add_f32 v117, 1.0, v117
    v_add_f32 v118, 1.0, v118
    v_add_f32 v119, 1.0, v119
    v_cvt_pk_bf16_f32 v20, v116, v117
    v_cvt_pk_bf16_f32 v21, v118, v119
    v_lshlrev_b32 v116, 16, v20
    v_and_b32 v117, 0xffff0000, v20
    v_lshlrev_b32 v118, 16, v21
    v_and_b32 v119, 0xffff0000, v21
    v_mul_f32 v116, v116, v204
    v_mul_f32 v117, v117, v205
    v_mul_f32 v118, v118, v206
    v_mul_f32 v119, v119, v207
    v_cvt_pk_bf16_f32 v26, v116, v117
    v_cvt_pk_bf16_f32 v27, v118, v119
    v_add_f32 v120, 1.0, v120
    v_add_f32 v121, 1.0, v121
    v_add_f32 v122, 1.0, v122
    v_add_f32 v123, 1.0, v123
    v_cvt_pk_bf16_f32 v20, v120, v121
    v_cvt_pk_bf16_f32 v21, v122, v123
    v_lshlrev_b32 v120, 16, v20
    v_and_b32 v121, 0xffff0000, v20
    v_lshlrev_b32 v122, 16, v21
    v_and_b32 v123, 0xffff0000, v21
    v_mul_f32 v120, v120, v208
    v_mul_f32 v121, v121, v209
    v_mul_f32 v122, v122, v210
    v_mul_f32 v123, v123, v211
    v_cvt_pk_bf16_f32 v28, v120, v121
    v_cvt_pk_bf16_f32 v29, v122, v123
    v_add_f32 v124, 1.0, v124
    v_add_f32 v125, 1.0, v125
    v_add_f32 v126, 1.0, v126
    v_add_f32 v127, 1.0, v127
    v_cvt_pk_bf16_f32 v20, v124, v125
    v_cvt_pk_bf16_f32 v21, v126, v127
    v_lshlrev_b32 v124, 16, v20
    v_and_b32 v125, 0xffff0000, v20
    v_lshlrev_b32 v126, 16, v21
    v_and_b32 v127, 0xffff0000, v21
    v_mul_f32 v124, v124, v212
    v_mul_f32 v125, v125, v213
    v_mul_f32 v126, v126, v214
    v_mul_f32 v127, v127, v215
    v_cvt_pk_bf16_f32 v30, v124, v125
    v_cvt_pk_bf16_f32 v31, v126, v127
    v_add_f32 v128, 1.0, v128
    v_add_f32 v129, 1.0, v129
    v_add_f32 v130, 1.0, v130
    v_add_f32 v131, 1.0, v131
    v_cvt_pk_bf16_f32 v20, v128, v129
    v_cvt_pk_bf16_f32 v21, v130, v131
    v_lshlrev_b32 v128, 16, v20
    v_and_b32 v129, 0xffff0000, v20
    v_lshlrev_b32 v130, 16, v21
    v_and_b32 v131, 0xffff0000, v21
    v_mul_f32 v128, v128, v216
    v_mul_f32 v129, v129, v217
    v_mul_f32 v130, v130, v218
    v_mul_f32 v131, v131, v219
    v_cvt_pk_bf16_f32 v32, v128, v129
    v_cvt_pk_bf16_f32 v33, v130, v131
    s_lshl_b32 s40, s33, 2
    s_add_u32 s40, s40, s32
    s_mul_i32 s40, s40, 20
    s_lshr_b32 s41, s34, 1
    s_mul_i32 s41, s41, 5
    s_add_u32 s40, s40, s41
    s_lshl_b32 s40, s40, 10
    v_lshrrev_b32 v34, 1, v236
    s_bitcmp1_b32 s34, 0
    s_cbranch_scc1 L_oproj_yodd
    buffer_store_dwordx4 v[24:27], v236, s[24:27], s40 offen sc1
    buffer_store_dwordx4 v[28:31], v236, s[24:27], s40 offen offset:1024 sc1
    buffer_store_dwordx2 v[32:33], v34, s[24:27], s40 offen offset:2048 sc1
    s_branch L_oproj_ydone
L_oproj_yodd:
    buffer_store_dwordx2 v[24:25], v34, s[24:27], s40 offen offset:2560 sc1
    s_add_u32 s41, s40, 3072
    buffer_store_dwordx4 v[26:29], v236, s[24:27], s41 offen sc1
    buffer_store_dwordx4 v[30:33], v236, s[24:27], s41 offen offset:1024 sc1
L_oproj_ydone:
    v_add_f32 v20, v200, v201
    v_add_f32 v21, v202, v203
    v_add_f32 v20, v20, v204
    v_add_f32 v21, v21, v205
    v_add_f32 v20, v20, v206
    v_add_f32 v21, v21, v207
    v_add_f32 v20, v20, v208
    v_add_f32 v21, v21, v209
    v_add_f32 v20, v20, v210
    v_add_f32 v21, v21, v211
    v_add_f32 v20, v20, v212
    v_add_f32 v21, v21, v213
    v_add_f32 v20, v20, v214
    v_add_f32 v21, v21, v215
    v_add_f32 v20, v20, v216
    v_add_f32 v21, v21, v217
    v_add_f32 v20, v20, v218
    v_add_f32 v21, v21, v219
    v_add_f32 v20, v20, v21
    v_mov_b32 v21, v20
    s_nop 1
    v_permlane16_swap_b32 v21, v20
    v_add_f32 v20, v20, v21
    v_mov_b32 v21, v20
    s_nop 1
    v_permlane32_swap_b32 v21, v20
    v_add_f32 v20, v20, v21
    v_mul_f32 v20, 0x3c4ccccd, v20
    v_sub_f32 v22, v200, v20
    v_sub_f32 v23, v201, v20
    v_mul_f32 v21, v22, v22
    v_mul_f32 v35, v23, v23
    v_sub_f32 v22, v202, v20
    v_sub_f32 v23, v203, v20
    v_fmac_f32 v21, v22, v22
    v_fmac_f32 v35, v23, v23
    v_sub_f32 v22, v204, v20
    v_sub_f32 v23, v205, v20
    v_fmac_f32 v21, v22, v22
    v_fmac_f32 v35, v23, v23
    v_sub_f32 v22, v206, v20
    v_sub_f32 v23, v207, v20
    v_fmac_f32 v21, v22, v22
    v_fmac_f32 v35, v23, v23
    v_sub_f32 v22, v208, v20
    v_sub_f32 v23, v209, v20
    v_fmac_f32 v21, v22, v22
    v_fmac_f32 v35, v23, v23
    v_sub_f32 v22, v210, v20
    v_sub_f32 v23, v211, v20
    v_fmac_f32 v21, v22, v22
    v_fmac_f32 v35, v23, v23
    v_sub_f32 v22, v212, v20
    v_sub_f32 v23, v213, v20
    v_fmac_f32 v21, v22, v22
    v_fmac_f32 v35, v23, v23
    v_sub_f32 v22, v214, v20
    v_sub_f32 v23, v215, v20
    v_fmac_f32 v21, v22, v22
    v_fmac_f32 v35, v23, v23
    v_sub_f32 v22, v216, v20
    v_sub_f32 v23, v217, v20
    v_fmac_f32 v21, v22, v22
    v_fmac_f32 v35, v23, v23
    v_sub_f32 v22, v218, v20
    v_sub_f32 v23, v219, v20
    v_fmac_f32 v21, v22, v22
    v_fmac_f32 v35, v23, v23
    v_add_f32 v21, v21, v35
    v_mov_b32 v22, v21
    s_nop 1
    v_permlane16_swap_b32 v22, v21
    v_add_f32 v21, v21, v22
    v_mov_b32 v22, v21
    s_nop 1
    v_permlane32_swap_b32 v22, v21
    v_add_f32 v21, v21, v22
    s_lshl_b32 s41, s33, 3
    s_add_u32 s41, s41, s34
    s_lshl_b32 s41, s41, 9
    s_lshl_b32 s42, s32, 7
    s_add_u32 s41, s41, s42
    v_lshlrev_b32 v22, 3, v239
    s_mov_b64 exec, 0xffff
    buffer_store_dwordx2 v[20:21], v22, s[52:55], s41 offen sc1
    s_mov_b64 exec, -1
    s_add_u32 s12, s90, 0x300000
    s_addc_u32 s13, s91, 0
    s_and_b32 s13, s13, 0xffff
    s_mov_b32 s14, 0x280000
    s_mov_b32 s15, 0x20000
    s_add_u32 s16, s90, 0x4000
    s_addc_u32 s17, s91, 0
    s_and_b32 s17, s17, 0xffff
    s_mov_b32 s18, 0x20000
    s_mov_b32 s19, 0x20000
    s_mov_b32 s56, s90
    s_mov_b32 s57, s91
    s_and_b32 s57, s57, 0xffff
    s_mov_b32 s58, 0x3c00
    s_mov_b32 s59, 0x20000
    s_add_u32 s8, s90, 0x1600000
    s_addc_u32 s9, s91, 0
    s_and_b32 s9, s9, 0xffff
    s_mov_b32 s10, 0x6c0000
    s_mov_b32 s11, 0x20000
    v_and_b32 v2, 63, v249
    v_and_b32 v236, 15, v2
    v_lshrrev_b32 v237, 4, v2
    v_cmp_eq_u32 vcc, 0, v236
    v_mov_b32 v10, 7680
    v_mov_b32 v11, 10240
    v_cndmask_b32 v10, v10, v11, vcc
    v_lshl_add_u32 v10, v237, 4, v10
    s_lshl_b32 s37, s32, 7
    v_add_u32 v10, s37, v10
    v_cndmask_b32 v11, 0, 1.0, vcc
    buffer_load_dwordx4 v[60:63], v10, s[56:59], 0 offen offset:0
    buffer_load_dwordx4 v[64:67], v10, s[56:59], 0 offen offset:64
    buffer_load_dwordx4 v[68:71], v10, s[56:59], 0 offen offset:512
    buffer_load_dwordx4 v[72:75], v10, s[56:59], 0 offen offset:576
    buffer_load_dwordx4 v[76:79], v10, s[56:59], 0 offen offset:1024
    buffer_load_dwordx4 v[80:83], v10, s[56:59], 0 offen offset:1088
    buffer_load_dwordx4 v[84:87], v10, s[56:59], 0 offen offset:1536
    buffer_load_dwordx4 v[88:91], v10, s[56:59], 0 offen offset:1600
    buffer_load_dwordx4 v[92:95], v10, s[56:59], 0 offen offset:2048
    buffer_load_dwordx4 v[96:99], v10, s[56:59], 0 offen offset:2112
    v_lshlrev_b32 v3, 4, v2
    v_lshlrev_b32 v4, 3, v2
    s_lshl_b32 s37, s46, 3
    s_lshl_b32 s38, s32, 1
    s_add_u32 s37, s37, s38
    s_add_u32 s37, s37, 0
    s_mul_i32 s37, s37, 20480
    v_add_u32 v240, s37, v3
    v_add_u32 v234, s37, v4
    s_lshl_b32 s37, s46, 3
    s_lshl_b32 s38, s32, 1
    s_add_u32 s37, s37, s38
    s_add_u32 s37, s37, 1
    s_mul_i32 s37, s37, 20480
    v_add_u32 v241, s37, v3
    v_add_u32 v235, s37, v4
    s_mov_b32 s36, 0
    s_mov_b32 s40, 4096
    s_mov_b32 s41, 8192
    s_mov_b32 s42, 12288
    s_mov_b32 s43, 16384
    v_mov_b32 v242, v3
    v_mov_b32 v233, v4
    s_lshl_b32 s37, s32, 1
    s_add_u32 s37, s37, 0
    s_and_b32 s37, s37, 3
    s_lshl_b32 s37, s37, 7
    v_lshlrev_b32 v5, 10, v237
    v_lshl_add_u32 v5, v236, 3, v5
    v_add_u32 v238, s37, v5
    s_lshl_b32 s37, s32, 1
    s_add_u32 s37, s37, 1
    s_and_b32 s37, s37, 3
    s_lshl_b32 s37, s37, 7
    v_lshlrev_b32 v5, 10, v237
    v_lshl_add_u32 v5, v236, 3, v5
    v_add_u32 v239, s37, v5
    s_lshl_b32 s60, s46, 1
    s_lshr_b32 s37, s32, 1
    s_add_u32 s60, s60, s37
    s_lshl_b32 s60, s60, 12
    v_lshrrev_b32 v5, 2, v236
    v_lshl_add_u32 v5, v237, 2, v5
    v_mul_u32_u24 v5, 224, v5
    v_and_b32 v6, 3, v236
    v_lshl_add_u32 v230, v6, 3, v5
    v_add_u32 v231, 64512, v230
    v_add_u32 v232, 129024, v230
    v_add_u32 v228, s45, v230
    v_add_u32 v229, 86016, v228
    s_waitcnt vmcnt(0) lgkmcnt(0)
    s_barrier
    s_cmp_lg_u32 s32, 0
    s_cbranch_scc1 L_arr2
    s_and_b32 s3, s2, 7
    s_lshl_b32 s3, s3, 7
    s_add_u32 s3, s3, 2048
    s_mov_b64 exec, 1
    v_mov_b32 v254, s3
    v_mov_b32 v255, 1
    buffer_atomic_add v255, v254, s[92:95], 0 offen sc1
    s_mov_b64 exec, -1
L_arr2:
    v_add_f32 v60, v60, v11
    v_add_f32 v61, v61, v11
    v_add_f32 v62, v62, v11
    v_add_f32 v63, v63, v11
    v_add_f32 v64, v64, v11
    v_add_f32 v65, v65, v11
    v_add_f32 v66, v66, v11
    v_add_f32 v67, v67, v11
    v_cvt_pk_bf16_f32 v110, v60, v61
    v_cvt_pk_bf16_f32 v111, v62, v63
    v_cvt_pk_bf16_f32 v112, v64, v65
    v_cvt_pk_bf16_f32 v113, v66, v67
    v_add_f32 v68, v68, v11
    v_add_f32 v69, v69, v11
    v_add_f32 v70, v70, v11
    v_add_f32 v71, v71, v11
    v_add_f32 v72, v72, v11
    v_add_f32 v73, v73, v11
    v_add_f32 v74, v74, v11
    v_add_f32 v75, v75, v11
    v_cvt_pk_bf16_f32 v114, v68, v69
    v_cvt_pk_bf16_f32 v115, v70, v71
    v_cvt_pk_bf16_f32 v116, v72, v73
    v_cvt_pk_bf16_f32 v117, v74, v75
    v_add_f32 v76, v76, v11
    v_add_f32 v77, v77, v11
    v_add_f32 v78, v78, v11
    v_add_f32 v79, v79, v11
    v_add_f32 v80, v80, v11
    v_add_f32 v81, v81, v11
    v_add_f32 v82, v82, v11
    v_add_f32 v83, v83, v11
    v_cvt_pk_bf16_f32 v118, v76, v77
    v_cvt_pk_bf16_f32 v119, v78, v79
    v_cvt_pk_bf16_f32 v120, v80, v81
    v_cvt_pk_bf16_f32 v121, v82, v83
    v_add_f32 v84, v84, v11
    v_add_f32 v85, v85, v11
    v_add_f32 v86, v86, v11
    v_add_f32 v87, v87, v11
    v_add_f32 v88, v88, v11
    v_add_f32 v89, v89, v11
    v_add_f32 v90, v90, v11
    v_add_f32 v91, v91, v11
    v_cvt_pk_bf16_f32 v122, v84, v85
    v_cvt_pk_bf16_f32 v123, v86, v87
    v_cvt_pk_bf16_f32 v124, v88, v89
    v_cvt_pk_bf16_f32 v125, v90, v91
    v_add_f32 v92, v92, v11
    v_add_f32 v93, v93, v11
    v_add_f32 v94, v94, v11
    v_add_f32 v95, v95, v11
    v_add_f32 v96, v96, v11
    v_add_f32 v97, v97, v11
    v_add_f32 v98, v98, v11
    v_add_f32 v99, v99, v11
    v_cvt_pk_bf16_f32 v126, v92, v93
    v_cvt_pk_bf16_f32 v127, v94, v95
    v_cvt_pk_bf16_f32 v128, v96, v97
    v_cvt_pk_bf16_f32 v129, v98, v99
    ds_read_b64_tr_b16 a[160:161], v228 offset:0
    ds_read_b64_tr_b16 a[162:163], v228 offset:3584
    ds_read_b64_tr_b16 a[164:165], v228 offset:32
    ds_read_b64_tr_b16 a[166:167], v228 offset:3616
    ds_read_b64_tr_b16 a[168:169], v228 offset:64
    ds_read_b64_tr_b16 a[170:171], v228 offset:3648
    ds_read_b64_tr_b16 a[172:173], v228 offset:96
    ds_read_b64_tr_b16 a[174:175], v228 offset:3680
    ds_read_b64_tr_b16 a[176:177], v228 offset:128
    ds_read_b64_tr_b16 a[178:179], v228 offset:3712
    ds_read_b64_tr_b16 a[180:181], v228 offset:160
    ds_read_b64_tr_b16 a[182:183], v228 offset:3744
    ds_read_b64_tr_b16 a[184:185], v228 offset:192
    ds_read_b64_tr_b16 a[186:187], v228 offset:3776
    s_waitcnt lgkmcnt(0)
    v_mfma_f32_16x16x32_bf16 v[140:143], a[160:163], v[110:113], 0
    ds_read_b64_tr_b16 a[188:189], v228 offset:28672
    ds_read_b64_tr_b16 a[190:191], v228 offset:32256
    v_mfma_f32_16x16x32_bf16 v[144:147], a[164:167], v[110:113], 0
    ds_read_b64_tr_b16 a[192:193], v228 offset:28704
    ds_read_b64_tr_b16 a[194:195], v228 offset:32288
    v_mfma_f32_16x16x32_bf16 v[148:151], a[168:171], v[110:113], 0
    ds_read_b64_tr_b16 a[196:197], v228 offset:28736
    ds_read_b64_tr_b16 a[198:199], v228 offset:32320
    v_mfma_f32_16x16x32_bf16 v[152:155], a[172:175], v[110:113], 0
    ds_read_b64_tr_b16 a[200:201], v228 offset:28768
    ds_read_b64_tr_b16 a[202:203], v228 offset:32352
    v_mfma_f32_16x16x32_bf16 v[156:159], a[176:179], v[110:113], 0
    ds_read_b64_tr_b16 a[204:205], v228 offset:28800
    ds_read_b64_tr_b16 a[206:207], v228 offset:32384
    v_mfma_f32_16x16x32_bf16 v[160:163], a[180:183], v[110:113], 0
    ds_read_b64_tr_b16 a[208:209], v228 offset:28832
    ds_read_b64_tr_b16 a[210:211], v228 offset:32416
    v_mfma_f32_16x16x32_bf16 v[164:167], a[184:187], v[110:113], 0
    ds_read_b64_tr_b16 a[212:213], v228 offset:28864
    ds_read_b64_tr_b16 a[214:215], v228 offset:32448
    s_waitcnt lgkmcnt(0)
    v_mfma_f32_16x16x32_bf16 v[140:143], a[188:191], v[114:117], v[140:143]
    ds_read_b64_tr_b16 a[160:161], v228 offset:57344
    ds_read_b64_tr_b16 a[162:163], v228 offset:60928
    v_mfma_f32_16x16x32_bf16 v[144:147], a[192:195], v[114:117], v[144:147]
    ds_read_b64_tr_b16 a[164:165], v228 offset:57376
    ds_read_b64_tr_b16 a[166:167], v228 offset:60960
    v_mfma_f32_16x16x32_bf16 v[148:151], a[196:199], v[114:117], v[148:151]
    ds_read_b64_tr_b16 a[168:169], v228 offset:57408
    ds_read_b64_tr_b16 a[170:171], v228 offset:60992
    v_mfma_f32_16x16x32_bf16 v[152:155], a[200:203], v[114:117], v[152:155]
    ds_read_b64_tr_b16 a[172:173], v228 offset:57440
    ds_read_b64_tr_b16 a[174:175], v228 offset:61024
    v_mfma_f32_16x16x32_bf16 v[156:159], a[204:207], v[114:117], v[156:159]
    ds_read_b64_tr_b16 a[176:177], v228 offset:57472
    ds_read_b64_tr_b16 a[178:179], v228 offset:61056
    v_mfma_f32_16x16x32_bf16 v[160:163], a[208:211], v[114:117], v[160:163]
    ds_read_b64_tr_b16 a[180:181], v228 offset:57504
    ds_read_b64_tr_b16 a[182:183], v228 offset:61088
    v_mfma_f32_16x16x32_bf16 v[164:167], a[212:215], v[114:117], v[164:167]
    ds_read_b64_tr_b16 a[184:185], v228 offset:57536
    ds_read_b64_tr_b16 a[186:187], v228 offset:61120
    s_waitcnt lgkmcnt(0)
    v_mfma_f32_16x16x32_bf16 v[140:143], a[160:163], v[118:121], v[140:143]
    ds_read_b64_tr_b16 a[188:189], v229 offset:0
    ds_read_b64_tr_b16 a[190:191], v229 offset:3584
    v_mfma_f32_16x16x32_bf16 v[144:147], a[164:167], v[118:121], v[144:147]
    ds_read_b64_tr_b16 a[192:193], v229 offset:32
    ds_read_b64_tr_b16 a[194:195], v229 offset:3616
    v_mfma_f32_16x16x32_bf16 v[148:151], a[168:171], v[118:121], v[148:151]
    ds_read_b64_tr_b16 a[196:197], v229 offset:64
    ds_read_b64_tr_b16 a[198:199], v229 offset:3648
    v_mfma_f32_16x16x32_bf16 v[152:155], a[172:175], v[118:121], v[152:155]
    ds_read_b64_tr_b16 a[200:201], v229 offset:96
    ds_read_b64_tr_b16 a[202:203], v229 offset:3680
    v_mfma_f32_16x16x32_bf16 v[156:159], a[176:179], v[118:121], v[156:159]
    ds_read_b64_tr_b16 a[204:205], v229 offset:128
    ds_read_b64_tr_b16 a[206:207], v229 offset:3712
    v_mfma_f32_16x16x32_bf16 v[160:163], a[180:183], v[118:121], v[160:163]
    ds_read_b64_tr_b16 a[208:209], v229 offset:160
    ds_read_b64_tr_b16 a[210:211], v229 offset:3744
    v_mfma_f32_16x16x32_bf16 v[164:167], a[184:187], v[118:121], v[164:167]
    ds_read_b64_tr_b16 a[212:213], v229 offset:192
    ds_read_b64_tr_b16 a[214:215], v229 offset:3776
    s_waitcnt lgkmcnt(0)
    v_mfma_f32_16x16x32_bf16 v[140:143], a[188:191], v[122:125], v[140:143]
    ds_read_b64_tr_b16 a[160:161], v229 offset:28672
    ds_read_b64_tr_b16 a[162:163], v229 offset:32256
    v_mfma_f32_16x16x32_bf16 v[144:147], a[192:195], v[122:125], v[144:147]
    ds_read_b64_tr_b16 a[164:165], v229 offset:28704
    ds_read_b64_tr_b16 a[166:167], v229 offset:32288
    v_mfma_f32_16x16x32_bf16 v[148:151], a[196:199], v[122:125], v[148:151]
    ds_read_b64_tr_b16 a[168:169], v229 offset:28736
    ds_read_b64_tr_b16 a[170:171], v229 offset:32320
    v_mfma_f32_16x16x32_bf16 v[152:155], a[200:203], v[122:125], v[152:155]
    ds_read_b64_tr_b16 a[172:173], v229 offset:28768
    ds_read_b64_tr_b16 a[174:175], v229 offset:32352
    v_mfma_f32_16x16x32_bf16 v[156:159], a[204:207], v[122:125], v[156:159]
    ds_read_b64_tr_b16 a[176:177], v229 offset:28800
    ds_read_b64_tr_b16 a[178:179], v229 offset:32384
    v_mfma_f32_16x16x32_bf16 v[160:163], a[208:211], v[122:125], v[160:163]
    ds_read_b64_tr_b16 a[180:181], v229 offset:28832
    ds_read_b64_tr_b16 a[182:183], v229 offset:32416
    v_mfma_f32_16x16x32_bf16 v[164:167], a[212:215], v[122:125], v[164:167]
    ds_read_b64_tr_b16 a[184:185], v229 offset:28864
    ds_read_b64_tr_b16 a[186:187], v229 offset:32448
    s_waitcnt lgkmcnt(0)
    v_mfma_f32_16x16x32_bf16 v[140:143], a[160:163], v[126:129], v[140:143]
    v_mfma_f32_16x16x32_bf16 v[144:147], a[164:167], v[126:129], v[144:147]
    v_mfma_f32_16x16x32_bf16 v[148:151], a[168:171], v[126:129], v[148:151]
    v_mfma_f32_16x16x32_bf16 v[152:155], a[172:175], v[126:129], v[152:155]
    v_mfma_f32_16x16x32_bf16 v[156:159], a[176:179], v[126:129], v[156:159]
    v_mfma_f32_16x16x32_bf16 v[160:163], a[180:183], v[126:129], v[160:163]
    v_mfma_f32_16x16x32_bf16 v[164:167], a[184:187], v[126:129], v[164:167]
    ds_read_b64_tr_b16 a[160:161], v230 offset:0
    ds_read_b64_tr_b16 a[162:163], v230 offset:3584
    ds_read_b64_tr_b16 a[164:165], v230 offset:32
    ds_read_b64_tr_b16 a[166:167], v230 offset:3616
    ds_read_b64_tr_b16 a[168:169], v230 offset:64
    ds_read_b64_tr_b16 a[170:171], v230 offset:3648
    ds_read_b64_tr_b16 a[172:173], v230 offset:96
    ds_read_b64_tr_b16 a[174:175], v230 offset:3680
    ds_read_b64_tr_b16 a[176:177], v230 offset:128
    ds_read_b64_tr_b16 a[178:179], v230 offset:3712
    ds_read_b64_tr_b16 a[180:181], v230 offset:160
    ds_read_b64_tr_b16 a[182:183], v230 offset:3744
    ds_read_b64_tr_b16 a[184:185], v230 offset:192
    ds_read_b64_tr_b16 a[186:187], v230 offset:3776
    v_lshlrev_b32 v5, 6, v236
    v_lshl_add_u32 v5, v237, 4, v5
    s_mul_i32 s37, s32, 896
    s_add_u32 s37, s37, 143360
    v_add_u32 v5, s37, v5
    v_cmp_gt_u32 vcc, 2, v236
    s_nop 3
    s_and_saveexec_b64 s[38:39], vcc
    ds_write_b128 v5, v[140:143] offset:0
    ds_write_b128 v5, v[144:147] offset:128
    ds_write_b128 v5, v[148:151] offset:256
    ds_write_b128 v5, v[152:155] offset:384
    ds_write_b128 v5, v[156:159] offset:512
    ds_write_b128 v5, v[160:163] offset:640
    ds_write_b128 v5, v[164:167] offset:768
    s_mov_b64 exec, s[38:39]
    s_waitcnt lgkmcnt(0)
    s_barrier
    v_min_u32 v5, 223, v249
    v_lshlrev_b32 v5, 2, v5
    v_add_u32 v6, 143360, v5
    ds_read_b32 v60, v6 offset:0
    ds_read_b32 v61, v6 offset:896
    ds_read_b32 v62, v6 offset:1792
    ds_read_b32 v63, v6 offset:2688
    s_waitcnt lgkmcnt(2)
    v_add_f32 v60, v60, v61
    s_waitcnt lgkmcnt(0)
    v_add_f32 v62, v62, v63
    v_add_f32 v60, v60, v62
    v_mul_f32 v60, 0x3fb8aa3b, v60
    ds_write_b32 v6, v60 offset:3584
    v_mov_b32 v0, 0
    v_mov_b32 v1, 0
    v_mov_b32 v2, 0
    v_mov_b32 v3, 0
    v_mov_b32 v4, 0
    v_mov_b32 v7, 0
    v_mov_b32 v8, 0
    v_mov_b32 v9, 0
    v_mov_b32 v10, 0
    v_mov_b32 v11, 0
    v_mov_b32 v12, 0
    v_mov_b32 v13, 0
    v_mov_b32 v14, 0
    v_mov_b32 v15, 0
    v_mov_b32 v16, 0
    v_mov_b32 v17, 0
    v_mov_b32 v18, 0
    v_mov_b32 v19, 0
    v_mov_b32 v20, 0
    v_mov_b32 v21, 0
    v_mov_b32 v22, 0
    v_mov_b32 v23, 0
    v_mov_b32 v24, 0
    v_mov_b32 v25, 0
    v_mov_b32 v26, 0
    v_mov_b32 v27, 0
    v_mov_b32 v28, 0
    v_mov_b32 v29, 0
    v_mov_b32 v30, 0
    v_mov_b32 v31, 0
    v_mov_b32 v32, 0
    v_mov_b32 v33, 0
    v_mov_b32 v34, 0
    v_mov_b32 v35, 0
    v_mov_b32 v36, 0
    v_mov_b32 v37, 0
    v_mov_b32 v38, 0
    v_mov_b32 v39, 0
    v_mov_b32 v40, 0
    v_mov_b32 v41, 0
    v_mov_b32 v42, 0
    v_mov_b32 v43, 0
    v_mov_b32 v44, 0
    v_mov_b32 v45, 0
    v_mov_b32 v46, 0
    v_mov_b32 v47, 0
    v_mov_b32 v48, 0
    v_mov_b32 v49, 0
    v_mov_b32 v50, 0
    v_mov_b32 v51, 0
    v_mov_b32 v52, 0
    v_mov_b32 v53, 0
    v_mov_b32 v54, 0
    v_mov_b32 v55, 0
    s_waitcnt lgkmcnt(0)
    s_cmp_lg_u32 s32, 0
    s_cbranch_scc1 L_pw2
    v_and_b32 v254, 7, v249
    v_lshlrev_b32 v254, 7, v254
    s_mov_b32 s3, 0
L_poll2:
    buffer_load_dword v255, v254, s[92:95], 0 offen offset:2048 sc1
    s_waitcnt vmcnt(0)
    v_cmp_gt_u32 vcc, 32, v255
    s_add_u32 s3, s3, 1
    s_cmp_gt_u32 s3, 400000
    s_cbranch_scc1 L_pw2
    s_cmp_eq_u64 vcc, 0
    s_cbranch_scc0 L_poll2
L_pw2:
    s_barrier
    buffer_load_dwordx4 a[0:3], v240, s[12:15], s36 offen offset:0
    buffer_load_dwordx4 a[4:7], v241, s[12:15], s36 offen offset:0
    buffer_load_dwordx4 a[8:11], v240, s[12:15], s36 offen offset:1024
    buffer_load_dwordx4 a[12:15], v241, s[12:15], s36 offen offset:1024
    buffer_load_dwordx2 a[16:17], v234, s[12:15], s36 offen offset:2048
    buffer_load_dwordx2 a[18:19], v234, s[12:15], s36 offen offset:2560
    buffer_load_dwordx2 a[20:21], v235, s[12:15], s36 offen offset:2048
    buffer_load_dwordx2 a[22:23], v235, s[12:15], s36 offen offset:2560
    buffer_load_dwordx4 a[24:27], v240, s[12:15], s36 offen offset:3072
    buffer_load_dwordx4 a[28:31], v241, s[12:15], s36 offen offset:3072
    buffer_load_dwordx4 a[32:35], v240, s[12:15], s40 offen offset:0
    buffer_load_dwordx4 a[36:39], v241, s[12:15], s40 offen offset:0
    buffer_load_dwordx4 a[40:43], v240, s[12:15], s40 offen offset:1024
    buffer_load_dwordx4 a[44:47], v241, s[12:15], s40 offen offset:1024
    buffer_load_dwordx4 a[48:51], v240, s[12:15], s40 offen offset:2048
    buffer_load_dwordx4 a[52:55], v241, s[12:15], s40 offen offset:2048
    buffer_load_dwordx2 a[56:57], v234, s[12:15], s40 offen offset:3072
    buffer_load_dwordx2 a[58:59], v234, s[12:15], s40 offen offset:3584
    buffer_load_dwordx2 a[60:61], v235, s[12:15], s40 offen offset:3072
    buffer_load_dwordx2 a[62:63], v235, s[12:15], s40 offen offset:3584
    buffer_load_dwordx2 v[100:101], v238, s[16:19], s60 offen offset:0
    buffer_load_dwordx2 v[102:103], v238, s[16:19], s60 offen offset:512
    buffer_load_dwordx2 v[104:105], v239, s[16:19], s60 offen offset:0
    buffer_load_dwordx2 v[106:107], v239, s[16:19], s60 offen offset:512
    v_lshlrev_b32 v5, 4, v237
    v_add_u32 v5, 146944, v5
    ds_read_b128 v[140:143], v5 offset:0
    ds_read_b128 v[170:173], v5 offset:64
    ds_read_b128 v[144:147], v5 offset:128
    ds_read_b128 v[174:177], v5 offset:192
    ds_read_b128 v[148:151], v5 offset:256
    ds_read_b128 v[178:181], v5 offset:320
    ds_read_b128 v[152:155], v5 offset:384
    ds_read_b128 v[182:185], v5 offset:448
    ds_read_b128 v[156:159], v5 offset:512
    ds_read_b128 v[186:189], v5 offset:576
    ds_read_b128 v[160:163], v5 offset:640
    ds_read_b128 v[190:193], v5 offset:704
    ds_read_b128 v[164:167], v5 offset:768
    ds_read_b128 v[194:197], v5 offset:832
    v_mov_b32 v5, 0
    v_mov_b32 v6, 0
    s_waitcnt vmcnt(22)
    v_mfma_f32_16x16x32_bf16 v[0:3], a[160:163], a[0:3], v[0:3]
    ds_read_b64_tr_b16 a[188:189], v230 offset:7168
    v_mfma_f32_16x16x32_bf16 v[28:31], a[160:163], a[4:7], v[28:31]
    buffer_load_dwordx4 a[64:67], v240, s[12:15], s41 offen offset:0
    v_mfma_f32_16x16x32_bf16 v[4:7], a[164:167], a[0:3], v[4:7]
    ds_read_b64_tr_b16 a[190:191], v230 offset:10752
    v_mfma_f32_16x16x32_bf16 v[32:35], a[164:167], a[4:7], v[32:35]
    ds_read_b64_tr_b16 a[192:193], v230 offset:7200
    v_mfma_f32_16x16x32_bf16 v[8:11], a[168:171], a[0:3], v[8:11]
    buffer_load_dwordx4 a[68:71], v241, s[12:15], s41 offen offset:0
    v_mfma_f32_16x16x32_bf16 v[36:39], a[168:171], a[4:7], v[36:39]
    ds_read_b64_tr_b16 a[194:195], v230 offset:10784
    v_mfma_f32_16x16x32_bf16 v[12:15], a[172:175], a[0:3], v[12:15]
    ds_read_b64_tr_b16 a[196:197], v230 offset:7232
    v_mfma_f32_16x16x32_bf16 v[40:43], a[172:175], a[4:7], v[40:43]
    ds_read_b64_tr_b16 a[198:199], v230 offset:10816
    v_mfma_f32_16x16x32_bf16 v[16:19], a[176:179], a[0:3], v[16:19]
    ds_read_b64_tr_b16 a[200:201], v230 offset:7264
    v_mfma_f32_16x16x32_bf16 v[44:47], a[176:179], a[4:7], v[44:47]
    ds_read_b64_tr_b16 a[202:203], v230 offset:10848
    v_mfma_f32_16x16x32_bf16 v[20:23], a[180:183], a[0:3], v[20:23]
    ds_read_b64_tr_b16 a[204:205], v230 offset:7296
    v_mfma_f32_16x16x32_bf16 v[48:51], a[180:183], a[4:7], v[48:51]
    ds_read_b64_tr_b16 a[206:207], v230 offset:10880
    v_mfma_f32_16x16x32_bf16 v[24:27], a[184:187], a[0:3], v[24:27]
    ds_read_b64_tr_b16 a[208:209], v230 offset:7328
    v_mfma_f32_16x16x32_bf16 v[52:55], a[184:187], a[4:7], v[52:55]
    ds_read_b64_tr_b16 a[210:211], v230 offset:10912
    ds_read_b64_tr_b16 a[212:213], v230 offset:7360
    ds_read_b64_tr_b16 a[214:215], v230 offset:10944
    s_waitcnt vmcnt(22)
    s_waitcnt lgkmcnt(0)
    v_mfma_f32_16x16x32_bf16 v[0:3], a[188:191], a[8:11], v[0:3]
    ds_read_b64_tr_b16 a[160:161], v230 offset:14336
    v_mfma_f32_16x16x32_bf16 v[28:31], a[188:191], a[12:15], v[28:31]
    buffer_load_dwordx4 a[72:75], v240, s[12:15], s41 offen offset:1024
    v_mfma_f32_16x16x32_bf16 v[4:7], a[192:195], a[8:11], v[4:7]
    ds_read_b64_tr_b16 a[162:163], v230 offset:17920
    v_mfma_f32_16x16x32_bf16 v[32:35], a[192:195], a[12:15], v[32:35]
    ds_read_b64_tr_b16 a[164:165], v230 offset:14368
    v_mfma_f32_16x16x32_bf16 v[8:11], a[196:199], a[8:11], v[8:11]
    buffer_load_dwordx4 a[76:79], v241, s[12:15], s41 offen offset:1024
    v_mfma_f32_16x16x32_bf16 v[36:39], a[196:199], a[12:15], v[36:39]
    ds_read_b64_tr_b16 a[166:167], v230 offset:17952
    v_mfma_f32_16x16x32_bf16 v[12:15], a[200:203], a[8:11], v[12:15]
    ds_read_b64_tr_b16 a[168:169], v230 offset:14400
    v_mfma_f32_16x16x32_bf16 v[40:43], a[200:203], a[12:15], v[40:43]
    ds_read_b64_tr_b16 a[170:171], v230 offset:17984
    v_mfma_f32_16x16x32_bf16 v[16:19], a[204:207], a[8:11], v[16:19]
    ds_read_b64_tr_b16 a[172:173], v230 offset:14432
    v_mfma_f32_16x16x32_bf16 v[44:47], a[204:207], a[12:15], v[44:47]
    ds_read_b64_tr_b16 a[174:175], v230 offset:18016
    v_mfma_f32_16x16x32_bf16 v[20:23], a[208:211], a[8:11], v[20:23]
    ds_read_b64_tr_b16 a[176:177], v230 offset:14464
    v_mfma_f32_16x16x32_bf16 v[48:51], a[208:211], a[12:15], v[48:51]
    ds_read_b64_tr_b16 a[178:179], v230 offset:18048
    v_mfma_f32_16x16x32_bf16 v[24:27], a[212:215], a[8:11], v[24:27]
    ds_read_b64_tr_b16 a[180:181], v230 offset:14496
    v_mfma_f32_16x16x32_bf16 v[52:55], a[212:215], a[12:15], v[52:55]
    ds_read_b64_tr_b16 a[182:183], v230 offset:18080
    ds_read_b64_tr_b16 a[184:185], v230 offset:14528
    ds_read_b64_tr_b16 a[186:187], v230 offset:18112
    s_waitcnt vmcnt(20)
    s_waitcnt lgkmcnt(0)
    v_mfma_f32_16x16x32_bf16 v[0:3], a[160:163], a[16:19], v[0:3]
    ds_read_b64_tr_b16 a[188:189], v230 offset:21504
    v_mfma_f32_16x16x32_bf16 v[28:31], a[160:163], a[20:23], v[28:31]
    buffer_load_dwordx4 a[80:83], v240, s[12:15], s41 offen offset:2048
    v_mfma_f32_16x16x32_bf16 v[4:7], a[164:167], a[16:19], v[4:7]
    ds_read_b64_tr_b16 a[190:191], v230 offset:25088
    v_mfma_f32_16x16x32_bf16 v[32:35], a[164:167], a[20:23], v[32:35]
    ds_read_b64_tr_b16 a[192:193], v230 offset:21536
    v_mfma_f32_16x16x32_bf16 v[8:11], a[168:171], a[16:19], v[8:11]
    buffer_load_dwordx4 a[84:87], v241, s[12:15], s41 offen offset:2048
    v_mfma_f32_16x16x32_bf16 v[36:39], a[168:171], a[20:23], v[36:39]
    ds_read_b64_tr_b16 a[194:195], v230 offset:25120
    v_mfma_f32_16x16x32_bf16 v[12:15], a[172:175], a[16:19], v[12:15]
    ds_read_b64_tr_b16 a[196:197], v230 offset:21568
    v_mfma_f32_16x16x32_bf16 v[40:43], a[172:175], a[20:23], v[40:43]
    ds_read_b64_tr_b16 a[198:199], v230 offset:25152
    v_mfma_f32_16x16x32_bf16 v[16:19], a[176:179], a[16:19], v[16:19]
    ds_read_b64_tr_b16 a[200:201], v230 offset:21600
    v_mfma_f32_16x16x32_bf16 v[44:47], a[176:179], a[20:23], v[44:47]
    ds_read_b64_tr_b16 a[202:203], v230 offset:25184
    v_mfma_f32_16x16x32_bf16 v[20:23], a[180:183], a[16:19], v[20:23]
    ds_read_b64_tr_b16 a[204:205], v230 offset:21632
    v_mfma_f32_16x16x32_bf16 v[48:51], a[180:183], a[20:23], v[48:51]
    ds_read_b64_tr_b16 a[206:207], v230 offset:25216
    v_mfma_f32_16x16x32_bf16 v[24:27], a[184:187], a[16:19], v[24:27]
    ds_read_b64_tr_b16 a[208:209], v230 offset:21664
    v_mfma_f32_16x16x32_bf16 v[52:55], a[184:187], a[20:23], v[52:55]
    ds_read_b64_tr_b16 a[210:211], v230 offset:25248
    ds_read_b64_tr_b16 a[212:213], v230 offset:21696
    ds_read_b64_tr_b16 a[214:215], v230 offset:25280
    s_waitcnt vmcnt(20)
    s_waitcnt lgkmcnt(0)
    v_mfma_f32_16x16x32_bf16 v[0:3], a[188:191], a[24:27], v[0:3]
    ds_read_b64_tr_b16 a[160:161], v230 offset:28672
    v_mfma_f32_16x16x32_bf16 v[28:31], a[188:191], a[28:31], v[28:31]
    buffer_load_dwordx4 a[88:91], v240, s[12:15], s41 offen offset:3072
    v_mfma_f32_16x16x32_bf16 v[4:7], a[192:195], a[24:27], v[4:7]
    ds_read_b64_tr_b16 a[162:163], v230 offset:32256
    v_mfma_f32_16x16x32_bf16 v[32:35], a[192:195], a[28:31], v[32:35]
    ds_read_b64_tr_b16 a[164:165], v230 offset:28704
    v_mfma_f32_16x16x32_bf16 v[8:11], a[196:199], a[24:27], v[8:11]
    buffer_load_dwordx4 a[92:95], v241, s[12:15], s41 offen offset:3072
    v_mfma_f32_16x16x32_bf16 v[36:39], a[196:199], a[28:31], v[36:39]
    ds_read_b64_tr_b16 a[166:167], v230 offset:32288
    v_mfma_f32_16x16x32_bf16 v[12:15], a[200:203], a[24:27], v[12:15]
    ds_read_b64_tr_b16 a[168:169], v230 offset:28736
    v_mfma_f32_16x16x32_bf16 v[40:43], a[200:203], a[28:31], v[40:43]
    ds_read_b64_tr_b16 a[170:171], v230 offset:32320
    v_mfma_f32_16x16x32_bf16 v[16:19], a[204:207], a[24:27], v[16:19]
    ds_read_b64_tr_b16 a[172:173], v230 offset:28768
    v_mfma_f32_16x16x32_bf16 v[44:47], a[204:207], a[28:31], v[44:47]
    ds_read_b64_tr_b16 a[174:175], v230 offset:32352
    v_mfma_f32_16x16x32_bf16 v[20:23], a[208:211], a[24:27], v[20:23]
    ds_read_b64_tr_b16 a[176:177], v230 offset:28800
    v_mfma_f32_16x16x32_bf16 v[48:51], a[208:211], a[28:31], v[48:51]
    ds_read_b64_tr_b16 a[178:179], v230 offset:32384
    v_mfma_f32_16x16x32_bf16 v[24:27], a[212:215], a[24:27], v[24:27]
    ds_read_b64_tr_b16 a[180:181], v230 offset:28832
    v_mfma_f32_16x16x32_bf16 v[52:55], a[212:215], a[28:31], v[52:55]
    ds_read_b64_tr_b16 a[182:183], v230 offset:32416
    ds_read_b64_tr_b16 a[184:185], v230 offset:28864
    ds_read_b64_tr_b16 a[186:187], v230 offset:32448
    s_waitcnt vmcnt(20)
    s_waitcnt lgkmcnt(0)
    v_mfma_f32_16x16x32_bf16 v[0:3], a[160:163], a[32:35], v[0:3]
    ds_read_b64_tr_b16 a[188:189], v230 offset:35840
    v_mfma_f32_16x16x32_bf16 v[28:31], a[160:163], a[36:39], v[28:31]
    buffer_load_dwordx2 a[96:97], v234, s[12:15], s42 offen offset:0
    v_mfma_f32_16x16x32_bf16 v[4:7], a[164:167], a[32:35], v[4:7]
    ds_read_b64_tr_b16 a[190:191], v230 offset:39424
    v_mfma_f32_16x16x32_bf16 v[32:35], a[164:167], a[36:39], v[32:35]
    ds_read_b64_tr_b16 a[192:193], v230 offset:35872
    v_mfma_f32_16x16x32_bf16 v[8:11], a[168:171], a[32:35], v[8:11]
    buffer_load_dwordx2 a[98:99], v234, s[12:15], s42 offen offset:512
    v_mfma_f32_16x16x32_bf16 v[36:39], a[168:171], a[36:39], v[36:39]
    ds_read_b64_tr_b16 a[194:195], v230 offset:39456
    v_mfma_f32_16x16x32_bf16 v[12:15], a[172:175], a[32:35], v[12:15]
    ds_read_b64_tr_b16 a[196:197], v230 offset:35904
    v_mfma_f32_16x16x32_bf16 v[40:43], a[172:175], a[36:39], v[40:43]
    buffer_load_dwordx2 a[100:101], v235, s[12:15], s42 offen offset:0
    v_mfma_f32_16x16x32_bf16 v[16:19], a[176:179], a[32:35], v[16:19]
    ds_read_b64_tr_b16 a[198:199], v230 offset:39488
    v_mfma_f32_16x16x32_bf16 v[44:47], a[176:179], a[36:39], v[44:47]
    ds_read_b64_tr_b16 a[200:201], v230 offset:35936
    v_mfma_f32_16x16x32_bf16 v[20:23], a[180:183], a[32:35], v[20:23]
    buffer_load_dwordx2 a[102:103], v235, s[12:15], s42 offen offset:512
    v_mfma_f32_16x16x32_bf16 v[48:51], a[180:183], a[36:39], v[48:51]
    ds_read_b64_tr_b16 a[202:203], v230 offset:39520
    v_mfma_f32_16x16x32_bf16 v[24:27], a[184:187], a[32:35], v[24:27]
    ds_read_b64_tr_b16 a[204:205], v230 offset:35968
    v_mfma_f32_16x16x32_bf16 v[52:55], a[184:187], a[36:39], v[52:55]
    ds_read_b64_tr_b16 a[206:207], v230 offset:39552
    ds_read_b64_tr_b16 a[208:209], v230 offset:36000
    ds_read_b64_tr_b16 a[210:211], v230 offset:39584
    ds_read_b64_tr_b16 a[212:213], v230 offset:36032
    ds_read_b64_tr_b16 a[214:215], v230 offset:39616
    s_waitcnt vmcnt(22)
    s_waitcnt lgkmcnt(0)
    v_mfma_f32_16x16x32_bf16 v[0:3], a[188:191], a[40:43], v[0:3]
    ds_read_b64_tr_b16 a[160:161], v230 offset:43008
    v_mfma_f32_16x16x32_bf16 v[28:31], a[188:191], a[44:47], v[28:31]
    buffer_load_dwordx4 a[104:107], v240, s[12:15], s42 offen offset:1024
    v_mfma_f32_16x16x32_bf16 v[4:7], a[192:195], a[40:43], v[4:7]
    ds_read_b64_tr_b16 a[162:163], v230 offset:46592
    v_mfma_f32_16x16x32_bf16 v[32:35], a[192:195], a[44:47], v[32:35]
    ds_read_b64_tr_b16 a[164:165], v230 offset:43040
    v_mfma_f32_16x16x32_bf16 v[8:11], a[196:199], a[40:43], v[8:11]
    buffer_load_dwordx4 a[108:111], v241, s[12:15], s42 offen offset:1024
    v_mfma_f32_16x16x32_bf16 v[36:39], a[196:199], a[44:47], v[36:39]
    ds_read_b64_tr_b16 a[166:167], v230 offset:46624
    v_mfma_f32_16x16x32_bf16 v[12:15], a[200:203], a[40:43], v[12:15]
    ds_read_b64_tr_b16 a[168:169], v230 offset:43072
    v_mfma_f32_16x16x32_bf16 v[40:43], a[200:203], a[44:47], v[40:43]
    ds_read_b64_tr_b16 a[170:171], v230 offset:46656
    v_mfma_f32_16x16x32_bf16 v[16:19], a[204:207], a[40:43], v[16:19]
    ds_read_b64_tr_b16 a[172:173], v230 offset:43104
    v_mfma_f32_16x16x32_bf16 v[44:47], a[204:207], a[44:47], v[44:47]
    ds_read_b64_tr_b16 a[174:175], v230 offset:46688
    v_mfma_f32_16x16x32_bf16 v[20:23], a[208:211], a[40:43], v[20:23]
    ds_read_b64_tr_b16 a[176:177], v230 offset:43136
    v_mfma_f32_16x16x32_bf16 v[48:51], a[208:211], a[44:47], v[48:51]
    ds_read_b64_tr_b16 a[178:179], v230 offset:46720
    v_mfma_f32_16x16x32_bf16 v[24:27], a[212:215], a[40:43], v[24:27]
    ds_read_b64_tr_b16 a[180:181], v230 offset:43168
    v_mfma_f32_16x16x32_bf16 v[52:55], a[212:215], a[44:47], v[52:55]
    ds_read_b64_tr_b16 a[182:183], v230 offset:46752
    ds_read_b64_tr_b16 a[184:185], v230 offset:43200
    ds_read_b64_tr_b16 a[186:187], v230 offset:46784
    s_waitcnt vmcnt(22)
    s_waitcnt lgkmcnt(0)
    v_mfma_f32_16x16x32_bf16 v[0:3], a[160:163], a[48:51], v[0:3]
    ds_read_b64_tr_b16 a[188:189], v230 offset:50176
    v_mfma_f32_16x16x32_bf16 v[28:31], a[160:163], a[52:55], v[28:31]
    buffer_load_dwordx4 a[112:115], v240, s[12:15], s42 offen offset:2048
    v_mfma_f32_16x16x32_bf16 v[4:7], a[164:167], a[48:51], v[4:7]
    ds_read_b64_tr_b16 a[190:191], v230 offset:53760
    v_mfma_f32_16x16x32_bf16 v[32:35], a[164:167], a[52:55], v[32:35]
    ds_read_b64_tr_b16 a[192:193], v230 offset:50208
    v_mfma_f32_16x16x32_bf16 v[8:11], a[168:171], a[48:51], v[8:11]
    buffer_load_dwordx4 a[116:119], v241, s[12:15], s42 offen offset:2048
    v_mfma_f32_16x16x32_bf16 v[36:39], a[168:171], a[52:55], v[36:39]
    ds_read_b64_tr_b16 a[194:195], v230 offset:53792
    v_mfma_f32_16x16x32_bf16 v[12:15], a[172:175], a[48:51], v[12:15]
    ds_read_b64_tr_b16 a[196:197], v230 offset:50240
    v_mfma_f32_16x16x32_bf16 v[40:43], a[172:175], a[52:55], v[40:43]
    ds_read_b64_tr_b16 a[198:199], v230 offset:53824
    v_mfma_f32_16x16x32_bf16 v[16:19], a[176:179], a[48:51], v[16:19]
    ds_read_b64_tr_b16 a[200:201], v230 offset:50272
    v_mfma_f32_16x16x32_bf16 v[44:47], a[176:179], a[52:55], v[44:47]
    ds_read_b64_tr_b16 a[202:203], v230 offset:53856
    v_mfma_f32_16x16x32_bf16 v[20:23], a[180:183], a[48:51], v[20:23]
    ds_read_b64_tr_b16 a[204:205], v230 offset:50304
    v_mfma_f32_16x16x32_bf16 v[48:51], a[180:183], a[52:55], v[48:51]
    ds_read_b64_tr_b16 a[206:207], v230 offset:53888
    v_mfma_f32_16x16x32_bf16 v[24:27], a[184:187], a[48:51], v[24:27]
    ds_read_b64_tr_b16 a[208:209], v230 offset:50336
    v_mfma_f32_16x16x32_bf16 v[52:55], a[184:187], a[52:55], v[52:55]
    ds_read_b64_tr_b16 a[210:211], v230 offset:53920
    ds_read_b64_tr_b16 a[212:213], v230 offset:50368
    ds_read_b64_tr_b16 a[214:215], v230 offset:53952
    s_waitcnt vmcnt(20)
    s_waitcnt lgkmcnt(0)
    v_mfma_f32_16x16x32_bf16 v[0:3], a[188:191], a[56:59], v[0:3]
    ds_read_b64_tr_b16 a[160:161], v230 offset:57344
    v_mfma_f32_16x16x32_bf16 v[28:31], a[188:191], a[60:63], v[28:31]
    buffer_load_dwordx4 a[120:123], v240, s[12:15], s42 offen offset:3072
    v_mfma_f32_16x16x32_bf16 v[4:7], a[192:195], a[56:59], v[4:7]
    ds_read_b64_tr_b16 a[162:163], v230 offset:60928
    v_mfma_f32_16x16x32_bf16 v[32:35], a[192:195], a[60:63], v[32:35]
    ds_read_b64_tr_b16 a[164:165], v230 offset:57376
    v_mfma_f32_16x16x32_bf16 v[8:11], a[196:199], a[56:59], v[8:11]
    buffer_load_dwordx4 a[124:127], v241, s[12:15], s42 offen offset:3072
    v_mfma_f32_16x16x32_bf16 v[36:39], a[196:199], a[60:63], v[36:39]
    ds_read_b64_tr_b16 a[166:167], v230 offset:60960
    v_mfma_f32_16x16x32_bf16 v[12:15], a[200:203], a[56:59], v[12:15]
    ds_read_b64_tr_b16 a[168:169], v230 offset:57408
    v_mfma_f32_16x16x32_bf16 v[40:43], a[200:203], a[60:63], v[40:43]
    ds_read_b64_tr_b16 a[170:171], v230 offset:60992
    v_mfma_f32_16x16x32_bf16 v[16:19], a[204:207], a[56:59], v[16:19]
    ds_read_b64_tr_b16 a[172:173], v230 offset:57440
    v_mfma_f32_16x16x32_bf16 v[44:47], a[204:207], a[60:63], v[44:47]
    ds_read_b64_tr_b16 a[174:175], v230 offset:61024
    v_mfma_f32_16x16x32_bf16 v[20:23], a[208:211], a[56:59], v[20:23]
    ds_read_b64_tr_b16 a[176:177], v230 offset:57472
    v_mfma_f32_16x16x32_bf16 v[48:51], a[208:211], a[60:63], v[48:51]
    ds_read_b64_tr_b16 a[178:179], v230 offset:61056
    v_mfma_f32_16x16x32_bf16 v[24:27], a[212:215], a[56:59], v[24:27]
    ds_read_b64_tr_b16 a[180:181], v230 offset:57504
    v_mfma_f32_16x16x32_bf16 v[52:55], a[212:215], a[60:63], v[52:55]
    ds_read_b64_tr_b16 a[182:183], v230 offset:61088
    ds_read_b64_tr_b16 a[184:185], v230 offset:57536
    ds_read_b64_tr_b16 a[186:187], v230 offset:61120
    s_waitcnt vmcnt(16)
    s_waitcnt lgkmcnt(0)
    v_mfma_f32_16x16x32_bf16 v[0:3], a[160:163], a[64:67], v[0:3]
    ds_read_b64_tr_b16 a[188:189], v231 offset:0
    v_mfma_f32_16x16x32_bf16 v[28:31], a[160:163], a[68:71], v[28:31]
    buffer_load_dwordx4 a[128:131], v240, s[12:15], s43 offen offset:0
    v_mfma_f32_16x16x32_bf16 v[4:7], a[164:167], a[64:67], v[4:7]
    ds_read_b64_tr_b16 a[190:191], v231 offset:3584
    v_mfma_f32_16x16x32_bf16 v[32:35], a[164:167], a[68:71], v[32:35]
    ds_read_b64_tr_b16 a[192:193], v231 offset:32
    v_mfma_f32_16x16x32_bf16 v[8:11], a[168:171], a[64:67], v[8:11]
    buffer_load_dwordx4 a[132:135], v241, s[12:15], s43 offen offset:0
    v_mfma_f32_16x16x32_bf16 v[36:39], a[168:171], a[68:71], v[36:39]
    ds_read_b64_tr_b16 a[194:195], v231 offset:3616
    v_mfma_f32_16x16x32_bf16 v[12:15], a[172:175], a[64:67], v[12:15]
    ds_read_b64_tr_b16 a[196:197], v231 offset:64
    v_mfma_f32_16x16x32_bf16 v[40:43], a[172:175], a[68:71], v[40:43]
    ds_read_b64_tr_b16 a[198:199], v231 offset:3648
    v_mfma_f32_16x16x32_bf16 v[16:19], a[176:179], a[64:67], v[16:19]
    ds_read_b64_tr_b16 a[200:201], v231 offset:96
    v_mfma_f32_16x16x32_bf16 v[44:47], a[176:179], a[68:71], v[44:47]
    ds_read_b64_tr_b16 a[202:203], v231 offset:3680
    v_mfma_f32_16x16x32_bf16 v[20:23], a[180:183], a[64:67], v[20:23]
    ds_read_b64_tr_b16 a[204:205], v231 offset:128
    v_mfma_f32_16x16x32_bf16 v[48:51], a[180:183], a[68:71], v[48:51]
    ds_read_b64_tr_b16 a[206:207], v231 offset:3712
    v_mfma_f32_16x16x32_bf16 v[24:27], a[184:187], a[64:67], v[24:27]
    ds_read_b64_tr_b16 a[208:209], v231 offset:160
    v_mfma_f32_16x16x32_bf16 v[52:55], a[184:187], a[68:71], v[52:55]
    ds_read_b64_tr_b16 a[210:211], v231 offset:3744
    ds_read_b64_tr_b16 a[212:213], v231 offset:192
    ds_read_b64_tr_b16 a[214:215], v231 offset:3776
    s_waitcnt vmcnt(16)
    s_waitcnt lgkmcnt(0)
    s_add_u32 s48, s90, 0x1300000
    s_addc_u32 s49, s91, 0
    s_and_b32 s49, s49, 0xffff
    s_mov_b32 s50, 0x21c000
    s_mov_b32 s51, 0x20000
    s_and_b32 s3, s2, 7
    s_lshr_b32 s36, s2, 3
    s_and_b32 s37, s3, 1
    s_lshl_b32 s37, s37, 3
    s_and_b32 s33, s36, 7
    s_add_u32 s33, s33, s37
    s_lshl_b32 s33, s33, 1
    s_lshr_b32 s37, s3, 2
    s_add_u32 s33, s33, s37
    s_lshr_b32 s34, s36, 3
    s_lshl_b32 s34, s34, 1
    s_bfe_u32 s37, s3, 0x10001
    s_add_u32 s34, s34, s37
    v_and_b32 v227, 63, v249
    v_lshlrev_b32 v227, 4, v227
    s_mul_i32 s60, s32, 14
    s_mul_i32 s61, s32, 5120
    s_mul_i32 s38, s34, 5
    s_add_u32 s38, s38, 0
    s_mul_i32 s38, s38, 54
    s_add_u32 s38, s38, s60
    s_lshl_b32 s52, s38, 10
    s_mul_i32 s38, s34, 5
    s_add_u32 s38, s38, 1
    s_mul_i32 s38, s38, 54
    s_add_u32 s38, s38, s60
    s_lshl_b32 s53, s38, 10
    s_mul_i32 s38, s34, 5
    s_add_u32 s38, s38, 2
    s_mul_i32 s38, s38, 54
    s_add_u32 s38, s38, s60
    s_lshl_b32 s54, s38, 10
    s_mul_i32 s38, s34, 5
    s_add_u32 s38, s38, 3
    s_mul_i32 s38, s38, 54
    s_add_u32 s38, s38, s60
    s_lshl_b32 s55, s38, 10
    s_mul_i32 s38, s34, 5
    s_add_u32 s38, s38, 4
    s_mul_i32 s38, s38, 54
    s_add_u32 s38, s38, s60
    s_lshl_b32 s56, s38, 10
    s_cmp_eq_u32 s32, 3
    s_cselect_b32 s57, 0, 1
    v_mfma_f32_16x16x32_bf16 v[0:3], a[188:191], a[72:75], v[0:3]
    ds_read_b64_tr_b16 a[160:161], v231 offset:7168
    v_mfma_f32_16x16x32_bf16 v[28:31], a[188:191], a[76:79], v[28:31]
    buffer_load_dwordx2 a[136:137], v234, s[12:15], s43 offen offset:1024
    v_mfma_f32_16x16x32_bf16 v[4:7], a[192:195], a[72:75], v[4:7]
    ds_read_b64_tr_b16 a[162:163], v231 offset:10752
    v_mfma_f32_16x16x32_bf16 v[32:35], a[192:195], a[76:79], v[32:35]
    ds_read_b64_tr_b16 a[164:165], v231 offset:7200
    v_mfma_f32_16x16x32_bf16 v[8:11], a[196:199], a[72:75], v[8:11]
    buffer_load_dwordx2 a[138:139], v234, s[12:15], s43 offen offset:1536
    v_mfma_f32_16x16x32_bf16 v[36:39], a[196:199], a[76:79], v[36:39]
    ds_read_b64_tr_b16 a[166:167], v231 offset:10784
    v_mfma_f32_16x16x32_bf16 v[12:15], a[200:203], a[72:75], v[12:15]
    ds_read_b64_tr_b16 a[168:169], v231 offset:7232
    v_mfma_f32_16x16x32_bf16 v[40:43], a[200:203], a[76:79], v[40:43]
    buffer_load_dwordx2 a[140:141], v235, s[12:15], s43 offen offset:1024
    v_mfma_f32_16x16x32_bf16 v[16:19], a[204:207], a[72:75], v[16:19]
    ds_read_b64_tr_b16 a[170:171], v231 offset:10816
    v_mfma_f32_16x16x32_bf16 v[44:47], a[204:207], a[76:79], v[44:47]
    ds_read_b64_tr_b16 a[172:173], v231 offset:7264
    v_mfma_f32_16x16x32_bf16 v[20:23], a[208:211], a[72:75], v[20:23]
    buffer_load_dwordx2 a[142:143], v235, s[12:15], s43 offen offset:1536
    v_mfma_f32_16x16x32_bf16 v[48:51], a[208:211], a[76:79], v[48:51]
    ds_read_b64_tr_b16 a[174:175], v231 offset:10848
    v_mfma_f32_16x16x32_bf16 v[24:27], a[212:215], a[72:75], v[24:27]
    ds_read_b64_tr_b16 a[176:177], v231 offset:7296
    v_mfma_f32_16x16x32_bf16 v[52:55], a[212:215], a[76:79], v[52:55]
    ds_read_b64_tr_b16 a[178:179], v231 offset:10880
    ds_read_b64_tr_b16 a[180:181], v231 offset:7328
    ds_read_b64_tr_b16 a[182:183], v231 offset:10912
    ds_read_b64_tr_b16 a[184:185], v231 offset:7360
    ds_read_b64_tr_b16 a[186:187], v231 offset:10944
    s_waitcnt vmcnt(18)
    s_waitcnt lgkmcnt(0)
    s_barrier
    v_mfma_f32_16x16x32_bf16 v[0:3], a[160:163], a[80:83], v[0:3]
    ds_read_b64_tr_b16 a[188:189], v231 offset:14336
    v_mfma_f32_16x16x32_bf16 v[28:31], a[160:163], a[84:87], v[28:31]
    buffer_load_dwordx4 a[144:147], v240, s[12:15], s43 offen offset:2048
    v_mfma_f32_16x16x32_bf16 v[4:7], a[164:167], a[80:83], v[4:7]
    ds_read_b64_tr_b16 a[190:191], v231 offset:17920
    s_add_u32 m0, s61, 0
    s_add_u32 s58, s52, 6144
    buffer_load_dwordx4 v227, s[48:51], s58 offen lds
    v_mfma_f32_16x16x32_bf16 v[32:35], a[164:167], a[84:87], v[32:35]
    ds_read_b64_tr_b16 a[192:193], v231 offset:14368
    v_mfma_f32_16x16x32_bf16 v[8:11], a[168:171], a[80:83], v[8:11]
    buffer_load_dwordx4 a[148:151], v241, s[12:15], s43 offen offset:2048
    v_mfma_f32_16x16x32_bf16 v[36:39], a[168:171], a[84:87], v[36:39]
    ds_read_b64_tr_b16 a[194:195], v231 offset:17952
    s_add_u32 m0, s61, 1024
    s_add_u32 s58, s53, 6144
    buffer_load_dwordx4 v227, s[48:51], s58 offen lds
    v_mfma_f32_16x16x32_bf16 v[12:15], a[172:175], a[80:83], v[12:15]
    ds_read_b64_tr_b16 a[196:197], v231 offset:14400
    v_mfma_f32_16x16x32_bf16 v[40:43], a[172:175], a[84:87], v[40:43]
    ds_read_b64_tr_b16 a[198:199], v231 offset:17984
    v_mfma_f32_16x16x32_bf16 v[16:19], a[176:179], a[80:83], v[16:19]
    ds_read_b64_tr_b16 a[200:201], v231 offset:14432
    s_add_u32 m0, s61, 2048
    s_add_u32 s58, s54, 6144
    buffer_load_dwordx4 v227, s[48:51], s58 offen lds
    v_mfma_f32_16x16x32_bf16 v[44:47], a[176:179], a[84:87], v[44:47]
    ds_read_b64_tr_b16 a[202:203], v231 offset:18016
    v_mfma_f32_16x16x32_bf16 v[20:23], a[180:183], a[80:83], v[20:23]
    ds_read_b64_tr_b16 a[204:205], v231 offset:14464
    v_mfma_f32_16x16x32_bf16 v[48:51], a[180:183], a[84:87], v[48:51]
    ds_read_b64_tr_b16 a[206:207], v231 offset:18048
    s_add_u32 m0, s61, 3072
    s_add_u32 s58, s55, 6144
    buffer_load_dwordx4 v227, s[48:51], s58 offen lds
    v_mfma_f32_16x16x32_bf16 v[24:27], a[184:187], a[80:83], v[24:27]
    ds_read_b64_tr_b16 a[208:209], v231 offset:14496
    v_mfma_f32_16x16x32_bf16 v[52:55], a[184:187], a[84:87], v[52:55]
    ds_read_b64_tr_b16 a[210:211], v231 offset:18080
    ds_read_b64_tr_b16 a[212:213], v231 offset:14528
    ds_read_b64_tr_b16 a[214:215], v231 offset:18112
    s_waitcnt vmcnt(22)
    s_waitcnt lgkmcnt(0)
    v_mfma_f32_16x16x32_bf16 v[0:3], a[188:191], a[88:91], v[0:3]
    ds_read_b64_tr_b16 a[160:161], v231 offset:21504
    v_mfma_f32_16x16x32_bf16 v[28:31], a[188:191], a[92:95], v[28:31]
    buffer_load_dwordx4 a[152:155], v240, s[12:15], s43 offen offset:3072
    v_mfma_f32_16x16x32_bf16 v[4:7], a[192:195], a[88:91], v[4:7]
    ds_read_b64_tr_b16 a[162:163], v231 offset:25088
    s_add_u32 m0, s61, 4096
    s_add_u32 s58, s56, 6144
    buffer_load_dwordx4 v227, s[48:51], s58 offen lds
    v_mfma_f32_16x16x32_bf16 v[32:35], a[192:195], a[92:95], v[32:35]
    ds_read_b64_tr_b16 a[164:165], v231 offset:21536
    v_mfma_f32_16x16x32_bf16 v[8:11], a[196:199], a[88:91], v[8:11]
    buffer_load_dwordx4 a[156:159], v241, s[12:15], s43 offen offset:3072
    v_mfma_f32_16x16x32_bf16 v[36:39], a[196:199], a[92:95], v[36:39]
    ds_read_b64_tr_b16 a[166:167], v231 offset:25120
    s_add_u32 m0, s61, 20480
    s_add_u32 s58, s52, 7168
    buffer_load_dwordx4 v227, s[48:51], s58 offen lds
    v_mfma_f32_16x16x32_bf16 v[12:15], a[200:203], a[88:91], v[12:15]
    ds_read_b64_tr_b16 a[168:169], v231 offset:21568
    v_mfma_f32_16x16x32_bf16 v[40:43], a[200:203], a[92:95], v[40:43]
    ds_read_b64_tr_b16 a[170:171], v231 offset:25152
    v_mfma_f32_16x16x32_bf16 v[16:19], a[204:207], a[88:91], v[16:19]
    ds_read_b64_tr_b16 a[172:173], v231 offset:21600
    s_add_u32 m0, s61, 21504
    s_add_u32 s58, s53, 7168
    buffer_load_dwordx4 v227, s[48:51], s58 offen lds
    v_mfma_f32_16x16x32_bf16 v[44:47], a[204:207], a[92:95], v[44:47]
    ds_read_b64_tr_b16 a[174:175], v231 offset:25184
    v_mfma_f32_16x16x32_bf16 v[20:23], a[208:211], a[88:91], v[20:23]
    ds_read_b64_tr_b16 a[176:177], v231 offset:21632
    v_mfma_f32_16x16x32_bf16 v[48:51], a[208:211], a[92:95], v[48:51]
    ds_read_b64_tr_b16 a[178:179], v231 offset:25216
    s_add_u32 m0, s61, 22528
    s_add_u32 s58, s54, 7168
    buffer_load_dwordx4 v227, s[48:51], s58 offen lds
    v_mfma_f32_16x16x32_bf16 v[24:27], a[212:215], a[88:91], v[24:27]
    ds_read_b64_tr_b16 a[180:181], v231 offset:21664
    v_mfma_f32_16x16x32_bf16 v[52:55], a[212:215], a[92:95], v[52:55]
    ds_read_b64_tr_b16 a[182:183], v231 offset:25248
    ds_read_b64_tr_b16 a[184:185], v231 offset:21696
    ds_read_b64_tr_b16 a[186:187], v231 offset:25280
    s_waitcnt vmcnt(24)
    s_waitcnt lgkmcnt(0)
    v_mfma_f32_16x16x32_bf16 v[0:3], a[160:163], a[96:99], v[0:3]
    ds_read_b64_tr_b16 a[188:189], v231 offset:28672
    v_mfma_f32_16x16x32_bf16 v[28:31], a[160:163], a[100:103], v[28:31]
    ds_read_b64_tr_b16 a[190:191], v231 offset:32256
    v_mfma_f32_16x16x32_bf16 v[4:7], a[164:167], a[96:99], v[4:7]
    ds_read_b64_tr_b16 a[192:193], v231 offset:28704
    s_add_u32 m0, s61, 23552
    s_add_u32 s58, s55, 7168
    buffer_load_dwordx4 v227, s[48:51], s58 offen lds
    v_mfma_f32_16x16x32_bf16 v[32:35], a[164:167], a[100:103], v[32:35]
    ds_read_b64_tr_b16 a[194:195], v231 offset:32288
    v_mfma_f32_16x16x32_bf16 v[8:11], a[168:171], a[96:99], v[8:11]
    ds_read_b64_tr_b16 a[196:197], v231 offset:28736
    v_mfma_f32_16x16x32_bf16 v[36:39], a[168:171], a[100:103], v[36:39]
    ds_read_b64_tr_b16 a[198:199], v231 offset:32320
    s_add_u32 m0, s61, 24576
    s_add_u32 s58, s56, 7168
    buffer_load_dwordx4 v227, s[48:51], s58 offen lds
    v_mfma_f32_16x16x32_bf16 v[12:15], a[172:175], a[96:99], v[12:15]
    ds_read_b64_tr_b16 a[200:201], v231 offset:28768
    v_mfma_f32_16x16x32_bf16 v[40:43], a[172:175], a[100:103], v[40:43]
    ds_read_b64_tr_b16 a[202:203], v231 offset:32352
    v_mfma_f32_16x16x32_bf16 v[16:19], a[176:179], a[96:99], v[16:19]
    ds_read_b64_tr_b16 a[204:205], v231 offset:28800
    s_add_u32 m0, s61, 40960
    s_add_u32 s58, s52, 8192
    buffer_load_dwordx4 v227, s[48:51], s58 offen lds
    v_mfma_f32_16x16x32_bf16 v[44:47], a[176:179], a[100:103], v[44:47]
    ds_read_b64_tr_b16 a[206:207], v231 offset:32384
    v_mfma_f32_16x16x32_bf16 v[20:23], a[180:183], a[96:99], v[20:23]
    ds_read_b64_tr_b16 a[208:209], v231 offset:28832
    v_mfma_f32_16x16x32_bf16 v[48:51], a[180:183], a[100:103], v[48:51]
    ds_read_b64_tr_b16 a[210:211], v231 offset:32416
    s_add_u32 m0, s61, 41984
    s_add_u32 s58, s53, 8192
    buffer_load_dwordx4 v227, s[48:51], s58 offen lds
    v_mfma_f32_16x16x32_bf16 v[24:27], a[184:187], a[96:99], v[24:27]
    ds_read_b64_tr_b16 a[212:213], v231 offset:28864
    v_mfma_f32_16x16x32_bf16 v[52:55], a[184:187], a[100:103], v[52:55]
    ds_read_b64_tr_b16 a[214:215], v231 offset:32448
    s_waitcnt vmcnt(26)
    s_waitcnt lgkmcnt(0)
    s_barrier
    v_mfma_f32_16x16x32_bf16 v[0:3], a[188:191], a[104:107], v[0:3]
    ds_read_b64_tr_b16 a[160:161], v231 offset:35840
    v_mfma_f32_16x16x32_bf16 v[28:31], a[188:191], a[108:111], v[28:31]
    ds_read_b64_tr_b16 a[162:163], v231 offset:39424
    v_mfma_f32_16x16x32_bf16 v[4:7], a[192:195], a[104:107], v[4:7]
    ds_read_b64_tr_b16 a[164:165], v231 offset:35872
    s_add_u32 m0, s61, 43008
    s_add_u32 s58, s54, 8192
    buffer_load_dwordx4 v227, s[48:51], s58 offen lds
    v_mfma_f32_16x16x32_bf16 v[32:35], a[192:195], a[108:111], v[32:35]
    ds_read_b64_tr_b16 a[166:167], v231 offset:39456
    v_mfma_f32_16x16x32_bf16 v[8:11], a[196:199], a[104:107], v[8:11]
    ds_read_b64_tr_b16 a[168:169], v231 offset:35904
    v_mfma_f32_16x16x32_bf16 v[36:39], a[196:199], a[108:111], v[36:39]
    ds_read_b64_tr_b16 a[170:171], v231 offset:39488
    s_add_u32 m0, s61, 44032
    s_add_u32 s58, s55, 8192
    buffer_load_dwordx4 v227, s[48:51], s58 offen lds
    v_mfma_f32_16x16x32_bf16 v[12:15], a[200:203], a[104:107], v[12:15]
    ds_read_b64_tr_b16 a[172:173], v231 offset:35936
    v_mfma_f32_16x16x32_bf16 v[40:43], a[200:203], a[108:111], v[40:43]
    ds_read_b64_tr_b16 a[174:175], v231 offset:39520
    v_mfma_f32_16x16x32_bf16 v[16:19], a[204:207], a[104:107], v[16:19]
    ds_read_b64_tr_b16 a[176:177], v231 offset:35968
    s_add_u32 m0, s61, 45056
    s_add_u32 s58, s56, 8192
    buffer_load_dwordx4 v227, s[48:51], s58 offen lds
    v_mfma_f32_16x16x32_bf16 v[44:47], a[204:207], a[108:111], v[44:47]
    ds_read_b64_tr_b16 a[178:179], v231 offset:39552
    v_mfma_f32_16x16x32_bf16 v[20:23], a[208:211], a[104:107], v[20:23]
    ds_read_b64_tr_b16 a[180:181], v231 offset:36000
    v_mfma_f32_16x16x32_bf16 v[48:51], a[208:211], a[108:111], v[48:51]
    ds_read_b64_tr_b16 a[182:183], v231 offset:39584
    s_add_u32 m0, s61, 61440
    s_add_u32 s58, s52, 9216
    buffer_load_dwordx4 v227, s[48:51], s58 offen lds
    v_mfma_f32_16x16x32_bf16 v[24:27], a[212:215], a[104:107], v[24:27]
    ds_read_b64_tr_b16 a[184:185], v231 offset:36032
    v_mfma_f32_16x16x32_bf16 v[52:55], a[212:215], a[108:111], v[52:55]
    ds_read_b64_tr_b16 a[186:187], v231 offset:39616
    s_waitcnt vmcnt(28)
    s_waitcnt lgkmcnt(0)
    v_mfma_f32_16x16x32_bf16 v[0:3], a[160:163], a[112:115], v[0:3]
    ds_read_b64_tr_b16 a[188:189], v231 offset:43008
    v_mfma_f32_16x16x32_bf16 v[28:31], a[160:163], a[116:119], v[28:31]
    ds_read_b64_tr_b16 a[190:191], v231 offset:46592
    v_mfma_f32_16x16x32_bf16 v[4:7], a[164:167], a[112:115], v[4:7]
    ds_read_b64_tr_b16 a[192:193], v231 offset:43040
    s_add_u32 m0, s61, 62464
    s_add_u32 s58, s53, 9216
    buffer_load_dwordx4 v227, s[48:51], s58 offen lds
    v_mfma_f32_16x16x32_bf16 v[32:35], a[164:167], a[116:119], v[32:35]
    ds_read_b64_tr_b16 a[194:195], v231 offset:46624
    v_mfma_f32_16x16x32_bf16 v[8:11], a[168:171], a[112:115], v[8:11]
    ds_read_b64_tr_b16 a[196:197], v231 offset:43072
    v_mfma_f32_16x16x32_bf16 v[36:39], a[168:171], a[116:119], v[36:39]
    ds_read_b64_tr_b16 a[198:199], v231 offset:46656
    s_add_u32 m0, s61, 63488
    s_add_u32 s58, s54, 9216
    buffer_load_dwordx4 v227, s[48:51], s58 offen lds
    v_mfma_f32_16x16x32_bf16 v[12:15], a[172:175], a[112:115], v[12:15]
    ds_read_b64_tr_b16 a[200:201], v231 offset:43104
    v_mfma_f32_16x16x32_bf16 v[40:43], a[172:175], a[116:119], v[40:43]
    ds_read_b64_tr_b16 a[202:203], v231 offset:46688
    v_mfma_f32_16x16x32_bf16 v[16:19], a[176:179], a[112:115], v[16:19]
    ds_read_b64_tr_b16 a[204:205], v231 offset:43136
    s_add_u32 m0, s61, 64512
    s_add_u32 s58, s55, 9216
    buffer_load_dwordx4 v227, s[48:51], s58 offen lds
    v_mfma_f32_16x16x32_bf16 v[44:47], a[176:179], a[116:119], v[44:47]
    ds_read_b64_tr_b16 a[206:207], v231 offset:46720
    v_mfma_f32_16x16x32_bf16 v[20:23], a[180:183], a[112:115], v[20:23]
    ds_read_b64_tr_b16 a[208:209], v231 offset:43168
    v_mfma_f32_16x16x32_bf16 v[48:51], a[180:183], a[116:119], v[48:51]
    ds_read_b64_tr_b16 a[210:211], v231 offset:46752
    s_add_u32 m0, s61, 65536
    s_add_u32 s58, s56, 9216
    buffer_load_dwordx4 v227, s[48:51], s58 offen lds
    v_mfma_f32_16x16x32_bf16 v[24:27], a[184:187], a[112:115], v[24:27]
    ds_read_b64_tr_b16 a[212:213], v231 offset:43200
    v_mfma_f32_16x16x32_bf16 v[52:55], a[184:187], a[116:119], v[52:55]
    ds_read_b64_tr_b16 a[214:215], v231 offset:46784
    s_waitcnt vmcnt(30)
    s_waitcnt lgkmcnt(0)
    v_mfma_f32_16x16x32_bf16 v[0:3], a[188:191], a[120:123], v[0:3]
    ds_read_b64_tr_b16 a[160:161], v231 offset:50176
    v_mfma_f32_16x16x32_bf16 v[28:31], a[188:191], a[124:127], v[28:31]
    ds_read_b64_tr_b16 a[162:163], v231 offset:53760
    v_mfma_f32_16x16x32_bf16 v[4:7], a[192:195], a[120:123], v[4:7]
    ds_read_b64_tr_b16 a[164:165], v231 offset:50208
    v_mfma_f32_16x16x32_bf16 v[32:35], a[192:195], a[124:127], v[32:35]
    ds_read_b64_tr_b16 a[166:167], v231 offset:53792
    v_mfma_f32_16x16x32_bf16 v[8:11], a[196:199], a[120:123], v[8:11]
    ds_read_b64_tr_b16 a[168:169], v231 offset:50240
    v_mfma_f32_16x16x32_bf16 v[36:39], a[196:199], a[124:127], v[36:39]
    ds_read_b64_tr_b16 a[170:171], v231 offset:53824
    v_mfma_f32_16x16x32_bf16 v[12:15], a[200:203], a[120:123], v[12:15]
    ds_read_b64_tr_b16 a[172:173], v231 offset:50272
    v_mfma_f32_16x16x32_bf16 v[40:43], a[200:203], a[124:127], v[40:43]
    ds_read_b64_tr_b16 a[174:175], v231 offset:53856
    v_mfma_f32_16x16x32_bf16 v[16:19], a[204:207], a[120:123], v[16:19]
    ds_read_b64_tr_b16 a[176:177], v231 offset:50304
    v_mfma_f32_16x16x32_bf16 v[44:47], a[204:207], a[124:127], v[44:47]
    ds_read_b64_tr_b16 a[178:179], v231 offset:53888
    v_mfma_f32_16x16x32_bf16 v[20:23], a[208:211], a[120:123], v[20:23]
    ds_read_b64_tr_b16 a[180:181], v231 offset:50336
    v_mfma_f32_16x16x32_bf16 v[48:51], a[208:211], a[124:127], v[48:51]
    ds_read_b64_tr_b16 a[182:183], v231 offset:53920
    v_mfma_f32_16x16x32_bf16 v[24:27], a[212:215], a[120:123], v[24:27]
    ds_read_b64_tr_b16 a[184:185], v231 offset:50368
    v_mfma_f32_16x16x32_bf16 v[52:55], a[212:215], a[124:127], v[52:55]
    ds_read_b64_tr_b16 a[186:187], v231 offset:53952
    s_waitcnt vmcnt(28)
    s_waitcnt lgkmcnt(0)
    s_barrier
    v_mfma_f32_16x16x32_bf16 v[0:3], a[160:163], a[128:131], v[0:3]
    ds_read_b64_tr_b16 a[188:189], v231 offset:57344
    v_mfma_f32_16x16x32_bf16 v[28:31], a[160:163], a[132:135], v[28:31]
    ds_read_b64_tr_b16 a[190:191], v231 offset:60928
    v_mfma_f32_16x16x32_bf16 v[4:7], a[164:167], a[128:131], v[4:7]
    ds_read_b64_tr_b16 a[192:193], v231 offset:57376
    s_add_u32 m0, s61, 81920
    s_add_u32 s58, s52, 10240
    buffer_load_dwordx4 v227, s[48:51], s58 offen lds
    v_mfma_f32_16x16x32_bf16 v[32:35], a[164:167], a[132:135], v[32:35]
    ds_read_b64_tr_b16 a[194:195], v231 offset:60960
    v_mfma_f32_16x16x32_bf16 v[8:11], a[168:171], a[128:131], v[8:11]
    ds_read_b64_tr_b16 a[196:197], v231 offset:57408
    v_mfma_f32_16x16x32_bf16 v[36:39], a[168:171], a[132:135], v[36:39]
    ds_read_b64_tr_b16 a[198:199], v231 offset:60992
    s_add_u32 m0, s61, 82944
    s_add_u32 s58, s53, 10240
    buffer_load_dwordx4 v227, s[48:51], s58 offen lds
    v_mfma_f32_16x16x32_bf16 v[12:15], a[172:175], a[128:131], v[12:15]
    ds_read_b64_tr_b16 a[200:201], v231 offset:57440
    v_mfma_f32_16x16x32_bf16 v[40:43], a[172:175], a[132:135], v[40:43]
    ds_read_b64_tr_b16 a[202:203], v231 offset:61024
    v_mfma_f32_16x16x32_bf16 v[16:19], a[176:179], a[128:131], v[16:19]
    ds_read_b64_tr_b16 a[204:205], v231 offset:57472
    s_add_u32 m0, s61, 83968
    s_add_u32 s58, s54, 10240
    buffer_load_dwordx4 v227, s[48:51], s58 offen lds
    v_mfma_f32_16x16x32_bf16 v[44:47], a[176:179], a[132:135], v[44:47]
    ds_read_b64_tr_b16 a[206:207], v231 offset:61056
    v_mfma_f32_16x16x32_bf16 v[20:23], a[180:183], a[128:131], v[20:23]
    ds_read_b64_tr_b16 a[208:209], v231 offset:57504
    v_mfma_f32_16x16x32_bf16 v[48:51], a[180:183], a[132:135], v[48:51]
    ds_read_b64_tr_b16 a[210:211], v231 offset:61088
    s_add_u32 m0, s61, 84992
    s_add_u32 s58, s55, 10240
    buffer_load_dwordx4 v227, s[48:51], s58 offen lds
    v_mfma_f32_16x16x32_bf16 v[24:27], a[184:187], a[128:131], v[24:27]
    ds_read_b64_tr_b16 a[212:213], v231 offset:57536
    v_mfma_f32_16x16x32_bf16 v[52:55], a[184:187], a[132:135], v[52:55]
    ds_read_b64_tr_b16 a[214:215], v231 offset:61120
    s_waitcnt vmcnt(28)
    s_waitcnt lgkmcnt(0)
    v_mfma_f32_16x16x32_bf16 v[0:3], a[188:191], a[136:139], v[0:3]
    ds_read_b64_tr_b16 a[160:161], v232 offset:0
    v_mfma_f32_16x16x32_bf16 v[28:31], a[188:191], a[140:143], v[28:31]
    ds_read_b64_tr_b16 a[162:163], v232 offset:3584
    v_mfma_f32_16x16x32_bf16 v[4:7], a[192:195], a[136:139], v[4:7]
    ds_read_b64_tr_b16 a[164:165], v232 offset:32
    s_add_u32 m0, s61, 86016
    s_add_u32 s58, s56, 10240
    buffer_load_dwordx4 v227, s[48:51], s58 offen lds
    v_mfma_f32_16x16x32_bf16 v[32:35], a[192:195], a[140:143], v[32:35]
    ds_read_b64_tr_b16 a[166:167], v232 offset:3616
    v_mfma_f32_16x16x32_bf16 v[8:11], a[196:199], a[136:139], v[8:11]
    ds_read_b64_tr_b16 a[168:169], v232 offset:64
    v_mfma_f32_16x16x32_bf16 v[36:39], a[196:199], a[140:143], v[36:39]
    ds_read_b64_tr_b16 a[170:171], v232 offset:3648
    v_mfma_f32_16x16x32_bf16 v[12:15], a[200:203], a[136:139], v[12:15]
    ds_read_b64_tr_b16 a[172:173], v232 offset:96
    v_mfma_f32_16x16x32_bf16 v[40:43], a[200:203], a[140:143], v[40:43]
    ds_read_b64_tr_b16 a[174:175], v232 offset:3680
    v_mfma_f32_16x16x32_bf16 v[16:19], a[204:207], a[136:139], v[16:19]
    ds_read_b64_tr_b16 a[176:177], v232 offset:128
    v_mfma_f32_16x16x32_bf16 v[44:47], a[204:207], a[140:143], v[44:47]
    ds_read_b64_tr_b16 a[178:179], v232 offset:3712
    v_mfma_f32_16x16x32_bf16 v[20:23], a[208:211], a[136:139], v[20:23]
    ds_read_b64_tr_b16 a[180:181], v232 offset:160
    v_mfma_f32_16x16x32_bf16 v[48:51], a[208:211], a[140:143], v[48:51]
    ds_read_b64_tr_b16 a[182:183], v232 offset:3744
    v_mfma_f32_16x16x32_bf16 v[24:27], a[212:215], a[136:139], v[24:27]
    ds_read_b64_tr_b16 a[184:185], v232 offset:192
    v_mfma_f32_16x16x32_bf16 v[52:55], a[212:215], a[140:143], v[52:55]
    ds_read_b64_tr_b16 a[186:187], v232 offset:3776
    s_waitcnt vmcnt(26)
    s_waitcnt lgkmcnt(0)
    v_mfma_f32_16x16x32_bf16 v[0:3], a[160:163], a[144:147], v[0:3]
    ds_read_b64_tr_b16 a[188:189], v232 offset:7168
    v_mfma_f32_16x16x32_bf16 v[28:31], a[160:163], a[148:151], v[28:31]
    ds_read_b64_tr_b16 a[190:191], v232 offset:10752
    v_mfma_f32_16x16x32_bf16 v[4:7], a[164:167], a[144:147], v[4:7]
    ds_read_b64_tr_b16 a[192:193], v232 offset:7200
    v_mfma_f32_16x16x32_bf16 v[32:35], a[164:167], a[148:151], v[32:35]
    ds_read_b64_tr_b16 a[194:195], v232 offset:10784
    v_mfma_f32_16x16x32_bf16 v[8:11], a[168:171], a[144:147], v[8:11]
    ds_read_b64_tr_b16 a[196:197], v232 offset:7232
    v_mfma_f32_16x16x32_bf16 v[36:39], a[168:171], a[148:151], v[36:39]
    ds_read_b64_tr_b16 a[198:199], v232 offset:10816
    v_mfma_f32_16x16x32_bf16 v[12:15], a[172:175], a[144:147], v[12:15]
    ds_read_b64_tr_b16 a[200:201], v232 offset:7264
    v_mfma_f32_16x16x32_bf16 v[40:43], a[172:175], a[148:151], v[40:43]
    ds_read_b64_tr_b16 a[202:203], v232 offset:10848
    v_mfma_f32_16x16x32_bf16 v[16:19], a[176:179], a[144:147], v[16:19]
    ds_read_b64_tr_b16 a[204:205], v232 offset:7296
    v_mfma_f32_16x16x32_bf16 v[44:47], a[176:179], a[148:151], v[44:47]
    ds_read_b64_tr_b16 a[206:207], v232 offset:10880
    v_mfma_f32_16x16x32_bf16 v[20:23], a[180:183], a[144:147], v[20:23]
    ds_read_b64_tr_b16 a[208:209], v232 offset:7328
    v_mfma_f32_16x16x32_bf16 v[48:51], a[180:183], a[148:151], v[48:51]
    ds_read_b64_tr_b16 a[210:211], v232 offset:10912
    v_mfma_f32_16x16x32_bf16 v[24:27], a[184:187], a[144:147], v[24:27]
    ds_read_b64_tr_b16 a[212:213], v232 offset:7360
    v_mfma_f32_16x16x32_bf16 v[52:55], a[184:187], a[148:151], v[52:55]
    ds_read_b64_tr_b16 a[214:215], v232 offset:10944
    s_waitcnt vmcnt(20)
    s_waitcnt lgkmcnt(0)
    s_barrier
    v_mfma_f32_16x16x32_bf16 v[0:3], a[188:191], a[152:155], v[0:3]
    v_mfma_f32_16x16x32_bf16 v[28:31], a[188:191], a[156:159], v[28:31]
    v_mfma_f32_16x16x32_bf16 v[4:7], a[192:195], a[152:155], v[4:7]
    s_add_u32 m0, s61, 102400
    s_add_u32 s58, s52, 11264
    buffer_load_dwordx4 v227, s[48:51], s58 offen lds
    v_mfma_f32_16x16x32_bf16 v[32:35], a[192:195], a[156:159], v[32:35]
    v_mfma_f32_16x16x32_bf16 v[8:11], a[196:199], a[152:155], v[8:11]
    v_mfma_f32_16x16x32_bf16 v[36:39], a[196:199], a[156:159], v[36:39]
    s_add_u32 m0, s61, 103424
    s_add_u32 s58, s53, 11264
    buffer_load_dwordx4 v227, s[48:51], s58 offen lds
    v_mfma_f32_16x16x32_bf16 v[12:15], a[200:203], a[152:155], v[12:15]
    v_mfma_f32_16x16x32_bf16 v[40:43], a[200:203], a[156:159], v[40:43]
    v_mfma_f32_16x16x32_bf16 v[16:19], a[204:207], a[152:155], v[16:19]
    s_add_u32 m0, s61, 104448
    s_add_u32 s58, s54, 11264
    buffer_load_dwordx4 v227, s[48:51], s58 offen lds
    v_mfma_f32_16x16x32_bf16 v[44:47], a[204:207], a[156:159], v[44:47]
    v_mfma_f32_16x16x32_bf16 v[20:23], a[208:211], a[152:155], v[20:23]
    v_mfma_f32_16x16x32_bf16 v[48:51], a[208:211], a[156:159], v[48:51]
    s_add_u32 m0, s61, 105472
    s_add_u32 s58, s55, 11264
    buffer_load_dwordx4 v227, s[48:51], s58 offen lds
    v_mfma_f32_16x16x32_bf16 v[24:27], a[212:215], a[152:155], v[24:27]
    v_mfma_f32_16x16x32_bf16 v[52:55], a[212:215], a[156:159], v[52:55]
    s_waitcnt lgkmcnt(0)
    s_barrier
    v_add_f32 v78, v100, v102
    v_mov_b32 v80, v78
    s_nop 1
    v_permlane16_swap_b32 v80, v78
    v_add_f32 v78, v78, v80
    v_mov_b32 v80, v78
    s_nop 1
    v_permlane32_swap_b32 v80, v78
    v_add_f32 v78, v78, v80
    v_mul_f32 v78, 0x3e000000, v78
    v_add_f32 v79, v101, v103
    v_sub_f32 v80, v100, v78
    v_mul_f32 v80, v80, v80
    v_fmac_f32 v79, 0x42a00000, v80
    v_sub_f32 v80, v102, v78
    v_mul_f32 v80, v80, v80
    s_add_u32 m0, s61, 106496
    s_add_u32 s58, s56, 11264
    buffer_load_dwordx4 v227, s[48:51], s58 offen lds
    v_fmac_f32 v79, 0x42a00000, v80
    v_mov_b32 v80, v79
    s_nop 1
    v_permlane16_swap_b32 v80, v79
    v_add_f32 v79, v79, v80
    v_mov_b32 v80, v79
    s_nop 1
    v_permlane32_swap_b32 v80, v79
    v_add_f32 v79, v79, v80
    v_mov_b32 v80, 0x3727c5ac
    v_fmac_f32 v80, 0x3acccccd, v79
    v_rsq_f32 v80, v80
    s_nop 0
    v_mul_f32 v244, 0x3fb8aa3b, v80
    v_mul_f32 v245, v78, v80
    v_add_f32 v78, v104, v106
    v_mov_b32 v80, v78
    s_nop 1
    v_permlane16_swap_b32 v80, v78
    v_add_f32 v78, v78, v80
    s_add_u32 m0, s61, 122880
    s_mul_i32 s58, s57, 12288
    s_add_u32 s58, s58, s52
    buffer_load_dwordx4 v227, s[48:51], s58 offen lds
    v_mov_b32 v80, v78
    s_nop 1
    v_permlane32_swap_b32 v80, v78
    v_add_f32 v78, v78, v80
    v_mul_f32 v78, 0x3e000000, v78
    v_add_f32 v79, v105, v107
    v_sub_f32 v80, v104, v78
    v_mul_f32 v80, v80, v80
    v_fmac_f32 v79, 0x42a00000, v80
    v_sub_f32 v80, v106, v78
    v_mul_f32 v80, v80, v80
    v_fmac_f32 v79, 0x42a00000, v80
    v_mov_b32 v80, v79
    s_nop 1
    v_permlane16_swap_b32 v80, v79
    v_add_f32 v79, v79, v80
    s_add_u32 m0, s61, 123904
    s_mul_i32 s58, s57, 12288
    s_add_u32 s58, s58, s53
    buffer_load_dwordx4 v227, s[48:51], s58 offen lds
    v_mov_b32 v80, v79
    s_nop 1
    v_permlane32_swap_b32 v80, v79
    v_add_f32 v79, v79, v80
    v_mov_b32 v80, 0x3727c5ac
    v_fmac_f32 v80, 0x3acccccd, v79
    v_rsq_f32 v80, v80
    s_nop 0
    v_mul_f32 v246, 0x3fb8aa3b, v80
    v_mul_f32 v247, v78, v80
    v_mov_b32 v82, 1.0
    v_mov_b32 v83, 1.0
    v_pk_fma_f32 v[60:61], v[244:245], v[140:141], v[170:171] op_sel:[1,0,0] op_sel_hi:[1,1,1] neg_lo:[1,0,0] neg_hi:[1,0,0]
    v_pk_fma_f32 v[62:63], v[244:245], v[142:143], v[172:173] op_sel:[1,0,0] op_sel_hi:[1,1,1] neg_lo:[1,0,0] neg_hi:[1,0,0]
    v_pk_fma_f32 v[0:1], v[244:245], v[0:1], v[60:61] op_sel:[0,0,0] op_sel_hi:[0,1,1]
    v_pk_fma_f32 v[2:3], v[244:245], v[2:3], v[62:63] op_sel:[0,0,0] op_sel_hi:[0,1,1]
    s_add_u32 m0, s61, 124928
    s_mul_i32 s58, s57, 12288
    s_add_u32 s58, s58, s54
    buffer_load_dwordx4 v227, s[48:51], s58 offen lds
    v_exp_f32 v60, -v0
    v_exp_f32 v61, -v1
    v_exp_f32 v62, -v2
    v_exp_f32 v63, -v3
    v_pk_add_f32 v[60:61], v[60:61], v[82:83]
    v_pk_add_f32 v[62:63], v[62:63], v[82:83]
    v_rcp_f32 v60, v60
    v_rcp_f32 v61, v61
    v_rcp_f32 v62, v62
    v_rcp_f32 v63, v63
    v_pk_mul_f32 v[0:1], v[0:1], v[60:61]
    v_pk_mul_f32 v[2:3], v[2:3], v[62:63]
    v_cvt_pk_bf16_f32 v110, v0, v1
    v_cvt_pk_bf16_f32 v111, v2, v3
    v_pk_fma_f32 v[68:69], v[246:247], v[140:141], v[170:171] op_sel:[1,0,0] op_sel_hi:[1,1,1] neg_lo:[1,0,0] neg_hi:[1,0,0]
    v_pk_fma_f32 v[70:71], v[246:247], v[142:143], v[172:173] op_sel:[1,0,0] op_sel_hi:[1,1,1] neg_lo:[1,0,0] neg_hi:[1,0,0]
    v_pk_fma_f32 v[28:29], v[246:247], v[28:29], v[68:69] op_sel:[0,0,0] op_sel_hi:[0,1,1]
    v_pk_fma_f32 v[30:31], v[246:247], v[30:31], v[70:71] op_sel:[0,0,0] op_sel_hi:[0,1,1]
    v_exp_f32 v68, -v28
    v_exp_f32 v69, -v29
    v_exp_f32 v70, -v30
    v_exp_f32 v71, -v31
    v_pk_add_f32 v[68:69], v[68:69], v[82:83]
    v_pk_add_f32 v[70:71], v[70:71], v[82:83]
    s_add_u32 m0, s61, 125952
    s_mul_i32 s58, s57, 12288
    s_add_u32 s58, s58, s55
    buffer_load_dwordx4 v227, s[48:51], s58 offen lds
    v_rcp_f32 v68, v68
    v_rcp_f32 v69, v69
    v_rcp_f32 v70, v70
    v_rcp_f32 v71, v71
    v_pk_mul_f32 v[28:29], v[28:29], v[68:69]
    v_pk_mul_f32 v[30:31], v[30:31], v[70:71]
    v_cvt_pk_bf16_f32 v124, v28, v29
    v_cvt_pk_bf16_f32 v125, v30, v31
    v_pk_fma_f32 v[60:61], v[244:245], v[144:145], v[174:175] op_sel:[1,0,0] op_sel_hi:[1,1,1] neg_lo:[1,0,0] neg_hi:[1,0,0]
    v_pk_fma_f32 v[62:63], v[244:245], v[146:147], v[176:177] op_sel:[1,0,0] op_sel_hi:[1,1,1] neg_lo:[1,0,0] neg_hi:[1,0,0]
    v_pk_fma_f32 v[4:5], v[244:245], v[4:5], v[60:61] op_sel:[0,0,0] op_sel_hi:[0,1,1]
    v_pk_fma_f32 v[6:7], v[244:245], v[6:7], v[62:63] op_sel:[0,0,0] op_sel_hi:[0,1,1]
    v_exp_f32 v60, -v4
    v_exp_f32 v61, -v5
    v_exp_f32 v62, -v6
    v_exp_f32 v63, -v7
    v_pk_add_f32 v[60:61], v[60:61], v[82:83]
    v_pk_add_f32 v[62:63], v[62:63], v[82:83]
    v_rcp_f32 v60, v60
    v_rcp_f32 v61, v61
    v_rcp_f32 v62, v62
    v_rcp_f32 v63, v63
    v_pk_mul_f32 v[4:5], v[4:5], v[60:61]
    v_pk_mul_f32 v[6:7], v[6:7], v[62:63]
    s_add_u32 m0, s61, 126976
    s_mul_i32 s58, s57, 12288
    s_add_u32 s58, s58, s56
    buffer_load_dwordx4 v227, s[48:51], s58 offen lds
    v_cvt_pk_bf16_f32 v112, v4, v5
    v_cvt_pk_bf16_f32 v113, v6, v7
    v_pk_fma_f32 v[68:69], v[246:247], v[144:145], v[174:175] op_sel:[1,0,0] op_sel_hi:[1,1,1] neg_lo:[1,0,0] neg_hi:[1,0,0]
    v_pk_fma_f32 v[70:71], v[246:247], v[146:147], v[176:177] op_sel:[1,0,0] op_sel_hi:[1,1,1] neg_lo:[1,0,0] neg_hi:[1,0,0]
    v_pk_fma_f32 v[32:33], v[246:247], v[32:33], v[68:69] op_sel:[0,0,0] op_sel_hi:[0,1,1]
    v_pk_fma_f32 v[34:35], v[246:247], v[34:35], v[70:71] op_sel:[0,0,0] op_sel_hi:[0,1,1]
    v_exp_f32 v68, -v32
    v_exp_f32 v69, -v33
    v_exp_f32 v70, -v34
    v_exp_f32 v71, -v35
    v_pk_add_f32 v[68:69], v[68:69], v[82:83]
    v_pk_add_f32 v[70:71], v[70:71], v[82:83]
    v_rcp_f32 v68, v68
    v_rcp_f32 v69, v69
    v_rcp_f32 v70, v70
    v_rcp_f32 v71, v71
    v_pk_mul_f32 v[32:33], v[32:33], v[68:69]
    v_pk_mul_f32 v[34:35], v[34:35], v[70:71]
    v_cvt_pk_bf16_f32 v126, v32, v33
    v_cvt_pk_bf16_f32 v127, v34, v35
    s_add_u32 m0, s61, 143360
    s_mul_i32 s58, s57, 13312
    s_add_u32 s58, s58, s52
    buffer_load_dwordx4 v227, s[48:51], s58 offen lds
    v_pk_fma_f32 v[60:61], v[244:245], v[148:149], v[178:179] op_sel:[1,0,0] op_sel_hi:[1,1,1] neg_lo:[1,0,0] neg_hi:[1,0,0]
    v_pk_fma_f32 v[62:63], v[244:245], v[150:151], v[180:181] op_sel:[1,0,0] op_sel_hi:[1,1,1] neg_lo:[1,0,0] neg_hi:[1,0,0]
    v_pk_fma_f32 v[8:9], v[244:245], v[8:9], v[60:61] op_sel:[0,0,0] op_sel_hi:[0,1,1]
    v_pk_fma_f32 v[10:11], v[244:245], v[10:11], v[62:63] op_sel:[0,0,0] op_sel_hi:[0,1,1]
    v_exp_f32 v60, -v8
    v_exp_f32 v61, -v9
    v_exp_f32 v62, -v10
    v_exp_f32 v63, -v11
    v_pk_add_f32 v[60:61], v[60:61], v[82:83]
    v_pk_add_f32 v[62:63], v[62:63], v[82:83]
    v_rcp_f32 v60, v60
    v_rcp_f32 v61, v61
    v_rcp_f32 v62, v62
    v_rcp_f32 v63, v63
    v_pk_mul_f32 v[8:9], v[8:9], v[60:61]
    v_pk_mul_f32 v[10:11], v[10:11], v[62:63]
    v_cvt_pk_bf16_f32 v114, v8, v9
    v_cvt_pk_bf16_f32 v115, v10, v11
    v_pk_fma_f32 v[68:69], v[246:247], v[148:149], v[178:179] op_sel:[1,0,0] op_sel_hi:[1,1,1] neg_lo:[1,0,0] neg_hi:[1,0,0]
    v_pk_fma_f32 v[70:71], v[246:247], v[150:151], v[180:181] op_sel:[1,0,0] op_sel_hi:[1,1,1] neg_lo:[1,0,0] neg_hi:[1,0,0]
    s_add_u32 m0, s61, 144384
    s_mul_i32 s58, s57, 13312
    s_add_u32 s58, s58, s53
    buffer_load_dwordx4 v227, s[48:51], s58 offen lds
    v_pk_fma_f32 v[36:37], v[246:247], v[36:37], v[68:69] op_sel:[0,0,0] op_sel_hi:[0,1,1]
    v_pk_fma_f32 v[38:39], v[246:247], v[38:39], v[70:71] op_sel:[0,0,0] op_sel_hi:[0,1,1]
    v_exp_f32 v68, -v36
    v_exp_f32 v69, -v37
    v_exp_f32 v70, -v38
    v_exp_f32 v71, -v39
    v_pk_add_f32 v[68:69], v[68:69], v[82:83]
    v_pk_add_f32 v[70:71], v[70:71], v[82:83]
    v_rcp_f32 v68, v68
    v_rcp_f32 v69, v69
    v_rcp_f32 v70, v70
    v_rcp_f32 v71, v71
    v_pk_mul_f32 v[36:37], v[36:37], v[68:69]
    v_pk_mul_f32 v[38:39], v[38:39], v[70:71]
    v_cvt_pk_bf16_f32 v128, v36, v37
    v_cvt_pk_bf16_f32 v129, v38, v39
    v_pk_fma_f32 v[60:61], v[244:245], v[152:153], v[182:183] op_sel:[1,0,0] op_sel_hi:[1,1,1] neg_lo:[1,0,0] neg_hi:[1,0,0]
    v_pk_fma_f32 v[62:63], v[244:245], v[154:155], v[184:185] op_sel:[1,0,0] op_sel_hi:[1,1,1] neg_lo:[1,0,0] neg_hi:[1,0,0]
    v_pk_fma_f32 v[12:13], v[244:245], v[12:13], v[60:61] op_sel:[0,0,0] op_sel_hi:[0,1,1]
    v_pk_fma_f32 v[14:15], v[244:245], v[14:15], v[62:63] op_sel:[0,0,0] op_sel_hi:[0,1,1]
    s_add_u32 m0, s61, 145408
    s_mul_i32 s58, s57, 13312
    s_add_u32 s58, s58, s54
    buffer_load_dwordx4 v227, s[48:51], s58 offen lds
    v_exp_f32 v60, -v12
    v_exp_f32 v61, -v13
    v_exp_f32 v62, -v14
    v_exp_f32 v63, -v15
    v_pk_add_f32 v[60:61], v[60:61], v[82:83]
    v_pk_add_f32 v[62:63], v[62:63], v[82:83]
    v_rcp_f32 v60, v60
    v_rcp_f32 v61, v61
    v_rcp_f32 v62, v62
    v_rcp_f32 v63, v63
    v_pk_mul_f32 v[12:13], v[12:13], v[60:61]
    v_pk_mul_f32 v[14:15], v[14:15], v[62:63]
    v_cvt_pk_bf16_f32 v116, v12, v13
    v_cvt_pk_bf16_f32 v117, v14, v15
    v_pk_fma_f32 v[68:69], v[246:247], v[152:153], v[182:183] op_sel:[1,0,0] op_sel_hi:[1,1,1] neg_lo:[1,0,0] neg_hi:[1,0,0]
    v_pk_fma_f32 v[70:71], v[246:247], v[154:155], v[184:185] op_sel:[1,0,0] op_sel_hi:[1,1,1] neg_lo:[1,0,0] neg_hi:[1,0,0]
    v_pk_fma_f32 v[40:41], v[246:247], v[40:41], v[68:69] op_sel:[0,0,0] op_sel_hi:[0,1,1]
    v_pk_fma_f32 v[42:43], v[246:247], v[42:43], v[70:71] op_sel:[0,0,0] op_sel_hi:[0,1,1]
    v_exp_f32 v68, -v40
    v_exp_f32 v69, -v41
    v_exp_f32 v70, -v42
    v_exp_f32 v71, -v43
    v_pk_add_f32 v[68:69], v[68:69], v[82:83]
    v_pk_add_f32 v[70:71], v[70:71], v[82:83]
    s_add_u32 m0, s61, 146432
    s_mul_i32 s58, s57, 13312
    s_add_u32 s58, s58, s55
    buffer_load_dwordx4 v227, s[48:51], s58 offen lds
    v_rcp_f32 v68, v68
    v_rcp_f32 v69, v69
    v_rcp_f32 v70, v70
    v_rcp_f32 v71, v71
    v_pk_mul_f32 v[40:41], v[40:41], v[68:69]
    v_pk_mul_f32 v[42:43], v[42:43], v[70:71]
    v_cvt_pk_bf16_f32 v130, v40, v41
    v_cvt_pk_bf16_f32 v131, v42, v43
    v_pk_fma_f32 v[60:61], v[244:245], v[156:157], v[186:187] op_sel:[1,0,0] op_sel_hi:[1,1,1] neg_lo:[1,0,0] neg_hi:[1,0,0]
    v_pk_fma_f32 v[62:63], v[244:245], v[158:159], v[188:189] op_sel:[1,0,0] op_sel_hi:[1,1,1] neg_lo:[1,0,0] neg_hi:[1,0,0]
    v_pk_fma_f32 v[16:17], v[244:245], v[16:17], v[60:61] op_sel:[0,0,0] op_sel_hi:[0,1,1]
    v_pk_fma_f32 v[18:19], v[244:245], v[18:19], v[62:63] op_sel:[0,0,0] op_sel_hi:[0,1,1]
    v_exp_f32 v60, -v16
    v_exp_f32 v61, -v17
    v_exp_f32 v62, -v18
    v_exp_f32 v63, -v19
    v_pk_add_f32 v[60:61], v[60:61], v[82:83]
    v_pk_add_f32 v[62:63], v[62:63], v[82:83]
    v_rcp_f32 v60, v60
    v_rcp_f32 v61, v61
    v_rcp_f32 v62, v62
    v_rcp_f32 v63, v63
    v_pk_mul_f32 v[16:17], v[16:17], v[60:61]
    v_pk_mul_f32 v[18:19], v[18:19], v[62:63]
    s_add_u32 m0, s61, 147456
    s_mul_i32 s58, s57, 13312
    s_add_u32 s58, s58, s56
    buffer_load_dwordx4 v227, s[48:51], s58 offen lds
    v_cvt_pk_bf16_f32 v118, v16, v17
    v_cvt_pk_bf16_f32 v119, v18, v19
    v_pk_fma_f32 v[68:69], v[246:247], v[156:157], v[186:187] op_sel:[1,0,0] op_sel_hi:[1,1,1] neg_lo:[1,0,0] neg_hi:[1,0,0]
    v_pk_fma_f32 v[70:71], v[246:247], v[158:159], v[188:189] op_sel:[1,0,0] op_sel_hi:[1,1,1] neg_lo:[1,0,0] neg_hi:[1,0,0]
    v_pk_fma_f32 v[44:45], v[246:247], v[44:45], v[68:69] op_sel:[0,0,0] op_sel_hi:[0,1,1]
    v_pk_fma_f32 v[46:47], v[246:247], v[46:47], v[70:71] op_sel:[0,0,0] op_sel_hi:[0,1,1]
    v_exp_f32 v68, -v44
    v_exp_f32 v69, -v45
    v_exp_f32 v70, -v46
    v_exp_f32 v71, -v47
    v_pk_add_f32 v[68:69], v[68:69], v[82:83]
    v_pk_add_f32 v[70:71], v[70:71], v[82:83]
    v_rcp_f32 v68, v68
    v_rcp_f32 v69, v69
    v_rcp_f32 v70, v70
    v_rcp_f32 v71, v71
    v_pk_mul_f32 v[44:45], v[44:45], v[68:69]
    v_pk_mul_f32 v[46:47], v[46:47], v[70:71]
    v_cvt_pk_bf16_f32 v132, v44, v45
    v_cvt_pk_bf16_f32 v133, v46, v47
    v_pk_fma_f32 v[60:61], v[244:245], v[160:161], v[190:191] op_sel:[1,0,0] op_sel_hi:[1,1,1] neg_lo:[1,0,0] neg_hi:[1,0,0]
    v_pk_fma_f32 v[62:63], v[244:245], v[162:163], v[192:193] op_sel:[1,0,0] op_sel_hi:[1,1,1] neg_lo:[1,0,0] neg_hi:[1,0,0]
    v_pk_fma_f32 v[20:21], v[244:245], v[20:21], v[60:61] op_sel:[0,0,0] op_sel_hi:[0,1,1]
    v_pk_fma_f32 v[22:23], v[244:245], v[22:23], v[62:63] op_sel:[0,0,0] op_sel_hi:[0,1,1]
    v_exp_f32 v60, -v20
    v_exp_f32 v61, -v21
    v_exp_f32 v62, -v22
    v_exp_f32 v63, -v23
    v_pk_add_f32 v[60:61], v[60:61], v[82:83]
    v_pk_add_f32 v[62:63], v[62:63], v[82:83]
    v_rcp_f32 v60, v60
    v_rcp_f32 v61, v61
    v_rcp_f32 v62, v62
    v_rcp_f32 v63, v63
    v_pk_mul_f32 v[20:21], v[20:21], v[60:61]
    v_pk_mul_f32 v[22:23], v[22:23], v[62:63]
    v_cvt_pk_bf16_f32 v120, v20, v21
    v_cvt_pk_bf16_f32 v121, v22, v23
    v_pk_fma_f32 v[68:69], v[246:247], v[160:161], v[190:191] op_sel:[1,0,0] op_sel_hi:[1,1,1] neg_lo:[1,0,0] neg_hi:[1,0,0]
    v_pk_fma_f32 v[70:71], v[246:247], v[162:163], v[192:193] op_sel:[1,0,0] op_sel_hi:[1,1,1] neg_lo:[1,0,0] neg_hi:[1,0,0]
    v_pk_fma_f32 v[48:49], v[246:247], v[48:49], v[68:69] op_sel:[0,0,0] op_sel_hi:[0,1,1]
    v_pk_fma_f32 v[50:51], v[246:247], v[50:51], v[70:71] op_sel:[0,0,0] op_sel_hi:[0,1,1]
    v_exp_f32 v68, -v48
    v_exp_f32 v69, -v49
    v_exp_f32 v70, -v50
    v_exp_f32 v71, -v51
    v_pk_add_f32 v[68:69], v[68:69], v[82:83]
    v_pk_add_f32 v[70:71], v[70:71], v[82:83]
    v_rcp_f32 v68, v68
    v_rcp_f32 v69, v69
    v_rcp_f32 v70, v70
    v_rcp_f32 v71, v71
    v_pk_mul_f32 v[48:49], v[48:49], v[68:69]
    v_pk_mul_f32 v[50:51], v[50:51], v[70:71]
    v_cvt_pk_bf16_f32 v134, v48, v49
    v_cvt_pk_bf16_f32 v135, v50, v51
    v_pk_fma_f32 v[60:61], v[244:245], v[164:165], v[194:195] op_sel:[1,0,0] op_sel_hi:[1,1,1] neg_lo:[1,0,0] neg_hi:[1,0,0]
    v_pk_fma_f32 v[62:63], v[244:245], v[166:167], v[196:197] op_sel:[1,0,0] op_sel_hi:[1,1,1] neg_lo:[1,0,0] neg_hi:[1,0,0]
    v_pk_fma_f32 v[24:25], v[244:245], v[24:25], v[60:61] op_sel:[0,0,0] op_sel_hi:[0,1,1]
    v_pk_fma_f32 v[26:27], v[244:245], v[26:27], v[62:63] op_sel:[0,0,0] op_sel_hi:[0,1,1]
    v_exp_f32 v60, -v24
    v_exp_f32 v61, -v25
    v_exp_f32 v62, -v26
    v_exp_f32 v63, -v27
    v_pk_add_f32 v[60:61], v[60:61], v[82:83]
    v_pk_add_f32 v[62:63], v[62:63], v[82:83]
    v_rcp_f32 v60, v60
    v_rcp_f32 v61, v61
    v_rcp_f32 v62, v62
    v_rcp_f32 v63, v63
    v_pk_mul_f32 v[24:25], v[24:25], v[60:61]
    v_pk_mul_f32 v[26:27], v[26:27], v[62:63]
    v_cvt_pk_bf16_f32 v122, v24, v25
    v_cvt_pk_bf16_f32 v123, v26, v27
    v_pk_fma_f32 v[68:69], v[246:247], v[164:165], v[194:195] op_sel:[1,0,0] op_sel_hi:[1,1,1] neg_lo:[1,0,0] neg_hi:[1,0,0]
    v_pk_fma_f32 v[70:71], v[246:247], v[166:167], v[196:197] op_sel:[1,0,0] op_sel_hi:[1,1,1] neg_lo:[1,0,0] neg_hi:[1,0,0]
    v_pk_fma_f32 v[52:53], v[246:247], v[52:53], v[68:69] op_sel:[0,0,0] op_sel_hi:[0,1,1]
    v_pk_fma_f32 v[54:55], v[246:247], v[54:55], v[70:71] op_sel:[0,0,0] op_sel_hi:[0,1,1]
    v_exp_f32 v68, -v52
    v_exp_f32 v69, -v53
    v_exp_f32 v70, -v54
    v_exp_f32 v71, -v55
    v_pk_add_f32 v[68:69], v[68:69], v[82:83]
    v_pk_add_f32 v[70:71], v[70:71], v[82:83]
    v_rcp_f32 v68, v68
    v_rcp_f32 v69, v69
    v_rcp_f32 v70, v70
    v_rcp_f32 v71, v71
    v_pk_mul_f32 v[52:53], v[52:53], v[68:69]
    v_pk_mul_f32 v[54:55], v[54:55], v[70:71]
    v_cvt_pk_bf16_f32 v136, v52, v53
    v_cvt_pk_bf16_f32 v137, v54, v55
    s_lshl_b32 s37, s46, 3
    s_lshl_b32 s38, s32, 1
    s_add_u32 s37, s37, s38
    s_add_u32 s37, s37, 0
    s_mul_i32 s37, s37, 54
    s_lshr_b32 s38, s47, 1
    s_mul_i32 s38, s38, 7
    s_add_u32 s37, s37, s38
    s_lshl_b32 s40, s37, 10
    s_lshl_b32 s37, s46, 3
    s_lshl_b32 s38, s32, 1
    s_add_u32 s37, s37, s38
    s_add_u32 s37, s37, 1
    s_mul_i32 s37, s37, 54
    s_lshr_b32 s38, s47, 1
    s_mul_i32 s38, s38, 7
    s_add_u32 s37, s37, s38
    s_lshl_b32 s41, s37, 10
    s_bitcmp1_b32 s47, 0
    s_cbranch_scc1 L_ffn1_odd
    buffer_store_dwordx4 v[110:113], v242, s[8:11], s40 offen offset:0 sc1
    buffer_store_dwordx4 v[114:117], v242, s[8:11], s40 offen offset:1024 sc1
    buffer_store_dwordx4 v[118:121], v242, s[8:11], s40 offen offset:2048 sc1
    buffer_store_dwordx2 v[122:123], v233, s[8:11], s40 offen offset:3072 sc1
    buffer_store_dwordx4 v[124:127], v242, s[8:11], s41 offen offset:0 sc1
    buffer_store_dwordx4 v[128:131], v242, s[8:11], s41 offen offset:1024 sc1
    buffer_store_dwordx4 v[132:135], v242, s[8:11], s41 offen offset:2048 sc1
    buffer_store_dwordx2 v[136:137], v233, s[8:11], s41 offen offset:3072 sc1
    s_branch L_ffn1_sdone
L_ffn1_odd:
    buffer_store_dwordx2 v[110:111], v233, s[8:11], s40 offen offset:3584 sc1
    s_add_u32 s42, s40, 4096
    buffer_store_dwordx4 v[112:115], v242, s[8:11], s42 offen sc1
    buffer_store_dwordx2 v[124:125], v233, s[8:11], s41 offen offset:3584 sc1
    s_add_u32 s43, s41, 4096
    buffer_store_dwordx4 v[126:129], v242, s[8:11], s43 offen sc1
    s_cmp_eq_u32 s47, 15
    s_cbranch_scc1 L_ffn1_sdone
    buffer_store_dwordx4 v[116:119], v242, s[8:11], s42 offen offset:1024 sc1
    buffer_store_dwordx4 v[120:123], v242, s[8:11], s42 offen offset:2048 sc1
    buffer_store_dwordx4 v[130:133], v242, s[8:11], s43 offen offset:1024 sc1
    buffer_store_dwordx4 v[134:137], v242, s[8:11], s43 offen offset:2048 sc1
L_ffn1_sdone:
    s_waitcnt vmcnt(0) lgkmcnt(0)
    s_barrier
    s_cmp_lg_u32 s32, 0
    s_cbranch_scc1 L_arr3
    s_lshl_b32 s3, s46, 7
    s_add_u32 s3, s3, 16384
    s_mov_b64 exec, 1
    v_mov_b32 v254, s3
    v_mov_b32 v255, 1
    buffer_atomic_add v255, v254, s[92:95], 0 offen sc1
    s_mov_b64 exec, -1
L_arr3:
    s_load_dwordx2 s[6:7], s[0:1], 80
    s_and_b32 s3, s2, 7
    s_lshr_b32 s36, s2, 3
    s_and_b32 s37, s3, 1
    s_lshl_b32 s37, s37, 3
    s_and_b32 s33, s36, 7
    s_add_u32 s33, s33, s37
    s_lshl_b32 s33, s33, 1
    s_lshr_b32 s37, s3, 2
    s_add_u32 s33, s33, s37
    s_lshr_b32 s34, s36, 3
    s_lshl_b32 s34, s34, 1
    s_bfe_u32 s37, s3, 0x10001
    s_add_u32 s34, s34, s37
    s_waitcnt lgkmcnt(0)
    s_add_u32 s8, s90, 0x1300000
    s_addc_u32 s9, s91, 0
    s_and_b32 s9, s9, 0xffff
    s_mov_b32 s10, 0x21c000
    s_mov_b32 s11, 0x20000
    s_add_u32 s12, s90, 0x1600000
    s_addc_u32 s13, s91, 0
    s_and_b32 s13, s13, 0xffff
    s_mov_b32 s14, 0x6c0000
    s_mov_b32 s15, 0x20000
    s_mov_b32 s24, s6
    s_mov_b32 s25, s7
    s_and_b32 s25, s25, 0xffff
    s_mov_b32 s26, 0x280000
    s_mov_b32 s27, 0x20000
    s_mov_b32 s20, s90
    s_mov_b32 s21, s91
    s_and_b32 s21, s21, 0xffff
    s_mov_b32 s22, 0x3c00
    s_mov_b32 s23, 0x20000
    s_mul_i32 s38, s32, 14
    v_and_b32 v2, 63, v249
    v_lshlrev_b32 v3, 4, v2
    s_lshl_b32 s39, s38, 10
    v_add_u32 v4, s39, v3
    v_lshlrev_b32 v12, 3, v2
    v_add_u32 v12, s39, v12
    s_add_u32 s40, s32, 0
    s_and_b32 s40, s40, 3
    s_lshl_b32 s39, s33, 2
    s_add_u32 s39, s39, s40
    s_mul_i32 s39, s39, 55296
    v_add_u32 v240, s39, v4
    v_add_u32 v232, s39, v12
    s_add_u32 s40, s32, 1
    s_and_b32 s40, s40, 3
    s_lshl_b32 s39, s33, 2
    s_add_u32 s39, s39, s40
    s_mul_i32 s39, s39, 55296
    v_add_u32 v241, s39, v4
    v_add_u32 v233, s39, v12
    s_add_u32 s40, s32, 2
    s_and_b32 s40, s40, 3
    s_lshl_b32 s39, s33, 2
    s_add_u32 s39, s39, s40
    s_mul_i32 s39, s39, 55296
    v_add_u32 v242, s39, v4
    v_add_u32 v234, s39, v12
    s_add_u32 s40, s32, 3
    s_and_b32 s40, s40, 3
    s_lshl_b32 s39, s33, 2
    s_add_u32 s39, s39, s40
    s_mul_i32 s39, s39, 55296
    v_add_u32 v243, s39, v4
    v_add_u32 v235, s39, v12
    s_mul_i32 s39, s34, 5
    s_add_u32 s39, s39, 0
    s_mul_i32 s39, s39, 55296
    v_add_u32 v244, s39, v4
    s_mul_i32 s39, s34, 5
    s_add_u32 s39, s39, 1
    s_mul_i32 s39, s39, 55296
    v_add_u32 v245, s39, v4
    s_mul_i32 s39, s34, 5
    s_add_u32 s39, s39, 2
    s_mul_i32 s39, s39, 55296
    v_add_u32 v246, s39, v4
    s_mul_i32 s39, s34, 5
    s_add_u32 s39, s39, 3
    s_mul_i32 s39, s39, 55296
    v_add_u32 v247, s39, v4
    s_mul_i32 s39, s34, 5
    s_add_u32 s39, s39, 4
    s_mul_i32 s39, s39, 55296
    v_add_u32 v248, s39, v4
    s_movk_i32 s35, 0
    buffer_load_dwordx4 a[16:19], v244, s[8:11], s35 offen
    buffer_load_dwordx4 a[20:23], v245, s[8:11], s35 offen
    buffer_load_dwordx4 a[24:27], v246, s[8:11], s35 offen
    buffer_load_dwordx4 a[28:31], v247, s[8:11], s35 offen
    buffer_load_dwordx4 a[32:35], v248, s[8:11], s35 offen
    s_movk_i32 s35, 1024
    buffer_load_dwordx4 a[52:55], v244, s[8:11], s35 offen
    buffer_load_dwordx4 a[56:59], v245, s[8:11], s35 offen
    buffer_load_dwordx4 a[60:63], v246, s[8:11], s35 offen
    buffer_load_dwordx4 a[64:67], v247, s[8:11], s35 offen
    buffer_load_dwordx4 a[68:71], v248, s[8:11], s35 offen
    s_movk_i32 s35, 2048
    buffer_load_dwordx4 a[88:91], v244, s[8:11], s35 offen
    buffer_load_dwordx4 a[92:95], v245, s[8:11], s35 offen
    buffer_load_dwordx4 a[96:99], v246, s[8:11], s35 offen
    buffer_load_dwordx4 a[100:103], v247, s[8:11], s35 offen
    buffer_load_dwordx4 a[104:107], v248, s[8:11], s35 offen
    s_movk_i32 s35, 3072
    buffer_load_dwordx4 a[124:127], v244, s[8:11], s35 offen
    buffer_load_dwordx4 a[128:131], v245, s[8:11], s35 offen
    buffer_load_dwordx4 a[132:135], v246, s[8:11], s35 offen
    buffer_load_dwordx4 a[136:139], v247, s[8:11], s35 offen
    buffer_load_dwordx4 a[140:143], v248, s[8:11], s35 offen
    s_movk_i32 s35, 4096
    buffer_load_dwordx4 a[160:163], v244, s[8:11], s35 offen
    buffer_load_dwordx4 a[164:167], v245, s[8:11], s35 offen
    buffer_load_dwordx4 a[168:171], v246, s[8:11], s35 offen
    buffer_load_dwordx4 a[172:175], v247, s[8:11], s35 offen
    buffer_load_dwordx4 a[176:179], v248, s[8:11], s35 offen
    s_movk_i32 s35, 5120
    buffer_load_dwordx4 a[196:199], v244, s[8:11], s35 offen
    buffer_load_dwordx4 a[200:203], v245, s[8:11], s35 offen
    buffer_load_dwordx4 a[204:207], v246, s[8:11], s35 offen
    buffer_load_dwordx4 a[208:211], v247, s[8:11], s35 offen
    buffer_load_dwordx4 a[212:215], v248, s[8:11], s35 offen
    v_and_b32 v5, 15, v2
    v_lshrrev_b32 v6, 4, v2
    s_mul_i32 s39, s34, 320
    v_lshl_add_u32 v7, v6, 4, s39
    s_lshl_b32 s40, s33, 2
    s_add_u32 s40, s40, s32
    s_lshl_b32 s41, s40, 4
    v_add_u32 v8, s41, v5
    s_movk_i32 s41, 12800
    buffer_load_dwordx4 v[100:103], v7, s[20:23], s41 offen offset:0
    buffer_load_dwordx4 v[104:107], v7, s[20:23], s41 offen offset:64
    buffer_load_dwordx4 v[108:111], v7, s[20:23], s41 offen offset:128
    buffer_load_dwordx4 v[112:115], v7, s[20:23], s41 offen offset:192
    buffer_load_dwordx4 v[116:119], v7, s[20:23], s41 offen offset:256
    v_mov_b32 v236, v3
    v_mov_b32 v237, v8
    v_mov_b32 v238, v6
    v_mov_b32 v239, v5
    v_mov_b32 v0, 0
    v_mov_b32 v1, 0
    v_mov_b32 v2, 0
    v_mov_b32 v3, 0
    v_mov_b32 v4, 0
    v_mov_b32 v5, 0
    v_mov_b32 v6, 0
    v_mov_b32 v7, 0
    v_mov_b32 v8, 0
    v_mov_b32 v9, 0
    v_mov_b32 v10, 0
    v_mov_b32 v11, 0
    v_mov_b32 v12, 0
    v_mov_b32 v13, 0
    v_mov_b32 v14, 0
    v_mov_b32 v15, 0
    v_mov_b32 v16, 0
    v_mov_b32 v17, 0
    v_mov_b32 v18, 0
    v_mov_b32 v19, 0
    v_mov_b32 v20, 0
    v_mov_b32 v21, 0
    v_mov_b32 v22, 0
    v_mov_b32 v23, 0
    v_mov_b32 v24, 0
    v_mov_b32 v25, 0
    v_mov_b32 v26, 0
    v_mov_b32 v27, 0
    v_mov_b32 v28, 0
    v_mov_b32 v29, 0
    v_mov_b32 v30, 0
    v_mov_b32 v31, 0
    v_mov_b32 v32, 0
    v_mov_b32 v33, 0
    v_mov_b32 v34, 0
    v_mov_b32 v35, 0
    v_mov_b32 v36, 0
    v_mov_b32 v37, 0
    v_mov_b32 v38, 0
    v_mov_b32 v39, 0
    v_mov_b32 v40, 0
    v_mov_b32 v41, 0
    v_mov_b32 v42, 0
    v_mov_b32 v43, 0
    v_mov_b32 v44, 0
    v_mov_b32 v45, 0
    v_mov_b32 v46, 0
    v_mov_b32 v47, 0
    v_mov_b32 v48, 0
    v_mov_b32 v49, 0
    v_mov_b32 v50, 0
    v_mov_b32 v51, 0
    v_mov_b32 v52, 0
    v_mov_b32 v53, 0
    v_mov_b32 v54, 0
    v_mov_b32 v55, 0
    v_mov_b32 v56, 0
    v_mov_b32 v57, 0
    v_mov_b32 v58, 0
    v_mov_b32 v59, 0
    v_mov_b32 v60, 0
    v_mov_b32 v61, 0
    v_mov_b32 v62, 0
    v_mov_b32 v63, 0
    v_mov_b32 v64, 0
    v_mov_b32 v65, 0
    v_mov_b32 v66, 0
    v_mov_b32 v67, 0
    v_mov_b32 v68, 0
    v_mov_b32 v69, 0
    v_mov_b32 v70, 0
    v_mov_b32 v71, 0
    v_mov_b32 v72, 0
    v_mov_b32 v73, 0
    v_mov_b32 v74, 0
    v_mov_b32 v75, 0
    v_mov_b32 v76, 0
    v_mov_b32 v77, 0
    v_mov_b32 v78, 0
    v_mov_b32 v79, 0
    s_cmp_lg_u32 s32, 0
    s_cbranch_scc1 L_pw3
    s_lshr_b32 s3, s33, 1
    s_lshl_b32 s3, s3, 7
    s_add_u32 s3, s3, 16384
    v_mov_b32 v254, s3
    s_mov_b32 s3, 0
L_poll3:
    buffer_load_dword v255, v254, s[92:95], 0 offen offset:0 sc1
    s_waitcnt vmcnt(0)
    v_cmp_gt_u32 vcc, 16, v255
    s_add_u32 s3, s3, 1
    s_cmp_gt_u32 s3, 400000
    s_cbranch_scc1 L_pw3
    s_cmp_eq_u64 vcc, 0
    s_cbranch_scc0 L_poll3
L_pw3:
    s_barrier
    s_movk_i32 s35, 0
    buffer_load_dwordx4 a[0:3], v240, s[12:15], s35 offen
    buffer_load_dwordx4 a[4:7], v241, s[12:15], s35 offen
    buffer_load_dwordx4 a[8:11], v242, s[12:15], s35 offen
    buffer_load_dwordx4 a[12:15], v243, s[12:15], s35 offen
    s_movk_i32 s35, 1024
    buffer_load_dwordx4 a[36:39], v240, s[12:15], s35 offen
    buffer_load_dwordx4 a[40:43], v241, s[12:15], s35 offen
    buffer_load_dwordx4 a[44:47], v242, s[12:15], s35 offen
    buffer_load_dwordx4 a[48:51], v243, s[12:15], s35 offen
    s_movk_i32 s35, 2048
    buffer_load_dwordx4 a[72:75], v240, s[12:15], s35 offen
    buffer_load_dwordx4 a[76:79], v241, s[12:15], s35 offen
    buffer_load_dwordx4 a[80:83], v242, s[12:15], s35 offen
    buffer_load_dwordx4 a[84:87], v243, s[12:15], s35 offen
    s_movk_i32 s35, 5120
    s_mul_i32 s39, s32, 5120
    v_add_u32 v231, s39, v236
    v_add_u32 v228, 61440, v231
    v_add_u32 v229, 61440, v228
    s_waitcnt vmcnt(8)
    s_add_u32 s35, s35, 1024
    v_mfma_f32_16x16x32_bf16 v[0:3], a[16:19], a[0:3], v[0:3]
    s_movk_i32 s42, 3072
    v_mfma_f32_16x16x32_bf16 v[20:23], a[16:19], a[4:7], v[20:23]
    v_mfma_f32_16x16x32_bf16 v[40:43], a[16:19], a[8:11], v[40:43]
    buffer_load_dwordx2 a[108:109], v232, s[12:15], s42 offen offset:0
    v_mfma_f32_16x16x32_bf16 v[60:63], a[16:19], a[12:15], v[60:63]
    ds_read_b128 a[16:19], v231 offset:0
    v_mfma_f32_16x16x32_bf16 v[4:7], a[20:23], a[0:3], v[4:7]
    buffer_load_dwordx2 a[110:111], v232, s[12:15], s42 offen offset:512
    v_mfma_f32_16x16x32_bf16 v[24:27], a[20:23], a[4:7], v[24:27]
    v_mfma_f32_16x16x32_bf16 v[44:47], a[20:23], a[8:11], v[44:47]
    buffer_load_dwordx2 a[112:113], v233, s[12:15], s42 offen offset:0
    v_mfma_f32_16x16x32_bf16 v[64:67], a[20:23], a[12:15], v[64:67]
    ds_read_b128 a[20:23], v231 offset:1024
    v_mfma_f32_16x16x32_bf16 v[8:11], a[24:27], a[0:3], v[8:11]
    buffer_load_dwordx2 a[114:115], v233, s[12:15], s42 offen offset:512
    v_mfma_f32_16x16x32_bf16 v[28:31], a[24:27], a[4:7], v[28:31]
    v_mfma_f32_16x16x32_bf16 v[48:51], a[24:27], a[8:11], v[48:51]
    buffer_load_dwordx2 a[116:117], v234, s[12:15], s42 offen offset:0
    v_mfma_f32_16x16x32_bf16 v[68:71], a[24:27], a[12:15], v[68:71]
    ds_read_b128 a[24:27], v231 offset:2048
    v_mfma_f32_16x16x32_bf16 v[12:15], a[28:31], a[0:3], v[12:15]
    buffer_load_dwordx2 a[118:119], v234, s[12:15], s42 offen offset:512
    v_mfma_f32_16x16x32_bf16 v[32:35], a[28:31], a[4:7], v[32:35]
    v_mfma_f32_16x16x32_bf16 v[52:55], a[28:31], a[8:11], v[52:55]
    buffer_load_dwordx2 a[120:121], v235, s[12:15], s42 offen offset:0
    v_mfma_f32_16x16x32_bf16 v[72:75], a[28:31], a[12:15], v[72:75]
    ds_read_b128 a[28:31], v231 offset:3072
    v_mfma_f32_16x16x32_bf16 v[16:19], a[32:35], a[0:3], v[16:19]
    buffer_load_dwordx2 a[122:123], v235, s[12:15], s42 offen offset:512
    v_mfma_f32_16x16x32_bf16 v[36:39], a[32:35], a[4:7], v[36:39]
    v_mfma_f32_16x16x32_bf16 v[56:59], a[32:35], a[8:11], v[56:59]
    v_mfma_f32_16x16x32_bf16 v[76:79], a[32:35], a[12:15], v[76:79]
    ds_read_b128 a[32:35], v231 offset:4096
    buffer_load_dwordx4 a[0:3], v240, s[12:15], s35 offen
    buffer_load_dwordx4 a[4:7], v241, s[12:15], s35 offen
    buffer_load_dwordx4 a[8:11], v242, s[12:15], s35 offen
    buffer_load_dwordx4 a[12:15], v243, s[12:15], s35 offen
    s_waitcnt vmcnt(16)
    s_add_u32 s35, s35, 1024
    v_mfma_f32_16x16x32_bf16 v[0:3], a[52:55], a[36:39], v[0:3]
    s_movk_i32 s42, 4096
    v_mfma_f32_16x16x32_bf16 v[20:23], a[52:55], a[40:43], v[20:23]
    v_mfma_f32_16x16x32_bf16 v[40:43], a[52:55], a[44:47], v[40:43]
    buffer_load_dwordx4 a[144:147], v240, s[12:15], s42 offen
    v_mfma_f32_16x16x32_bf16 v[60:63], a[52:55], a[48:51], v[60:63]
    ds_read_b128 a[52:55], v231 offset:20480
    v_mfma_f32_16x16x32_bf16 v[4:7], a[56:59], a[36:39], v[4:7]
    buffer_load_dwordx4 a[148:151], v241, s[12:15], s42 offen
    v_mfma_f32_16x16x32_bf16 v[24:27], a[56:59], a[40:43], v[24:27]
    v_mfma_f32_16x16x32_bf16 v[44:47], a[56:59], a[44:47], v[44:47]
    buffer_load_dwordx4 a[152:155], v242, s[12:15], s42 offen
    v_mfma_f32_16x16x32_bf16 v[64:67], a[56:59], a[48:51], v[64:67]
    ds_read_b128 a[56:59], v231 offset:21504
    v_mfma_f32_16x16x32_bf16 v[8:11], a[60:63], a[36:39], v[8:11]
    buffer_load_dwordx4 a[156:159], v243, s[12:15], s42 offen
    v_mfma_f32_16x16x32_bf16 v[28:31], a[60:63], a[40:43], v[28:31]
    v_mfma_f32_16x16x32_bf16 v[48:51], a[60:63], a[44:47], v[48:51]
    v_mfma_f32_16x16x32_bf16 v[68:71], a[60:63], a[48:51], v[68:71]
    ds_read_b128 a[60:63], v231 offset:22528
    v_mfma_f32_16x16x32_bf16 v[12:15], a[64:67], a[36:39], v[12:15]
    v_mfma_f32_16x16x32_bf16 v[32:35], a[64:67], a[40:43], v[32:35]
    v_mfma_f32_16x16x32_bf16 v[52:55], a[64:67], a[44:47], v[52:55]
    v_mfma_f32_16x16x32_bf16 v[72:75], a[64:67], a[48:51], v[72:75]
    ds_read_b128 a[64:67], v231 offset:23552
    v_mfma_f32_16x16x32_bf16 v[16:19], a[68:71], a[36:39], v[16:19]
    v_mfma_f32_16x16x32_bf16 v[36:39], a[68:71], a[40:43], v[36:39]
    v_mfma_f32_16x16x32_bf16 v[56:59], a[68:71], a[44:47], v[56:59]
    v_mfma_f32_16x16x32_bf16 v[76:79], a[68:71], a[48:51], v[76:79]
    ds_read_b128 a[68:71], v231 offset:24576
    buffer_load_dwordx4 a[36:39], v240, s[12:15], s35 offen
    buffer_load_dwordx4 a[40:43], v241, s[12:15], s35 offen
    buffer_load_dwordx4 a[44:47], v242, s[12:15], s35 offen
    buffer_load_dwordx4 a[48:51], v243, s[12:15], s35 offen
    s_waitcnt vmcnt(20)
    s_add_u32 s35, s35, 1024
    v_mfma_f32_16x16x32_bf16 v[0:3], a[88:91], a[72:75], v[0:3]
    s_movk_i32 s42, 5120
    v_mfma_f32_16x16x32_bf16 v[20:23], a[88:91], a[76:79], v[20:23]
    v_mfma_f32_16x16x32_bf16 v[40:43], a[88:91], a[80:83], v[40:43]
    buffer_load_dwordx4 a[180:183], v240, s[12:15], s42 offen
    v_mfma_f32_16x16x32_bf16 v[60:63], a[88:91], a[84:87], v[60:63]
    ds_read_b128 a[88:91], v231 offset:40960
    v_mfma_f32_16x16x32_bf16 v[4:7], a[92:95], a[72:75], v[4:7]
    buffer_load_dwordx4 a[184:187], v241, s[12:15], s42 offen
    v_mfma_f32_16x16x32_bf16 v[24:27], a[92:95], a[76:79], v[24:27]
    v_mfma_f32_16x16x32_bf16 v[44:47], a[92:95], a[80:83], v[44:47]
    buffer_load_dwordx4 a[188:191], v242, s[12:15], s42 offen
    v_mfma_f32_16x16x32_bf16 v[64:67], a[92:95], a[84:87], v[64:67]
    ds_read_b128 a[92:95], v231 offset:41984
    v_mfma_f32_16x16x32_bf16 v[8:11], a[96:99], a[72:75], v[8:11]
    buffer_load_dwordx4 a[192:195], v243, s[12:15], s42 offen
    v_mfma_f32_16x16x32_bf16 v[28:31], a[96:99], a[76:79], v[28:31]
    v_mfma_f32_16x16x32_bf16 v[48:51], a[96:99], a[80:83], v[48:51]
    v_mfma_f32_16x16x32_bf16 v[68:71], a[96:99], a[84:87], v[68:71]
    ds_read_b128 a[96:99], v231 offset:43008
    v_mfma_f32_16x16x32_bf16 v[12:15], a[100:103], a[72:75], v[12:15]
    v_mfma_f32_16x16x32_bf16 v[32:35], a[100:103], a[76:79], v[32:35]
    v_mfma_f32_16x16x32_bf16 v[52:55], a[100:103], a[80:83], v[52:55]
    v_mfma_f32_16x16x32_bf16 v[72:75], a[100:103], a[84:87], v[72:75]
    ds_read_b128 a[100:103], v231 offset:44032
    v_mfma_f32_16x16x32_bf16 v[16:19], a[104:107], a[72:75], v[16:19]
    v_mfma_f32_16x16x32_bf16 v[36:39], a[104:107], a[76:79], v[36:39]
    v_mfma_f32_16x16x32_bf16 v[56:59], a[104:107], a[80:83], v[56:59]
    v_mfma_f32_16x16x32_bf16 v[76:79], a[104:107], a[84:87], v[76:79]
    ds_read_b128 a[104:107], v231 offset:45056
    buffer_load_dwordx4 a[72:75], v240, s[12:15], s35 offen
    buffer_load_dwordx4 a[76:79], v241, s[12:15], s35 offen
    buffer_load_dwordx4 a[80:83], v242, s[12:15], s35 offen
    buffer_load_dwordx4 a[84:87], v243, s[12:15], s35 offen
    s_waitcnt vmcnt(20)
    s_add_u32 s35, s35, 1024
    v_mfma_f32_16x16x32_bf16 v[0:3], a[124:127], a[108:111], v[0:3]
    v_mfma_f32_16x16x32_bf16 v[20:23], a[124:127], a[112:115], v[20:23]
    v_mfma_f32_16x16x32_bf16 v[40:43], a[124:127], a[116:119], v[40:43]
    v_mfma_f32_16x16x32_bf16 v[60:63], a[124:127], a[120:123], v[60:63]
    ds_read_b128 a[124:127], v228 offset:0
    v_mfma_f32_16x16x32_bf16 v[4:7], a[128:131], a[108:111], v[4:7]
    v_mfma_f32_16x16x32_bf16 v[24:27], a[128:131], a[112:115], v[24:27]
    v_mfma_f32_16x16x32_bf16 v[44:47], a[128:131], a[116:119], v[44:47]
    v_mfma_f32_16x16x32_bf16 v[64:67], a[128:131], a[120:123], v[64:67]
    ds_read_b128 a[128:131], v228 offset:1024
    v_mfma_f32_16x16x32_bf16 v[8:11], a[132:135], a[108:111], v[8:11]
    v_mfma_f32_16x16x32_bf16 v[28:31], a[132:135], a[112:115], v[28:31]
    v_mfma_f32_16x16x32_bf16 v[48:51], a[132:135], a[116:119], v[48:51]
    v_mfma_f32_16x16x32_bf16 v[68:71], a[132:135], a[120:123], v[68:71]
    ds_read_b128 a[132:135], v228 offset:2048
    v_mfma_f32_16x16x32_bf16 v[12:15], a[136:139], a[108:111], v[12:15]
    v_mfma_f32_16x16x32_bf16 v[32:35], a[136:139], a[112:115], v[32:35]
    v_mfma_f32_16x16x32_bf16 v[52:55], a[136:139], a[116:119], v[52:55]
    v_mfma_f32_16x16x32_bf16 v[72:75], a[136:139], a[120:123], v[72:75]
    ds_read_b128 a[136:139], v228 offset:3072
    v_mfma_f32_16x16x32_bf16 v[16:19], a[140:143], a[108:111], v[16:19]
    v_mfma_f32_16x16x32_bf16 v[36:39], a[140:143], a[112:115], v[36:39]
    v_mfma_f32_16x16x32_bf16 v[56:59], a[140:143], a[116:119], v[56:59]
    v_mfma_f32_16x16x32_bf16 v[76:79], a[140:143], a[120:123], v[76:79]
    ds_read_b128 a[140:143], v228 offset:4096
    buffer_load_dwordx4 a[108:111], v240, s[12:15], s35 offen
    buffer_load_dwordx4 a[112:115], v241, s[12:15], s35 offen
    buffer_load_dwordx4 a[116:119], v242, s[12:15], s35 offen
    buffer_load_dwordx4 a[120:123], v243, s[12:15], s35 offen
    s_waitcnt vmcnt(16)
    s_add_u32 s35, s35, 1024
    v_mfma_f32_16x16x32_bf16 v[0:3], a[160:163], a[144:147], v[0:3]
    v_mfma_f32_16x16x32_bf16 v[20:23], a[160:163], a[148:151], v[20:23]
    v_mfma_f32_16x16x32_bf16 v[40:43], a[160:163], a[152:155], v[40:43]
    v_mfma_f32_16x16x32_bf16 v[60:63], a[160:163], a[156:159], v[60:63]
    ds_read_b128 a[160:163], v228 offset:20480
    v_mfma_f32_16x16x32_bf16 v[4:7], a[164:167], a[144:147], v[4:7]
    v_mfma_f32_16x16x32_bf16 v[24:27], a[164:167], a[148:151], v[24:27]
    v_mfma_f32_16x16x32_bf16 v[44:47], a[164:167], a[152:155], v[44:47]
    v_mfma_f32_16x16x32_bf16 v[64:67], a[164:167], a[156:159], v[64:67]
    ds_read_b128 a[164:167], v228 offset:21504
    v_mfma_f32_16x16x32_bf16 v[8:11], a[168:171], a[144:147], v[8:11]
    v_mfma_f32_16x16x32_bf16 v[28:31], a[168:171], a[148:151], v[28:31]
    v_mfma_f32_16x16x32_bf16 v[48:51], a[168:171], a[152:155], v[48:51]
    v_mfma_f32_16x16x32_bf16 v[68:71], a[168:171], a[156:159], v[68:71]
    ds_read_b128 a[168:171], v228 offset:22528
    v_mfma_f32_16x16x32_bf16 v[12:15], a[172:175], a[144:147], v[12:15]
    v_mfma_f32_16x16x32_bf16 v[32:35], a[172:175], a[148:151], v[32:35]
    v_mfma_f32_16x16x32_bf16 v[52:55], a[172:175], a[152:155], v[52:55]
    v_mfma_f32_16x16x32_bf16 v[72:75], a[172:175], a[156:159], v[72:75]
    ds_read_b128 a[172:175], v228 offset:23552
    v_mfma_f32_16x16x32_bf16 v[16:19], a[176:179], a[144:147], v[16:19]
    v_mfma_f32_16x16x32_bf16 v[36:39], a[176:179], a[148:151], v[36:39]
    v_mfma_f32_16x16x32_bf16 v[56:59], a[176:179], a[152:155], v[56:59]
    v_mfma_f32_16x16x32_bf16 v[76:79], a[176:179], a[156:159], v[76:79]
    ds_read_b128 a[176:179], v228 offset:24576
    buffer_load_dwordx2 a[144:145], v232, s[12:15], s35 offen offset:0
    buffer_load_dwordx2 a[146:147], v232, s[12:15], s35 offen offset:512
    buffer_load_dwordx2 a[148:149], v233, s[12:15], s35 offen offset:0
    buffer_load_dwordx2 a[150:151], v233, s[12:15], s35 offen offset:512
    buffer_load_dwordx2 a[152:153], v234, s[12:15], s35 offen offset:0
    buffer_load_dwordx2 a[154:155], v234, s[12:15], s35 offen offset:512
    buffer_load_dwordx2 a[156:157], v235, s[12:15], s35 offen offset:0
    buffer_load_dwordx2 a[158:159], v235, s[12:15], s35 offen offset:512
    s_waitcnt vmcnt(16)
    s_add_u32 s35, s35, 1024
    v_mfma_f32_16x16x32_bf16 v[0:3], a[196:199], a[180:183], v[0:3]
    v_mfma_f32_16x16x32_bf16 v[20:23], a[196:199], a[184:187], v[20:23]
    v_mfma_f32_16x16x32_bf16 v[40:43], a[196:199], a[188:191], v[40:43]
    v_mfma_f32_16x16x32_bf16 v[60:63], a[196:199], a[192:195], v[60:63]
    ds_read_b128 a[196:199], v228 offset:40960
    v_mfma_f32_16x16x32_bf16 v[4:7], a[200:203], a[180:183], v[4:7]
    v_mfma_f32_16x16x32_bf16 v[24:27], a[200:203], a[184:187], v[24:27]
    v_mfma_f32_16x16x32_bf16 v[44:47], a[200:203], a[188:191], v[44:47]
    v_mfma_f32_16x16x32_bf16 v[64:67], a[200:203], a[192:195], v[64:67]
    ds_read_b128 a[200:203], v228 offset:41984
    v_mfma_f32_16x16x32_bf16 v[8:11], a[204:207], a[180:183], v[8:11]
    v_mfma_f32_16x16x32_bf16 v[28:31], a[204:207], a[184:187], v[28:31]
    v_mfma_f32_16x16x32_bf16 v[48:51], a[204:207], a[188:191], v[48:51]
    v_mfma_f32_16x16x32_bf16 v[68:71], a[204:207], a[192:195], v[68:71]
    ds_read_b128 a[204:207], v228 offset:43008
    v_mfma_f32_16x16x32_bf16 v[12:15], a[208:211], a[180:183], v[12:15]
    v_mfma_f32_16x16x32_bf16 v[32:35], a[208:211], a[184:187], v[32:35]
    v_mfma_f32_16x16x32_bf16 v[52:55], a[208:211], a[188:191], v[52:55]
    v_mfma_f32_16x16x32_bf16 v[72:75], a[208:211], a[192:195], v[72:75]
    ds_read_b128 a[208:211], v228 offset:44032
    v_mfma_f32_16x16x32_bf16 v[16:19], a[212:215], a[180:183], v[16:19]
    v_mfma_f32_16x16x32_bf16 v[36:39], a[212:215], a[184:187], v[36:39]
    v_mfma_f32_16x16x32_bf16 v[56:59], a[212:215], a[188:191], v[56:59]
    v_mfma_f32_16x16x32_bf16 v[76:79], a[212:215], a[192:195], v[76:79]
    ds_read_b128 a[212:215], v228 offset:45056
    buffer_load_dwordx4 a[180:183], v240, s[12:15], s35 offen
    buffer_load_dwordx4 a[184:187], v241, s[12:15], s35 offen
    buffer_load_dwordx4 a[188:191], v242, s[12:15], s35 offen
    buffer_load_dwordx4 a[192:195], v243, s[12:15], s35 offen
    s_cmp_eq_u32 s32, 3
    s_cselect_b32 s39, 0, 1024
    s_add_u32 s35, s35, s39
    s_waitcnt lgkmcnt(15)
    v_mfma_f32_16x16x32_bf16 v[0:3], a[16:19], a[0:3], v[0:3]
    v_mfma_f32_16x16x32_bf16 v[20:23], a[16:19], a[4:7], v[20:23]
    v_mfma_f32_16x16x32_bf16 v[40:43], a[16:19], a[8:11], v[40:43]
    v_mfma_f32_16x16x32_bf16 v[60:63], a[16:19], a[12:15], v[60:63]
    ds_read_b128 a[16:19], v229 offset:0
    v_mfma_f32_16x16x32_bf16 v[4:7], a[20:23], a[0:3], v[4:7]
    v_mfma_f32_16x16x32_bf16 v[24:27], a[20:23], a[4:7], v[24:27]
    v_mfma_f32_16x16x32_bf16 v[44:47], a[20:23], a[8:11], v[44:47]
    v_mfma_f32_16x16x32_bf16 v[64:67], a[20:23], a[12:15], v[64:67]
    ds_read_b128 a[20:23], v229 offset:1024
    v_mfma_f32_16x16x32_bf16 v[8:11], a[24:27], a[0:3], v[8:11]
    v_mfma_f32_16x16x32_bf16 v[28:31], a[24:27], a[4:7], v[28:31]
    v_mfma_f32_16x16x32_bf16 v[48:51], a[24:27], a[8:11], v[48:51]
    v_mfma_f32_16x16x32_bf16 v[68:71], a[24:27], a[12:15], v[68:71]
    ds_read_b128 a[24:27], v229 offset:2048
    v_mfma_f32_16x16x32_bf16 v[12:15], a[28:31], a[0:3], v[12:15]
    v_mfma_f32_16x16x32_bf16 v[32:35], a[28:31], a[4:7], v[32:35]
    v_mfma_f32_16x16x32_bf16 v[52:55], a[28:31], a[8:11], v[52:55]
    v_mfma_f32_16x16x32_bf16 v[72:75], a[28:31], a[12:15], v[72:75]
    ds_read_b128 a[28:31], v229 offset:3072
    v_mfma_f32_16x16x32_bf16 v[16:19], a[32:35], a[0:3], v[16:19]
    v_mfma_f32_16x16x32_bf16 v[36:39], a[32:35], a[4:7], v[36:39]
    v_mfma_f32_16x16x32_bf16 v[56:59], a[32:35], a[8:11], v[56:59]
    v_mfma_f32_16x16x32_bf16 v[76:79], a[32:35], a[12:15], v[76:79]
    ds_read_b128 a[32:35], v229 offset:4096
    buffer_load_dwordx4 a[0:3], v240, s[12:15], s35 offen
    buffer_load_dwordx4 a[4:7], v241, s[12:15], s35 offen
    buffer_load_dwordx4 a[8:11], v242, s[12:15], s35 offen
    buffer_load_dwordx4 a[12:15], v243, s[12:15], s35 offen
    s_cmp_eq_u32 s32, 3
    s_cselect_b32 s39, 0, 1024
    s_add_u32 s35, s35, s39
    v_mfma_f32_16x16x32_bf16 v[0:3], a[52:55], a[36:39], v[0:3]
    v_mfma_f32_16x16x32_bf16 v[20:23], a[52:55], a[40:43], v[20:23]
    v_mfma_f32_16x16x32_bf16 v[40:43], a[52:55], a[44:47], v[40:43]
    v_mfma_f32_16x16x32_bf16 v[60:63], a[52:55], a[48:51], v[60:63]
    ds_read_b128 a[52:55], v229 offset:20480
    v_mfma_f32_16x16x32_bf16 v[4:7], a[56:59], a[36:39], v[4:7]
    v_mfma_f32_16x16x32_bf16 v[24:27], a[56:59], a[40:43], v[24:27]
    v_mfma_f32_16x16x32_bf16 v[44:47], a[56:59], a[44:47], v[44:47]
    v_mfma_f32_16x16x32_bf16 v[64:67], a[56:59], a[48:51], v[64:67]
    ds_read_b128 a[56:59], v229 offset:21504
    v_mfma_f32_16x16x32_bf16 v[8:11], a[60:63], a[36:39], v[8:11]
    v_mfma_f32_16x16x32_bf16 v[28:31], a[60:63], a[40:43], v[28:31]
    v_mfma_f32_16x16x32_bf16 v[48:51], a[60:63], a[44:47], v[48:51]
    v_mfma_f32_16x16x32_bf16 v[68:71], a[60:63], a[48:51], v[68:71]
    ds_read_b128 a[60:63], v229 offset:22528
    v_mfma_f32_16x16x32_bf16 v[12:15], a[64:67], a[36:39], v[12:15]
    v_mfma_f32_16x16x32_bf16 v[32:35], a[64:67], a[40:43], v[32:35]
    v_mfma_f32_16x16x32_bf16 v[52:55], a[64:67], a[44:47], v[52:55]
    v_mfma_f32_16x16x32_bf16 v[72:75], a[64:67], a[48:51], v[72:75]
    ds_read_b128 a[64:67], v229 offset:23552
    v_mfma_f32_16x16x32_bf16 v[16:19], a[68:71], a[36:39], v[16:19]
    v_mfma_f32_16x16x32_bf16 v[36:39], a[68:71], a[40:43], v[36:39]
    v_mfma_f32_16x16x32_bf16 v[56:59], a[68:71], a[44:47], v[56:59]
    v_mfma_f32_16x16x32_bf16 v[76:79], a[68:71], a[48:51], v[76:79]
    ds_read_b128 a[68:71], v229 offset:24576
    buffer_load_dwordx4 a[36:39], v240, s[12:15], s35 offen
    buffer_load_dwordx4 a[40:43], v241, s[12:15], s35 offen
    buffer_load_dwordx4 a[44:47], v242, s[12:15], s35 offen
    buffer_load_dwordx4 a[48:51], v243, s[12:15], s35 offen
    s_waitcnt vmcnt(24)
    v_mfma_f32_16x16x32_bf16 v[0:3], a[88:91], a[72:75], v[0:3]
    v_mfma_f32_16x16x32_bf16 v[20:23], a[88:91], a[76:79], v[20:23]
    v_mfma_f32_16x16x32_bf16 v[40:43], a[88:91], a[80:83], v[40:43]
    v_mfma_f32_16x16x32_bf16 v[60:63], a[88:91], a[84:87], v[60:63]
    v_mfma_f32_16x16x32_bf16 v[4:7], a[92:95], a[72:75], v[4:7]
    v_mfma_f32_16x16x32_bf16 v[24:27], a[92:95], a[76:79], v[24:27]
    v_mfma_f32_16x16x32_bf16 v[44:47], a[92:95], a[80:83], v[44:47]
    v_mfma_f32_16x16x32_bf16 v[64:67], a[92:95], a[84:87], v[64:67]
    v_mfma_f32_16x16x32_bf16 v[8:11], a[96:99], a[72:75], v[8:11]
    v_mfma_f32_16x16x32_bf16 v[28:31], a[96:99], a[76:79], v[28:31]
    v_mfma_f32_16x16x32_bf16 v[48:51], a[96:99], a[80:83], v[48:51]
    v_mfma_f32_16x16x32_bf16 v[68:71], a[96:99], a[84:87], v[68:71]
    v_mfma_f32_16x16x32_bf16 v[12:15], a[100:103], a[72:75], v[12:15]
    v_mfma_f32_16x16x32_bf16 v[32:35], a[100:103], a[76:79], v[32:35]
    v_mfma_f32_16x16x32_bf16 v[52:55], a[100:103], a[80:83], v[52:55]
    v_mfma_f32_16x16x32_bf16 v[72:75], a[100:103], a[84:87], v[72:75]
    v_mfma_f32_16x16x32_bf16 v[16:19], a[104:107], a[72:75], v[16:19]
    v_mfma_f32_16x16x32_bf16 v[36:39], a[104:107], a[76:79], v[36:39]
    v_mfma_f32_16x16x32_bf16 v[56:59], a[104:107], a[80:83], v[56:59]
    v_mfma_f32_16x16x32_bf16 v[76:79], a[104:107], a[84:87], v[76:79]
    s_waitcnt vmcnt(20)
    s_waitcnt lgkmcnt(15)
    v_mfma_f32_16x16x32_bf16 v[0:3], a[124:127], a[108:111], v[0:3]
    v_mfma_f32_16x16x32_bf16 v[20:23], a[124:127], a[112:115], v[20:23]
    v_mfma_f32_16x16x32_bf16 v[40:43], a[124:127], a[116:119], v[40:43]
    v_mfma_f32_16x16x32_bf16 v[60:63], a[124:127], a[120:123], v[60:63]
    v_mfma_f32_16x16x32_bf16 v[4:7], a[128:131], a[108:111], v[4:7]
    v_mfma_f32_16x16x32_bf16 v[24:27], a[128:131], a[112:115], v[24:27]
    v_mfma_f32_16x16x32_bf16 v[44:47], a[128:131], a[116:119], v[44:47]
    v_mfma_f32_16x16x32_bf16 v[64:67], a[128:131], a[120:123], v[64:67]
    v_mfma_f32_16x16x32_bf16 v[8:11], a[132:135], a[108:111], v[8:11]
    v_mfma_f32_16x16x32_bf16 v[28:31], a[132:135], a[112:115], v[28:31]
    v_mfma_f32_16x16x32_bf16 v[48:51], a[132:135], a[116:119], v[48:51]
    v_mfma_f32_16x16x32_bf16 v[68:71], a[132:135], a[120:123], v[68:71]
    v_mfma_f32_16x16x32_bf16 v[12:15], a[136:139], a[108:111], v[12:15]
    v_mfma_f32_16x16x32_bf16 v[32:35], a[136:139], a[112:115], v[32:35]
    v_mfma_f32_16x16x32_bf16 v[52:55], a[136:139], a[116:119], v[52:55]
    v_mfma_f32_16x16x32_bf16 v[72:75], a[136:139], a[120:123], v[72:75]
    v_mfma_f32_16x16x32_bf16 v[16:19], a[140:143], a[108:111], v[16:19]
    v_mfma_f32_16x16x32_bf16 v[36:39], a[140:143], a[112:115], v[36:39]
    v_mfma_f32_16x16x32_bf16 v[56:59], a[140:143], a[116:119], v[56:59]
    v_mfma_f32_16x16x32_bf16 v[76:79], a[140:143], a[120:123], v[76:79]
    s_waitcnt vmcnt(12)
    v_mfma_f32_16x16x32_bf16 v[0:3], a[160:163], a[144:147], v[0:3]
    v_mfma_f32_16x16x32_bf16 v[20:23], a[160:163], a[148:151], v[20:23]
    v_mfma_f32_16x16x32_bf16 v[40:43], a[160:163], a[152:155], v[40:43]
    v_mfma_f32_16x16x32_bf16 v[60:63], a[160:163], a[156:159], v[60:63]
    v_mfma_f32_16x16x32_bf16 v[4:7], a[164:167], a[144:147], v[4:7]
    v_mfma_f32_16x16x32_bf16 v[24:27], a[164:167], a[148:151], v[24:27]
    v_mfma_f32_16x16x32_bf16 v[44:47], a[164:167], a[152:155], v[44:47]
    v_mfma_f32_16x16x32_bf16 v[64:67], a[164:167], a[156:159], v[64:67]
    v_mfma_f32_16x16x32_bf16 v[8:11], a[168:171], a[144:147], v[8:11]
    v_mfma_f32_16x16x32_bf16 v[28:31], a[168:171], a[148:151], v[28:31]
    v_mfma_f32_16x16x32_bf16 v[48:51], a[168:171], a[152:155], v[48:51]
    v_mfma_f32_16x16x32_bf16 v[68:71], a[168:171], a[156:159], v[68:71]
    v_mfma_f32_16x16x32_bf16 v[12:15], a[172:175], a[144:147], v[12:15]
    v_mfma_f32_16x16x32_bf16 v[32:35], a[172:175], a[148:151], v[32:35]
    v_mfma_f32_16x16x32_bf16 v[52:55], a[172:175], a[152:155], v[52:55]
    v_mfma_f32_16x16x32_bf16 v[72:75], a[172:175], a[156:159], v[72:75]
    v_mfma_f32_16x16x32_bf16 v[16:19], a[176:179], a[144:147], v[16:19]
    v_mfma_f32_16x16x32_bf16 v[36:39], a[176:179], a[148:151], v[36:39]
    v_mfma_f32_16x16x32_bf16 v[56:59], a[176:179], a[152:155], v[56:59]
    v_mfma_f32_16x16x32_bf16 v[76:79], a[176:179], a[156:159], v[76:79]
    s_waitcnt vmcnt(8)
    s_waitcnt lgkmcnt(14)
    v_mfma_f32_16x16x32_bf16 v[0:3], a[196:199], a[180:183], v[0:3]
    v_mfma_f32_16x16x32_bf16 v[20:23], a[196:199], a[184:187], v[20:23]
    v_mfma_f32_16x16x32_bf16 v[40:43], a[196:199], a[188:191], v[40:43]
    v_mfma_f32_16x16x32_bf16 v[60:63], a[196:199], a[192:195], v[60:63]
    s_waitcnt lgkmcnt(13)
    v_mfma_f32_16x16x32_bf16 v[4:7], a[200:203], a[180:183], v[4:7]
    v_mfma_f32_16x16x32_bf16 v[24:27], a[200:203], a[184:187], v[24:27]
    v_mfma_f32_16x16x32_bf16 v[44:47], a[200:203], a[188:191], v[44:47]
    v_mfma_f32_16x16x32_bf16 v[64:67], a[200:203], a[192:195], v[64:67]
    s_waitcnt lgkmcnt(12)
    v_mfma_f32_16x16x32_bf16 v[8:11], a[204:207], a[180:183], v[8:11]
    v_mfma_f32_16x16x32_bf16 v[28:31], a[204:207], a[184:187], v[28:31]
    v_mfma_f32_16x16x32_bf16 v[48:51], a[204:207], a[188:191], v[48:51]
    v_mfma_f32_16x16x32_bf16 v[68:71], a[204:207], a[192:195], v[68:71]
    s_waitcnt lgkmcnt(11)
    v_mfma_f32_16x16x32_bf16 v[12:15], a[208:211], a[180:183], v[12:15]
    v_mfma_f32_16x16x32_bf16 v[32:35], a[208:211], a[184:187], v[32:35]
    v_mfma_f32_16x16x32_bf16 v[52:55], a[208:211], a[188:191], v[52:55]
    v_mfma_f32_16x16x32_bf16 v[72:75], a[208:211], a[192:195], v[72:75]
    s_waitcnt lgkmcnt(10)
    v_mfma_f32_16x16x32_bf16 v[16:19], a[212:215], a[180:183], v[16:19]
    v_mfma_f32_16x16x32_bf16 v[36:39], a[212:215], a[184:187], v[36:39]
    v_mfma_f32_16x16x32_bf16 v[56:59], a[212:215], a[188:191], v[56:59]
    v_mfma_f32_16x16x32_bf16 v[76:79], a[212:215], a[192:195], v[76:79]
    s_cmp_eq_u32 s32, 3
    s_cbranch_scc1 L_ffn2_skip
    s_waitcnt vmcnt(4)
    s_waitcnt lgkmcnt(9)
    v_mfma_f32_16x16x32_bf16 v[0:3], a[16:19], a[0:3], v[0:3]
    v_mfma_f32_16x16x32_bf16 v[20:23], a[16:19], a[4:7], v[20:23]
    v_mfma_f32_16x16x32_bf16 v[40:43], a[16:19], a[8:11], v[40:43]
    v_mfma_f32_16x16x32_bf16 v[60:63], a[16:19], a[12:15], v[60:63]
    s_waitcnt lgkmcnt(8)
    v_mfma_f32_16x16x32_bf16 v[4:7], a[20:23], a[0:3], v[4:7]
    v_mfma_f32_16x16x32_bf16 v[24:27], a[20:23], a[4:7], v[24:27]
    v_mfma_f32_16x16x32_bf16 v[44:47], a[20:23], a[8:11], v[44:47]
    v_mfma_f32_16x16x32_bf16 v[64:67], a[20:23], a[12:15], v[64:67]
    s_waitcnt lgkmcnt(7)
    v_mfma_f32_16x16x32_bf16 v[8:11], a[24:27], a[0:3], v[8:11]
    v_mfma_f32_16x16x32_bf16 v[28:31], a[24:27], a[4:7], v[28:31]
    v_mfma_f32_16x16x32_bf16 v[48:51], a[24:27], a[8:11], v[48:51]
    v_mfma_f32_16x16x32_bf16 v[68:71], a[24:27], a[12:15], v[68:71]
    s_waitcnt lgkmcnt(6)
    v_mfma_f32_16x16x32_bf16 v[12:15], a[28:31], a[0:3], v[12:15]
    v_mfma_f32_16x16x32_bf16 v[32:35], a[28:31], a[4:7], v[32:35]
    v_mfma_f32_16x16x32_bf16 v[52:55], a[28:31], a[8:11], v[52:55]
    v_mfma_f32_16x16x32_bf16 v[72:75], a[28:31], a[12:15], v[72:75]
    s_waitcnt lgkmcnt(5)
    v_mfma_f32_16x16x32_bf16 v[16:19], a[32:35], a[0:3], v[16:19]
    v_mfma_f32_16x16x32_bf16 v[36:39], a[32:35], a[4:7], v[36:39]
    v_mfma_f32_16x16x32_bf16 v[56:59], a[32:35], a[8:11], v[56:59]
    v_mfma_f32_16x16x32_bf16 v[76:79], a[32:35], a[12:15], v[76:79]
    s_waitcnt vmcnt(0)
    s_waitcnt lgkmcnt(4)
    v_mfma_f32_16x16x32_bf16 v[0:3], a[52:55], a[36:39], v[0:3]
    v_mfma_f32_16x16x32_bf16 v[20:23], a[52:55], a[40:43], v[20:23]
    v_mfma_f32_16x16x32_bf16 v[40:43], a[52:55], a[44:47], v[40:43]
    v_mfma_f32_16x16x32_bf16 v[60:63], a[52:55], a[48:51], v[60:63]
    s_waitcnt lgkmcnt(3)
    v_mfma_f32_16x16x32_bf16 v[4:7], a[56:59], a[36:39], v[4:7]
    v_mfma_f32_16x16x32_bf16 v[24:27], a[56:59], a[40:43], v[24:27]
    v_mfma_f32_16x16x32_bf16 v[44:47], a[56:59], a[44:47], v[44:47]
    v_mfma_f32_16x16x32_bf16 v[64:67], a[56:59], a[48:51], v[64:67]
    s_waitcnt lgkmcnt(2)
    v_mfma_f32_16x16x32_bf16 v[8:11], a[60:63], a[36:39], v[8:11]
    v_mfma_f32_16x16x32_bf16 v[28:31], a[60:63], a[40:43], v[28:31]
    v_mfma_f32_16x16x32_bf16 v[48:51], a[60:63], a[44:47], v[48:51]
    v_mfma_f32_16x16x32_bf16 v[68:71], a[60:63], a[48:51], v[68:71]
    s_waitcnt lgkmcnt(1)
    v_mfma_f32_16x16x32_bf16 v[12:15], a[64:67], a[36:39], v[12:15]
    v_mfma_f32_16x16x32_bf16 v[32:35], a[64:67], a[40:43], v[32:35]
    v_mfma_f32_16x16x32_bf16 v[52:55], a[64:67], a[44:47], v[52:55]
    v_mfma_f32_16x16x32_bf16 v[72:75], a[64:67], a[48:51], v[72:75]
    s_waitcnt lgkmcnt(0)
    v_mfma_f32_16x16x32_bf16 v[16:19], a[68:71], a[36:39], v[16:19]
    v_mfma_f32_16x16x32_bf16 v[36:39], a[68:71], a[40:43], v[36:39]
    v_mfma_f32_16x16x32_bf16 v[56:59], a[68:71], a[44:47], v[56:59]
    v_mfma_f32_16x16x32_bf16 v[76:79], a[68:71], a[48:51], v[76:79]
L_ffn2_skip:
    s_waitcnt vmcnt(0) lgkmcnt(0)
    s_barrier
    s_nop 7
    s_mul_i32 s39, s32, 5120
    v_add_u32 v230, s39, v236
    v_add_u32 v229, 40960, v230
    ds_write_b128 v230, v[20:23] offset:0
    ds_write_b128 v230, v[24:27] offset:1024
    ds_write_b128 v230, v[28:31] offset:2048
    ds_write_b128 v230, v[32:35] offset:3072
    ds_write_b128 v230, v[36:39] offset:4096
    ds_write_b128 v230, v[40:43] offset:20480
    ds_write_b128 v230, v[44:47] offset:21504
    ds_write_b128 v230, v[48:51] offset:22528
    ds_write_b128 v230, v[52:55] offset:23552
    ds_write_b128 v230, v[56:59] offset:24576
    ds_write_b128 v229, v[60:63] offset:0
    ds_write_b128 v229, v[64:67] offset:1024
    ds_write_b128 v229, v[68:71] offset:2048
    ds_write_b128 v229, v[72:75] offset:3072
    ds_write_b128 v229, v[76:79] offset:4096
    s_sub_u32 s39, s32, 1
    s_and_b32 s39, s39, 3
    s_mul_i32 s39, s39, 5120
    s_add_u32 s39, s39, 0
    v_add_u32 v227, s39, v236
    s_sub_u32 s39, s32, 2
    s_and_b32 s39, s39, 3
    s_mul_i32 s39, s39, 5120
    s_add_u32 s39, s39, 20480
    v_add_u32 v228, s39, v236
    s_sub_u32 s39, s32, 3
    s_and_b32 s39, s39, 3
    s_mul_i32 s39, s39, 5120
    s_add_u32 s39, s39, 40960
    v_add_u32 v229, s39, v236
    s_waitcnt lgkmcnt(0)
    s_barrier
    ds_read_b128 v[20:23], v227 offset:0
    ds_read_b128 v[40:43], v228 offset:0
    ds_read_b128 v[60:63], v229 offset:0
    ds_read_b128 v[24:27], v227 offset:1024
    ds_read_b128 v[44:47], v228 offset:1024
    ds_read_b128 v[64:67], v229 offset:1024
    ds_read_b128 v[28:31], v227 offset:2048
    ds_read_b128 v[48:51], v228 offset:2048
    ds_read_b128 v[68:71], v229 offset:2048
    ds_read_b128 v[32:35], v227 offset:3072
    ds_read_b128 v[52:55], v228 offset:3072
    ds_read_b128 v[72:75], v229 offset:3072
    ds_read_b128 v[36:39], v227 offset:4096
    ds_read_b128 v[56:59], v228 offset:4096
    ds_read_b128 v[76:79], v229 offset:4096
    s_waitcnt lgkmcnt(14)
    v_add_f32 v0, v0, v20
    s_waitcnt lgkmcnt(12)
    v_add_f32 v40, v40, v60
    v_add_f32 v0, v0, v40
    v_add_f32 v1, v1, v21
    v_add_f32 v41, v41, v61
    v_add_f32 v1, v1, v41
    v_add_f32 v2, v2, v22
    v_add_f32 v42, v42, v62
    v_add_f32 v2, v2, v42
    v_add_f32 v3, v3, v23
    v_add_f32 v43, v43, v63
    v_add_f32 v3, v3, v43
    s_waitcnt lgkmcnt(11)
    v_add_f32 v4, v4, v24
    s_waitcnt lgkmcnt(9)
    v_add_f32 v44, v44, v64
    v_add_f32 v4, v4, v44
    v_add_f32 v5, v5, v25
    v_add_f32 v45, v45, v65
    v_add_f32 v5, v5, v45
    v_add_f32 v6, v6, v26
    v_add_f32 v46, v46, v66
    v_add_f32 v6, v6, v46
    v_add_f32 v7, v7, v27
    v_add_f32 v47, v47, v67
    v_add_f32 v7, v7, v47
    s_waitcnt lgkmcnt(8)
    v_add_f32 v8, v8, v28
    s_waitcnt lgkmcnt(6)
    v_add_f32 v48, v48, v68
    v_add_f32 v8, v8, v48
    v_add_f32 v9, v9, v29
    v_add_f32 v49, v49, v69
    v_add_f32 v9, v9, v49
    v_add_f32 v10, v10, v30
    v_add_f32 v50, v50, v70
    v_add_f32 v10, v10, v50
    v_add_f32 v11, v11, v31
    v_add_f32 v51, v51, v71
    v_add_f32 v11, v11, v51
    s_waitcnt lgkmcnt(5)
    v_add_f32 v12, v12, v32
    s_waitcnt lgkmcnt(3)
    v_add_f32 v52, v52, v72
    v_add_f32 v12, v12, v52
    v_add_f32 v13, v13, v33
    v_add_f32 v53, v53, v73
    v_add_f32 v13, v13, v53
    v_add_f32 v14, v14, v34
    v_add_f32 v54, v54, v74
    v_add_f32 v14, v14, v54
    v_add_f32 v15, v15, v35
    v_add_f32 v55, v55, v75
    v_add_f32 v15, v15, v55
    s_waitcnt lgkmcnt(2)
    v_add_f32 v16, v16, v36
    s_waitcnt lgkmcnt(0)
    v_add_f32 v56, v56, v76
    v_add_f32 v16, v16, v56
    v_add_f32 v17, v17, v37
    v_add_f32 v57, v57, v77
    v_add_f32 v17, v17, v57
    v_add_f32 v18, v18, v38
    v_add_f32 v58, v58, v78
    v_add_f32 v18, v18, v58
    v_add_f32 v19, v19, v39
    v_add_f32 v59, v59, v79
    v_add_f32 v19, v19, v59
    s_mul_i32 s39, s32, 2560
    s_add_u32 s39, s39, 61440
    v_mul_u32_u24 v22, 160, v239
    v_lshl_add_u32 v22, v238, 3, v22
    v_add_u32 v22, s39, v22
    v_add_u32 v23, s39, v236
    v_mul_f32 v100, 0x3f317218, v100
    v_fma_f32 v0, v100, v0, v200
    v_mul_f32 v101, 0x3f317218, v101
    v_fma_f32 v1, v101, v1, v201
    v_mul_f32 v102, 0x3f317218, v102
    v_fma_f32 v2, v102, v2, v202
    v_mul_f32 v103, 0x3f317218, v103
    v_fma_f32 v3, v103, v3, v203
    v_cvt_pk_bf16_f32 v24, v0, v1
    v_cvt_pk_bf16_f32 v25, v2, v3
    ds_write_b64 v22, v[24:25] offset:0
    v_mul_f32 v104, 0x3f317218, v104
    v_fma_f32 v4, v104, v4, v204
    v_mul_f32 v105, 0x3f317218, v105
    v_fma_f32 v5, v105, v5, v205
    v_mul_f32 v106, 0x3f317218, v106
    v_fma_f32 v6, v106, v6, v206
    v_mul_f32 v107, 0x3f317218, v107
    v_fma_f32 v7, v107, v7, v207
    v_cvt_pk_bf16_f32 v26, v4, v5
    v_cvt_pk_bf16_f32 v27, v6, v7
    ds_write_b64 v22, v[26:27] offset:32
    v_mul_f32 v108, 0x3f317218, v108
    v_fma_f32 v8, v108, v8, v208
    v_mul_f32 v109, 0x3f317218, v109
    v_fma_f32 v9, v109, v9, v209
    v_mul_f32 v110, 0x3f317218, v110
    v_fma_f32 v10, v110, v10, v210
    v_mul_f32 v111, 0x3f317218, v111
    v_fma_f32 v11, v111, v11, v211
    v_cvt_pk_bf16_f32 v28, v8, v9
    v_cvt_pk_bf16_f32 v29, v10, v11
    ds_write_b64 v22, v[28:29] offset:64
    v_mul_f32 v112, 0x3f317218, v112
    v_fma_f32 v12, v112, v12, v212
    v_mul_f32 v113, 0x3f317218, v113
    v_fma_f32 v13, v113, v13, v213
    v_mul_f32 v114, 0x3f317218, v114
    v_fma_f32 v14, v114, v14, v214
    v_mul_f32 v115, 0x3f317218, v115
    v_fma_f32 v15, v115, v15, v215
    v_cvt_pk_bf16_f32 v30, v12, v13
    v_cvt_pk_bf16_f32 v31, v14, v15
    ds_write_b64 v22, v[30:31] offset:96
    v_mul_f32 v116, 0x3f317218, v116
    v_fma_f32 v16, v116, v16, v216
    v_mul_f32 v117, 0x3f317218, v117
    v_fma_f32 v17, v117, v17, v217
    v_mul_f32 v118, 0x3f317218, v118
    v_fma_f32 v18, v118, v18, v218
    v_mul_f32 v119, 0x3f317218, v119
    v_fma_f32 v19, v119, v19, v219
    v_cvt_pk_bf16_f32 v32, v16, v17
    v_cvt_pk_bf16_f32 v33, v18, v19
    ds_write_b64 v22, v[32:33] offset:128
    s_lshl_b32 s40, s33, 2
    s_add_u32 s40, s40, s32
    s_mul_i32 s40, s40, 20480
    s_mul_i32 s41, s34, 160
    s_add_u32 s40, s40, s41
    v_lshrrev_b32 v40, 4, v236
    v_mul_u32_u24 v41, 6554, v40
    v_lshrrev_b32 v41, 16, v41
    v_mul_u32_u24 v42, 10, v41
    v_sub_u32 v42, v40, v42
    v_mul_u32_u24 v41, 1280, v41
    v_lshl_add_u32 v44, v42, 4, v41
    v_add_u32 v40, 64, v40
    v_mul_u32_u24 v41, 6554, v40
    v_lshrrev_b32 v41, 16, v41
    v_mul_u32_u24 v42, 10, v41
    v_sub_u32 v42, v40, v42
    v_mul_u32_u24 v41, 1280, v41
    v_lshl_add_u32 v45, v42, 4, v41
    v_add_u32 v40, 64, v40
    v_mul_u32_u24 v41, 6554, v40
    v_lshrrev_b32 v41, 16, v41
    v_mul_u32_u24 v42, 10, v41
    v_sub_u32 v42, v40, v42
    v_mul_u32_u24 v41, 1280, v41
    v_lshl_add_u32 v46, v42, 4, v41
    s_waitcnt lgkmcnt(0)
    ds_read_b128 v[48:51], v23 offset:0
    ds_read_b128 v[52:55], v23 offset:1024
    ds_read_b128 v[56:59], v23 offset:2048
    s_waitcnt lgkmcnt(2)
    buffer_store_dwordx4 v[48:51], v44, s[24:27], s40 offen sc1
    s_waitcnt lgkmcnt(1)
    buffer_store_dwordx4 v[52:55], v45, s[24:27], s40 offen sc1
    s_mov_b32 exec_hi, 0
    s_waitcnt lgkmcnt(0)
    buffer_store_dwordx4 v[56:59], v46, s[24:27], s40 offen sc1
    s_mov_b64 exec, -1
    s_endpgm
L_side0:
    s_load_dwordx2 s[4:5], s[0:1], 32
    s_lshl_b32 s40, s2, 2
    s_add_u32 s40, s40, s32
    s_mul_i32 s40, s40, 40
    v_and_b32 v220, 63, v249
    v_min_u32 v220, 39, v220
    v_add_u32 v220, s40, v220
    v_lshlrev_b32 v220, 7, v220
    s_waitcnt lgkmcnt(0)
    s_mov_b32 s56, s4
    s_mov_b32 s57, s5
    s_and_b32 s57, s57, 0xffff
    s_mov_b32 s58, 0x500000
    s_mov_b32 s59, 0x20000
    buffer_load_dword v221, v220, s[56:59], 0 offen
    s_load_dwordx2 s[4:5], s[0:1], 56
    s_lshl_b32 s40, s2, 2
    s_add_u32 s40, s40, s32
    s_mul_i32 s40, s40, 17
    v_and_b32 v220, 63, v249
    v_min_u32 v220, 16, v220
    v_add_u32 v220, s40, v220
    v_lshlrev_b32 v220, 7, v220
    s_waitcnt lgkmcnt(0)
    s_mov_b32 s56, s4
    s_mov_b32 s57, s5
    s_and_b32 s57, s57, 0xffff
    s_mov_b32 s58, 0x21c000
    s_mov_b32 s59, 0x20000
    buffer_load_dword v222, v220, s[56:59], 0 offen
    s_branch L_side_ret

L_exact:
    s_lshl_b32 s40, s32, 14
    v_add_u32 v176, s40, v164
    v_subrev_u32 v188, s35, v244
    v_add_u32 v177, s40, v165
    v_subrev_u32 v189, s35, v245
    v_add_u32 v178, s40, v166
    v_subrev_u32 v190, s35, v246
    v_add_u32 v179, s40, v167
    v_subrev_u32 v191, s35, v247
    v_add_u32 v180, s40, v236
    v_add_u32 v181, s40, v237
    v_add_u32 v182, s40, v238
    v_add_u32 v183, s40, v239
    v_add_u32 v184, s40, v240
    v_add_u32 v185, s40, v241
    v_add_u32 v186, s40, v242
    v_add_u32 v187, s40, v243
    v_subrev_u32 v192, s35, v252
    v_subrev_u32 v193, s35, v253
    v_mov_b32 v0, 0
    v_mov_b32 v1, 0
    v_mov_b32 v2, 0
    v_mov_b32 v3, 0
    v_mov_b32 v4, 0
    v_mov_b32 v5, 0
    v_mov_b32 v6, 0
    v_mov_b32 v7, 0
    v_mov_b32 v8, 0
    v_mov_b32 v9, 0
    v_mov_b32 v10, 0
    v_mov_b32 v11, 0
    v_mov_b32 v12, 0
    v_mov_b32 v13, 0
    v_mov_b32 v14, 0
    v_mov_b32 v15, 0
    v_mov_b32 v16, 0
    v_mov_b32 v17, 0
    v_mov_b32 v18, 0
    v_mov_b32 v19, 0
    v_mov_b32 v20, 0
    v_mov_b32 v21, 0
    v_mov_b32 v22, 0
    v_mov_b32 v23, 0
    v_mov_b32 v24, 0
    v_mov_b32 v25, 0
    v_mov_b32 v26, 0
    v_mov_b32 v27, 0
    v_mov_b32 v28, 0
    v_mov_b32 v29, 0
    v_mov_b32 v30, 0
    v_mov_b32 v31, 0
    v_mov_b32 v32, 0
    v_mov_b32 v33, 0
    v_mov_b32 v34, 0
    v_mov_b32 v35, 0
    v_mov_b32 v36, 0
    v_mov_b32 v37, 0
    v_mov_b32 v38, 0
    v_mov_b32 v39, 0
    v_mov_b32 v40, 0
    v_mov_b32 v41, 0
    v_mov_b32 v42, 0
    v_mov_b32 v43, 0
    v_mov_b32 v44, 0
    v_mov_b32 v45, 0
    v_mov_b32 v46, 0
    v_mov_b32 v47, 0
    v_mov_b32 v48, 0
    v_mov_b32 v49, 0
    v_mov_b32 v50, 0
    v_mov_b32 v51, 0
    v_mov_b32 v52, 0
    v_mov_b32 v53, 0
    v_mov_b32 v54, 0
    v_mov_b32 v55, 0
    v_mov_b32 v56, 0
    v_mov_b32 v57, 0
    v_mov_b32 v58, 0
    v_mov_b32 v59, 0
    v_mov_b32 v60, 0
    v_mov_b32 v61, 0
    v_mov_b32 v62, 0
    v_mov_b32 v63, 0
    v_mov_b32 v64, 0
    v_mov_b32 v65, 0
    v_mov_b32 v66, 0
    v_mov_b32 v67, 0
    v_mov_b32 v68, 0
    v_mov_b32 v69, 0
    v_mov_b32 v70, 0
    v_mov_b32 v71, 0
    v_mov_b32 v72, 0
    v_mov_b32 v73, 0
    v_mov_b32 v74, 0
    v_mov_b32 v75, 0
    v_mov_b32 v76, 0
    v_mov_b32 v77, 0
    v_mov_b32 v78, 0
    v_mov_b32 v79, 0
    v_mov_b32 v80, 0
    v_mov_b32 v81, 0
    v_mov_b32 v82, 0
    v_mov_b32 v83, 0
    v_mov_b32 v84, 0
    v_mov_b32 v85, 0
    v_mov_b32 v86, 0
    v_mov_b32 v87, 0
    v_mov_b32 v88, 0
    v_mov_b32 v89, 0
    v_mov_b32 v90, 0
    v_mov_b32 v91, 0
    v_mov_b32 v92, 0
    v_mov_b32 v93, 0
    v_mov_b32 v94, 0
    v_mov_b32 v95, 0
    v_mov_b32 v96, 0
    v_mov_b32 v97, 0
    v_mov_b32 v98, 0
    v_mov_b32 v99, 0
    v_mov_b32 v100, 0
    v_mov_b32 v101, 0
    v_mov_b32 v102, 0
    v_mov_b32 v103, 0
    v_mov_b32 v104, 0
    v_mov_b32 v105, 0
    v_mov_b32 v106, 0
    v_mov_b32 v107, 0
    v_mov_b32 v108, 0
    v_mov_b32 v109, 0
    v_mov_b32 v110, 0
    v_mov_b32 v111, 0
    v_mov_b32 v112, 0
    v_mov_b32 v113, 0
    v_mov_b32 v114, 0
    v_mov_b32 v115, 0
    v_mov_b32 v116, 0
    v_mov_b32 v117, 0
    v_mov_b32 v118, 0
    v_mov_b32 v119, 0
    v_mov_b32 v120, 0
    v_mov_b32 v121, 0
    v_mov_b32 v122, 0
    v_mov_b32 v123, 0
    v_mov_b32 v124, 0
    v_mov_b32 v125, 0
    v_mov_b32 v126, 0
    v_mov_b32 v127, 0
    v_mov_b32 v168, 0xff800000
    v_mov_b32 v160, 0
    v_mov_b32 v169, 0xff800000
    v_mov_b32 v161, 0
    v_mov_b32 v170, 0xff800000
    v_mov_b32 v162, 0
    v_mov_b32 v171, 0xff800000
    v_mov_b32 v163, 0
    s_mov_b32 s39, 0
L_exact_loop:
    s_add_u32 m0, s40, 0
    s_add_u32 s41, s39, 0
    buffer_load_dwordx4 v188, s[8:11], s41 offen offset:0 lds
    buffer_load_dwordx4 v189, s[8:11], s41 offen offset:1024 lds
    buffer_load_dwordx4 v190, s[8:11], s41 offen offset:2048 lds
    buffer_load_dwordx4 v191, s[8:11], s41 offen offset:3072 lds
    s_add_u32 m0, s40, 65536
    s_nop 0
    buffer_load_dwordx4 v192, s[12:15], s41 offen offset:0 lds
    buffer_load_dwordx4 v193, s[12:15], s41 offen offset:1024 lds
    buffer_load_dwordx4 v192, s[12:15], s41 offen offset:2048 lds
    buffer_load_dwordx4 v193, s[12:15], s41 offen offset:3072 lds
    s_add_u32 m0, s40, 4096
    s_add_u32 s41, s39, 4096
    buffer_load_dwordx4 v188, s[8:11], s41 offen offset:0 lds
    buffer_load_dwordx4 v189, s[8:11], s41 offen offset:1024 lds
    buffer_load_dwordx4 v190, s[8:11], s41 offen offset:2048 lds
    buffer_load_dwordx4 v191, s[8:11], s41 offen offset:3072 lds
    s_add_u32 m0, s40, 69632
    s_nop 0
    buffer_load_dwordx4 v192, s[12:15], s41 offen offset:0 lds
    buffer_load_dwordx4 v193, s[12:15], s41 offen offset:1024 lds
    buffer_load_dwordx4 v192, s[12:15], s41 offen offset:2048 lds
    buffer_load_dwordx4 v193, s[12:15], s41 offen offset:3072 lds
    s_waitcnt vmcnt(0)
    ds_read_b128 a[64:67], v176 offset:0
    ds_read_b128 a[68:71], v177 offset:0
    ds_read_b128 a[72:75], v178 offset:0
    ds_read_b128 a[76:79], v179 offset:0
    ds_read_b128 a[80:83], v176 offset:4096
    ds_read_b128 a[84:87], v177 offset:4096
    ds_read_b128 a[88:91], v178 offset:4096
    ds_read_b128 a[92:95], v179 offset:4096
    ds_read_b64_tr_b16 a[128:129], v180 offset:0
    ds_read_b64_tr_b16 a[130:131], v180 offset:4096
    ds_read_b64_tr_b16 a[132:133], v181 offset:0
    ds_read_b64_tr_b16 a[134:135], v181 offset:4096
    ds_read_b64_tr_b16 a[136:137], v182 offset:0
    ds_read_b64_tr_b16 a[138:139], v182 offset:4096
    ds_read_b64_tr_b16 a[140:141], v183 offset:0
    ds_read_b64_tr_b16 a[142:143], v183 offset:4096
    ds_read_b64_tr_b16 a[144:145], v184 offset:0
    ds_read_b64_tr_b16 a[146:147], v184 offset:4096
    ds_read_b64_tr_b16 a[148:149], v185 offset:0
    ds_read_b64_tr_b16 a[150:151], v185 offset:4096
    ds_read_b64_tr_b16 a[152:153], v186 offset:0
    ds_read_b64_tr_b16 a[154:155], v186 offset:4096
    ds_read_b64_tr_b16 a[156:157], v187 offset:0
    ds_read_b64_tr_b16 a[158:159], v187 offset:4096
    s_waitcnt lgkmcnt(0)
    v_mfma_f32_16x16x32_bf16 v[128:131], a[64:67], a[0:3], 0
    v_mfma_f32_16x16x32_bf16 v[128:131], a[68:71], a[4:7], v[128:131]
    v_mfma_f32_16x16x32_bf16 v[128:131], a[72:75], a[8:11], v[128:131]
    v_mfma_f32_16x16x32_bf16 v[128:131], a[76:79], a[12:15], v[128:131]
    v_mfma_f32_16x16x32_bf16 v[132:135], a[80:83], a[0:3], 0
    v_mfma_f32_16x16x32_bf16 v[132:135], a[84:87], a[4:7], v[132:135]
    v_mfma_f32_16x16x32_bf16 v[132:135], a[88:91], a[8:11], v[132:135]
    v_mfma_f32_16x16x32_bf16 v[132:135], a[92:95], a[12:15], v[132:135]
    s_nop 7
    v_max3_f32 v173, v128, v129, v130
    v_max3_f32 v173, v131, v132, v173
    v_max3_f32 v173, v133, v134, v173
    v_max_f32 v173, v135, v173
    v_mov_b32 v174, v173
    s_nop 1
    v_permlane16_swap_b32 v174, v173
    v_max_f32 v173, v173, v174
    v_mov_b32 v174, v173
    s_nop 1
    v_permlane32_swap_b32 v174, v173
    v_max_f32 v173, v173, v174
    v_max_f32 v173, v168, v173
    v_sub_f32 v172, v168, v173
    v_exp_f32 v172, v172
    v_mov_b32 v168, v173
    v_sub_f32 v152, v128, v173
    v_sub_f32 v153, v129, v173
    v_sub_f32 v154, v130, v173
    v_sub_f32 v155, v131, v173
    v_sub_f32 v156, v132, v173
    v_sub_f32 v157, v133, v173
    v_sub_f32 v158, v134, v173
    v_sub_f32 v159, v135, v173
    v_exp_f32 v152, v152
    v_exp_f32 v153, v153
    v_exp_f32 v154, v154
    v_exp_f32 v155, v155
    v_exp_f32 v156, v156
    v_exp_f32 v157, v157
    v_exp_f32 v158, v158
    v_exp_f32 v159, v159
    v_mul_f32 v160, v160, v172
    v_mul_f32 v0, v0, v172
    v_mul_f32 v1, v1, v172
    v_mul_f32 v2, v2, v172
    v_mul_f32 v3, v3, v172
    v_mul_f32 v4, v4, v172
    v_mul_f32 v5, v5, v172
    v_mul_f32 v6, v6, v172
    v_mul_f32 v7, v7, v172
    v_mul_f32 v8, v8, v172
    v_mul_f32 v9, v9, v172
    v_mul_f32 v10, v10, v172
    v_mul_f32 v11, v11, v172
    v_mul_f32 v12, v12, v172
    v_mul_f32 v13, v13, v172
    v_mul_f32 v14, v14, v172
    v_mul_f32 v15, v15, v172
    v_mul_f32 v16, v16, v172
    v_mul_f32 v17, v17, v172
    v_mul_f32 v18, v18, v172
    v_mul_f32 v19, v19, v172
    v_mul_f32 v20, v20, v172
    v_mul_f32 v21, v21, v172
    v_mul_f32 v22, v22, v172
    v_mul_f32 v23, v23, v172
    v_mul_f32 v24, v24, v172
    v_mul_f32 v25, v25, v172
    v_mul_f32 v26, v26, v172
    v_mul_f32 v27, v27, v172
    v_mul_f32 v28, v28, v172
    v_mul_f32 v29, v29, v172
    v_mul_f32 v30, v30, v172
    v_mul_f32 v31, v31, v172
    v_add_f32 v160, v152, v160
    v_add_f32 v160, v153, v160
    v_add_f32 v160, v154, v160
    v_add_f32 v160, v155, v160
    v_add_f32 v160, v156, v160
    v_add_f32 v160, v157, v160
    v_add_f32 v160, v158, v160
    v_add_f32 v160, v159, v160
    v_cvt_pk_bf16_f32 v144, v152, v153
    v_cvt_pk_bf16_f32 v145, v154, v155
    v_cvt_pk_bf16_f32 v146, v156, v157
    v_cvt_pk_bf16_f32 v147, v158, v159
    s_nop 1
    v_mfma_f32_16x16x32_bf16 v[0:3], a[128:131], v[144:147], v[0:3]
    v_mfma_f32_16x16x32_bf16 v[4:7], a[132:135], v[144:147], v[4:7]
    v_mfma_f32_16x16x32_bf16 v[8:11], a[136:139], v[144:147], v[8:11]
    v_mfma_f32_16x16x32_bf16 v[12:15], a[140:143], v[144:147], v[12:15]
    v_mfma_f32_16x16x32_bf16 v[16:19], a[144:147], v[144:147], v[16:19]
    v_mfma_f32_16x16x32_bf16 v[20:23], a[148:151], v[144:147], v[20:23]
    v_mfma_f32_16x16x32_bf16 v[24:27], a[152:155], v[144:147], v[24:27]
    v_mfma_f32_16x16x32_bf16 v[28:31], a[156:159], v[144:147], v[28:31]
    s_nop 3
    v_mfma_f32_16x16x32_bf16 v[128:131], a[64:67], a[16:19], 0
    v_mfma_f32_16x16x32_bf16 v[128:131], a[68:71], a[20:23], v[128:131]
    v_mfma_f32_16x16x32_bf16 v[128:131], a[72:75], a[24:27], v[128:131]
    v_mfma_f32_16x16x32_bf16 v[128:131], a[76:79], a[28:31], v[128:131]
    v_mfma_f32_16x16x32_bf16 v[132:135], a[80:83], a[16:19], 0
    v_mfma_f32_16x16x32_bf16 v[132:135], a[84:87], a[20:23], v[132:135]
    v_mfma_f32_16x16x32_bf16 v[132:135], a[88:91], a[24:27], v[132:135]
    v_mfma_f32_16x16x32_bf16 v[132:135], a[92:95], a[28:31], v[132:135]
    s_nop 7
    v_max3_f32 v173, v128, v129, v130
    v_max3_f32 v173, v131, v132, v173
    v_max3_f32 v173, v133, v134, v173
    v_max_f32 v173, v135, v173
    v_mov_b32 v174, v173
    s_nop 1
    v_permlane16_swap_b32 v174, v173
    v_max_f32 v173, v173, v174
    v_mov_b32 v174, v173
    s_nop 1
    v_permlane32_swap_b32 v174, v173
    v_max_f32 v173, v173, v174
    v_max_f32 v173, v169, v173
    v_sub_f32 v172, v169, v173
    v_exp_f32 v172, v172
    v_mov_b32 v169, v173
    v_sub_f32 v152, v128, v173
    v_sub_f32 v153, v129, v173
    v_sub_f32 v154, v130, v173
    v_sub_f32 v155, v131, v173
    v_sub_f32 v156, v132, v173
    v_sub_f32 v157, v133, v173
    v_sub_f32 v158, v134, v173
    v_sub_f32 v159, v135, v173
    v_exp_f32 v152, v152
    v_exp_f32 v153, v153
    v_exp_f32 v154, v154
    v_exp_f32 v155, v155
    v_exp_f32 v156, v156
    v_exp_f32 v157, v157
    v_exp_f32 v158, v158
    v_exp_f32 v159, v159
    v_mul_f32 v161, v161, v172
    v_mul_f32 v32, v32, v172
    v_mul_f32 v33, v33, v172
    v_mul_f32 v34, v34, v172
    v_mul_f32 v35, v35, v172
    v_mul_f32 v36, v36, v172
    v_mul_f32 v37, v37, v172
    v_mul_f32 v38, v38, v172
    v_mul_f32 v39, v39, v172
    v_mul_f32 v40, v40, v172
    v_mul_f32 v41, v41, v172
    v_mul_f32 v42, v42, v172
    v_mul_f32 v43, v43, v172
    v_mul_f32 v44, v44, v172
    v_mul_f32 v45, v45, v172
    v_mul_f32 v46, v46, v172
    v_mul_f32 v47, v47, v172
    v_mul_f32 v48, v48, v172
    v_mul_f32 v49, v49, v172
    v_mul_f32 v50, v50, v172
    v_mul_f32 v51, v51, v172
    v_mul_f32 v52, v52, v172
    v_mul_f32 v53, v53, v172
    v_mul_f32 v54, v54, v172
    v_mul_f32 v55, v55, v172
    v_mul_f32 v56, v56, v172
    v_mul_f32 v57, v57, v172
    v_mul_f32 v58, v58, v172
    v_mul_f32 v59, v59, v172
    v_mul_f32 v60, v60, v172
    v_mul_f32 v61, v61, v172
    v_mul_f32 v62, v62, v172
    v_mul_f32 v63, v63, v172
    v_add_f32 v161, v152, v161
    v_add_f32 v161, v153, v161
    v_add_f32 v161, v154, v161
    v_add_f32 v161, v155, v161
    v_add_f32 v161, v156, v161
    v_add_f32 v161, v157, v161
    v_add_f32 v161, v158, v161
    v_add_f32 v161, v159, v161
    v_cvt_pk_bf16_f32 v144, v152, v153
    v_cvt_pk_bf16_f32 v145, v154, v155
    v_cvt_pk_bf16_f32 v146, v156, v157
    v_cvt_pk_bf16_f32 v147, v158, v159
    s_nop 1
    v_mfma_f32_16x16x32_bf16 v[32:35], a[128:131], v[144:147], v[32:35]
    v_mfma_f32_16x16x32_bf16 v[36:39], a[132:135], v[144:147], v[36:39]
    v_mfma_f32_16x16x32_bf16 v[40:43], a[136:139], v[144:147], v[40:43]
    v_mfma_f32_16x16x32_bf16 v[44:47], a[140:143], v[144:147], v[44:47]
    v_mfma_f32_16x16x32_bf16 v[48:51], a[144:147], v[144:147], v[48:51]
    v_mfma_f32_16x16x32_bf16 v[52:55], a[148:151], v[144:147], v[52:55]
    v_mfma_f32_16x16x32_bf16 v[56:59], a[152:155], v[144:147], v[56:59]
    v_mfma_f32_16x16x32_bf16 v[60:63], a[156:159], v[144:147], v[60:63]
    s_nop 3
    v_mfma_f32_16x16x32_bf16 v[128:131], a[64:67], a[32:35], 0
    v_mfma_f32_16x16x32_bf16 v[128:131], a[68:71], a[36:39], v[128:131]
    v_mfma_f32_16x16x32_bf16 v[128:131], a[72:75], a[40:43], v[128:131]
    v_mfma_f32_16x16x32_bf16 v[128:131], a[76:79], a[44:47], v[128:131]
    v_mfma_f32_16x16x32_bf16 v[132:135], a[80:83], a[32:35], 0
    v_mfma_f32_16x16x32_bf16 v[132:135], a[84:87], a[36:39], v[132:135]
    v_mfma_f32_16x16x32_bf16 v[132:135], a[88:91], a[40:43], v[132:135]
    v_mfma_f32_16x16x32_bf16 v[132:135], a[92:95], a[44:47], v[132:135]
    s_nop 7
    v_max3_f32 v173, v128, v129, v130
    v_max3_f32 v173, v131, v132, v173
    v_max3_f32 v173, v133, v134, v173
    v_max_f32 v173, v135, v173
    v_mov_b32 v174, v173
    s_nop 1
    v_permlane16_swap_b32 v174, v173
    v_max_f32 v173, v173, v174
    v_mov_b32 v174, v173
    s_nop 1
    v_permlane32_swap_b32 v174, v173
    v_max_f32 v173, v173, v174
    v_max_f32 v173, v170, v173
    v_sub_f32 v172, v170, v173
    v_exp_f32 v172, v172
    v_mov_b32 v170, v173
    v_sub_f32 v152, v128, v173
    v_sub_f32 v153, v129, v173
    v_sub_f32 v154, v130, v173
    v_sub_f32 v155, v131, v173
    v_sub_f32 v156, v132, v173
    v_sub_f32 v157, v133, v173
    v_sub_f32 v158, v134, v173
    v_sub_f32 v159, v135, v173
    v_exp_f32 v152, v152
    v_exp_f32 v153, v153
    v_exp_f32 v154, v154
    v_exp_f32 v155, v155
    v_exp_f32 v156, v156
    v_exp_f32 v157, v157
    v_exp_f32 v158, v158
    v_exp_f32 v159, v159
    v_mul_f32 v162, v162, v172
    v_mul_f32 v64, v64, v172
    v_mul_f32 v65, v65, v172
    v_mul_f32 v66, v66, v172
    v_mul_f32 v67, v67, v172
    v_mul_f32 v68, v68, v172
    v_mul_f32 v69, v69, v172
    v_mul_f32 v70, v70, v172
    v_mul_f32 v71, v71, v172
    v_mul_f32 v72, v72, v172
    v_mul_f32 v73, v73, v172
    v_mul_f32 v74, v74, v172
    v_mul_f32 v75, v75, v172
    v_mul_f32 v76, v76, v172
    v_mul_f32 v77, v77, v172
    v_mul_f32 v78, v78, v172
    v_mul_f32 v79, v79, v172
    v_mul_f32 v80, v80, v172
    v_mul_f32 v81, v81, v172
    v_mul_f32 v82, v82, v172
    v_mul_f32 v83, v83, v172
    v_mul_f32 v84, v84, v172
    v_mul_f32 v85, v85, v172
    v_mul_f32 v86, v86, v172
    v_mul_f32 v87, v87, v172
    v_mul_f32 v88, v88, v172
    v_mul_f32 v89, v89, v172
    v_mul_f32 v90, v90, v172
    v_mul_f32 v91, v91, v172
    v_mul_f32 v92, v92, v172
    v_mul_f32 v93, v93, v172
    v_mul_f32 v94, v94, v172
    v_mul_f32 v95, v95, v172
    v_add_f32 v162, v152, v162
    v_add_f32 v162, v153, v162
    v_add_f32 v162, v154, v162
    v_add_f32 v162, v155, v162
    v_add_f32 v162, v156, v162
    v_add_f32 v162, v157, v162
    v_add_f32 v162, v158, v162
    v_add_f32 v162, v159, v162
    v_cvt_pk_bf16_f32 v144, v152, v153
    v_cvt_pk_bf16_f32 v145, v154, v155
    v_cvt_pk_bf16_f32 v146, v156, v157
    v_cvt_pk_bf16_f32 v147, v158, v159
    s_nop 1
    v_mfma_f32_16x16x32_bf16 v[64:67], a[128:131], v[144:147], v[64:67]
    v_mfma_f32_16x16x32_bf16 v[68:71], a[132:135], v[144:147], v[68:71]
    v_mfma_f32_16x16x32_bf16 v[72:75], a[136:139], v[144:147], v[72:75]
    v_mfma_f32_16x16x32_bf16 v[76:79], a[140:143], v[144:147], v[76:79]
    v_mfma_f32_16x16x32_bf16 v[80:83], a[144:147], v[144:147], v[80:83]
    v_mfma_f32_16x16x32_bf16 v[84:87], a[148:151], v[144:147], v[84:87]
    v_mfma_f32_16x16x32_bf16 v[88:91], a[152:155], v[144:147], v[88:91]
    v_mfma_f32_16x16x32_bf16 v[92:95], a[156:159], v[144:147], v[92:95]
    s_nop 3
    v_mfma_f32_16x16x32_bf16 v[128:131], a[64:67], a[48:51], 0
    v_mfma_f32_16x16x32_bf16 v[128:131], a[68:71], a[52:55], v[128:131]
    v_mfma_f32_16x16x32_bf16 v[128:131], a[72:75], a[56:59], v[128:131]
    v_mfma_f32_16x16x32_bf16 v[128:131], a[76:79], a[60:63], v[128:131]
    v_mfma_f32_16x16x32_bf16 v[132:135], a[80:83], a[48:51], 0
    v_mfma_f32_16x16x32_bf16 v[132:135], a[84:87], a[52:55], v[132:135]
    v_mfma_f32_16x16x32_bf16 v[132:135], a[88:91], a[56:59], v[132:135]
    v_mfma_f32_16x16x32_bf16 v[132:135], a[92:95], a[60:63], v[132:135]
    s_nop 7
    v_max3_f32 v173, v128, v129, v130
    v_max3_f32 v173, v131, v132, v173
    v_max3_f32 v173, v133, v134, v173
    v_max_f32 v173, v135, v173
    v_mov_b32 v174, v173
    s_nop 1
    v_permlane16_swap_b32 v174, v173
    v_max_f32 v173, v173, v174
    v_mov_b32 v174, v173
    s_nop 1
    v_permlane32_swap_b32 v174, v173
    v_max_f32 v173, v173, v174
    v_max_f32 v173, v171, v173
    v_sub_f32 v172, v171, v173
    v_exp_f32 v172, v172
    v_mov_b32 v171, v173
    v_sub_f32 v152, v128, v173
    v_sub_f32 v153, v129, v173
    v_sub_f32 v154, v130, v173
    v_sub_f32 v155, v131, v173
    v_sub_f32 v156, v132, v173
    v_sub_f32 v157, v133, v173
    v_sub_f32 v158, v134, v173
    v_sub_f32 v159, v135, v173
    v_exp_f32 v152, v152
    v_exp_f32 v153, v153
    v_exp_f32 v154, v154
    v_exp_f32 v155, v155
    v_exp_f32 v156, v156
    v_exp_f32 v157, v157
    v_exp_f32 v158, v158
    v_exp_f32 v159, v159
    v_mul_f32 v163, v163, v172
    v_mul_f32 v96, v96, v172
    v_mul_f32 v97, v97, v172
    v_mul_f32 v98, v98, v172
    v_mul_f32 v99, v99, v172
    v_mul_f32 v100, v100, v172
    v_mul_f32 v101, v101, v172
    v_mul_f32 v102, v102, v172
    v_mul_f32 v103, v103, v172
    v_mul_f32 v104, v104, v172
    v_mul_f32 v105, v105, v172
    v_mul_f32 v106, v106, v172
    v_mul_f32 v107, v107, v172
    v_mul_f32 v108, v108, v172
    v_mul_f32 v109, v109, v172
    v_mul_f32 v110, v110, v172
    v_mul_f32 v111, v111, v172
    v_mul_f32 v112, v112, v172
    v_mul_f32 v113, v113, v172
    v_mul_f32 v114, v114, v172
    v_mul_f32 v115, v115, v172
    v_mul_f32 v116, v116, v172
    v_mul_f32 v117, v117, v172
    v_mul_f32 v118, v118, v172
    v_mul_f32 v119, v119, v172
    v_mul_f32 v120, v120, v172
    v_mul_f32 v121, v121, v172
    v_mul_f32 v122, v122, v172
    v_mul_f32 v123, v123, v172
    v_mul_f32 v124, v124, v172
    v_mul_f32 v125, v125, v172
    v_mul_f32 v126, v126, v172
    v_mul_f32 v127, v127, v172
    v_add_f32 v163, v152, v163
    v_add_f32 v163, v153, v163
    v_add_f32 v163, v154, v163
    v_add_f32 v163, v155, v163
    v_add_f32 v163, v156, v163
    v_add_f32 v163, v157, v163
    v_add_f32 v163, v158, v163
    v_add_f32 v163, v159, v163
    v_cvt_pk_bf16_f32 v144, v152, v153
    v_cvt_pk_bf16_f32 v145, v154, v155
    v_cvt_pk_bf16_f32 v146, v156, v157
    v_cvt_pk_bf16_f32 v147, v158, v159
    s_nop 1
    v_mfma_f32_16x16x32_bf16 v[96:99], a[128:131], v[144:147], v[96:99]
    v_mfma_f32_16x16x32_bf16 v[100:103], a[132:135], v[144:147], v[100:103]
    v_mfma_f32_16x16x32_bf16 v[104:107], a[136:139], v[144:147], v[104:107]
    v_mfma_f32_16x16x32_bf16 v[108:111], a[140:143], v[144:147], v[108:111]
    v_mfma_f32_16x16x32_bf16 v[112:115], a[144:147], v[144:147], v[112:115]
    v_mfma_f32_16x16x32_bf16 v[116:119], a[148:151], v[144:147], v[116:119]
    v_mfma_f32_16x16x32_bf16 v[120:123], a[152:155], v[144:147], v[120:123]
    v_mfma_f32_16x16x32_bf16 v[124:127], a[156:159], v[144:147], v[124:127]
    s_nop 3
    s_add_u32 s39, s39, 8192
    s_cmp_lt_u32 s39, 524288
    s_cbranch_scc1 L_exact_loop
    s_nop 7
    v_mov_b32 v173, v160
    s_nop 1
    v_permlane16_swap_b32 v173, v160
    v_add_f32 v160, v160, v173
    v_mov_b32 v173, v160
    s_nop 1
    v_permlane32_swap_b32 v173, v160
    v_add_f32 v160, v160, v173
    v_mov_b32 v173, v161
    s_nop 1
    v_permlane16_swap_b32 v173, v161
    v_add_f32 v161, v161, v173
    v_mov_b32 v173, v161
    s_nop 1
    v_permlane32_swap_b32 v173, v161
    v_add_f32 v161, v161, v173
    v_mov_b32 v173, v162
    s_nop 1
    v_permlane16_swap_b32 v173, v162
    v_add_f32 v162, v162, v173
    v_mov_b32 v173, v162
    s_nop 1
    v_permlane32_swap_b32 v173, v162
    v_add_f32 v162, v162, v173
    v_mov_b32 v173, v163
    s_nop 1
    v_permlane16_swap_b32 v173, v163
    v_add_f32 v163, v163, v173
    v_mov_b32 v173, v163
    s_nop 1
    v_permlane32_swap_b32 v173, v163
    v_add_f32 v163, v163, v173
    s_branch L_exact_ret

L_done:
    s_endpgm

.section .rodata,"a"
.p2align 6
.amdhsa_kernel adaLN_cond__mha_block_cached__dense_activation_silu__prompt_kernel
  .amdhsa_next_free_vgpr 512
  .amdhsa_next_free_sgpr 102
  .amdhsa_accum_offset 256
  .amdhsa_group_segment_fixed_size 0
  .amdhsa_kernarg_size 104
  .amdhsa_user_sgpr_count 2
  .amdhsa_user_sgpr_kernarg_segment_ptr 1
  .amdhsa_system_sgpr_workgroup_id_x 1
  .amdhsa_float_denorm_mode_32 3
.end_amdhsa_kernel
```
